```python
import torch

def _softmax(x, axis=-1):
    return torch.softmax(x, dim=axis)

def _gelu(x):
    return torch.nn.functional.gelu(x, approximate='tanh')

def _silu(x):
    return torch.nn.functional.silu(x)

def _sigmoid(x):
    return torch.sigmoid(x)

def _layernorm(x, axis=-1, eps=1e-05):
    m = x.mean(dim=axis, keepdim=True)
    v = x.var(dim=axis, keepdim=True, unbiased=False)
    return (x - m) / torch.sqrt(v + eps)

def _scatter_add(tgt, idx, src, axis=0):
    return tgt.clone().index_add_(axis, idx, src)

def _segment_sum(src, seg, n):
    out = torch.zeros((n,) + src.shape[1:], dtype=src.dtype)
    return out.index_add_(0, seg, src)

def _pad(x, pw):
    flat = tuple((v for pair in reversed(pw) for v in pair))
    return torch.nn.functional.pad(x, flat)
kernel_name = 'sequential_preLN__memory_aug_recurrent_mem_tr__mixer_s_mlp__prompt'

def setup_inputs():

    _w = lambda a: (lambda t: t.to(torch.bfloat16) if t.is_floating_point() else t)(torch.as_tensor(a))

    def _A_setup():
        B, S, Dm = (1, 2048, 640)
        H, Dh = (32, 128)
        M, seg = (8, 32)
        seg = min(seg, S)
        S = S // seg * seg
        return {'x': _w((lambda *s: torch.randn(*s, dtype=torch.bfloat16) * 0.05)(B, S, Dm)), 'mem0': _w((lambda *s: torch.randn(*s, dtype=torch.bfloat16) * 0.2)(B, M, Dm)), 'Wq': _w((lambda *s: torch.randn(*s, dtype=torch.bfloat16) * 1.6)(Dm, H, Dh) * Dm ** (-0.5)), 'Wk': _w((lambda *s: torch.randn(*s, dtype=torch.bfloat16) * 1.6)(Dm, H, Dh) * Dm ** (-0.5)), 'Wv': _w((lambda *s: torch.randn(*s, dtype=torch.bfloat16) * 0.2)(Dm, H, Dh) * Dm ** (-0.5)), 'Wo': _w((lambda *s: torch.randn(*s, dtype=torch.bfloat16) * 0.2)(H, Dh, Dm) * (H * Dh) ** (-0.5)), 'seg_len': seg}
    _A_in = _A_setup()

    def _B_setup():
        B, S, D, F = (1, 2048, 640, 1728)
        return {'x': _w((lambda *s: torch.randn(*s, dtype=torch.bfloat16) * 0.05)(B, S, D)), 'w1': _w((lambda *s: torch.randn(*s, dtype=torch.bfloat16) * 0.8)(D, D) * D ** (-0.5)), 'w2': _w((lambda *s: torch.randn(*s, dtype=torch.bfloat16) * 0.8)(D, D) * D ** (-0.5)), 'w3': _w((lambda *s: torch.randn(*s, dtype=torch.bfloat16) * 0.8)(D, F) * D ** (-0.5)), 'w4': _w((lambda *s: torch.randn(*s, dtype=torch.bfloat16) * 0.8)(F, D) * F ** (-0.5))}
    _B_in = _B_setup()
    return {'A_x': _A_in['x'], 'A_mem0': _A_in['mem0'], 'A_Wq': _A_in['Wq'], 'A_Wk': _A_in['Wk'], 'A_Wv': _A_in['Wv'], 'A_Wo': _A_in['Wo'], 'A_seg_len': _A_in['seg_len'], 'B_x': _B_in['x'], 'B_w1': _B_in['w1'], 'B_w2': _B_in['w2'], 'B_w3': _B_in['w3'], 'B_w4': _B_in['w4']}

def reference(A_x, A_mem0, A_Wq, A_Wk, A_Wv, A_Wo, A_seg_len, B_x, B_w1, B_w2, B_w3, B_w4):

    def _A_ref(x, mem0, Wq, Wk, Wv, Wo, seg_len):
        B, S, Dm = x.shape
        H, Dh = (Wq.shape[1], Wq.shape[2])
        M = mem0.shape[1]
        scale = Dh ** (-0.5)
        n_seg = S // seg_len
        L = M + seg_len
        idx = torch.arange(L)
        mask = (idx[:, None] < M) | (idx[:, None] >= idx[None, :])
        mem = mem0
        outs = []
        for s in range(n_seg):
            xs = x[:, s * seg_len:(s + 1) * seg_len, :].clone()
            h = torch.concatenate([mem, xs], axis=1)
            q = torch.einsum('btd,dhe->bhte', h, Wq)
            k = torch.einsum('btd,dhe->bhte', h, Wk)
            v = torch.einsum('btd,dhe->bhte', h, Wv)
            scores = torch.einsum('bhqe,bhke->bhqk', q, k) * scale
            scores = torch.where(mask[None, None], scores, -1000000000.0)
            p = _softmax(scores, axis=-1)
            o = torch.einsum('bhqk,bhke->bhqe', p, v)
            o = torch.einsum('bhte,hed->btd', o, Wo)
            mem = o[:, :M, :].clone()
            outs.append(o[:, M:, :])
        return torch.concatenate(outs, axis=1)

    def _B_ref(x, w1, w2, w3, w4):
        B, S, D = x.shape
        h = _gelu(_layernorm(x, axis=-1) @ w1)
        c = D // 4
        g0 = _pad(h[:, :, 0 * c:1 * c], ((0, 0), (1, 0), (0, 0)))[:, :S, :]
        g1 = _pad(h[:, :, 1 * c:2 * c], ((0, 0), (0, 1), (0, 0)))[:, 1:, :]
        g2 = _pad(h[:, :, 2 * c:3 * c], ((0, 0), (2, 0), (0, 0)))[:, :S, :]
        g3 = _pad(h[:, :, 3 * c:], ((0, 0), (0, 2), (0, 0)))[:, 2:, :]
        hs = torch.concatenate([g0, g1, g2, g3], axis=-1) @ w2
        x1 = x + hs
        h2 = _gelu(_layernorm(x1, axis=-1) @ w3) @ w4
        return x1 + h2
    x = A_x
    h = x + _A_ref(_layernorm(x, axis=-1), A_mem0, A_Wq, A_Wk, A_Wv, A_Wo, A_seg_len)
    h2 = h + _B_ref(_layernorm(h, axis=-1), B_w1, B_w2, B_w3, B_w4)
    return h2
```

```asm
; @launch grid=(256,1,1) block=(256,1,1) lds=163840
.amdgcn_target "amdgcn-amd-amdhsa--gfx950"
.text
.globl sequential_preLN__memory_aug_recurrent_mem_tr__mixer_s_mlp__prompt_kernel
.p2align 8
.type sequential_preLN__memory_aug_recurrent_mem_tr__mixer_s_mlp__prompt_kernel,@function
sequential_preLN__memory_aug_recurrent_mem_tr__mixer_s_mlp__prompt_kernel:
    s_cmp_ge_u32 s2, 256
    s_cbranch_scc1 L_done
    s_load_dwordx4 s[20:23], s[0:1], 104
    s_and_b32 s3, s2, 7
    s_lshr_b32 s4, s2, 3
    v_lshrrev_b32 v1, 6, v0
    s_mov_b32 s6, 0
    v_readfirstlane_b32 s5, v1
    s_waitcnt lgkmcnt(0)
    s_mov_b32 s12, s20
    s_and_b32 s13, s21, 0xffff
    s_mov_b32 s14, 0x100
    s_mov_b32 s15, 0x20000
    s_mov_b32 s8, s22
    s_and_b32 s9, s23, 0xffff
    s_mov_b32 s10, 0x10000000
    s_mov_b32 s11, 0x20000
    s_cmp_lt_u32 s3, 2
    s_cbranch_scc1 L_R
    v_and_b32 v0, 63, v0
    v_lshlrev_b32 v1, 4, v0
    s_sub_u32 s26, s3, 2
    s_lshl_b32 s26, s26, 5
    s_add_u32 s26, s26, s4
    s_mov_b32 s42, -1
    s_mov_b32 s43, 0
    s_sub_u32 s20, s3, 2
    s_lshr_b32 s64, s20, 1
    s_and_b32 s20, s20, 1
    s_lshl_b32 s20, s20, 4
    s_lshr_b32 s21, s4, 1
    s_add_u32 s65, s20, s21
    s_and_b32 s66, s4, 1
    s_lshl_b32 s36, s65, 7
    s_lshl_b32 s20, s64, 3
    s_add_u32 s36, s36, s20
    s_lshl_b32 s20, s66, 2
    s_add_u32 s36, s36, s20
    s_add_u32 s36, s36, 0x0
    s_lshl_b32 s37, s26, 2
    s_add_u32 s37, s37, 0x2000
    s_cmp_lg_u32 s5, 0
    s_cbranch_scc1 ic_1
    v_mov_b32_e64 v4, 0
    v_mov_b32 v5, 0
    s_mov_b64 exec, 1
    buffer_store_dword v4, v5, s[8:11], s36 offen sc1
    s_mov_b64 exec, -1
    v_mov_b32 v4, 0
    v_mov_b32 v5, 0
    s_mov_b64 exec, 1
    buffer_store_dword v4, v5, s[8:11], s37 offen sc1
    s_mov_b64 exec, -1
    s_cmp_lg_u32 s26, 0
    s_cbranch_scc1 ic_1
    v_mov_b32 v4, 0
    v_mov_b32 v5, 0
    v_mov_b32 v6, 0
    v_mov_b32_e64 v7, 0
    s_mov_b32 s20, 0x2400
    buffer_store_dwordx4 v[4:7], v1, s[8:11], s20 offen sc1
    s_mov_b32 s20, 0x2800
    buffer_store_dwordx4 v[4:7], v1, s[8:11], s20 offen sc1
    s_mov_b32 s20, 0x2c00
    buffer_store_dwordx4 v[4:7], v1, s[8:11], s20 offen sc1
    s_mov_b32 s20, 0x4390000
    buffer_store_dwordx4 v[4:7], v1, s[8:11], s20 offen sc1
    s_mov_b32 s20, 0x4390400
    buffer_store_dwordx4 v[4:7], v1, s[8:11], s20 offen sc1
    s_mov_b32 s20, 0x4390600
    buffer_store_dwordx4 v[4:7], v1, s[8:11], s20 offen sc1
    s_mov_b32 s20, 0x4610a00
    buffer_store_dwordx4 v[4:7], v1, s[8:11], s20 offen sc1
    s_mov_b32 s20, 0x4610e00
    buffer_store_dwordx4 v[4:7], v1, s[8:11], s20 offen sc1
    s_mov_b32 s20, 0x4611000
    buffer_store_dwordx4 v[4:7], v1, s[8:11], s20 offen sc1
ic_1:
    v_and_b32_e64 v80, 15, v0
    v_mov_b32 v81, 0x3f80
    v_cmp_eq_u32 vcc, 0, v80
    s_nop 1
    v_cndmask_b32_e64 v36, 0, v81, vcc
    v_cmp_eq_u32 vcc, 1, v80
    s_nop 1
    v_cndmask_b32 v36, v36, 1.0, vcc
    v_cmp_eq_u32 vcc, 2, v80
    s_nop 1
    v_cndmask_b32_e64 v37, 0, v81, vcc
    v_cmp_eq_u32 vcc, 3, v80
    s_nop 1
    v_cndmask_b32 v37, v37, 1.0, vcc
    v_cmp_eq_u32 vcc, 4, v80
    s_nop 1
    v_cndmask_b32_e64 v38, 0, v81, vcc
    v_cmp_eq_u32 vcc, 5, v80
    s_nop 1
    v_cndmask_b32 v38, v38, 1.0, vcc
    v_cmp_eq_u32 vcc, 6, v80
    s_nop 1
    v_cndmask_b32_e64 v39, 0, v81, vcc
    v_cmp_eq_u32 vcc, 7, v80
    s_nop 1
    v_cndmask_b32 v39, v39, 1.0, vcc
    v_cmp_eq_u32 vcc, 8, v80
    s_nop 1
    v_cndmask_b32_e64 v40, 0, v81, vcc
    v_cmp_eq_u32 vcc, 9, v80
    s_nop 1
    v_cndmask_b32 v40, v40, 1.0, vcc
    v_cmp_eq_u32 vcc, 10, v80
    s_nop 1
    v_cndmask_b32_e64 v41, 0, v81, vcc
    v_cmp_eq_u32 vcc, 11, v80
    s_nop 1
    v_cndmask_b32 v41, v41, 1.0, vcc
    v_cmp_eq_u32 vcc, 12, v80
    s_nop 1
    v_cndmask_b32_e64 v42, 0, v81, vcc
    v_cmp_eq_u32 vcc, 13, v80
    s_nop 1
    v_cndmask_b32 v42, v42, 1.0, vcc
    v_cmp_eq_u32 vcc, 14, v80
    s_nop 1
    v_cndmask_b32_e64 v43, 0, v81, vcc
    v_cmp_eq_u32 vcc, 15, v80
    s_nop 1
    v_cndmask_b32 v43, v43, 1.0, vcc
    v_lshrrev_b32_e64 v80, 4, v0
    v_and_b32 v81, 0xf0, v1
    v_mul_u32_u24 v33, 1280, v80
    v_add_u32 v33, v33, v81
    v_lshrrev_b32 v32, 5, v0
    v_lshl_add_u32 v81, v32, 8, v81
    v_and_b32_e64 v80, 1, v80
    v_lshl_add_u32 v32, v80, 3, v81
    s_mov_b32 s44, 0x3727c5ac
    s_cmp_ge_u32 s26, 128
    s_cbranch_scc1 ln0f_3
    s_load_dwordx2 s[76:77], s[0:1], 0
    s_waitcnt lgkmcnt(0)
    s_mov_b32 s32, s76
    s_and_b32 s33, s77, 0xffff
    s_mov_b32 s34, 0x280000
    s_mov_b32 s35, 0x20000
    s_lshl_b32 s40, s26, 2
    s_add_u32 s40, s40, s5
    s_mul_i32 s40, s40, 5120
    s_add_u32 s21, s40, 0
    v_mov_b32 v60, 0
    v_mov_b32 v61, 0
    buffer_load_dwordx2 v[56:57], v32, s[32:35], s21 offen offset:0
    buffer_load_dwordx2 v[58:59], v32, s[32:35], s21 offen offset:512
    s_mov_b64 exec, s[42:43]
    buffer_load_dwordx2 v[60:61], v32, s[32:35], s21 offen offset:1024
    s_mov_b64 exec, -1
    s_add_u32 s21, s40, 1280
    v_mov_b32 v66, 0
    v_mov_b32 v67, 0
    buffer_load_dwordx2 v[62:63], v32, s[32:35], s21 offen offset:0
    buffer_load_dwordx2 v[64:65], v32, s[32:35], s21 offen offset:512
    s_mov_b64 exec, s[42:43]
    buffer_load_dwordx2 v[66:67], v32, s[32:35], s21 offen offset:1024
    s_mov_b64 exec, -1
    s_add_u32 s21, s40, 2560
    v_mov_b32 v72, 0
    v_mov_b32 v73, 0
    buffer_load_dwordx2 v[68:69], v32, s[32:35], s21 offen offset:0
    buffer_load_dwordx2 v[70:71], v32, s[32:35], s21 offen offset:512
    s_mov_b64 exec, s[42:43]
    buffer_load_dwordx2 v[72:73], v32, s[32:35], s21 offen offset:1024
    s_mov_b64 exec, -1
    s_add_u32 s21, s40, 3840
    v_mov_b32 v78, 0
    v_mov_b32 v79, 0
    buffer_load_dwordx2 v[74:75], v32, s[32:35], s21 offen offset:0
    buffer_load_dwordx2 v[76:77], v32, s[32:35], s21 offen offset:512
    s_mov_b64 exec, s[42:43]
    buffer_load_dwordx2 v[78:79], v32, s[32:35], s21 offen offset:1024
    s_mov_b64 exec, -1
ln0f_3:
    s_lshl_b32 s20, s64, 3
    s_add_u32 s20, s20, 16
    s_load_dwordx2 s[76:77], s[0:1], s20
    s_waitcnt lgkmcnt(0)
    s_mov_b32 s16, s76
    s_and_b32 s17, s77, 0xffff
    s_mov_b32 s18, 0x500000
    s_mov_b32 s19, 0x20000
    s_lshl_b32 s23, s65, 8
    v_lshrrev_b32 v26, 4, v0
    v_and_b32 v27, 15, v0
    v_lshlrev_b32 v24, 2, v26
    v_xor_b32 v24, v24, v27
    v_lshlrev_b32 v24, 4, v24
    v_mul_u32_u24 v27, 8192, v26
    v_add_u32 v24, v24, v27
    s_mul_i32 s20, s5, 131072
    s_add_u32 s20, s20, s23
    s_lshl_b32 s21, s5, 12
    s_barrier
    s_add_u32 m0, s21, 0
    s_add_u32 s22, s20, 0
    buffer_load_dwordx4 v24, s[16:19], s22 offen lds
    s_add_u32 m0, s21, 1024
    s_add_u32 s22, s20, 32768
    buffer_load_dwordx4 v24, s[16:19], s22 offen lds
    s_add_u32 m0, s21, 2048
    s_add_u32 s22, s20, 65536
    buffer_load_dwordx4 v24, s[16:19], s22 offen lds
    s_add_u32 m0, s21, 3072
    s_add_u32 s22, s20, 98304
    buffer_load_dwordx4 v24, s[16:19], s22 offen lds
    s_add_u32 m0, s21, 16384
    s_add_u32 s22, s20, 524288
    buffer_load_dwordx4 v24, s[16:19], s22 offen lds
    s_add_u32 m0, s21, 17408
    s_add_u32 s22, s20, 557056
    buffer_load_dwordx4 v24, s[16:19], s22 offen lds
    s_add_u32 m0, s21, 18432
    s_add_u32 s22, s20, 589824
    buffer_load_dwordx4 v24, s[16:19], s22 offen lds
    s_add_u32 m0, s21, 19456
    s_add_u32 s22, s20, 622592
    buffer_load_dwordx4 v24, s[16:19], s22 offen lds
    s_add_u32 m0, s21, 32768
    s_add_u32 s22, s20, 1048576
    buffer_load_dwordx4 v24, s[16:19], s22 offen lds
    s_add_u32 m0, s21, 33792
    s_add_u32 s22, s20, 1081344
    buffer_load_dwordx4 v24, s[16:19], s22 offen lds
    s_add_u32 m0, s21, 34816
    s_add_u32 s22, s20, 1114112
    buffer_load_dwordx4 v24, s[16:19], s22 offen lds
    s_add_u32 m0, s21, 35840
    s_add_u32 s22, s20, 1146880
    buffer_load_dwordx4 v24, s[16:19], s22 offen lds
    s_add_u32 m0, s21, 49152
    s_add_u32 s22, s20, 1572864
    buffer_load_dwordx4 v24, s[16:19], s22 offen lds
    s_add_u32 m0, s21, 50176
    s_add_u32 s22, s20, 1605632
    buffer_load_dwordx4 v24, s[16:19], s22 offen lds
    s_add_u32 m0, s21, 51200
    s_add_u32 s22, s20, 1638400
    buffer_load_dwordx4 v24, s[16:19], s22 offen lds
    s_add_u32 m0, s21, 52224
    s_add_u32 s22, s20, 1671168
    buffer_load_dwordx4 v24, s[16:19], s22 offen lds
    s_add_u32 m0, s21, 65536
    s_add_u32 s22, s20, 2097152
    buffer_load_dwordx4 v24, s[16:19], s22 offen lds
    s_add_u32 m0, s21, 66560
    s_add_u32 s22, s20, 2129920
    buffer_load_dwordx4 v24, s[16:19], s22 offen lds
    s_add_u32 m0, s21, 67584
    s_add_u32 s22, s20, 2162688
    buffer_load_dwordx4 v24, s[16:19], s22 offen lds
    s_add_u32 m0, s21, 68608
    s_add_u32 s22, s20, 2195456
    buffer_load_dwordx4 v24, s[16:19], s22 offen lds
    s_add_u32 m0, s21, 81920
    s_add_u32 s22, s20, 2621440
    buffer_load_dwordx4 v24, s[16:19], s22 offen lds
    s_add_u32 m0, s21, 82944
    s_add_u32 s22, s20, 2654208
    buffer_load_dwordx4 v24, s[16:19], s22 offen lds
    s_add_u32 m0, s21, 83968
    s_add_u32 s22, s20, 2686976
    buffer_load_dwordx4 v24, s[16:19], s22 offen lds
    s_add_u32 m0, s21, 84992
    s_add_u32 s22, s20, 2719744
    buffer_load_dwordx4 v24, s[16:19], s22 offen lds
    s_add_u32 m0, s21, 98304
    s_add_u32 s22, s20, 3145728
    buffer_load_dwordx4 v24, s[16:19], s22 offen lds
    s_add_u32 m0, s21, 99328
    s_add_u32 s22, s20, 3178496
    buffer_load_dwordx4 v24, s[16:19], s22 offen lds
    s_add_u32 m0, s21, 100352
    s_add_u32 s22, s20, 3211264
    buffer_load_dwordx4 v24, s[16:19], s22 offen lds
    s_add_u32 m0, s21, 101376
    s_add_u32 s22, s20, 3244032
    buffer_load_dwordx4 v24, s[16:19], s22 offen lds
    s_add_u32 m0, s21, 114688
    s_add_u32 s22, s20, 3670016
    buffer_load_dwordx4 v24, s[16:19], s22 offen lds
    s_add_u32 m0, s21, 115712
    s_add_u32 s22, s20, 3702784
    buffer_load_dwordx4 v24, s[16:19], s22 offen lds
    s_add_u32 m0, s21, 116736
    s_add_u32 s22, s20, 3735552
    buffer_load_dwordx4 v24, s[16:19], s22 offen lds
    s_add_u32 m0, s21, 117760
    s_add_u32 s22, s20, 3768320
    buffer_load_dwordx4 v24, s[16:19], s22 offen lds
    s_add_u32 m0, s21, 131072
    s_add_u32 s22, s20, 4194304
    buffer_load_dwordx4 v24, s[16:19], s22 offen lds
    s_add_u32 m0, s21, 132096
    s_add_u32 s22, s20, 4227072
    buffer_load_dwordx4 v24, s[16:19], s22 offen lds
    s_add_u32 m0, s21, 133120
    s_add_u32 s22, s20, 4259840
    buffer_load_dwordx4 v24, s[16:19], s22 offen lds
    s_add_u32 m0, s21, 134144
    s_add_u32 s22, s20, 4292608
    buffer_load_dwordx4 v24, s[16:19], s22 offen lds
    s_add_u32 m0, s21, 147456
    s_add_u32 s22, s20, 4718592
    buffer_load_dwordx4 v24, s[16:19], s22 offen lds
    s_add_u32 m0, s21, 148480
    s_add_u32 s22, s20, 4751360
    buffer_load_dwordx4 v24, s[16:19], s22 offen lds
    s_add_u32 m0, s21, 149504
    s_add_u32 s22, s20, 4784128
    buffer_load_dwordx4 v24, s[16:19], s22 offen lds
    s_add_u32 m0, s21, 150528
    s_add_u32 s22, s20, 4816896
    buffer_load_dwordx4 v24, s[16:19], s22 offen lds
    s_waitcnt vmcnt(40)
    s_barrier
    s_cmp_lg_u32 s5, 3
    s_cbranch_scc1 arr_4
    s_mov_b64 exec, 1
    v_mov_b32 v89, 0
    s_cmp_lg_u32 s2, 7
    s_cbranch_scc1 cal_5
    s_waitcnt vmcnt(0)
    s_mov_b32 s80, -1
    s_mov_b32 s81, -1
    s_mov_b32 s86, 0x11c00
    s_mov_b32 s87, 0x13c00
    s_memtime s[82:83]
    s_waitcnt lgkmcnt(0)
    buffer_store_dword v89, v89, s[8:11], s86 offen sc1
    s_waitcnt vmcnt(0)
    s_memtime s[84:85]
    s_waitcnt lgkmcnt(0)
    s_sub_u32 s84, s84, s82
    s_min_u32 s80, s80, s84
    s_memtime s[82:83]
    s_waitcnt lgkmcnt(0)
    buffer_store_dword v89, v89, s[8:11], s87 offen sc1
    s_waitcnt vmcnt(0)
    s_memtime s[84:85]
    s_waitcnt lgkmcnt(0)
    s_sub_u32 s84, s84, s82
    s_min_u32 s81, s81, s84
    s_memtime s[82:83]
    s_waitcnt lgkmcnt(0)
    buffer_store_dword v89, v89, s[8:11], s86 offen sc1
    s_waitcnt vmcnt(0)
    s_memtime s[84:85]
    s_waitcnt lgkmcnt(0)
    s_sub_u32 s84, s84, s82
    s_min_u32 s80, s80, s84
    s_memtime s[82:83]
    s_waitcnt lgkmcnt(0)
    buffer_store_dword v89, v89, s[8:11], s87 offen sc1
    s_waitcnt vmcnt(0)
    s_memtime s[84:85]
    s_waitcnt lgkmcnt(0)
    s_sub_u32 s84, s84, s82
    s_min_u32 s81, s81, s84
    s_memtime s[82:83]
    s_waitcnt lgkmcnt(0)
    buffer_store_dword v89, v89, s[8:11], s86 offen sc1
    s_waitcnt vmcnt(0)
    s_memtime s[84:85]
    s_waitcnt lgkmcnt(0)
    s_sub_u32 s84, s84, s82
    s_min_u32 s80, s80, s84
    s_memtime s[82:83]
    s_waitcnt lgkmcnt(0)
    buffer_store_dword v89, v89, s[8:11], s87 offen sc1
    s_waitcnt vmcnt(0)
    s_memtime s[84:85]
    s_waitcnt lgkmcnt(0)
    s_sub_u32 s84, s84, s82
    s_min_u32 s81, s81, s84
    s_memtime s[82:83]
    s_waitcnt lgkmcnt(0)
    buffer_store_dword v89, v89, s[8:11], s86 offen sc1
    s_waitcnt vmcnt(0)
    s_memtime s[84:85]
    s_waitcnt lgkmcnt(0)
    s_sub_u32 s84, s84, s82
    s_min_u32 s80, s80, s84
    s_memtime s[82:83]
    s_waitcnt lgkmcnt(0)
    buffer_store_dword v89, v89, s[8:11], s87 offen sc1
    s_waitcnt vmcnt(0)
    s_memtime s[84:85]
    s_waitcnt lgkmcnt(0)
    s_sub_u32 s84, s84, s82
    s_min_u32 s81, s81, s84
    s_memtime s[82:83]
    s_waitcnt lgkmcnt(0)
    buffer_store_dword v89, v89, s[8:11], s86 offen sc1
    s_waitcnt vmcnt(0)
    s_memtime s[84:85]
    s_waitcnt lgkmcnt(0)
    s_sub_u32 s84, s84, s82
    s_min_u32 s80, s80, s84
    s_memtime s[82:83]
    s_waitcnt lgkmcnt(0)
    buffer_store_dword v89, v89, s[8:11], s87 offen sc1
    s_waitcnt vmcnt(0)
    s_memtime s[84:85]
    s_waitcnt lgkmcnt(0)
    s_sub_u32 s84, s84, s82
    s_min_u32 s81, s81, s84
    s_memtime s[82:83]
    s_waitcnt lgkmcnt(0)
    buffer_store_dword v89, v89, s[8:11], s86 offen sc1
    s_waitcnt vmcnt(0)
    s_memtime s[84:85]
    s_waitcnt lgkmcnt(0)
    s_sub_u32 s84, s84, s82
    s_min_u32 s80, s80, s84
    s_memtime s[82:83]
    s_waitcnt lgkmcnt(0)
    buffer_store_dword v89, v89, s[8:11], s87 offen sc1
    s_waitcnt vmcnt(0)
    s_memtime s[84:85]
    s_waitcnt lgkmcnt(0)
    s_sub_u32 s84, s84, s82
    s_min_u32 s81, s81, s84
    s_cmp_lt_u32 s81, s80
    s_cselect_b32 s84, 0x2000, 0
    s_getreg_b32 s85, hwreg(HW_REG_XCC_ID)
    s_lshl_b32 s85, s85, 11
    s_xor_b32 s84, s84, s85
    v_mov_b32 v88, s84
    buffer_store_dword v88, v89, s[12:15], 0 offen offset:40 sc1
    v_mov_b32_e64 v88, s80
    buffer_store_dword v88, v89, s[12:15], 0 offen offset:48 sc1
    v_mov_b32_e64 v88, s81
    buffer_store_dword v88, v89, s[12:15], 0 offen offset:52 sc1
    s_waitcnt vmcnt(0)
cal_5:
    s_getreg_b32 s7, hwreg(HW_REG_XCC_ID)
    s_and_b32 s7, s7, 15
    v_mov_b32 v88, s7
    v_mul_u32_u24 v88, s7, v88
    v_lshlrev_b32 v88, 15, v88
    s_lshl_b32 s7, s7, 6
    v_add3_u32 v88, v88, s7, 1
    s_lshl_b32 s7, s3, 2
    buffer_atomic_add v88, v89, s[12:15], s7 offen offset:4
    s_mov_b64 exec, -1
arr_4:
    s_cmp_ge_u32 s26, 128
    s_cbranch_scc1 ln0skip_6
    v_and_b32 v45, 0xffff0000, v56
    v_lshlrev_b32_e64 v44, 16, v56
    v_and_b32 v47, 0xffff0000, v57
    v_lshlrev_b32_e64 v46, 16, v57
    v_and_b32 v49, 0xffff0000, v58
    v_lshlrev_b32_e64 v48, 16, v58
    v_and_b32 v51, 0xffff0000, v59
    v_lshlrev_b32_e64 v50, 16, v59
    v_and_b32 v53, 0xffff0000, v60
    v_lshlrev_b32_e64 v52, 16, v60
    v_and_b32 v55, 0xffff0000, v61
    v_lshlrev_b32_e64 v54, 16, v61
    v_pk_add_f32 v[80:81], v[44:45], v[46:47]
    v_pk_add_f32 v[82:83], v[48:49], v[50:51]
    v_pk_add_f32 v[84:85], v[52:53], v[54:55]
    v_pk_add_f32 v[80:81], v[80:81], v[82:83]
    v_pk_add_f32 v[80:81], v[80:81], v[84:85]
    v_add_f32 v80, v80, v81
    s_nop 1
    v_add_f32_dpp v80, v80, v80 row_ror:8 row_mask:0xf bank_mask:0xf
    s_nop 1
    v_add_f32_dpp v80, v80, v80 row_ror:4 row_mask:0xf bank_mask:0xf
    s_nop 1
    v_add_f32_dpp v80, v80, v80 row_ror:2 row_mask:0xf bank_mask:0xf
    s_nop 1
    v_add_f32_dpp v80, v80, v80 row_ror:1 row_mask:0xf bank_mask:0xf
    v_mov_b32 v81, v80
    s_nop 1
    v_permlane16_swap_b32 v80, v81
    v_add_f32 v80, v80, v81
    v_mov_b32 v81, v80
    s_nop 1
    v_permlane32_swap_b32 v80, v81
    v_add_f32_e64 v80, v80, v81
    v_mul_f32 v80, 0x3acccccd, v80
    v_cvt_pk_bf16_f32 v84, v80, v80
    v_and_b32 v84, 0xffff0000, v84
    v_sub_f32_e64 v80, v84, v80
    v_pk_add_f32 v[44:45], v[44:45], v[84:85] op_sel_hi:[1,0] neg_lo:[0,1] neg_hi:[0,1]
    v_pk_add_f32 v[46:47], v[46:47], v[84:85] op_sel_hi:[1,0] neg_lo:[0,1] neg_hi:[0,1]
    v_pk_add_f32 v[48:49], v[48:49], v[84:85] op_sel_hi:[1,0] neg_lo:[0,1] neg_hi:[0,1]
    v_pk_add_f32 v[50:51], v[50:51], v[84:85] op_sel_hi:[1,0] neg_lo:[0,1] neg_hi:[0,1]
    s_mov_b64 exec, s[42:43]
    v_pk_add_f32 v[52:53], v[52:53], v[84:85] op_sel_hi:[1,0] neg_lo:[0,1] neg_hi:[0,1]
    v_pk_add_f32 v[54:55], v[54:55], v[84:85] op_sel_hi:[1,0] neg_lo:[0,1] neg_hi:[0,1]
    s_mov_b64 exec, -1
    v_pk_mul_f32 v[82:83], v[44:45], v[44:45]
    v_pk_fma_f32 v[82:83], v[46:47], v[46:47], v[82:83]
    v_pk_fma_f32 v[82:83], v[48:49], v[48:49], v[82:83]
    v_pk_fma_f32 v[82:83], v[50:51], v[50:51], v[82:83]
    v_pk_fma_f32 v[82:83], v[52:53], v[52:53], v[82:83]
    v_pk_fma_f32 v[82:83], v[54:55], v[54:55], v[82:83]
    v_add_f32 v82, v82, v83
    s_nop 1
    v_add_f32_dpp v82, v82, v82 row_ror:8 row_mask:0xf bank_mask:0xf
    s_nop 1
    v_add_f32_dpp v82, v82, v82 row_ror:4 row_mask:0xf bank_mask:0xf
    s_nop 1
    v_add_f32_dpp v82, v82, v82 row_ror:2 row_mask:0xf bank_mask:0xf
    s_nop 1
    v_add_f32_dpp v82, v82, v82 row_ror:1 row_mask:0xf bank_mask:0xf
    v_mov_b32 v83, v82
    s_nop 1
    v_permlane16_swap_b32 v82, v83
    v_add_f32 v82, v82, v83
    v_mov_b32 v83, v82
    s_nop 1
    v_permlane32_swap_b32 v82, v83
    v_add_f32_e64 v82, v82, v83
    v_mul_f32 v82, 0x3acccccd, v82
    v_fma_f32 v82, -v80, v80, v82
    v_max_f32_e64 v83, 0, v82
    v_cvt_pk_bf16_f32 v82, v83, v83
    v_and_b32 v82, 0xffff0000, v82
    v_add_f32_e64 v82, s44, v82
    v_cvt_pk_bf16_f32 v82, v82, v82
    v_and_b32 v82, 0xffff0000, v82
    v_sqrt_f32 v82, v82
    s_nop 0
    v_cvt_pk_bf16_f32 v82, v82, v82
    v_and_b32 v82, 0xffff0000, v82
    v_rcp_f32 v82, v82
    s_nop 0
    v_pk_mul_f32 v[44:45], v[44:45], v[82:83] op_sel_hi:[1,0]
    v_pk_mul_f32 v[46:47], v[46:47], v[82:83] op_sel_hi:[1,0]
    v_pk_mul_f32 v[48:49], v[48:49], v[82:83] op_sel_hi:[1,0]
    v_pk_mul_f32 v[50:51], v[50:51], v[82:83] op_sel_hi:[1,0]
    v_pk_mul_f32 v[52:53], v[52:53], v[82:83] op_sel_hi:[1,0]
    v_pk_mul_f32 v[54:55], v[54:55], v[82:83] op_sel_hi:[1,0]
    v_cvt_pk_bf16_f32 v56, v44, v45
    v_cvt_pk_bf16_f32 v57, v46, v47
    v_cvt_pk_bf16_f32 v58, v48, v49
    v_cvt_pk_bf16_f32 v59, v50, v51
    v_cvt_pk_bf16_f32 v60, v52, v53
    v_cvt_pk_bf16_f32 v61, v54, v55
    s_add_u32 s21, s40, 0x4100a00
    buffer_store_dwordx2 v[56:57], v32, s[8:11], s21 offen offset:0 sc1
    buffer_store_dwordx2 v[58:59], v32, s[8:11], s21 offen offset:512 sc1
    s_mov_b64 exec, s[42:43]
    buffer_store_dwordx2 v[60:61], v32, s[8:11], s21 offen offset:1024 sc1
    s_mov_b64 exec, -1
    v_and_b32 v45, 0xffff0000, v62
    v_lshlrev_b32_e64 v44, 16, v62
    v_and_b32 v47, 0xffff0000, v63
    v_lshlrev_b32_e64 v46, 16, v63
    v_and_b32 v49, 0xffff0000, v64
    v_lshlrev_b32_e64 v48, 16, v64
    v_and_b32 v51, 0xffff0000, v65
    v_lshlrev_b32_e64 v50, 16, v65
    v_and_b32 v53, 0xffff0000, v66
    v_lshlrev_b32_e64 v52, 16, v66
    v_and_b32 v55, 0xffff0000, v67
    v_lshlrev_b32_e64 v54, 16, v67
    v_pk_add_f32 v[80:81], v[44:45], v[46:47]
    v_pk_add_f32 v[82:83], v[48:49], v[50:51]
    v_pk_add_f32 v[84:85], v[52:53], v[54:55]
    v_pk_add_f32 v[80:81], v[80:81], v[82:83]
    v_pk_add_f32 v[80:81], v[80:81], v[84:85]
    v_add_f32 v80, v80, v81
    s_nop 1
    v_add_f32_dpp v80, v80, v80 row_ror:8 row_mask:0xf bank_mask:0xf
    s_nop 1
    v_add_f32_dpp v80, v80, v80 row_ror:4 row_mask:0xf bank_mask:0xf
    s_nop 1
    v_add_f32_dpp v80, v80, v80 row_ror:2 row_mask:0xf bank_mask:0xf
    s_nop 1
    v_add_f32_dpp v80, v80, v80 row_ror:1 row_mask:0xf bank_mask:0xf
    v_mov_b32 v81, v80
    s_nop 1
    v_permlane16_swap_b32 v80, v81
    v_add_f32 v80, v80, v81
    v_mov_b32 v81, v80
    s_nop 1
    v_permlane32_swap_b32 v80, v81
    v_add_f32_e64 v80, v80, v81
    v_mul_f32 v80, 0x3acccccd, v80
    v_cvt_pk_bf16_f32 v84, v80, v80
    v_and_b32 v84, 0xffff0000, v84
    v_sub_f32_e64 v80, v84, v80
    v_pk_add_f32 v[44:45], v[44:45], v[84:85] op_sel_hi:[1,0] neg_lo:[0,1] neg_hi:[0,1]
    v_pk_add_f32 v[46:47], v[46:47], v[84:85] op_sel_hi:[1,0] neg_lo:[0,1] neg_hi:[0,1]
    v_pk_add_f32 v[48:49], v[48:49], v[84:85] op_sel_hi:[1,0] neg_lo:[0,1] neg_hi:[0,1]
    v_pk_add_f32 v[50:51], v[50:51], v[84:85] op_sel_hi:[1,0] neg_lo:[0,1] neg_hi:[0,1]
    s_mov_b64 exec, s[42:43]
    v_pk_add_f32 v[52:53], v[52:53], v[84:85] op_sel_hi:[1,0] neg_lo:[0,1] neg_hi:[0,1]
    v_pk_add_f32 v[54:55], v[54:55], v[84:85] op_sel_hi:[1,0] neg_lo:[0,1] neg_hi:[0,1]
    s_mov_b64 exec, -1
    v_pk_mul_f32 v[82:83], v[44:45], v[44:45]
    v_pk_fma_f32 v[82:83], v[46:47], v[46:47], v[82:83]
    v_pk_fma_f32 v[82:83], v[48:49], v[48:49], v[82:83]
    v_pk_fma_f32 v[82:83], v[50:51], v[50:51], v[82:83]
    v_pk_fma_f32 v[82:83], v[52:53], v[52:53], v[82:83]
    v_pk_fma_f32 v[82:83], v[54:55], v[54:55], v[82:83]
    v_add_f32_e64 v82, v82, v83
    s_nop 1
    v_add_f32_dpp v82, v82, v82 row_ror:8 row_mask:0xf bank_mask:0xf
    s_nop 1
    v_add_f32_dpp v82, v82, v82 row_ror:4 row_mask:0xf bank_mask:0xf
    s_nop 1
    v_add_f32_dpp v82, v82, v82 row_ror:2 row_mask:0xf bank_mask:0xf
    s_nop 1
    v_add_f32_dpp v82, v82, v82 row_ror:1 row_mask:0xf bank_mask:0xf
    v_mov_b32 v83, v82
    s_nop 1
    v_permlane16_swap_b32 v82, v83
    v_add_f32 v82, v82, v83
    v_mov_b32 v83, v82
    s_nop 1
    v_permlane32_swap_b32 v82, v83
    v_add_f32 v82, v82, v83
    v_mul_f32 v82, 0x3acccccd, v82
    v_fma_f32 v82, -v80, v80, v82
    v_max_f32_e64 v83, 0, v82
    v_cvt_pk_bf16_f32 v82, v83, v83
    v_and_b32 v82, 0xffff0000, v82
    v_add_f32_e64 v82, s44, v82
    v_cvt_pk_bf16_f32 v82, v82, v82
    v_and_b32 v82, 0xffff0000, v82
    v_sqrt_f32 v82, v82
    s_nop 0
    v_cvt_pk_bf16_f32 v82, v82, v82
    v_and_b32 v82, 0xffff0000, v82
    v_rcp_f32 v82, v82
    s_nop 0
    v_pk_mul_f32 v[44:45], v[44:45], v[82:83] op_sel_hi:[1,0]
    v_pk_mul_f32 v[46:47], v[46:47], v[82:83] op_sel_hi:[1,0]
    v_pk_mul_f32 v[48:49], v[48:49], v[82:83] op_sel_hi:[1,0]
    v_pk_mul_f32 v[50:51], v[50:51], v[82:83] op_sel_hi:[1,0]
    v_pk_mul_f32 v[52:53], v[52:53], v[82:83] op_sel_hi:[1,0]
    v_pk_mul_f32 v[54:55], v[54:55], v[82:83] op_sel_hi:[1,0]
    v_cvt_pk_bf16_f32 v62, v44, v45
    v_cvt_pk_bf16_f32 v63, v46, v47
    v_cvt_pk_bf16_f32 v64, v48, v49
    v_cvt_pk_bf16_f32 v65, v50, v51
    v_cvt_pk_bf16_f32 v66, v52, v53
    v_cvt_pk_bf16_f32 v67, v54, v55
    s_add_u32 s21, s40, 0x4100f00
    buffer_store_dwordx2 v[62:63], v32, s[8:11], s21 offen offset:0 sc1
    buffer_store_dwordx2 v[64:65], v32, s[8:11], s21 offen offset:512 sc1
    s_mov_b64 exec, s[42:43]
    buffer_store_dwordx2 v[66:67], v32, s[8:11], s21 offen offset:1024 sc1
    s_mov_b64 exec, -1
    v_and_b32 v45, 0xffff0000, v68
    v_lshlrev_b32_e64 v44, 16, v68
    v_and_b32 v47, 0xffff0000, v69
    v_lshlrev_b32_e64 v46, 16, v69
    v_and_b32 v49, 0xffff0000, v70
    v_lshlrev_b32_e64 v48, 16, v70
    v_and_b32 v51, 0xffff0000, v71
    v_lshlrev_b32_e64 v50, 16, v71
    v_and_b32 v53, 0xffff0000, v72
    v_lshlrev_b32_e64 v52, 16, v72
    v_and_b32 v55, 0xffff0000, v73
    v_lshlrev_b32_e64 v54, 16, v73
    v_pk_add_f32 v[80:81], v[44:45], v[46:47]
    v_pk_add_f32 v[82:83], v[48:49], v[50:51]
    v_pk_add_f32 v[84:85], v[52:53], v[54:55]
    v_pk_add_f32 v[80:81], v[80:81], v[82:83]
    v_pk_add_f32 v[80:81], v[80:81], v[84:85]
    v_add_f32 v80, v80, v81
    s_nop 1
    v_add_f32_dpp v80, v80, v80 row_ror:8 row_mask:0xf bank_mask:0xf
    s_nop 1
    v_add_f32_dpp v80, v80, v80 row_ror:4 row_mask:0xf bank_mask:0xf
    s_nop 1
    v_add_f32_dpp v80, v80, v80 row_ror:2 row_mask:0xf bank_mask:0xf
    s_nop 1
    v_add_f32_dpp v80, v80, v80 row_ror:1 row_mask:0xf bank_mask:0xf
    v_mov_b32 v81, v80
    s_nop 1
    v_permlane16_swap_b32 v80, v81
    v_add_f32 v80, v80, v81
    v_mov_b32 v81, v80
    s_nop 1
    v_permlane32_swap_b32 v80, v81
    v_add_f32_e64 v80, v80, v81
    v_mul_f32 v80, 0x3acccccd, v80
    v_cvt_pk_bf16_f32 v84, v80, v80
    v_and_b32 v84, 0xffff0000, v84
    v_sub_f32_e64 v80, v84, v80
    v_pk_add_f32 v[44:45], v[44:45], v[84:85] op_sel_hi:[1,0] neg_lo:[0,1] neg_hi:[0,1]
    v_pk_add_f32 v[46:47], v[46:47], v[84:85] op_sel_hi:[1,0] neg_lo:[0,1] neg_hi:[0,1]
    v_pk_add_f32 v[48:49], v[48:49], v[84:85] op_sel_hi:[1,0] neg_lo:[0,1] neg_hi:[0,1]
    v_pk_add_f32 v[50:51], v[50:51], v[84:85] op_sel_hi:[1,0] neg_lo:[0,1] neg_hi:[0,1]
    s_mov_b64 exec, s[42:43]
    v_pk_add_f32 v[52:53], v[52:53], v[84:85] op_sel_hi:[1,0] neg_lo:[0,1] neg_hi:[0,1]
    v_pk_add_f32 v[54:55], v[54:55], v[84:85] op_sel_hi:[1,0] neg_lo:[0,1] neg_hi:[0,1]
    s_mov_b64 exec, -1
    v_pk_mul_f32 v[82:83], v[44:45], v[44:45]
    v_pk_fma_f32 v[82:83], v[46:47], v[46:47], v[82:83]
    v_pk_fma_f32 v[82:83], v[48:49], v[48:49], v[82:83]
    v_pk_fma_f32 v[82:83], v[50:51], v[50:51], v[82:83]
    v_pk_fma_f32 v[82:83], v[52:53], v[52:53], v[82:83]
    v_pk_fma_f32 v[82:83], v[54:55], v[54:55], v[82:83]
    v_add_f32 v82, v82, v83
    s_nop 1
    v_add_f32_dpp v82, v82, v82 row_ror:8 row_mask:0xf bank_mask:0xf
    s_nop 1
    v_add_f32_dpp v82, v82, v82 row_ror:4 row_mask:0xf bank_mask:0xf
    s_nop 1
    v_add_f32_dpp v82, v82, v82 row_ror:2 row_mask:0xf bank_mask:0xf
    s_nop 1
    v_add_f32_dpp v82, v82, v82 row_ror:1 row_mask:0xf bank_mask:0xf
    v_mov_b32 v83, v82
    s_nop 1
    v_permlane16_swap_b32 v82, v83
    v_add_f32 v82, v82, v83
    v_mov_b32 v83, v82
    s_nop 1
    v_permlane32_swap_b32 v82, v83
    v_add_f32_e64 v82, v82, v83
    v_mul_f32 v82, 0x3acccccd, v82
    v_fma_f32 v82, -v80, v80, v82
    v_max_f32_e64 v83, 0, v82
    v_cvt_pk_bf16_f32 v82, v83, v83
    v_and_b32 v82, 0xffff0000, v82
    v_add_f32_e64 v82, s44, v82
    v_cvt_pk_bf16_f32 v82, v82, v82
    v_and_b32 v82, 0xffff0000, v82
    v_sqrt_f32 v82, v82
    s_nop 0
    v_cvt_pk_bf16_f32 v82, v82, v82
    v_and_b32 v82, 0xffff0000, v82
    v_rcp_f32 v82, v82
    s_nop 0
    v_pk_mul_f32 v[44:45], v[44:45], v[82:83] op_sel_hi:[1,0]
    v_pk_mul_f32 v[46:47], v[46:47], v[82:83] op_sel_hi:[1,0]
    v_pk_mul_f32 v[48:49], v[48:49], v[82:83] op_sel_hi:[1,0]
    v_pk_mul_f32 v[50:51], v[50:51], v[82:83] op_sel_hi:[1,0]
    v_pk_mul_f32 v[52:53], v[52:53], v[82:83] op_sel_hi:[1,0]
    v_pk_mul_f32 v[54:55], v[54:55], v[82:83] op_sel_hi:[1,0]
    v_cvt_pk_bf16_f32 v68, v44, v45
    v_cvt_pk_bf16_f32 v69, v46, v47
    v_cvt_pk_bf16_f32 v70, v48, v49
    v_cvt_pk_bf16_f32 v71, v50, v51
    v_cvt_pk_bf16_f32 v72, v52, v53
    v_cvt_pk_bf16_f32 v73, v54, v55
    s_add_u32 s21, s40, 0x4101400
    buffer_store_dwordx2 v[68:69], v32, s[8:11], s21 offen offset:0 sc1
    buffer_store_dwordx2 v[70:71], v32, s[8:11], s21 offen offset:512 sc1
    s_mov_b64 exec, s[42:43]
    buffer_store_dwordx2 v[72:73], v32, s[8:11], s21 offen offset:1024 sc1
    s_mov_b64 exec, -1
    v_and_b32 v45, 0xffff0000, v74
    v_lshlrev_b32_e64 v44, 16, v74
    v_and_b32 v47, 0xffff0000, v75
    v_lshlrev_b32_e64 v46, 16, v75
    v_and_b32 v49, 0xffff0000, v76
    v_lshlrev_b32_e64 v48, 16, v76
    v_and_b32 v51, 0xffff0000, v77
    v_lshlrev_b32_e64 v50, 16, v77
    v_and_b32 v53, 0xffff0000, v78
    v_lshlrev_b32_e64 v52, 16, v78
    v_and_b32 v55, 0xffff0000, v79
    v_lshlrev_b32_e64 v54, 16, v79
    v_pk_add_f32 v[80:81], v[44:45], v[46:47]
    v_pk_add_f32 v[82:83], v[48:49], v[50:51]
    v_pk_add_f32 v[84:85], v[52:53], v[54:55]
    v_pk_add_f32 v[80:81], v[80:81], v[82:83]
    v_pk_add_f32 v[80:81], v[80:81], v[84:85]
    v_add_f32 v80, v80, v81
    s_nop 1
    v_add_f32_dpp v80, v80, v80 row_ror:8 row_mask:0xf bank_mask:0xf
    s_nop 1
    v_add_f32_dpp v80, v80, v80 row_ror:4 row_mask:0xf bank_mask:0xf
    s_nop 1
    v_add_f32_dpp v80, v80, v80 row_ror:2 row_mask:0xf bank_mask:0xf
    s_nop 1
    v_add_f32_dpp v80, v80, v80 row_ror:1 row_mask:0xf bank_mask:0xf
    v_mov_b32 v81, v80
    s_nop 1
    v_permlane16_swap_b32 v80, v81
    v_add_f32 v80, v80, v81
    v_mov_b32 v81, v80
    s_nop 1
    v_permlane32_swap_b32 v80, v81
    v_add_f32_e64 v80, v80, v81
    v_mul_f32 v80, 0x3acccccd, v80
    v_cvt_pk_bf16_f32 v84, v80, v80
    v_and_b32 v84, 0xffff0000, v84
    v_sub_f32_e64 v80, v84, v80
    v_pk_add_f32 v[44:45], v[44:45], v[84:85] op_sel_hi:[1,0] neg_lo:[0,1] neg_hi:[0,1]
    v_pk_add_f32 v[46:47], v[46:47], v[84:85] op_sel_hi:[1,0] neg_lo:[0,1] neg_hi:[0,1]
    v_pk_add_f32 v[48:49], v[48:49], v[84:85] op_sel_hi:[1,0] neg_lo:[0,1] neg_hi:[0,1]
    v_pk_add_f32 v[50:51], v[50:51], v[84:85] op_sel_hi:[1,0] neg_lo:[0,1] neg_hi:[0,1]
    s_mov_b64 exec, s[42:43]
    v_pk_add_f32 v[52:53], v[52:53], v[84:85] op_sel_hi:[1,0] neg_lo:[0,1] neg_hi:[0,1]
    v_pk_add_f32 v[54:55], v[54:55], v[84:85] op_sel_hi:[1,0] neg_lo:[0,1] neg_hi:[0,1]
    s_mov_b64 exec, -1
    v_pk_mul_f32 v[82:83], v[44:45], v[44:45]
    v_pk_fma_f32 v[82:83], v[46:47], v[46:47], v[82:83]
    v_pk_fma_f32 v[82:83], v[48:49], v[48:49], v[82:83]
    v_pk_fma_f32 v[82:83], v[50:51], v[50:51], v[82:83]
    v_pk_fma_f32 v[82:83], v[52:53], v[52:53], v[82:83]
    v_pk_fma_f32 v[82:83], v[54:55], v[54:55], v[82:83]
    v_add_f32 v82, v82, v83
    s_nop 1
    v_add_f32_dpp v82, v82, v82 row_ror:8 row_mask:0xf bank_mask:0xf
    s_nop 1
    v_add_f32_dpp v82, v82, v82 row_ror:4 row_mask:0xf bank_mask:0xf
    s_nop 1
    v_add_f32_dpp v82, v82, v82 row_ror:2 row_mask:0xf bank_mask:0xf
    s_nop 1
    v_add_f32_dpp v82, v82, v82 row_ror:1 row_mask:0xf bank_mask:0xf
    v_mov_b32 v83, v82
    s_nop 1
    v_permlane16_swap_b32 v82, v83
    v_add_f32 v82, v82, v83
    v_mov_b32 v83, v82
    s_nop 1
    v_permlane32_swap_b32 v82, v83
    v_add_f32_e64 v82, v82, v83
    v_mul_f32 v82, 0x3acccccd, v82
    v_fma_f32 v82, -v80, v80, v82
    v_max_f32_e64 v83, 0, v82
    v_cvt_pk_bf16_f32 v82, v83, v83
    v_and_b32 v82, 0xffff0000, v82
    v_add_f32_e64 v82, s44, v82
    v_cvt_pk_bf16_f32 v82, v82, v82
    v_and_b32 v82, 0xffff0000, v82
    v_sqrt_f32 v82, v82
    s_nop 0
    v_cvt_pk_bf16_f32 v82, v82, v82
    v_and_b32 v82, 0xffff0000, v82
    v_rcp_f32 v82, v82
    s_nop 0
    v_pk_mul_f32 v[44:45], v[44:45], v[82:83] op_sel_hi:[1,0]
    v_pk_mul_f32 v[46:47], v[46:47], v[82:83] op_sel_hi:[1,0]
    v_pk_mul_f32 v[48:49], v[48:49], v[82:83] op_sel_hi:[1,0]
    v_pk_mul_f32 v[50:51], v[50:51], v[82:83] op_sel_hi:[1,0]
    v_pk_mul_f32 v[52:53], v[52:53], v[82:83] op_sel_hi:[1,0]
    v_pk_mul_f32 v[54:55], v[54:55], v[82:83] op_sel_hi:[1,0]
    v_cvt_pk_bf16_f32 v74, v44, v45
    v_cvt_pk_bf16_f32 v75, v46, v47
    v_cvt_pk_bf16_f32 v76, v48, v49
    v_cvt_pk_bf16_f32 v77, v50, v51
    v_cvt_pk_bf16_f32 v78, v52, v53
    v_cvt_pk_bf16_f32 v79, v54, v55
    s_add_u32 s21, s40, 0x4101900
    buffer_store_dwordx2 v[74:75], v32, s[8:11], s21 offen offset:0 sc1
    buffer_store_dwordx2 v[76:77], v32, s[8:11], s21 offen offset:512 sc1
    s_mov_b64 exec, s[42:43]
    buffer_store_dwordx2 v[78:79], v32, s[8:11], s21 offen offset:1024 sc1
    s_mov_b64 exec, -1
    s_waitcnt vmcnt(0)
    s_barrier
    s_cmp_lg_u32 s5, 0
    s_cbranch_scc1 sig_7
    v_mov_b32_e64 v34, 1
    v_mov_b32 v35, 0
    s_mov_b64 exec, 1
    buffer_store_dword v34, v35, s[8:11], s37 offen sc1
    s_mov_b64 exec, -1
sig_7:
ln0skip_6:
    s_waitcnt vmcnt(0)
    v_lshrrev_b32_e64 v26, 4, v0
    v_bfe_u32 v27, v0, 2, 2
    v_and_b32 v25, 1, v26
    s_lshl_b32 s22, s5, 1
    v_add_u32 v25, s22, v25
    v_lshlrev_b32 v24, 1, v27
    v_xor_b32 v25, v25, v24
    v_lshlrev_b32 v25, 5, v25
    v_lshrrev_b32_e64 v26, 1, v26
    v_lshl_add_u32 v27, v26, 3, v27
    v_lshl_add_u32 v25, v27, 8, v25
    v_and_b32_e64 v26, 3, v0
    v_lshl_add_u32 v25, v26, 3, v25
    s_waitcnt vmcnt(36)
    s_barrier
    ds_read_b64_tr_b16 a[0:1], v25 offset:0
    ds_read_b64_tr_b16 a[2:3], v25 offset:1024
    ds_read_b64_tr_b16 a[4:5], v25 offset:4096
    ds_read_b64_tr_b16 a[6:7], v25 offset:5120
    ds_read_b64_tr_b16 a[8:9], v25 offset:8192
    ds_read_b64_tr_b16 a[10:11], v25 offset:9216
    ds_read_b64_tr_b16 a[12:13], v25 offset:12288
    ds_read_b64_tr_b16 a[14:15], v25 offset:13312
    s_waitcnt vmcnt(32)
    s_barrier
    ds_read_b64_tr_b16 a[16:17], v25 offset:16384
    ds_read_b64_tr_b16 a[18:19], v25 offset:17408
    ds_read_b64_tr_b16 a[20:21], v25 offset:20480
    ds_read_b64_tr_b16 a[22:23], v25 offset:21504
    ds_read_b64_tr_b16 a[24:25], v25 offset:24576
    ds_read_b64_tr_b16 a[26:27], v25 offset:25600
    ds_read_b64_tr_b16 a[28:29], v25 offset:28672
    ds_read_b64_tr_b16 a[30:31], v25 offset:29696
    s_waitcnt vmcnt(28)
    s_barrier
    ds_read_b64_tr_b16 a[32:33], v25 offset:32768
    ds_read_b64_tr_b16 a[34:35], v25 offset:33792
    ds_read_b64_tr_b16 a[36:37], v25 offset:36864
    ds_read_b64_tr_b16 a[38:39], v25 offset:37888
    ds_read_b64_tr_b16 a[40:41], v25 offset:40960
    ds_read_b64_tr_b16 a[42:43], v25 offset:41984
    ds_read_b64_tr_b16 a[44:45], v25 offset:45056
    ds_read_b64_tr_b16 a[46:47], v25 offset:46080
    s_waitcnt vmcnt(24)
    s_barrier
    ds_read_b64_tr_b16 a[48:49], v25 offset:49152
    ds_read_b64_tr_b16 a[50:51], v25 offset:50176
    ds_read_b64_tr_b16 a[52:53], v25 offset:53248
    ds_read_b64_tr_b16 a[54:55], v25 offset:54272
    ds_read_b64_tr_b16 a[56:57], v25 offset:57344
    ds_read_b64_tr_b16 a[58:59], v25 offset:58368
    ds_read_b64_tr_b16 a[60:61], v25 offset:61440
    ds_read_b64_tr_b16 a[62:63], v25 offset:62464
    v_add_u32 v25, 0x10000, v25
    s_waitcnt vmcnt(20)
    s_barrier
    ds_read_b64_tr_b16 a[64:65], v25 offset:0
    ds_read_b64_tr_b16 a[66:67], v25 offset:1024
    ds_read_b64_tr_b16 a[68:69], v25 offset:4096
    ds_read_b64_tr_b16 a[70:71], v25 offset:5120
    ds_read_b64_tr_b16 a[72:73], v25 offset:8192
    ds_read_b64_tr_b16 a[74:75], v25 offset:9216
    ds_read_b64_tr_b16 a[76:77], v25 offset:12288
    ds_read_b64_tr_b16 a[78:79], v25 offset:13312
    s_waitcnt vmcnt(16)
    s_barrier
    ds_read_b64_tr_b16 a[80:81], v25 offset:16384
    ds_read_b64_tr_b16 a[82:83], v25 offset:17408
    ds_read_b64_tr_b16 a[84:85], v25 offset:20480
    ds_read_b64_tr_b16 a[86:87], v25 offset:21504
    ds_read_b64_tr_b16 a[88:89], v25 offset:24576
    ds_read_b64_tr_b16 a[90:91], v25 offset:25600
    ds_read_b64_tr_b16 a[92:93], v25 offset:28672
    ds_read_b64_tr_b16 a[94:95], v25 offset:29696
    s_waitcnt vmcnt(12)
    s_barrier
    ds_read_b64_tr_b16 a[96:97], v25 offset:32768
    ds_read_b64_tr_b16 a[98:99], v25 offset:33792
    ds_read_b64_tr_b16 a[100:101], v25 offset:36864
    ds_read_b64_tr_b16 a[102:103], v25 offset:37888
    ds_read_b64_tr_b16 a[104:105], v25 offset:40960
    ds_read_b64_tr_b16 a[106:107], v25 offset:41984
    ds_read_b64_tr_b16 a[108:109], v25 offset:45056
    ds_read_b64_tr_b16 a[110:111], v25 offset:46080
    s_waitcnt vmcnt(8)
    s_barrier
    ds_read_b64_tr_b16 a[112:113], v25 offset:49152
    ds_read_b64_tr_b16 a[114:115], v25 offset:50176
    ds_read_b64_tr_b16 a[116:117], v25 offset:53248
    ds_read_b64_tr_b16 a[118:119], v25 offset:54272
    ds_read_b64_tr_b16 a[120:121], v25 offset:57344
    ds_read_b64_tr_b16 a[122:123], v25 offset:58368
    ds_read_b64_tr_b16 a[124:125], v25 offset:61440
    ds_read_b64_tr_b16 a[126:127], v25 offset:62464
    v_add_u32 v25, 0x10000, v25
    s_waitcnt vmcnt(4)
    s_barrier
    ds_read_b64_tr_b16 a[128:129], v25 offset:0
    ds_read_b64_tr_b16 a[130:131], v25 offset:1024
    ds_read_b64_tr_b16 a[132:133], v25 offset:4096
    ds_read_b64_tr_b16 a[134:135], v25 offset:5120
    ds_read_b64_tr_b16 a[136:137], v25 offset:8192
    ds_read_b64_tr_b16 a[138:139], v25 offset:9216
    ds_read_b64_tr_b16 a[140:141], v25 offset:12288
    ds_read_b64_tr_b16 a[142:143], v25 offset:13312
    s_waitcnt vmcnt(0)
    s_barrier
    ds_read_b64_tr_b16 a[144:145], v25 offset:16384
    ds_read_b64_tr_b16 a[146:147], v25 offset:17408
    ds_read_b64_tr_b16 a[148:149], v25 offset:20480
    ds_read_b64_tr_b16 a[150:151], v25 offset:21504
    ds_read_b64_tr_b16 a[152:153], v25 offset:24576
    ds_read_b64_tr_b16 a[154:155], v25 offset:25600
    ds_read_b64_tr_b16 a[156:157], v25 offset:28672
    ds_read_b64_tr_b16 a[158:159], v25 offset:29696
    s_waitcnt lgkmcnt(0)
    s_barrier
    s_lshl_b32 s20, s5, 2
    v_lshrrev_b32 v24, 4, v0
    v_and_b32 v25, 15, v0
    v_add_u32 v26, s20, v24
    v_xor_b32_e64 v25, v25, v26
    v_mul_u32_u24 v24, 1280, v24
    v_lshl_add_u32 v8, v25, 4, v24
    v_and_b32 v24, 31, v0
    v_and_b32 v25, 15, v24
    v_lshrrev_b32 v26, 5, v0
    v_xor_b32 v25, v25, v26
    v_lshlrev_b32 v24, 8, v24
    v_xor_b32 v26, 0, v25
    v_lshl_add_u32 v16, v26, 4, v24
    v_xor_b32_e64 v26, 2, v25
    v_lshl_add_u32 v17, v26, 4, v24
    v_xor_b32_e64 v26, 4, v25
    v_lshl_add_u32 v18, v26, 4, v24
    v_xor_b32_e64 v26, 6, v25
    v_lshl_add_u32 v19, v26, 4, v24
    v_xor_b32_e64 v26, 8, v25
    v_lshl_add_u32 v20, v26, 4, v24
    v_xor_b32_e64 v26, 10, v25
    v_lshl_add_u32 v21, v26, 4, v24
    v_xor_b32_e64 v26, 12, v25
    v_lshl_add_u32 v22, v26, 4, v24
    v_xor_b32_e64 v26, 14, v25
    v_lshl_add_u32 v23, v26, 4, v24
    v_and_b32_e64 v24, 15, v0
    v_bfe_u32 v25, v0, 4, 1
    v_lshrrev_b32_e64 v26, 5, v0
    v_lshl_add_u32 v24, v26, 4, v24
    v_lshlrev_b32_e64 v24, 4, v24
    v_lshl_add_u32 v104, v25, 10, v24
    s_cmp_eq_u32 s64, 0
    s_cselect_b32 s20, 3, s64
    s_sub_u32 s20, s20, 1
    s_lshl_b32 s40, s20, 24
    s_lshl_b32 s20, s65, 2
    s_add_u32 s20, s20, s5
    s_lshl_b32 s20, s20, 11
    s_add_u32 s40, s40, s20
    s_lshl_b32 s20, s66, 18
    s_add_u32 s40, s40, s20
    s_add_u32 s40, s40, 0x100000
    s_mul_i32 s21, s5, 5120
    s_lshl_b32 s30, s5, 10
    s_mul_i32 s20, s66, 40960
    s_add_u32 s38, s20, s21
    s_add_u32 s38, s38, 0x4100a00
    s_cmp_eq_u32 s5, 0
    s_cselect_b32 s46, 1, 0
    s_mov_b32 s47, 0
    v_mov_b32 v105, 0
    v_mbcnt_lo_u32_b32 v89, -1, 0
    v_and_b32 v89, 7, v89
    v_lshlrev_b32 v89, 2, v89
wa_8:
    buffer_load_dword v88, v89, s[12:15], 0 offen offset:4 sc1
    s_waitcnt vmcnt(0)
    v_and_b32 v88, 63, v88
    v_cmp_ne_u32 vcc, 32, v88
    s_cbranch_vccz waok_9
    s_sleep 2
    s_add_u32 s6, s6, 1
    s_cmp_lt_u32 s6, 400000
    s_cbranch_scc1 wa_8
    s_branch waok_9
waok_9:
    s_mov_b32 s29, 1
    s_mov_b32 s20, 0x2000
    v_min_u32 v24, 63, v0
    v_lshlrev_b32 v24, 2, v24
pg_10:
    buffer_load_dword v25, v24, s[8:11], s20 offen sc1
    s_waitcnt vmcnt(0)
    v_cmp_gt_u32 vcc, s29, v25
    s_cbranch_vccz pgok_11
    s_sleep 1
    s_add_u32 s6, s6, 1
    s_cmp_lt_u32 s6, 400000
    s_cbranch_scc1 pg_10
    s_branch pgok_11
pgok_11:
    s_mov_b32 s20, 0x2100
    v_min_u32 v24, 63, v0
    v_lshlrev_b32 v24, 2, v24
pg_12:
    buffer_load_dword v25, v24, s[8:11], s20 offen sc1
    s_waitcnt vmcnt(0)
    v_cmp_gt_u32 vcc, s29, v25
    s_cbranch_vccz pgok_13
    s_sleep 1
    s_add_u32 s6, s6, 1
    s_cmp_lt_u32 s6, 400000
    s_cbranch_scc1 pg_12
    s_branch pgok_13
pgok_13:
    s_add_u32 s39, s30, 0
    s_add_u32 s24, s38, 0
    s_add_u32 m0, s39, 0
    s_nop 0
    buffer_load_dwordx4 v8, s[8:11], s24 offen sc1 lds
    s_add_u32 s24, s38, 20480
    s_add_u32 m0, s39, 4096
    s_nop 0
    buffer_load_dwordx4 v8, s[8:11], s24 offen sc1 lds
    s_add_u32 s24, s38, 256
    s_add_u32 m0, s39, 8192
    s_nop 0
    buffer_load_dwordx4 v8, s[8:11], s24 offen sc1 lds
    s_add_u32 s24, s38, 20736
    s_add_u32 m0, s39, 12288
    s_nop 0
    buffer_load_dwordx4 v8, s[8:11], s24 offen sc1 lds
    s_add_u32 s24, s38, 512
    s_add_u32 m0, s39, 16384
    s_nop 0
    buffer_load_dwordx4 v8, s[8:11], s24 offen sc1 lds
    s_add_u32 s24, s38, 20992
    s_add_u32 m0, s39, 20480
    s_nop 0
    buffer_load_dwordx4 v8, s[8:11], s24 offen sc1 lds
    s_add_u32 s24, s38, 768
    s_add_u32 m0, s39, 24576
    s_nop 0
    buffer_load_dwordx4 v8, s[8:11], s24 offen sc1 lds
    s_add_u32 s24, s38, 21248
    s_add_u32 m0, s39, 28672
    s_nop 0
    buffer_load_dwordx4 v8, s[8:11], s24 offen sc1 lds
    s_add_u32 s24, s38, 1024
    s_add_u32 m0, s39, 32768
    s_nop 0
    buffer_load_dwordx4 v8, s[8:11], s24 offen sc1 lds
    s_add_u32 s24, s38, 21504
    s_add_u32 m0, s39, 36864
    s_nop 0
    buffer_load_dwordx4 v8, s[8:11], s24 offen sc1 lds
    s_add_u32 s38, s38, 81920
    s_add_u32 s39, s30, 40960
    s_add_u32 s24, s38, 0
    s_add_u32 m0, s39, 0
    s_nop 0
    buffer_load_dwordx4 v8, s[8:11], s24 offen sc1 lds
    s_add_u32 s24, s38, 20480
    s_add_u32 m0, s39, 4096
    s_nop 0
    buffer_load_dwordx4 v8, s[8:11], s24 offen sc1 lds
    s_add_u32 s24, s38, 256
    s_add_u32 m0, s39, 8192
    s_nop 0
    buffer_load_dwordx4 v8, s[8:11], s24 offen sc1 lds
    s_add_u32 s24, s38, 20736
    s_add_u32 m0, s39, 12288
    s_nop 0
    buffer_load_dwordx4 v8, s[8:11], s24 offen sc1 lds
    s_add_u32 s24, s38, 512
    s_add_u32 m0, s39, 16384
    s_nop 0
    buffer_load_dwordx4 v8, s[8:11], s24 offen sc1 lds
    s_add_u32 s24, s38, 20992
    s_add_u32 m0, s39, 20480
    s_nop 0
    buffer_load_dwordx4 v8, s[8:11], s24 offen sc1 lds
    s_add_u32 s24, s38, 768
    s_add_u32 m0, s39, 24576
    s_nop 0
    buffer_load_dwordx4 v8, s[8:11], s24 offen sc1 lds
    s_add_u32 s24, s38, 21248
    s_add_u32 m0, s39, 28672
    s_nop 0
    buffer_load_dwordx4 v8, s[8:11], s24 offen sc1 lds
    s_add_u32 s24, s38, 1024
    s_add_u32 m0, s39, 32768
    s_nop 0
    buffer_load_dwordx4 v8, s[8:11], s24 offen sc1 lds
    s_add_u32 s24, s38, 21504
    s_add_u32 m0, s39, 36864
    s_nop 0
    buffer_load_dwordx4 v8, s[8:11], s24 offen sc1 lds
    s_add_u32 s38, s38, 81920
    s_mov_b32 s28, 0
    s_waitcnt vmcnt(10)
    s_barrier
    ds_read_b128 v[24:27], v16 offset:0
    ds_read_b128 v[28:31], v17 offset:0
    ds_read_b128 v[32:35], v18 offset:0
    ds_read_b128 v[36:39], v19 offset:0
    ds_read_b128 v[40:43], v20 offset:0
    s_cmp_eq_u32 s64, 2
    s_cbranch_scc1 P_v_14
P_top_16:
    s_waitcnt lgkmcnt(4)
    v_mfma_f32_32x32x16_bf16 v[64:79], a[0:3], v[24:27], 0
    ds_read_b128 v[44:47], v21 offset:0
    s_min_u32 s20, s28, 1
    s_lshl_b32 s20, s20, 19
    s_add_u32 s39, s30, 81920
    s_waitcnt lgkmcnt(4)
    v_mfma_f32_32x32x16_bf16 v[64:79], a[4:7], v[28:31], v[64:79]
    ds_read_b128 v[48:51], v22 offset:0
    s_waitcnt lgkmcnt(4)
    v_mfma_f32_32x32x16_bf16 v[64:79], a[8:11], v[32:35], v[64:79]
    ds_read_b128 v[52:55], v23 offset:0
    v_cvt_pk_bf16_f32 v96, v80, v81
    v_cvt_pk_bf16_f32 v97, v82, v83
    s_waitcnt lgkmcnt(4)
    v_mfma_f32_32x32x16_bf16 v[64:79], a[12:15], v[36:39], v[64:79]
    ds_read_b128 v[24:27], v16 offset:8192
    v_cvt_pk_bf16_f32 v98, v88, v89
    v_cvt_pk_bf16_f32 v99, v90, v91
    s_waitcnt lgkmcnt(4)
    v_mfma_f32_32x32x16_bf16 v[64:79], a[16:19], v[40:43], v[64:79]
    ds_read_b128 v[28:31], v17 offset:8192
    v_cvt_pk_bf16_f32 v100, v84, v85
    v_cvt_pk_bf16_f32 v101, v86, v87
    s_waitcnt lgkmcnt(4)
    v_mfma_f32_32x32x16_bf16 v[64:79], a[20:23], v[44:47], v[64:79]
    ds_read_b128 v[32:35], v18 offset:8192
    v_cvt_pk_bf16_f32 v102, v92, v93
    v_cvt_pk_bf16_f32 v103, v94, v95
    s_waitcnt lgkmcnt(4)
    v_mfma_f32_32x32x16_bf16 v[64:79], a[24:27], v[48:51], v[64:79]
    ds_read_b128 v[36:39], v19 offset:8192
    buffer_store_dwordx4 v[96:99], v104, s[8:11], s40 offen offset:0 sc1
    s_waitcnt lgkmcnt(4)
    v_mfma_f32_32x32x16_bf16 v[64:79], a[28:31], v[52:55], v[64:79]
    ds_read_b128 v[40:43], v20 offset:8192
    buffer_store_dwordx4 v[100:103], v104, s[8:11], s40 offen offset:512 sc1
    s_waitcnt lgkmcnt(4)
    v_mfma_f32_32x32x16_bf16 v[64:79], a[32:35], v[24:27], v[64:79]
    ds_read_b128 v[44:47], v21 offset:8192
    s_add_u32 s40, s40, s20
    s_add_u32 s24, s38, 0
    s_add_u32 m0, s39, 0
    s_nop 0
    buffer_load_dwordx4 v8, s[8:11], s24 offen sc1 lds
    s_waitcnt lgkmcnt(4)
    v_mfma_f32_32x32x16_bf16 v[64:79], a[36:39], v[28:31], v[64:79]
    ds_read_b128 v[48:51], v22 offset:8192
    s_waitcnt lgkmcnt(4)
    v_mfma_f32_32x32x16_bf16 v[64:79], a[40:43], v[32:35], v[64:79]
    ds_read_b128 v[52:55], v23 offset:8192
    s_add_u32 s24, s38, 20480
    s_add_u32 m0, s39, 4096
    s_nop 0
    buffer_load_dwordx4 v8, s[8:11], s24 offen sc1 lds
    s_waitcnt lgkmcnt(4)
    v_mfma_f32_32x32x16_bf16 v[64:79], a[44:47], v[36:39], v[64:79]
    ds_read_b128 v[24:27], v16 offset:16384
    s_waitcnt lgkmcnt(4)
    v_mfma_f32_32x32x16_bf16 v[64:79], a[48:51], v[40:43], v[64:79]
    ds_read_b128 v[28:31], v17 offset:16384
    s_add_u32 s24, s38, 256
    s_add_u32 m0, s39, 8192
    s_nop 0
    buffer_load_dwordx4 v8, s[8:11], s24 offen sc1 lds
    s_waitcnt lgkmcnt(4)
    v_mfma_f32_32x32x16_bf16 v[64:79], a[52:55], v[44:47], v[64:79]
    ds_read_b128 v[32:35], v18 offset:16384
    s_waitcnt lgkmcnt(4)
    v_mfma_f32_32x32x16_bf16 v[64:79], a[56:59], v[48:51], v[64:79]
    ds_read_b128 v[36:39], v19 offset:16384
    s_add_u32 s24, s38, 20736
    s_add_u32 m0, s39, 12288
    s_nop 0
    buffer_load_dwordx4 v8, s[8:11], s24 offen sc1 lds
    s_waitcnt lgkmcnt(4)
    v_mfma_f32_32x32x16_bf16 v[64:79], a[60:63], v[52:55], v[64:79]
    ds_read_b128 v[40:43], v20 offset:16384
    s_waitcnt lgkmcnt(4)
    v_mfma_f32_32x32x16_bf16 v[64:79], a[64:67], v[24:27], v[64:79]
    ds_read_b128 v[44:47], v21 offset:16384
    s_add_u32 s24, s38, 512
    s_add_u32 m0, s39, 16384
    s_nop 0
    buffer_load_dwordx4 v8, s[8:11], s24 offen sc1 lds
    s_waitcnt lgkmcnt(4)
    v_mfma_f32_32x32x16_bf16 v[64:79], a[68:71], v[28:31], v[64:79]
    ds_read_b128 v[48:51], v22 offset:16384
    s_waitcnt lgkmcnt(4)
    v_mfma_f32_32x32x16_bf16 v[64:79], a[72:75], v[32:35], v[64:79]
    ds_read_b128 v[52:55], v23 offset:16384
    s_add_u32 s24, s38, 20992
    s_add_u32 m0, s39, 20480
    s_nop 0
    buffer_load_dwordx4 v8, s[8:11], s24 offen sc1 lds
    s_waitcnt lgkmcnt(4)
    v_mfma_f32_32x32x16_bf16 v[64:79], a[76:79], v[36:39], v[64:79]
    ds_read_b128 v[24:27], v16 offset:24576
    s_waitcnt lgkmcnt(4)
    v_mfma_f32_32x32x16_bf16 v[64:79], a[80:83], v[40:43], v[64:79]
    ds_read_b128 v[28:31], v17 offset:24576
    s_add_u32 s24, s38, 768
    s_add_u32 m0, s39, 24576
    s_nop 0
    buffer_load_dwordx4 v8, s[8:11], s24 offen sc1 lds
    s_waitcnt lgkmcnt(4)
    v_mfma_f32_32x32x16_bf16 v[64:79], a[84:87], v[44:47], v[64:79]
    ds_read_b128 v[32:35], v18 offset:24576
    s_waitcnt lgkmcnt(4)
    v_mfma_f32_32x32x16_bf16 v[64:79], a[88:91], v[48:51], v[64:79]
    ds_read_b128 v[36:39], v19 offset:24576
    s_add_u32 s24, s38, 21248
    s_add_u32 m0, s39, 28672
    s_nop 0
    buffer_load_dwordx4 v8, s[8:11], s24 offen sc1 lds
    s_waitcnt lgkmcnt(4)
    v_mfma_f32_32x32x16_bf16 v[64:79], a[92:95], v[52:55], v[64:79]
    ds_read_b128 v[40:43], v20 offset:24576
    s_waitcnt lgkmcnt(4)
    v_mfma_f32_32x32x16_bf16 v[64:79], a[96:99], v[24:27], v[64:79]
    ds_read_b128 v[44:47], v21 offset:24576
    s_add_u32 s24, s38, 1024
    s_add_u32 m0, s39, 32768
    s_nop 0
    buffer_load_dwordx4 v8, s[8:11], s24 offen sc1 lds
    s_waitcnt lgkmcnt(4)
    v_mfma_f32_32x32x16_bf16 v[64:79], a[100:103], v[28:31], v[64:79]
    ds_read_b128 v[48:51], v22 offset:24576
    s_waitcnt lgkmcnt(4)
    v_mfma_f32_32x32x16_bf16 v[64:79], a[104:107], v[32:35], v[64:79]
    ds_read_b128 v[52:55], v23 offset:24576
    s_add_u32 s24, s38, 21504
    s_add_u32 m0, s39, 36864
    s_nop 0
    buffer_load_dwordx4 v8, s[8:11], s24 offen sc1 lds
    s_waitcnt lgkmcnt(4)
    v_mfma_f32_32x32x16_bf16 v[64:79], a[108:111], v[36:39], v[64:79]
    ds_read_b128 v[24:27], v16 offset:32768
    s_waitcnt lgkmcnt(4)
    v_mfma_f32_32x32x16_bf16 v[64:79], a[112:115], v[40:43], v[64:79]
    ds_read_b128 v[28:31], v17 offset:32768
    v_add_u32 v16, 40960, v16
    s_waitcnt lgkmcnt(4)
    v_mfma_f32_32x32x16_bf16 v[64:79], a[116:119], v[44:47], v[64:79]
    ds_read_b128 v[32:35], v18 offset:32768
    v_add_u32 v17, 40960, v17
    s_waitcnt lgkmcnt(4)
    v_mfma_f32_32x32x16_bf16 v[64:79], a[120:123], v[48:51], v[64:79]
    ds_read_b128 v[36:39], v19 offset:32768
    v_add_u32 v18, 40960, v18
    s_add_u32 s38, s38, 81920
    s_max_u32 s20, s28, 1
    s_sub_u32 s20, s20, 1
    s_waitcnt lgkmcnt(4)
    v_mfma_f32_32x32x16_bf16 v[64:79], a[124:127], v[52:55], v[64:79]
    ds_read_b128 v[40:43], v20 offset:32768
    v_add_u32 v19, 40960, v19
    v_mov_b32 v106, s20
    s_add_u32 s28, s28, 1
    s_waitcnt lgkmcnt(4)
    v_mfma_f32_32x32x16_bf16 v[64:79], a[128:131], v[24:27], v[64:79]
    ds_read_b128 v[44:47], v21 offset:32768
    v_add_u32 v20, 40960, v20
    s_waitcnt lgkmcnt(4)
    v_mfma_f32_32x32x16_bf16 v[64:79], a[132:135], v[28:31], v[64:79]
    ds_read_b128 v[48:51], v22 offset:32768
    v_add_u32 v21, 40960, v21
    s_waitcnt lgkmcnt(4)
    v_mfma_f32_32x32x16_bf16 v[64:79], a[136:139], v[32:35], v[64:79]
    ds_read_b128 v[52:55], v23 offset:32768
    v_add_u32 v22, 40960, v22
    s_waitcnt lgkmcnt(4)
    v_mfma_f32_32x32x16_bf16 v[64:79], a[140:143], v[36:39], v[64:79]
    v_add_u32 v23, 40960, v23
    s_waitcnt vmcnt(12) lgkmcnt(0)
    s_barrier
    ds_read_b128 v[24:27], v16 offset:0
    s_mov_b64 exec, s[46:47]
    buffer_store_dword v106, v105, s[8:11], s36 offen sc1
    s_mov_b64 exec, -1
    v_mfma_f32_32x32x16_bf16 v[64:79], a[144:147], v[40:43], v[64:79]
    ds_read_b128 v[28:31], v17 offset:0
    v_mfma_f32_32x32x16_bf16 v[64:79], a[148:151], v[44:47], v[64:79]
    ds_read_b128 v[32:35], v18 offset:0
    v_mfma_f32_32x32x16_bf16 v[64:79], a[152:155], v[48:51], v[64:79]
    ds_read_b128 v[36:39], v19 offset:0
    v_mfma_f32_32x32x16_bf16 v[64:79], a[156:159], v[52:55], v[64:79]
    ds_read_b128 v[40:43], v20 offset:0
    s_cmp_eq_u32 s28, 32
    s_waitcnt lgkmcnt(4)
    v_mfma_f32_32x32x16_bf16 v[80:95], a[0:3], v[24:27], 0
    ds_read_b128 v[44:47], v21 offset:0
    s_min_u32 s20, s28, 1
    s_lshl_b32 s20, s20, 19
    s_add_u32 s39, s30, 0
    s_waitcnt lgkmcnt(4)
    v_mfma_f32_32x32x16_bf16 v[80:95], a[4:7], v[28:31], v[80:95]
    ds_read_b128 v[48:51], v22 offset:0
    s_waitcnt lgkmcnt(4)
    v_mfma_f32_32x32x16_bf16 v[80:95], a[8:11], v[32:35], v[80:95]
    ds_read_b128 v[52:55], v23 offset:0
    v_cvt_pk_bf16_f32 v96, v64, v65
    v_cvt_pk_bf16_f32 v97, v66, v67
    s_waitcnt lgkmcnt(4)
    v_mfma_f32_32x32x16_bf16 v[80:95], a[12:15], v[36:39], v[80:95]
    ds_read_b128 v[24:27], v16 offset:8192
    v_cvt_pk_bf16_f32 v98, v72, v73
    v_cvt_pk_bf16_f32 v99, v74, v75
    s_waitcnt lgkmcnt(4)
    v_mfma_f32_32x32x16_bf16 v[80:95], a[16:19], v[40:43], v[80:95]
    ds_read_b128 v[28:31], v17 offset:8192
    v_cvt_pk_bf16_f32 v100, v68, v69
    v_cvt_pk_bf16_f32 v101, v70, v71
    s_waitcnt lgkmcnt(4)
    v_mfma_f32_32x32x16_bf16 v[80:95], a[20:23], v[44:47], v[80:95]
    ds_read_b128 v[32:35], v18 offset:8192
    v_cvt_pk_bf16_f32 v102, v76, v77
    v_cvt_pk_bf16_f32 v103, v78, v79
    s_waitcnt lgkmcnt(4)
    v_mfma_f32_32x32x16_bf16 v[80:95], a[24:27], v[48:51], v[80:95]
    ds_read_b128 v[36:39], v19 offset:8192
    buffer_store_dwordx4 v[96:99], v104, s[8:11], s40 offen offset:0 sc1
    s_waitcnt lgkmcnt(4)
    v_mfma_f32_32x32x16_bf16 v[80:95], a[28:31], v[52:55], v[80:95]
    ds_read_b128 v[40:43], v20 offset:8192
    buffer_store_dwordx4 v[100:103], v104, s[8:11], s40 offen offset:512 sc1
    s_waitcnt lgkmcnt(4)
    v_mfma_f32_32x32x16_bf16 v[80:95], a[32:35], v[24:27], v[80:95]
    ds_read_b128 v[44:47], v21 offset:8192
    s_add_u32 s40, s40, s20
    s_add_u32 s24, s38, 0
    s_add_u32 m0, s39, 0
    s_nop 0
    buffer_load_dwordx4 v8, s[8:11], s24 offen sc1 lds
    s_waitcnt lgkmcnt(4)
    v_mfma_f32_32x32x16_bf16 v[80:95], a[36:39], v[28:31], v[80:95]
    ds_read_b128 v[48:51], v22 offset:8192
    s_waitcnt lgkmcnt(4)
    v_mfma_f32_32x32x16_bf16 v[80:95], a[40:43], v[32:35], v[80:95]
    ds_read_b128 v[52:55], v23 offset:8192
    s_add_u32 s24, s38, 20480
    s_add_u32 m0, s39, 4096
    s_nop 0
    buffer_load_dwordx4 v8, s[8:11], s24 offen sc1 lds
    s_waitcnt lgkmcnt(4)
    v_mfma_f32_32x32x16_bf16 v[80:95], a[44:47], v[36:39], v[80:95]
    ds_read_b128 v[24:27], v16 offset:16384
    s_waitcnt lgkmcnt(4)
    v_mfma_f32_32x32x16_bf16 v[80:95], a[48:51], v[40:43], v[80:95]
    ds_read_b128 v[28:31], v17 offset:16384
    s_add_u32 s24, s38, 256
    s_add_u32 m0, s39, 8192
    s_nop 0
    buffer_load_dwordx4 v8, s[8:11], s24 offen sc1 lds
    s_waitcnt lgkmcnt(4)
    v_mfma_f32_32x32x16_bf16 v[80:95], a[52:55], v[44:47], v[80:95]
    ds_read_b128 v[32:35], v18 offset:16384
    s_waitcnt lgkmcnt(4)
    v_mfma_f32_32x32x16_bf16 v[80:95], a[56:59], v[48:51], v[80:95]
    ds_read_b128 v[36:39], v19 offset:16384
    s_add_u32 s24, s38, 20736
    s_add_u32 m0, s39, 12288
    s_nop 0
    buffer_load_dwordx4 v8, s[8:11], s24 offen sc1 lds
    s_waitcnt lgkmcnt(4)
    v_mfma_f32_32x32x16_bf16 v[80:95], a[60:63], v[52:55], v[80:95]
    ds_read_b128 v[40:43], v20 offset:16384
    s_waitcnt lgkmcnt(4)
    v_mfma_f32_32x32x16_bf16 v[80:95], a[64:67], v[24:27], v[80:95]
    ds_read_b128 v[44:47], v21 offset:16384
    s_add_u32 s24, s38, 512
    s_add_u32 m0, s39, 16384
    s_nop 0
    buffer_load_dwordx4 v8, s[8:11], s24 offen sc1 lds
    s_waitcnt lgkmcnt(4)
    v_mfma_f32_32x32x16_bf16 v[80:95], a[68:71], v[28:31], v[80:95]
    ds_read_b128 v[48:51], v22 offset:16384
    s_waitcnt lgkmcnt(4)
    v_mfma_f32_32x32x16_bf16 v[80:95], a[72:75], v[32:35], v[80:95]
    ds_read_b128 v[52:55], v23 offset:16384
    s_add_u32 s24, s38, 20992
    s_add_u32 m0, s39, 20480
    s_nop 0
    buffer_load_dwordx4 v8, s[8:11], s24 offen sc1 lds
    s_waitcnt lgkmcnt(4)
    v_mfma_f32_32x32x16_bf16 v[80:95], a[76:79], v[36:39], v[80:95]
    ds_read_b128 v[24:27], v16 offset:24576
    s_waitcnt lgkmcnt(4)
    v_mfma_f32_32x32x16_bf16 v[80:95], a[80:83], v[40:43], v[80:95]
    ds_read_b128 v[28:31], v17 offset:24576
    s_add_u32 s24, s38, 768
    s_add_u32 m0, s39, 24576
    s_nop 0
    buffer_load_dwordx4 v8, s[8:11], s24 offen sc1 lds
    s_waitcnt lgkmcnt(4)
    v_mfma_f32_32x32x16_bf16 v[80:95], a[84:87], v[44:47], v[80:95]
    ds_read_b128 v[32:35], v18 offset:24576
    s_waitcnt lgkmcnt(4)
    v_mfma_f32_32x32x16_bf16 v[80:95], a[88:91], v[48:51], v[80:95]
    ds_read_b128 v[36:39], v19 offset:24576
    s_add_u32 s24, s38, 21248
    s_add_u32 m0, s39, 28672
    s_nop 0
    buffer_load_dwordx4 v8, s[8:11], s24 offen sc1 lds
    s_waitcnt lgkmcnt(4)
    v_mfma_f32_32x32x16_bf16 v[80:95], a[92:95], v[52:55], v[80:95]
    ds_read_b128 v[40:43], v20 offset:24576
    s_waitcnt lgkmcnt(4)
    v_mfma_f32_32x32x16_bf16 v[80:95], a[96:99], v[24:27], v[80:95]
    ds_read_b128 v[44:47], v21 offset:24576
    s_add_u32 s24, s38, 1024
    s_add_u32 m0, s39, 32768
    s_nop 0
    buffer_load_dwordx4 v8, s[8:11], s24 offen sc1 lds
    s_waitcnt lgkmcnt(4)
    v_mfma_f32_32x32x16_bf16 v[80:95], a[100:103], v[28:31], v[80:95]
    ds_read_b128 v[48:51], v22 offset:24576
    s_waitcnt lgkmcnt(4)
    v_mfma_f32_32x32x16_bf16 v[80:95], a[104:107], v[32:35], v[80:95]
    ds_read_b128 v[52:55], v23 offset:24576
    s_add_u32 s24, s38, 21504
    s_add_u32 m0, s39, 36864
    s_nop 0
    buffer_load_dwordx4 v8, s[8:11], s24 offen sc1 lds
    s_waitcnt lgkmcnt(4)
    v_mfma_f32_32x32x16_bf16 v[80:95], a[108:111], v[36:39], v[80:95]
    ds_read_b128 v[24:27], v16 offset:32768
    s_waitcnt lgkmcnt(4)
    v_mfma_f32_32x32x16_bf16 v[80:95], a[112:115], v[40:43], v[80:95]
    ds_read_b128 v[28:31], v17 offset:32768
    v_add_u32 v16, 40960, v16
    s_waitcnt lgkmcnt(4)
    v_mfma_f32_32x32x16_bf16 v[80:95], a[116:119], v[44:47], v[80:95]
    ds_read_b128 v[32:35], v18 offset:32768
    v_add_u32 v17, 40960, v17
    s_waitcnt lgkmcnt(4)
    v_mfma_f32_32x32x16_bf16 v[80:95], a[120:123], v[48:51], v[80:95]
    ds_read_b128 v[36:39], v19 offset:32768
    v_add_u32 v18, 40960, v18
    s_add_u32 s38, s38, 81920
    s_max_u32 s20, s28, 1
    s_sub_u32 s20, s20, 1
    s_waitcnt lgkmcnt(4)
    v_mfma_f32_32x32x16_bf16 v[80:95], a[124:127], v[52:55], v[80:95]
    ds_read_b128 v[40:43], v20 offset:32768
    v_add_u32 v19, 40960, v19
    v_mov_b32 v106, s20
    s_add_u32 s28, s28, 1
    s_waitcnt lgkmcnt(4)
    v_mfma_f32_32x32x16_bf16 v[80:95], a[128:131], v[24:27], v[80:95]
    ds_read_b128 v[44:47], v21 offset:32768
    v_add_u32 v20, 40960, v20
    s_waitcnt lgkmcnt(4)
    v_mfma_f32_32x32x16_bf16 v[80:95], a[132:135], v[28:31], v[80:95]
    ds_read_b128 v[48:51], v22 offset:32768
    v_add_u32 v21, 40960, v21
    s_waitcnt lgkmcnt(4)
    v_mfma_f32_32x32x16_bf16 v[80:95], a[136:139], v[32:35], v[80:95]
    ds_read_b128 v[52:55], v23 offset:32768
    v_add_u32 v22, 40960, v22
    s_waitcnt lgkmcnt(4)
    v_mfma_f32_32x32x16_bf16 v[80:95], a[140:143], v[36:39], v[80:95]
    v_add_u32 v23, 40960, v23
    s_waitcnt vmcnt(12) lgkmcnt(0)
    s_barrier
    ds_read_b128 v[24:27], v16 offset:0
    s_mov_b64 exec, s[46:47]
    buffer_store_dword v106, v105, s[8:11], s36 offen sc1
    s_mov_b64 exec, -1
    v_mfma_f32_32x32x16_bf16 v[80:95], a[144:147], v[40:43], v[80:95]
    ds_read_b128 v[28:31], v17 offset:0
    v_mfma_f32_32x32x16_bf16 v[80:95], a[148:151], v[44:47], v[80:95]
    ds_read_b128 v[32:35], v18 offset:0
    v_mfma_f32_32x32x16_bf16 v[80:95], a[152:155], v[48:51], v[80:95]
    ds_read_b128 v[36:39], v19 offset:0
    v_mfma_f32_32x32x16_bf16 v[80:95], a[156:159], v[52:55], v[80:95]
    ds_read_b128 v[40:43], v20 offset:0
    s_cmp_eq_u32 s28, 32
    s_cbranch_scc1 P_end_15
    s_waitcnt lgkmcnt(4)
    v_mfma_f32_32x32x16_bf16 v[64:79], a[0:3], v[24:27], 0
    ds_read_b128 v[44:47], v21 offset:0
    s_min_u32 s20, s28, 1
    s_lshl_b32 s20, s20, 19
    s_add_u32 s39, s30, 40960
    s_waitcnt lgkmcnt(4)
    v_mfma_f32_32x32x16_bf16 v[64:79], a[4:7], v[28:31], v[64:79]
    ds_read_b128 v[48:51], v22 offset:0
    s_waitcnt lgkmcnt(4)
    v_mfma_f32_32x32x16_bf16 v[64:79], a[8:11], v[32:35], v[64:79]
    ds_read_b128 v[52:55], v23 offset:0
    v_cvt_pk_bf16_f32 v96, v80, v81
    v_cvt_pk_bf16_f32 v97, v82, v83
    s_waitcnt lgkmcnt(4)
    v_mfma_f32_32x32x16_bf16 v[64:79], a[12:15], v[36:39], v[64:79]
    ds_read_b128 v[24:27], v16 offset:8192
    v_cvt_pk_bf16_f32 v98, v88, v89
    v_cvt_pk_bf16_f32 v99, v90, v91
    s_waitcnt lgkmcnt(4)
    v_mfma_f32_32x32x16_bf16 v[64:79], a[16:19], v[40:43], v[64:79]
    ds_read_b128 v[28:31], v17 offset:8192
    v_cvt_pk_bf16_f32 v100, v84, v85
    v_cvt_pk_bf16_f32 v101, v86, v87
    s_waitcnt lgkmcnt(4)
    v_mfma_f32_32x32x16_bf16 v[64:79], a[20:23], v[44:47], v[64:79]
    ds_read_b128 v[32:35], v18 offset:8192
    v_cvt_pk_bf16_f32 v102, v92, v93
    v_cvt_pk_bf16_f32 v103, v94, v95
    s_waitcnt lgkmcnt(4)
    v_mfma_f32_32x32x16_bf16 v[64:79], a[24:27], v[48:51], v[64:79]
    ds_read_b128 v[36:39], v19 offset:8192
    buffer_store_dwordx4 v[96:99], v104, s[8:11], s40 offen offset:0 sc1
    s_waitcnt lgkmcnt(4)
    v_mfma_f32_32x32x16_bf16 v[64:79], a[28:31], v[52:55], v[64:79]
    ds_read_b128 v[40:43], v20 offset:8192
    buffer_store_dwordx4 v[100:103], v104, s[8:11], s40 offen offset:512 sc1
    s_waitcnt lgkmcnt(4)
    v_mfma_f32_32x32x16_bf16 v[64:79], a[32:35], v[24:27], v[64:79]
    ds_read_b128 v[44:47], v21 offset:8192
    s_add_u32 s40, s40, s20
    s_add_u32 s24, s38, 0
    s_add_u32 m0, s39, 0
    s_nop 0
    buffer_load_dwordx4 v8, s[8:11], s24 offen sc1 lds
    s_waitcnt lgkmcnt(4)
    v_mfma_f32_32x32x16_bf16 v[64:79], a[36:39], v[28:31], v[64:79]
    ds_read_b128 v[48:51], v22 offset:8192
    s_waitcnt lgkmcnt(4)
    v_mfma_f32_32x32x16_bf16 v[64:79], a[40:43], v[32:35], v[64:79]
    ds_read_b128 v[52:55], v23 offset:8192
    s_add_u32 s24, s38, 20480
    s_add_u32 m0, s39, 4096
    s_nop 0
    buffer_load_dwordx4 v8, s[8:11], s24 offen sc1 lds
    s_waitcnt lgkmcnt(4)
    v_mfma_f32_32x32x16_bf16 v[64:79], a[44:47], v[36:39], v[64:79]
    ds_read_b128 v[24:27], v16 offset:16384
    s_waitcnt lgkmcnt(4)
    v_mfma_f32_32x32x16_bf16 v[64:79], a[48:51], v[40:43], v[64:79]
    ds_read_b128 v[28:31], v17 offset:16384
    s_add_u32 s24, s38, 256
    s_add_u32 m0, s39, 8192
    s_nop 0
    buffer_load_dwordx4 v8, s[8:11], s24 offen sc1 lds
    s_waitcnt lgkmcnt(4)
    v_mfma_f32_32x32x16_bf16 v[64:79], a[52:55], v[44:47], v[64:79]
    ds_read_b128 v[32:35], v18 offset:16384
    s_waitcnt lgkmcnt(4)
    v_mfma_f32_32x32x16_bf16 v[64:79], a[56:59], v[48:51], v[64:79]
    ds_read_b128 v[36:39], v19 offset:16384
    s_add_u32 s24, s38, 20736
    s_add_u32 m0, s39, 12288
    s_nop 0
    buffer_load_dwordx4 v8, s[8:11], s24 offen sc1 lds
    s_waitcnt lgkmcnt(4)
    v_mfma_f32_32x32x16_bf16 v[64:79], a[60:63], v[52:55], v[64:79]
    ds_read_b128 v[40:43], v20 offset:16384
    s_waitcnt lgkmcnt(4)
    v_mfma_f32_32x32x16_bf16 v[64:79], a[64:67], v[24:27], v[64:79]
    ds_read_b128 v[44:47], v21 offset:16384
    s_add_u32 s24, s38, 512
    s_add_u32 m0, s39, 16384
    s_nop 0
    buffer_load_dwordx4 v8, s[8:11], s24 offen sc1 lds
    s_waitcnt lgkmcnt(4)
    v_mfma_f32_32x32x16_bf16 v[64:79], a[68:71], v[28:31], v[64:79]
    ds_read_b128 v[48:51], v22 offset:16384
    s_waitcnt lgkmcnt(4)
    v_mfma_f32_32x32x16_bf16 v[64:79], a[72:75], v[32:35], v[64:79]
    ds_read_b128 v[52:55], v23 offset:16384
    s_add_u32 s24, s38, 20992
    s_add_u32 m0, s39, 20480
    s_nop 0
    buffer_load_dwordx4 v8, s[8:11], s24 offen sc1 lds
    s_waitcnt lgkmcnt(4)
    v_mfma_f32_32x32x16_bf16 v[64:79], a[76:79], v[36:39], v[64:79]
    ds_read_b128 v[24:27], v16 offset:24576
    s_waitcnt lgkmcnt(4)
    v_mfma_f32_32x32x16_bf16 v[64:79], a[80:83], v[40:43], v[64:79]
    ds_read_b128 v[28:31], v17 offset:24576
    s_add_u32 s24, s38, 768
    s_add_u32 m0, s39, 24576
    s_nop 0
    buffer_load_dwordx4 v8, s[8:11], s24 offen sc1 lds
    s_waitcnt lgkmcnt(4)
    v_mfma_f32_32x32x16_bf16 v[64:79], a[84:87], v[44:47], v[64:79]
    ds_read_b128 v[32:35], v18 offset:24576
    s_waitcnt lgkmcnt(4)
    v_mfma_f32_32x32x16_bf16 v[64:79], a[88:91], v[48:51], v[64:79]
    ds_read_b128 v[36:39], v19 offset:24576
    s_add_u32 s24, s38, 21248
    s_add_u32 m0, s39, 28672
    s_nop 0
    buffer_load_dwordx4 v8, s[8:11], s24 offen sc1 lds
    s_waitcnt lgkmcnt(4)
    v_mfma_f32_32x32x16_bf16 v[64:79], a[92:95], v[52:55], v[64:79]
    ds_read_b128 v[40:43], v20 offset:24576
    s_waitcnt lgkmcnt(4)
    v_mfma_f32_32x32x16_bf16 v[64:79], a[96:99], v[24:27], v[64:79]
    ds_read_b128 v[44:47], v21 offset:24576
    s_add_u32 s24, s38, 1024
    s_add_u32 m0, s39, 32768
    s_nop 0
    buffer_load_dwordx4 v8, s[8:11], s24 offen sc1 lds
    s_waitcnt lgkmcnt(4)
    v_mfma_f32_32x32x16_bf16 v[64:79], a[100:103], v[28:31], v[64:79]
    ds_read_b128 v[48:51], v22 offset:24576
    s_waitcnt lgkmcnt(4)
    v_mfma_f32_32x32x16_bf16 v[64:79], a[104:107], v[32:35], v[64:79]
    ds_read_b128 v[52:55], v23 offset:24576
    s_add_u32 s24, s38, 21504
    s_add_u32 m0, s39, 36864
    s_nop 0
    buffer_load_dwordx4 v8, s[8:11], s24 offen sc1 lds
    s_waitcnt lgkmcnt(4)
    v_mfma_f32_32x32x16_bf16 v[64:79], a[108:111], v[36:39], v[64:79]
    ds_read_b128 v[24:27], v16 offset:32768
    s_waitcnt lgkmcnt(4)
    v_mfma_f32_32x32x16_bf16 v[64:79], a[112:115], v[40:43], v[64:79]
    ds_read_b128 v[28:31], v17 offset:32768
    v_add_u32 v16, -81920, v16
    s_waitcnt lgkmcnt(4)
    v_mfma_f32_32x32x16_bf16 v[64:79], a[116:119], v[44:47], v[64:79]
    ds_read_b128 v[32:35], v18 offset:32768
    v_add_u32 v17, -81920, v17
    s_waitcnt lgkmcnt(4)
    v_mfma_f32_32x32x16_bf16 v[64:79], a[120:123], v[48:51], v[64:79]
    ds_read_b128 v[36:39], v19 offset:32768
    v_add_u32 v18, -81920, v18
    s_add_u32 s38, s38, 81920
    s_max_u32 s20, s28, 1
    s_sub_u32 s20, s20, 1
    s_waitcnt lgkmcnt(4)
    v_mfma_f32_32x32x16_bf16 v[64:79], a[124:127], v[52:55], v[64:79]
    ds_read_b128 v[40:43], v20 offset:32768
    v_add_u32 v19, -81920, v19
    v_mov_b32 v106, s20
    s_add_u32 s28, s28, 1
    s_waitcnt lgkmcnt(4)
    v_mfma_f32_32x32x16_bf16 v[64:79], a[128:131], v[24:27], v[64:79]
    ds_read_b128 v[44:47], v21 offset:32768
    v_add_u32 v20, -81920, v20
    s_waitcnt lgkmcnt(4)
    v_mfma_f32_32x32x16_bf16 v[64:79], a[132:135], v[28:31], v[64:79]
    ds_read_b128 v[48:51], v22 offset:32768
    v_add_u32 v21, -81920, v21
    s_waitcnt lgkmcnt(4)
    v_mfma_f32_32x32x16_bf16 v[64:79], a[136:139], v[32:35], v[64:79]
    ds_read_b128 v[52:55], v23 offset:32768
    v_add_u32 v22, -81920, v22
    s_waitcnt lgkmcnt(4)
    v_mfma_f32_32x32x16_bf16 v[64:79], a[140:143], v[36:39], v[64:79]
    v_add_u32 v23, -81920, v23
    s_waitcnt vmcnt(12) lgkmcnt(0)
    s_barrier
    ds_read_b128 v[24:27], v16 offset:0
    s_mov_b64 exec, s[46:47]
    buffer_store_dword v106, v105, s[8:11], s36 offen sc1
    s_mov_b64 exec, -1
    v_mfma_f32_32x32x16_bf16 v[64:79], a[144:147], v[40:43], v[64:79]
    ds_read_b128 v[28:31], v17 offset:0
    v_mfma_f32_32x32x16_bf16 v[64:79], a[148:151], v[44:47], v[64:79]
    ds_read_b128 v[32:35], v18 offset:0
    v_mfma_f32_32x32x16_bf16 v[64:79], a[152:155], v[48:51], v[64:79]
    ds_read_b128 v[36:39], v19 offset:0
    v_mfma_f32_32x32x16_bf16 v[64:79], a[156:159], v[52:55], v[64:79]
    ds_read_b128 v[40:43], v20 offset:0
    s_cmp_eq_u32 s28, 32
    s_waitcnt lgkmcnt(4)
    v_mfma_f32_32x32x16_bf16 v[80:95], a[0:3], v[24:27], 0
    ds_read_b128 v[44:47], v21 offset:0
    s_min_u32 s20, s28, 1
    s_lshl_b32 s20, s20, 19
    s_add_u32 s39, s30, 81920
    s_waitcnt lgkmcnt(4)
    v_mfma_f32_32x32x16_bf16 v[80:95], a[4:7], v[28:31], v[80:95]
    ds_read_b128 v[48:51], v22 offset:0
    s_waitcnt lgkmcnt(4)
    v_mfma_f32_32x32x16_bf16 v[80:95], a[8:11], v[32:35], v[80:95]
    ds_read_b128 v[52:55], v23 offset:0
    v_cvt_pk_bf16_f32 v96, v64, v65
    v_cvt_pk_bf16_f32 v97, v66, v67
    s_waitcnt lgkmcnt(4)
    v_mfma_f32_32x32x16_bf16 v[80:95], a[12:15], v[36:39], v[80:95]
    ds_read_b128 v[24:27], v16 offset:8192
    v_cvt_pk_bf16_f32 v98, v72, v73
    v_cvt_pk_bf16_f32 v99, v74, v75
    s_waitcnt lgkmcnt(4)
    v_mfma_f32_32x32x16_bf16 v[80:95], a[16:19], v[40:43], v[80:95]
    ds_read_b128 v[28:31], v17 offset:8192
    v_cvt_pk_bf16_f32 v100, v68, v69
    v_cvt_pk_bf16_f32 v101, v70, v71
    s_waitcnt lgkmcnt(4)
    v_mfma_f32_32x32x16_bf16 v[80:95], a[20:23], v[44:47], v[80:95]
    ds_read_b128 v[32:35], v18 offset:8192
    v_cvt_pk_bf16_f32 v102, v76, v77
    v_cvt_pk_bf16_f32 v103, v78, v79
    s_waitcnt lgkmcnt(4)
    v_mfma_f32_32x32x16_bf16 v[80:95], a[24:27], v[48:51], v[80:95]
    ds_read_b128 v[36:39], v19 offset:8192
    buffer_store_dwordx4 v[96:99], v104, s[8:11], s40 offen offset:0 sc1
    s_waitcnt lgkmcnt(4)
    v_mfma_f32_32x32x16_bf16 v[80:95], a[28:31], v[52:55], v[80:95]
    ds_read_b128 v[40:43], v20 offset:8192
    buffer_store_dwordx4 v[100:103], v104, s[8:11], s40 offen offset:512 sc1
    s_waitcnt lgkmcnt(4)
    v_mfma_f32_32x32x16_bf16 v[80:95], a[32:35], v[24:27], v[80:95]
    ds_read_b128 v[44:47], v21 offset:8192
    s_add_u32 s40, s40, s20
    s_add_u32 s24, s38, 0
    s_add_u32 m0, s39, 0
    s_nop 0
    buffer_load_dwordx4 v8, s[8:11], s24 offen sc1 lds
    s_waitcnt lgkmcnt(4)
    v_mfma_f32_32x32x16_bf16 v[80:95], a[36:39], v[28:31], v[80:95]
    ds_read_b128 v[48:51], v22 offset:8192
    s_waitcnt lgkmcnt(4)
    v_mfma_f32_32x32x16_bf16 v[80:95], a[40:43], v[32:35], v[80:95]
    ds_read_b128 v[52:55], v23 offset:8192
    s_add_u32 s24, s38, 20480
    s_add_u32 m0, s39, 4096
    s_nop 0
    buffer_load_dwordx4 v8, s[8:11], s24 offen sc1 lds
    s_waitcnt lgkmcnt(4)
    v_mfma_f32_32x32x16_bf16 v[80:95], a[44:47], v[36:39], v[80:95]
    ds_read_b128 v[24:27], v16 offset:16384
    s_waitcnt lgkmcnt(4)
    v_mfma_f32_32x32x16_bf16 v[80:95], a[48:51], v[40:43], v[80:95]
    ds_read_b128 v[28:31], v17 offset:16384
    s_add_u32 s24, s38, 256
    s_add_u32 m0, s39, 8192
    s_nop 0
    buffer_load_dwordx4 v8, s[8:11], s24 offen sc1 lds
    s_waitcnt lgkmcnt(4)
    v_mfma_f32_32x32x16_bf16 v[80:95], a[52:55], v[44:47], v[80:95]
    ds_read_b128 v[32:35], v18 offset:16384
    s_waitcnt lgkmcnt(4)
    v_mfma_f32_32x32x16_bf16 v[80:95], a[56:59], v[48:51], v[80:95]
    ds_read_b128 v[36:39], v19 offset:16384
    s_add_u32 s24, s38, 20736
    s_add_u32 m0, s39, 12288
    s_nop 0
    buffer_load_dwordx4 v8, s[8:11], s24 offen sc1 lds
    s_waitcnt lgkmcnt(4)
    v_mfma_f32_32x32x16_bf16 v[80:95], a[60:63], v[52:55], v[80:95]
    ds_read_b128 v[40:43], v20 offset:16384
    s_waitcnt lgkmcnt(4)
    v_mfma_f32_32x32x16_bf16 v[80:95], a[64:67], v[24:27], v[80:95]
    ds_read_b128 v[44:47], v21 offset:16384
    s_add_u32 s24, s38, 512
    s_add_u32 m0, s39, 16384
    s_nop 0
    buffer_load_dwordx4 v8, s[8:11], s24 offen sc1 lds
    s_waitcnt lgkmcnt(4)
    v_mfma_f32_32x32x16_bf16 v[80:95], a[68:71], v[28:31], v[80:95]
    ds_read_b128 v[48:51], v22 offset:16384
    s_waitcnt lgkmcnt(4)
    v_mfma_f32_32x32x16_bf16 v[80:95], a[72:75], v[32:35], v[80:95]
    ds_read_b128 v[52:55], v23 offset:16384
    s_add_u32 s24, s38, 20992
    s_add_u32 m0, s39, 20480
    s_nop 0
    buffer_load_dwordx4 v8, s[8:11], s24 offen sc1 lds
    s_waitcnt lgkmcnt(4)
    v_mfma_f32_32x32x16_bf16 v[80:95], a[76:79], v[36:39], v[80:95]
    ds_read_b128 v[24:27], v16 offset:24576
    s_waitcnt lgkmcnt(4)
    v_mfma_f32_32x32x16_bf16 v[80:95], a[80:83], v[40:43], v[80:95]
    ds_read_b128 v[28:31], v17 offset:24576
    s_add_u32 s24, s38, 768
    s_add_u32 m0, s39, 24576
    s_nop 0
    buffer_load_dwordx4 v8, s[8:11], s24 offen sc1 lds
    s_waitcnt lgkmcnt(4)
    v_mfma_f32_32x32x16_bf16 v[80:95], a[84:87], v[44:47], v[80:95]
    ds_read_b128 v[32:35], v18 offset:24576
    s_waitcnt lgkmcnt(4)
    v_mfma_f32_32x32x16_bf16 v[80:95], a[88:91], v[48:51], v[80:95]
    ds_read_b128 v[36:39], v19 offset:24576
    s_add_u32 s24, s38, 21248
    s_add_u32 m0, s39, 28672
    s_nop 0
    buffer_load_dwordx4 v8, s[8:11], s24 offen sc1 lds
    s_waitcnt lgkmcnt(4)
    v_mfma_f32_32x32x16_bf16 v[80:95], a[92:95], v[52:55], v[80:95]
    ds_read_b128 v[40:43], v20 offset:24576
    s_waitcnt lgkmcnt(4)
    v_mfma_f32_32x32x16_bf16 v[80:95], a[96:99], v[24:27], v[80:95]
    ds_read_b128 v[44:47], v21 offset:24576
    s_add_u32 s24, s38, 1024
    s_add_u32 m0, s39, 32768
    s_nop 0
    buffer_load_dwordx4 v8, s[8:11], s24 offen sc1 lds
    s_waitcnt lgkmcnt(4)
    v_mfma_f32_32x32x16_bf16 v[80:95], a[100:103], v[28:31], v[80:95]
    ds_read_b128 v[48:51], v22 offset:24576
    s_waitcnt lgkmcnt(4)
    v_mfma_f32_32x32x16_bf16 v[80:95], a[104:107], v[32:35], v[80:95]
    ds_read_b128 v[52:55], v23 offset:24576
    s_add_u32 s24, s38, 21504
    s_add_u32 m0, s39, 36864
    s_nop 0
    buffer_load_dwordx4 v8, s[8:11], s24 offen sc1 lds
    s_waitcnt lgkmcnt(4)
    v_mfma_f32_32x32x16_bf16 v[80:95], a[108:111], v[36:39], v[80:95]
    ds_read_b128 v[24:27], v16 offset:32768
    s_waitcnt lgkmcnt(4)
    v_mfma_f32_32x32x16_bf16 v[80:95], a[112:115], v[40:43], v[80:95]
    ds_read_b128 v[28:31], v17 offset:32768
    v_add_u32 v16, 40960, v16
    s_waitcnt lgkmcnt(4)
    v_mfma_f32_32x32x16_bf16 v[80:95], a[116:119], v[44:47], v[80:95]
    ds_read_b128 v[32:35], v18 offset:32768
    v_add_u32 v17, 40960, v17
    s_waitcnt lgkmcnt(4)
    v_mfma_f32_32x32x16_bf16 v[80:95], a[120:123], v[48:51], v[80:95]
    ds_read_b128 v[36:39], v19 offset:32768
    v_add_u32 v18, 40960, v18
    s_add_u32 s38, s38, 81920
    s_max_u32 s20, s28, 1
    s_sub_u32 s20, s20, 1
    s_waitcnt lgkmcnt(4)
    v_mfma_f32_32x32x16_bf16 v[80:95], a[124:127], v[52:55], v[80:95]
    ds_read_b128 v[40:43], v20 offset:32768
    v_add_u32 v19, 40960, v19
    v_mov_b32 v106, s20
    s_add_u32 s28, s28, 1
    s_waitcnt lgkmcnt(4)
    v_mfma_f32_32x32x16_bf16 v[80:95], a[128:131], v[24:27], v[80:95]
    ds_read_b128 v[44:47], v21 offset:32768
    v_add_u32 v20, 40960, v20
    s_waitcnt lgkmcnt(4)
    v_mfma_f32_32x32x16_bf16 v[80:95], a[132:135], v[28:31], v[80:95]
    ds_read_b128 v[48:51], v22 offset:32768
    v_add_u32 v21, 40960, v21
    s_waitcnt lgkmcnt(4)
    v_mfma_f32_32x32x16_bf16 v[80:95], a[136:139], v[32:35], v[80:95]
    ds_read_b128 v[52:55], v23 offset:32768
    v_add_u32 v22, 40960, v22
    s_waitcnt lgkmcnt(4)
    v_mfma_f32_32x32x16_bf16 v[80:95], a[140:143], v[36:39], v[80:95]
    v_add_u32 v23, 40960, v23
    s_waitcnt vmcnt(12) lgkmcnt(0)
    s_barrier
    ds_read_b128 v[24:27], v16 offset:0
    s_mov_b64 exec, s[46:47]
    buffer_store_dword v106, v105, s[8:11], s36 offen sc1
    s_mov_b64 exec, -1
    v_mfma_f32_32x32x16_bf16 v[80:95], a[144:147], v[40:43], v[80:95]
    ds_read_b128 v[28:31], v17 offset:0
    v_mfma_f32_32x32x16_bf16 v[80:95], a[148:151], v[44:47], v[80:95]
    ds_read_b128 v[32:35], v18 offset:0
    v_mfma_f32_32x32x16_bf16 v[80:95], a[152:155], v[48:51], v[80:95]
    ds_read_b128 v[36:39], v19 offset:0
    v_mfma_f32_32x32x16_bf16 v[80:95], a[156:159], v[52:55], v[80:95]
    ds_read_b128 v[40:43], v20 offset:0
    s_cmp_eq_u32 s28, 32
    s_cbranch_scc1 P_end_15
    s_waitcnt lgkmcnt(4)
    v_mfma_f32_32x32x16_bf16 v[64:79], a[0:3], v[24:27], 0
    ds_read_b128 v[44:47], v21 offset:0
    s_min_u32 s20, s28, 1
    s_lshl_b32 s20, s20, 19
    s_add_u32 s39, s30, 0
    s_waitcnt lgkmcnt(4)
    v_mfma_f32_32x32x16_bf16 v[64:79], a[4:7], v[28:31], v[64:79]
    ds_read_b128 v[48:51], v22 offset:0
    s_waitcnt lgkmcnt(4)
    v_mfma_f32_32x32x16_bf16 v[64:79], a[8:11], v[32:35], v[64:79]
    ds_read_b128 v[52:55], v23 offset:0
    v_cvt_pk_bf16_f32 v96, v80, v81
    v_cvt_pk_bf16_f32 v97, v82, v83
    s_waitcnt lgkmcnt(4)
    v_mfma_f32_32x32x16_bf16 v[64:79], a[12:15], v[36:39], v[64:79]
    ds_read_b128 v[24:27], v16 offset:8192
    v_cvt_pk_bf16_f32 v98, v88, v89
    v_cvt_pk_bf16_f32 v99, v90, v91
    s_waitcnt lgkmcnt(4)
    v_mfma_f32_32x32x16_bf16 v[64:79], a[16:19], v[40:43], v[64:79]
    ds_read_b128 v[28:31], v17 offset:8192
    v_cvt_pk_bf16_f32 v100, v84, v85
    v_cvt_pk_bf16_f32 v101, v86, v87
    s_waitcnt lgkmcnt(4)
    v_mfma_f32_32x32x16_bf16 v[64:79], a[20:23], v[44:47], v[64:79]
    ds_read_b128 v[32:35], v18 offset:8192
    v_cvt_pk_bf16_f32 v102, v92, v93
    v_cvt_pk_bf16_f32 v103, v94, v95
    s_waitcnt lgkmcnt(4)
    v_mfma_f32_32x32x16_bf16 v[64:79], a[24:27], v[48:51], v[64:79]
    ds_read_b128 v[36:39], v19 offset:8192
    buffer_store_dwordx4 v[96:99], v104, s[8:11], s40 offen offset:0 sc1
    s_waitcnt lgkmcnt(4)
    v_mfma_f32_32x32x16_bf16 v[64:79], a[28:31], v[52:55], v[64:79]
    ds_read_b128 v[40:43], v20 offset:8192
    buffer_store_dwordx4 v[100:103], v104, s[8:11], s40 offen offset:512 sc1
    s_waitcnt lgkmcnt(4)
    v_mfma_f32_32x32x16_bf16 v[64:79], a[32:35], v[24:27], v[64:79]
    ds_read_b128 v[44:47], v21 offset:8192
    s_add_u32 s40, s40, s20
    s_add_u32 s24, s38, 0
    s_add_u32 m0, s39, 0
    s_nop 0
    buffer_load_dwordx4 v8, s[8:11], s24 offen sc1 lds
    s_waitcnt lgkmcnt(4)
    v_mfma_f32_32x32x16_bf16 v[64:79], a[36:39], v[28:31], v[64:79]
    ds_read_b128 v[48:51], v22 offset:8192
    s_waitcnt lgkmcnt(4)
    v_mfma_f32_32x32x16_bf16 v[64:79], a[40:43], v[32:35], v[64:79]
    ds_read_b128 v[52:55], v23 offset:8192
    s_add_u32 s24, s38, 20480
    s_add_u32 m0, s39, 4096
    s_nop 0
    buffer_load_dwordx4 v8, s[8:11], s24 offen sc1 lds
    s_waitcnt lgkmcnt(4)
    v_mfma_f32_32x32x16_bf16 v[64:79], a[44:47], v[36:39], v[64:79]
    ds_read_b128 v[24:27], v16 offset:16384
    s_waitcnt lgkmcnt(4)
    v_mfma_f32_32x32x16_bf16 v[64:79], a[48:51], v[40:43], v[64:79]
    ds_read_b128 v[28:31], v17 offset:16384
    s_add_u32 s24, s38, 256
    s_add_u32 m0, s39, 8192
    s_nop 0
    buffer_load_dwordx4 v8, s[8:11], s24 offen sc1 lds
    s_waitcnt lgkmcnt(4)
    v_mfma_f32_32x32x16_bf16 v[64:79], a[52:55], v[44:47], v[64:79]
    ds_read_b128 v[32:35], v18 offset:16384
    s_waitcnt lgkmcnt(4)
    v_mfma_f32_32x32x16_bf16 v[64:79], a[56:59], v[48:51], v[64:79]
    ds_read_b128 v[36:39], v19 offset:16384
    s_add_u32 s24, s38, 20736
    s_add_u32 m0, s39, 12288
    s_nop 0
    buffer_load_dwordx4 v8, s[8:11], s24 offen sc1 lds
    s_waitcnt lgkmcnt(4)
    v_mfma_f32_32x32x16_bf16 v[64:79], a[60:63], v[52:55], v[64:79]
    ds_read_b128 v[40:43], v20 offset:16384
    s_waitcnt lgkmcnt(4)
    v_mfma_f32_32x32x16_bf16 v[64:79], a[64:67], v[24:27], v[64:79]
    ds_read_b128 v[44:47], v21 offset:16384
    s_add_u32 s24, s38, 512
    s_add_u32 m0, s39, 16384
    s_nop 0
    buffer_load_dwordx4 v8, s[8:11], s24 offen sc1 lds
    s_waitcnt lgkmcnt(4)
    v_mfma_f32_32x32x16_bf16 v[64:79], a[68:71], v[28:31], v[64:79]
    ds_read_b128 v[48:51], v22 offset:16384
    s_waitcnt lgkmcnt(4)
    v_mfma_f32_32x32x16_bf16 v[64:79], a[72:75], v[32:35], v[64:79]
    ds_read_b128 v[52:55], v23 offset:16384
    s_add_u32 s24, s38, 20992
    s_add_u32 m0, s39, 20480
    s_nop 0
    buffer_load_dwordx4 v8, s[8:11], s24 offen sc1 lds
    s_waitcnt lgkmcnt(4)
    v_mfma_f32_32x32x16_bf16 v[64:79], a[76:79], v[36:39], v[64:79]
    ds_read_b128 v[24:27], v16 offset:24576
    s_waitcnt lgkmcnt(4)
    v_mfma_f32_32x32x16_bf16 v[64:79], a[80:83], v[40:43], v[64:79]
    ds_read_b128 v[28:31], v17 offset:24576
    s_add_u32 s24, s38, 768
    s_add_u32 m0, s39, 24576
    s_nop 0
    buffer_load_dwordx4 v8, s[8:11], s24 offen sc1 lds
    s_waitcnt lgkmcnt(4)
    v_mfma_f32_32x32x16_bf16 v[64:79], a[84:87], v[44:47], v[64:79]
    ds_read_b128 v[32:35], v18 offset:24576
    s_waitcnt lgkmcnt(4)
    v_mfma_f32_32x32x16_bf16 v[64:79], a[88:91], v[48:51], v[64:79]
    ds_read_b128 v[36:39], v19 offset:24576
    s_add_u32 s24, s38, 21248
    s_add_u32 m0, s39, 28672
    s_nop 0
    buffer_load_dwordx4 v8, s[8:11], s24 offen sc1 lds
    s_waitcnt lgkmcnt(4)
    v_mfma_f32_32x32x16_bf16 v[64:79], a[92:95], v[52:55], v[64:79]
    ds_read_b128 v[40:43], v20 offset:24576
    s_waitcnt lgkmcnt(4)
    v_mfma_f32_32x32x16_bf16 v[64:79], a[96:99], v[24:27], v[64:79]
    ds_read_b128 v[44:47], v21 offset:24576
    s_add_u32 s24, s38, 1024
    s_add_u32 m0, s39, 32768
    s_nop 0
    buffer_load_dwordx4 v8, s[8:11], s24 offen sc1 lds
    s_waitcnt lgkmcnt(4)
    v_mfma_f32_32x32x16_bf16 v[64:79], a[100:103], v[28:31], v[64:79]
    ds_read_b128 v[48:51], v22 offset:24576
    s_waitcnt lgkmcnt(4)
    v_mfma_f32_32x32x16_bf16 v[64:79], a[104:107], v[32:35], v[64:79]
    ds_read_b128 v[52:55], v23 offset:24576
    s_add_u32 s24, s38, 21504
    s_add_u32 m0, s39, 36864
    s_nop 0
    buffer_load_dwordx4 v8, s[8:11], s24 offen sc1 lds
    s_waitcnt lgkmcnt(4)
    v_mfma_f32_32x32x16_bf16 v[64:79], a[108:111], v[36:39], v[64:79]
    ds_read_b128 v[24:27], v16 offset:32768
    s_waitcnt lgkmcnt(4)
    v_mfma_f32_32x32x16_bf16 v[64:79], a[112:115], v[40:43], v[64:79]
    ds_read_b128 v[28:31], v17 offset:32768
    v_add_u32 v16, 40960, v16
    s_waitcnt lgkmcnt(4)
    v_mfma_f32_32x32x16_bf16 v[64:79], a[116:119], v[44:47], v[64:79]
    ds_read_b128 v[32:35], v18 offset:32768
    v_add_u32 v17, 40960, v17
    s_waitcnt lgkmcnt(4)
    v_mfma_f32_32x32x16_bf16 v[64:79], a[120:123], v[48:51], v[64:79]
    ds_read_b128 v[36:39], v19 offset:32768
    v_add_u32 v18, 40960, v18
    s_add_u32 s38, s38, 81920
    s_max_u32 s20, s28, 1
    s_sub_u32 s20, s20, 1
    s_waitcnt lgkmcnt(4)
    v_mfma_f32_32x32x16_bf16 v[64:79], a[124:127], v[52:55], v[64:79]
    ds_read_b128 v[40:43], v20 offset:32768
    v_add_u32 v19, 40960, v19
    v_mov_b32 v106, s20
    s_add_u32 s28, s28, 1
    s_waitcnt lgkmcnt(4)
    v_mfma_f32_32x32x16_bf16 v[64:79], a[128:131], v[24:27], v[64:79]
    ds_read_b128 v[44:47], v21 offset:32768
    v_add_u32 v20, 40960, v20
    s_waitcnt lgkmcnt(4)
    v_mfma_f32_32x32x16_bf16 v[64:79], a[132:135], v[28:31], v[64:79]
    ds_read_b128 v[48:51], v22 offset:32768
    v_add_u32 v21, 40960, v21
    s_waitcnt lgkmcnt(4)
    v_mfma_f32_32x32x16_bf16 v[64:79], a[136:139], v[32:35], v[64:79]
    ds_read_b128 v[52:55], v23 offset:32768
    v_add_u32 v22, 40960, v22
    s_waitcnt lgkmcnt(4)
    v_mfma_f32_32x32x16_bf16 v[64:79], a[140:143], v[36:39], v[64:79]
    v_add_u32 v23, 40960, v23
    s_waitcnt vmcnt(12) lgkmcnt(0)
    s_barrier
    ds_read_b128 v[24:27], v16 offset:0
    s_mov_b64 exec, s[46:47]
    buffer_store_dword v106, v105, s[8:11], s36 offen sc1
    s_mov_b64 exec, -1
    v_mfma_f32_32x32x16_bf16 v[64:79], a[144:147], v[40:43], v[64:79]
    ds_read_b128 v[28:31], v17 offset:0
    v_mfma_f32_32x32x16_bf16 v[64:79], a[148:151], v[44:47], v[64:79]
    ds_read_b128 v[32:35], v18 offset:0
    v_mfma_f32_32x32x16_bf16 v[64:79], a[152:155], v[48:51], v[64:79]
    ds_read_b128 v[36:39], v19 offset:0
    v_mfma_f32_32x32x16_bf16 v[64:79], a[156:159], v[52:55], v[64:79]
    ds_read_b128 v[40:43], v20 offset:0
    s_cmp_eq_u32 s28, 32
    s_waitcnt lgkmcnt(4)
    v_mfma_f32_32x32x16_bf16 v[80:95], a[0:3], v[24:27], 0
    ds_read_b128 v[44:47], v21 offset:0
    s_min_u32 s20, s28, 1
    s_lshl_b32 s20, s20, 19
    s_add_u32 s39, s30, 40960
    s_waitcnt lgkmcnt(4)
    v_mfma_f32_32x32x16_bf16 v[80:95], a[4:7], v[28:31], v[80:95]
    ds_read_b128 v[48:51], v22 offset:0
    s_waitcnt lgkmcnt(4)
    v_mfma_f32_32x32x16_bf16 v[80:95], a[8:11], v[32:35], v[80:95]
    ds_read_b128 v[52:55], v23 offset:0
    v_cvt_pk_bf16_f32 v96, v64, v65
    v_cvt_pk_bf16_f32 v97, v66, v67
    s_waitcnt lgkmcnt(4)
    v_mfma_f32_32x32x16_bf16 v[80:95], a[12:15], v[36:39], v[80:95]
    ds_read_b128 v[24:27], v16 offset:8192
    v_cvt_pk_bf16_f32 v98, v72, v73
    v_cvt_pk_bf16_f32 v99, v74, v75
    s_waitcnt lgkmcnt(4)
    v_mfma_f32_32x32x16_bf16 v[80:95], a[16:19], v[40:43], v[80:95]
    ds_read_b128 v[28:31], v17 offset:8192
    v_cvt_pk_bf16_f32 v100, v68, v69
    v_cvt_pk_bf16_f32 v101, v70, v71
    s_waitcnt lgkmcnt(4)
    v_mfma_f32_32x32x16_bf16 v[80:95], a[20:23], v[44:47], v[80:95]
    ds_read_b128 v[32:35], v18 offset:8192
    v_cvt_pk_bf16_f32 v102, v76, v77
    v_cvt_pk_bf16_f32 v103, v78, v79
    s_waitcnt lgkmcnt(4)
    v_mfma_f32_32x32x16_bf16 v[80:95], a[24:27], v[48:51], v[80:95]
    ds_read_b128 v[36:39], v19 offset:8192
    buffer_store_dwordx4 v[96:99], v104, s[8:11], s40 offen offset:0 sc1
    s_waitcnt lgkmcnt(4)
    v_mfma_f32_32x32x16_bf16 v[80:95], a[28:31], v[52:55], v[80:95]
    ds_read_b128 v[40:43], v20 offset:8192
    buffer_store_dwordx4 v[100:103], v104, s[8:11], s40 offen offset:512 sc1
    s_waitcnt lgkmcnt(4)
    v_mfma_f32_32x32x16_bf16 v[80:95], a[32:35], v[24:27], v[80:95]
    ds_read_b128 v[44:47], v21 offset:8192
    s_add_u32 s40, s40, s20
    s_add_u32 s24, s38, 0
    s_add_u32 m0, s39, 0
    s_nop 0
    buffer_load_dwordx4 v8, s[8:11], s24 offen sc1 lds
    s_waitcnt lgkmcnt(4)
    v_mfma_f32_32x32x16_bf16 v[80:95], a[36:39], v[28:31], v[80:95]
    ds_read_b128 v[48:51], v22 offset:8192
    s_waitcnt lgkmcnt(4)
    v_mfma_f32_32x32x16_bf16 v[80:95], a[40:43], v[32:35], v[80:95]
    ds_read_b128 v[52:55], v23 offset:8192
    s_add_u32 s24, s38, 20480
    s_add_u32 m0, s39, 4096
    s_nop 0
    buffer_load_dwordx4 v8, s[8:11], s24 offen sc1 lds
    s_waitcnt lgkmcnt(4)
    v_mfma_f32_32x32x16_bf16 v[80:95], a[44:47], v[36:39], v[80:95]
    ds_read_b128 v[24:27], v16 offset:16384
    s_waitcnt lgkmcnt(4)
    v_mfma_f32_32x32x16_bf16 v[80:95], a[48:51], v[40:43], v[80:95]
    ds_read_b128 v[28:31], v17 offset:16384
    s_add_u32 s24, s38, 256
    s_add_u32 m0, s39, 8192
    s_nop 0
    buffer_load_dwordx4 v8, s[8:11], s24 offen sc1 lds
    s_waitcnt lgkmcnt(4)
    v_mfma_f32_32x32x16_bf16 v[80:95], a[52:55], v[44:47], v[80:95]
    ds_read_b128 v[32:35], v18 offset:16384
    s_waitcnt lgkmcnt(4)
    v_mfma_f32_32x32x16_bf16 v[80:95], a[56:59], v[48:51], v[80:95]
    ds_read_b128 v[36:39], v19 offset:16384
    s_add_u32 s24, s38, 20736
    s_add_u32 m0, s39, 12288
    s_nop 0
    buffer_load_dwordx4 v8, s[8:11], s24 offen sc1 lds
    s_waitcnt lgkmcnt(4)
    v_mfma_f32_32x32x16_bf16 v[80:95], a[60:63], v[52:55], v[80:95]
    ds_read_b128 v[40:43], v20 offset:16384
    s_waitcnt lgkmcnt(4)
    v_mfma_f32_32x32x16_bf16 v[80:95], a[64:67], v[24:27], v[80:95]
    ds_read_b128 v[44:47], v21 offset:16384
    s_add_u32 s24, s38, 512
    s_add_u32 m0, s39, 16384
    s_nop 0
    buffer_load_dwordx4 v8, s[8:11], s24 offen sc1 lds
    s_waitcnt lgkmcnt(4)
    v_mfma_f32_32x32x16_bf16 v[80:95], a[68:71], v[28:31], v[80:95]
    ds_read_b128 v[48:51], v22 offset:16384
    s_waitcnt lgkmcnt(4)
    v_mfma_f32_32x32x16_bf16 v[80:95], a[72:75], v[32:35], v[80:95]
    ds_read_b128 v[52:55], v23 offset:16384
    s_add_u32 s24, s38, 20992
    s_add_u32 m0, s39, 20480
    s_nop 0
    buffer_load_dwordx4 v8, s[8:11], s24 offen sc1 lds
    s_waitcnt lgkmcnt(4)
    v_mfma_f32_32x32x16_bf16 v[80:95], a[76:79], v[36:39], v[80:95]
    ds_read_b128 v[24:27], v16 offset:24576
    s_waitcnt lgkmcnt(4)
    v_mfma_f32_32x32x16_bf16 v[80:95], a[80:83], v[40:43], v[80:95]
    ds_read_b128 v[28:31], v17 offset:24576
    s_add_u32 s24, s38, 768
    s_add_u32 m0, s39, 24576
    s_nop 0
    buffer_load_dwordx4 v8, s[8:11], s24 offen sc1 lds
    s_waitcnt lgkmcnt(4)
    v_mfma_f32_32x32x16_bf16 v[80:95], a[84:87], v[44:47], v[80:95]
    ds_read_b128 v[32:35], v18 offset:24576
    s_waitcnt lgkmcnt(4)
    v_mfma_f32_32x32x16_bf16 v[80:95], a[88:91], v[48:51], v[80:95]
    ds_read_b128 v[36:39], v19 offset:24576
    s_add_u32 s24, s38, 21248
    s_add_u32 m0, s39, 28672
    s_nop 0
    buffer_load_dwordx4 v8, s[8:11], s24 offen sc1 lds
    s_waitcnt lgkmcnt(4)
    v_mfma_f32_32x32x16_bf16 v[80:95], a[92:95], v[52:55], v[80:95]
    ds_read_b128 v[40:43], v20 offset:24576
    s_waitcnt lgkmcnt(4)
    v_mfma_f32_32x32x16_bf16 v[80:95], a[96:99], v[24:27], v[80:95]
    ds_read_b128 v[44:47], v21 offset:24576
    s_add_u32 s24, s38, 1024
    s_add_u32 m0, s39, 32768
    s_nop 0
    buffer_load_dwordx4 v8, s[8:11], s24 offen sc1 lds
    s_waitcnt lgkmcnt(4)
    v_mfma_f32_32x32x16_bf16 v[80:95], a[100:103], v[28:31], v[80:95]
    ds_read_b128 v[48:51], v22 offset:24576
    s_waitcnt lgkmcnt(4)
    v_mfma_f32_32x32x16_bf16 v[80:95], a[104:107], v[32:35], v[80:95]
    ds_read_b128 v[52:55], v23 offset:24576
    s_add_u32 s24, s38, 21504
    s_add_u32 m0, s39, 36864
    s_nop 0
    buffer_load_dwordx4 v8, s[8:11], s24 offen sc1 lds
    s_waitcnt lgkmcnt(4)
    v_mfma_f32_32x32x16_bf16 v[80:95], a[108:111], v[36:39], v[80:95]
    ds_read_b128 v[24:27], v16 offset:32768
    s_waitcnt lgkmcnt(4)
    v_mfma_f32_32x32x16_bf16 v[80:95], a[112:115], v[40:43], v[80:95]
    ds_read_b128 v[28:31], v17 offset:32768
    v_add_u32 v16, -81920, v16
    s_waitcnt lgkmcnt(4)
    v_mfma_f32_32x32x16_bf16 v[80:95], a[116:119], v[44:47], v[80:95]
    ds_read_b128 v[32:35], v18 offset:32768
    v_add_u32 v17, -81920, v17
    s_waitcnt lgkmcnt(4)
    v_mfma_f32_32x32x16_bf16 v[80:95], a[120:123], v[48:51], v[80:95]
    ds_read_b128 v[36:39], v19 offset:32768
    v_add_u32 v18, -81920, v18
    s_add_u32 s38, s38, 81920
    s_max_u32 s20, s28, 1
    s_sub_u32 s20, s20, 1
    s_waitcnt lgkmcnt(4)
    v_mfma_f32_32x32x16_bf16 v[80:95], a[124:127], v[52:55], v[80:95]
    ds_read_b128 v[40:43], v20 offset:32768
    v_add_u32 v19, -81920, v19
    v_mov_b32 v106, s20
    s_add_u32 s28, s28, 1
    s_waitcnt lgkmcnt(4)
    v_mfma_f32_32x32x16_bf16 v[80:95], a[128:131], v[24:27], v[80:95]
    ds_read_b128 v[44:47], v21 offset:32768
    v_add_u32 v20, -81920, v20
    s_waitcnt lgkmcnt(4)
    v_mfma_f32_32x32x16_bf16 v[80:95], a[132:135], v[28:31], v[80:95]
    ds_read_b128 v[48:51], v22 offset:32768
    v_add_u32 v21, -81920, v21
    s_waitcnt lgkmcnt(4)
    v_mfma_f32_32x32x16_bf16 v[80:95], a[136:139], v[32:35], v[80:95]
    ds_read_b128 v[52:55], v23 offset:32768
    v_add_u32 v22, -81920, v22
    s_waitcnt lgkmcnt(4)
    v_mfma_f32_32x32x16_bf16 v[80:95], a[140:143], v[36:39], v[80:95]
    v_add_u32 v23, -81920, v23
    s_waitcnt vmcnt(12) lgkmcnt(0)
    s_barrier
    ds_read_b128 v[24:27], v16 offset:0
    s_mov_b64 exec, s[46:47]
    buffer_store_dword v106, v105, s[8:11], s36 offen sc1
    s_mov_b64 exec, -1
    v_mfma_f32_32x32x16_bf16 v[80:95], a[144:147], v[40:43], v[80:95]
    ds_read_b128 v[28:31], v17 offset:0
    v_mfma_f32_32x32x16_bf16 v[80:95], a[148:151], v[44:47], v[80:95]
    ds_read_b128 v[32:35], v18 offset:0
    v_mfma_f32_32x32x16_bf16 v[80:95], a[152:155], v[48:51], v[80:95]
    ds_read_b128 v[36:39], v19 offset:0
    v_mfma_f32_32x32x16_bf16 v[80:95], a[156:159], v[52:55], v[80:95]
    ds_read_b128 v[40:43], v20 offset:0
    s_cmp_eq_u32 s28, 32
    s_cbranch_scc1 P_end_15
    s_branch P_top_16
P_v_14:
P_top_17:
    s_waitcnt lgkmcnt(4)
    v_mfma_f32_32x32x16_bf16 v[64:79], v[24:27], a[0:3], 0
    ds_read_b128 v[44:47], v21 offset:0
    s_min_u32 s20, s28, 1
    s_lshl_b32 s20, s20, 19
    s_add_u32 s39, s30, 81920
    s_waitcnt lgkmcnt(4)
    v_mfma_f32_32x32x16_bf16 v[64:79], v[28:31], a[4:7], v[64:79]
    ds_read_b128 v[48:51], v22 offset:0
    s_waitcnt lgkmcnt(4)
    v_mfma_f32_32x32x16_bf16 v[64:79], v[32:35], a[8:11], v[64:79]
    ds_read_b128 v[52:55], v23 offset:0
    v_cvt_pk_bf16_f32 v96, v80, v81
    v_cvt_pk_bf16_f32 v97, v82, v83
    s_waitcnt lgkmcnt(4)
    v_mfma_f32_32x32x16_bf16 v[64:79], v[36:39], a[12:15], v[64:79]
    ds_read_b128 v[24:27], v16 offset:8192
    v_cvt_pk_bf16_f32 v98, v88, v89
    v_cvt_pk_bf16_f32 v99, v90, v91
    s_waitcnt lgkmcnt(4)
    v_mfma_f32_32x32x16_bf16 v[64:79], v[40:43], a[16:19], v[64:79]
    ds_read_b128 v[28:31], v17 offset:8192
    v_cvt_pk_bf16_f32 v100, v84, v85
    v_cvt_pk_bf16_f32 v101, v86, v87
    s_waitcnt lgkmcnt(4)
    v_mfma_f32_32x32x16_bf16 v[64:79], v[44:47], a[20:23], v[64:79]
    ds_read_b128 v[32:35], v18 offset:8192
    v_cvt_pk_bf16_f32 v102, v92, v93
    v_cvt_pk_bf16_f32 v103, v94, v95
    s_waitcnt lgkmcnt(4)
    v_mfma_f32_32x32x16_bf16 v[64:79], v[48:51], a[24:27], v[64:79]
    ds_read_b128 v[36:39], v19 offset:8192
    buffer_store_dwordx4 v[96:99], v104, s[8:11], s40 offen offset:0 sc1
    s_waitcnt lgkmcnt(4)
    v_mfma_f32_32x32x16_bf16 v[64:79], v[52:55], a[28:31], v[64:79]
    ds_read_b128 v[40:43], v20 offset:8192
    buffer_store_dwordx4 v[100:103], v104, s[8:11], s40 offen offset:512 sc1
    s_waitcnt lgkmcnt(4)
    v_mfma_f32_32x32x16_bf16 v[64:79], v[24:27], a[32:35], v[64:79]
    ds_read_b128 v[44:47], v21 offset:8192
    s_add_u32 s40, s40, s20
    s_add_u32 s24, s38, 0
    s_add_u32 m0, s39, 0
    s_nop 0
    buffer_load_dwordx4 v8, s[8:11], s24 offen sc1 lds
    s_waitcnt lgkmcnt(4)
    v_mfma_f32_32x32x16_bf16 v[64:79], v[28:31], a[36:39], v[64:79]
    ds_read_b128 v[48:51], v22 offset:8192
    s_waitcnt lgkmcnt(4)
    v_mfma_f32_32x32x16_bf16 v[64:79], v[32:35], a[40:43], v[64:79]
    ds_read_b128 v[52:55], v23 offset:8192
    s_add_u32 s24, s38, 20480
    s_add_u32 m0, s39, 4096
    s_nop 0
    buffer_load_dwordx4 v8, s[8:11], s24 offen sc1 lds
    s_waitcnt lgkmcnt(4)
    v_mfma_f32_32x32x16_bf16 v[64:79], v[36:39], a[44:47], v[64:79]
    ds_read_b128 v[24:27], v16 offset:16384
    s_waitcnt lgkmcnt(4)
    v_mfma_f32_32x32x16_bf16 v[64:79], v[40:43], a[48:51], v[64:79]
    ds_read_b128 v[28:31], v17 offset:16384
    s_add_u32 s24, s38, 256
    s_add_u32 m0, s39, 8192
    s_nop 0
    buffer_load_dwordx4 v8, s[8:11], s24 offen sc1 lds
    s_waitcnt lgkmcnt(4)
    v_mfma_f32_32x32x16_bf16 v[64:79], v[44:47], a[52:55], v[64:79]
    ds_read_b128 v[32:35], v18 offset:16384
    s_waitcnt lgkmcnt(4)
    v_mfma_f32_32x32x16_bf16 v[64:79], v[48:51], a[56:59], v[64:79]
    ds_read_b128 v[36:39], v19 offset:16384
    s_add_u32 s24, s38, 20736
    s_add_u32 m0, s39, 12288
    s_nop 0
    buffer_load_dwordx4 v8, s[8:11], s24 offen sc1 lds
    s_waitcnt lgkmcnt(4)
    v_mfma_f32_32x32x16_bf16 v[64:79], v[52:55], a[60:63], v[64:79]
    ds_read_b128 v[40:43], v20 offset:16384
    s_waitcnt lgkmcnt(4)
    v_mfma_f32_32x32x16_bf16 v[64:79], v[24:27], a[64:67], v[64:79]
    ds_read_b128 v[44:47], v21 offset:16384
    s_add_u32 s24, s38, 512
    s_add_u32 m0, s39, 16384
    s_nop 0
    buffer_load_dwordx4 v8, s[8:11], s24 offen sc1 lds
    s_waitcnt lgkmcnt(4)
    v_mfma_f32_32x32x16_bf16 v[64:79], v[28:31], a[68:71], v[64:79]
    ds_read_b128 v[48:51], v22 offset:16384
    s_waitcnt lgkmcnt(4)
    v_mfma_f32_32x32x16_bf16 v[64:79], v[32:35], a[72:75], v[64:79]
    ds_read_b128 v[52:55], v23 offset:16384
    s_add_u32 s24, s38, 20992
    s_add_u32 m0, s39, 20480
    s_nop 0
    buffer_load_dwordx4 v8, s[8:11], s24 offen sc1 lds
    s_waitcnt lgkmcnt(4)
    v_mfma_f32_32x32x16_bf16 v[64:79], v[36:39], a[76:79], v[64:79]
    ds_read_b128 v[24:27], v16 offset:24576
    s_waitcnt lgkmcnt(4)
    v_mfma_f32_32x32x16_bf16 v[64:79], v[40:43], a[80:83], v[64:79]
    ds_read_b128 v[28:31], v17 offset:24576
    s_add_u32 s24, s38, 768
    s_add_u32 m0, s39, 24576
    s_nop 0
    buffer_load_dwordx4 v8, s[8:11], s24 offen sc1 lds
    s_waitcnt lgkmcnt(4)
    v_mfma_f32_32x32x16_bf16 v[64:79], v[44:47], a[84:87], v[64:79]
    ds_read_b128 v[32:35], v18 offset:24576
    s_waitcnt lgkmcnt(4)
    v_mfma_f32_32x32x16_bf16 v[64:79], v[48:51], a[88:91], v[64:79]
    ds_read_b128 v[36:39], v19 offset:24576
    s_add_u32 s24, s38, 21248
    s_add_u32 m0, s39, 28672
    s_nop 0
    buffer_load_dwordx4 v8, s[8:11], s24 offen sc1 lds
    s_waitcnt lgkmcnt(4)
    v_mfma_f32_32x32x16_bf16 v[64:79], v[52:55], a[92:95], v[64:79]
    ds_read_b128 v[40:43], v20 offset:24576
    s_waitcnt lgkmcnt(4)
    v_mfma_f32_32x32x16_bf16 v[64:79], v[24:27], a[96:99], v[64:79]
    ds_read_b128 v[44:47], v21 offset:24576
    s_add_u32 s24, s38, 1024
    s_add_u32 m0, s39, 32768
    s_nop 0
    buffer_load_dwordx4 v8, s[8:11], s24 offen sc1 lds
    s_waitcnt lgkmcnt(4)
    v_mfma_f32_32x32x16_bf16 v[64:79], v[28:31], a[100:103], v[64:79]
    ds_read_b128 v[48:51], v22 offset:24576
    s_waitcnt lgkmcnt(4)
    v_mfma_f32_32x32x16_bf16 v[64:79], v[32:35], a[104:107], v[64:79]
    ds_read_b128 v[52:55], v23 offset:24576
    s_add_u32 s24, s38, 21504
    s_add_u32 m0, s39, 36864
    s_nop 0
    buffer_load_dwordx4 v8, s[8:11], s24 offen sc1 lds
    s_waitcnt lgkmcnt(4)
    v_mfma_f32_32x32x16_bf16 v[64:79], v[36:39], a[108:111], v[64:79]
    ds_read_b128 v[24:27], v16 offset:32768
    s_waitcnt lgkmcnt(4)
    v_mfma_f32_32x32x16_bf16 v[64:79], v[40:43], a[112:115], v[64:79]
    ds_read_b128 v[28:31], v17 offset:32768
    v_add_u32 v16, 40960, v16
    s_waitcnt lgkmcnt(4)
    v_mfma_f32_32x32x16_bf16 v[64:79], v[44:47], a[116:119], v[64:79]
    ds_read_b128 v[32:35], v18 offset:32768
    v_add_u32 v17, 40960, v17
    s_waitcnt lgkmcnt(4)
    v_mfma_f32_32x32x16_bf16 v[64:79], v[48:51], a[120:123], v[64:79]
    ds_read_b128 v[36:39], v19 offset:32768
    v_add_u32 v18, 40960, v18
    s_add_u32 s38, s38, 81920
    s_max_u32 s20, s28, 1
    s_sub_u32 s20, s20, 1
    s_waitcnt lgkmcnt(4)
    v_mfma_f32_32x32x16_bf16 v[64:79], v[52:55], a[124:127], v[64:79]
    ds_read_b128 v[40:43], v20 offset:32768
    v_add_u32 v19, 40960, v19
    v_mov_b32 v106, s20
    s_add_u32 s28, s28, 1
    s_waitcnt lgkmcnt(4)
    v_mfma_f32_32x32x16_bf16 v[64:79], v[24:27], a[128:131], v[64:79]
    ds_read_b128 v[44:47], v21 offset:32768
    v_add_u32 v20, 40960, v20
    s_waitcnt lgkmcnt(4)
    v_mfma_f32_32x32x16_bf16 v[64:79], v[28:31], a[132:135], v[64:79]
    ds_read_b128 v[48:51], v22 offset:32768
    v_add_u32 v21, 40960, v21
    s_waitcnt lgkmcnt(4)
    v_mfma_f32_32x32x16_bf16 v[64:79], v[32:35], a[136:139], v[64:79]
    ds_read_b128 v[52:55], v23 offset:32768
    v_add_u32 v22, 40960, v22
    s_waitcnt lgkmcnt(4)
    v_mfma_f32_32x32x16_bf16 v[64:79], v[36:39], a[140:143], v[64:79]
    v_add_u32 v23, 40960, v23
    s_waitcnt vmcnt(12) lgkmcnt(0)
    s_barrier
    ds_read_b128 v[24:27], v16 offset:0
    s_mov_b64 exec, s[46:47]
    buffer_store_dword v106, v105, s[8:11], s36 offen sc1
    s_mov_b64 exec, -1
    v_mfma_f32_32x32x16_bf16 v[64:79], v[40:43], a[144:147], v[64:79]
    ds_read_b128 v[28:31], v17 offset:0
    v_mfma_f32_32x32x16_bf16 v[64:79], v[44:47], a[148:151], v[64:79]
    ds_read_b128 v[32:35], v18 offset:0
    v_mfma_f32_32x32x16_bf16 v[64:79], v[48:51], a[152:155], v[64:79]
    ds_read_b128 v[36:39], v19 offset:0
    v_mfma_f32_32x32x16_bf16 v[64:79], v[52:55], a[156:159], v[64:79]
    ds_read_b128 v[40:43], v20 offset:0
    s_cmp_eq_u32 s28, 32
    s_waitcnt lgkmcnt(4)
    v_mfma_f32_32x32x16_bf16 v[80:95], v[24:27], a[0:3], 0
    ds_read_b128 v[44:47], v21 offset:0
    s_min_u32 s20, s28, 1
    s_lshl_b32 s20, s20, 19
    s_add_u32 s39, s30, 0
    s_waitcnt lgkmcnt(4)
    v_mfma_f32_32x32x16_bf16 v[80:95], v[28:31], a[4:7], v[80:95]
    ds_read_b128 v[48:51], v22 offset:0
    s_waitcnt lgkmcnt(4)
    v_mfma_f32_32x32x16_bf16 v[80:95], v[32:35], a[8:11], v[80:95]
    ds_read_b128 v[52:55], v23 offset:0
    v_cvt_pk_bf16_f32 v96, v64, v65
    v_cvt_pk_bf16_f32 v97, v66, v67
    s_waitcnt lgkmcnt(4)
    v_mfma_f32_32x32x16_bf16 v[80:95], v[36:39], a[12:15], v[80:95]
    ds_read_b128 v[24:27], v16 offset:8192
    v_cvt_pk_bf16_f32 v98, v72, v73
    v_cvt_pk_bf16_f32 v99, v74, v75
    s_waitcnt lgkmcnt(4)
    v_mfma_f32_32x32x16_bf16 v[80:95], v[40:43], a[16:19], v[80:95]
    ds_read_b128 v[28:31], v17 offset:8192
    v_cvt_pk_bf16_f32 v100, v68, v69
    v_cvt_pk_bf16_f32 v101, v70, v71
    s_waitcnt lgkmcnt(4)
    v_mfma_f32_32x32x16_bf16 v[80:95], v[44:47], a[20:23], v[80:95]
    ds_read_b128 v[32:35], v18 offset:8192
    v_cvt_pk_bf16_f32 v102, v76, v77
    v_cvt_pk_bf16_f32 v103, v78, v79
    s_waitcnt lgkmcnt(4)
    v_mfma_f32_32x32x16_bf16 v[80:95], v[48:51], a[24:27], v[80:95]
    ds_read_b128 v[36:39], v19 offset:8192
    buffer_store_dwordx4 v[96:99], v104, s[8:11], s40 offen offset:0 sc1
    s_waitcnt lgkmcnt(4)
    v_mfma_f32_32x32x16_bf16 v[80:95], v[52:55], a[28:31], v[80:95]
    ds_read_b128 v[40:43], v20 offset:8192
    buffer_store_dwordx4 v[100:103], v104, s[8:11], s40 offen offset:512 sc1
    s_waitcnt lgkmcnt(4)
    v_mfma_f32_32x32x16_bf16 v[80:95], v[24:27], a[32:35], v[80:95]
    ds_read_b128 v[44:47], v21 offset:8192
    s_add_u32 s40, s40, s20
    s_add_u32 s24, s38, 0
    s_add_u32 m0, s39, 0
    s_nop 0
    buffer_load_dwordx4 v8, s[8:11], s24 offen sc1 lds
    s_waitcnt lgkmcnt(4)
    v_mfma_f32_32x32x16_bf16 v[80:95], v[28:31], a[36:39], v[80:95]
    ds_read_b128 v[48:51], v22 offset:8192
    s_waitcnt lgkmcnt(4)
    v_mfma_f32_32x32x16_bf16 v[80:95], v[32:35], a[40:43], v[80:95]
    ds_read_b128 v[52:55], v23 offset:8192
    s_add_u32 s24, s38, 20480
    s_add_u32 m0, s39, 4096
    s_nop 0
    buffer_load_dwordx4 v8, s[8:11], s24 offen sc1 lds
    s_waitcnt lgkmcnt(4)
    v_mfma_f32_32x32x16_bf16 v[80:95], v[36:39], a[44:47], v[80:95]
    ds_read_b128 v[24:27], v16 offset:16384
    s_waitcnt lgkmcnt(4)
    v_mfma_f32_32x32x16_bf16 v[80:95], v[40:43], a[48:51], v[80:95]
    ds_read_b128 v[28:31], v17 offset:16384
    s_add_u32 s24, s38, 256
    s_add_u32 m0, s39, 8192
    s_nop 0
    buffer_load_dwordx4 v8, s[8:11], s24 offen sc1 lds
    s_waitcnt lgkmcnt(4)
    v_mfma_f32_32x32x16_bf16 v[80:95], v[44:47], a[52:55], v[80:95]
    ds_read_b128 v[32:35], v18 offset:16384
    s_waitcnt lgkmcnt(4)
    v_mfma_f32_32x32x16_bf16 v[80:95], v[48:51], a[56:59], v[80:95]
    ds_read_b128 v[36:39], v19 offset:16384
    s_add_u32 s24, s38, 20736
    s_add_u32 m0, s39, 12288
    s_nop 0
    buffer_load_dwordx4 v8, s[8:11], s24 offen sc1 lds
    s_waitcnt lgkmcnt(4)
    v_mfma_f32_32x32x16_bf16 v[80:95], v[52:55], a[60:63], v[80:95]
    ds_read_b128 v[40:43], v20 offset:16384
    s_waitcnt lgkmcnt(4)
    v_mfma_f32_32x32x16_bf16 v[80:95], v[24:27], a[64:67], v[80:95]
    ds_read_b128 v[44:47], v21 offset:16384
    s_add_u32 s24, s38, 512
    s_add_u32 m0, s39, 16384
    s_nop 0
    buffer_load_dwordx4 v8, s[8:11], s24 offen sc1 lds
    s_waitcnt lgkmcnt(4)
    v_mfma_f32_32x32x16_bf16 v[80:95], v[28:31], a[68:71], v[80:95]
    ds_read_b128 v[48:51], v22 offset:16384
    s_waitcnt lgkmcnt(4)
    v_mfma_f32_32x32x16_bf16 v[80:95], v[32:35], a[72:75], v[80:95]
    ds_read_b128 v[52:55], v23 offset:16384
    s_add_u32 s24, s38, 20992
    s_add_u32 m0, s39, 20480
    s_nop 0
    buffer_load_dwordx4 v8, s[8:11], s24 offen sc1 lds
    s_waitcnt lgkmcnt(4)
    v_mfma_f32_32x32x16_bf16 v[80:95], v[36:39], a[76:79], v[80:95]
    ds_read_b128 v[24:27], v16 offset:24576
    s_waitcnt lgkmcnt(4)
    v_mfma_f32_32x32x16_bf16 v[80:95], v[40:43], a[80:83], v[80:95]
    ds_read_b128 v[28:31], v17 offset:24576
    s_add_u32 s24, s38, 768
    s_add_u32 m0, s39, 24576
    s_nop 0
    buffer_load_dwordx4 v8, s[8:11], s24 offen sc1 lds
    s_waitcnt lgkmcnt(4)
    v_mfma_f32_32x32x16_bf16 v[80:95], v[44:47], a[84:87], v[80:95]
    ds_read_b128 v[32:35], v18 offset:24576
    s_waitcnt lgkmcnt(4)
    v_mfma_f32_32x32x16_bf16 v[80:95], v[48:51], a[88:91], v[80:95]
    ds_read_b128 v[36:39], v19 offset:24576
    s_add_u32 s24, s38, 21248
    s_add_u32 m0, s39, 28672
    s_nop 0
    buffer_load_dwordx4 v8, s[8:11], s24 offen sc1 lds
    s_waitcnt lgkmcnt(4)
    v_mfma_f32_32x32x16_bf16 v[80:95], v[52:55], a[92:95], v[80:95]
    ds_read_b128 v[40:43], v20 offset:24576
    s_waitcnt lgkmcnt(4)
    v_mfma_f32_32x32x16_bf16 v[80:95], v[24:27], a[96:99], v[80:95]
    ds_read_b128 v[44:47], v21 offset:24576
    s_add_u32 s24, s38, 1024
    s_add_u32 m0, s39, 32768
    s_nop 0
    buffer_load_dwordx4 v8, s[8:11], s24 offen sc1 lds
    s_waitcnt lgkmcnt(4)
    v_mfma_f32_32x32x16_bf16 v[80:95], v[28:31], a[100:103], v[80:95]
    ds_read_b128 v[48:51], v22 offset:24576
    s_waitcnt lgkmcnt(4)
    v_mfma_f32_32x32x16_bf16 v[80:95], v[32:35], a[104:107], v[80:95]
    ds_read_b128 v[52:55], v23 offset:24576
    s_add_u32 s24, s38, 21504
    s_add_u32 m0, s39, 36864
    s_nop 0
    buffer_load_dwordx4 v8, s[8:11], s24 offen sc1 lds
    s_waitcnt lgkmcnt(4)
    v_mfma_f32_32x32x16_bf16 v[80:95], v[36:39], a[108:111], v[80:95]
    ds_read_b128 v[24:27], v16 offset:32768
    s_waitcnt lgkmcnt(4)
    v_mfma_f32_32x32x16_bf16 v[80:95], v[40:43], a[112:115], v[80:95]
    ds_read_b128 v[28:31], v17 offset:32768
    v_add_u32 v16, 40960, v16
    s_waitcnt lgkmcnt(4)
    v_mfma_f32_32x32x16_bf16 v[80:95], v[44:47], a[116:119], v[80:95]
    ds_read_b128 v[32:35], v18 offset:32768
    v_add_u32 v17, 40960, v17
    s_waitcnt lgkmcnt(4)
    v_mfma_f32_32x32x16_bf16 v[80:95], v[48:51], a[120:123], v[80:95]
    ds_read_b128 v[36:39], v19 offset:32768
    v_add_u32 v18, 40960, v18
    s_add_u32 s38, s38, 81920
    s_max_u32 s20, s28, 1
    s_sub_u32 s20, s20, 1
    s_waitcnt lgkmcnt(4)
    v_mfma_f32_32x32x16_bf16 v[80:95], v[52:55], a[124:127], v[80:95]
    ds_read_b128 v[40:43], v20 offset:32768
    v_add_u32 v19, 40960, v19
    v_mov_b32 v106, s20
    s_add_u32 s28, s28, 1
    s_waitcnt lgkmcnt(4)
    v_mfma_f32_32x32x16_bf16 v[80:95], v[24:27], a[128:131], v[80:95]
    ds_read_b128 v[44:47], v21 offset:32768
    v_add_u32 v20, 40960, v20
    s_waitcnt lgkmcnt(4)
    v_mfma_f32_32x32x16_bf16 v[80:95], v[28:31], a[132:135], v[80:95]
    ds_read_b128 v[48:51], v22 offset:32768
    v_add_u32 v21, 40960, v21
    s_waitcnt lgkmcnt(4)
    v_mfma_f32_32x32x16_bf16 v[80:95], v[32:35], a[136:139], v[80:95]
    ds_read_b128 v[52:55], v23 offset:32768
    v_add_u32 v22, 40960, v22
    s_waitcnt lgkmcnt(4)
    v_mfma_f32_32x32x16_bf16 v[80:95], v[36:39], a[140:143], v[80:95]
    v_add_u32 v23, 40960, v23
    s_waitcnt vmcnt(12) lgkmcnt(0)
    s_barrier
    ds_read_b128 v[24:27], v16 offset:0
    s_mov_b64 exec, s[46:47]
    buffer_store_dword v106, v105, s[8:11], s36 offen sc1
    s_mov_b64 exec, -1
    v_mfma_f32_32x32x16_bf16 v[80:95], v[40:43], a[144:147], v[80:95]
    ds_read_b128 v[28:31], v17 offset:0
    v_mfma_f32_32x32x16_bf16 v[80:95], v[44:47], a[148:151], v[80:95]
    ds_read_b128 v[32:35], v18 offset:0
    v_mfma_f32_32x32x16_bf16 v[80:95], v[48:51], a[152:155], v[80:95]
    ds_read_b128 v[36:39], v19 offset:0
    v_mfma_f32_32x32x16_bf16 v[80:95], v[52:55], a[156:159], v[80:95]
    ds_read_b128 v[40:43], v20 offset:0
    s_cmp_eq_u32 s28, 32
    s_cbranch_scc1 P_end_15
    s_waitcnt lgkmcnt(4)
    v_mfma_f32_32x32x16_bf16 v[64:79], v[24:27], a[0:3], 0
    ds_read_b128 v[44:47], v21 offset:0
    s_min_u32 s20, s28, 1
    s_lshl_b32 s20, s20, 19
    s_add_u32 s39, s30, 40960
    s_waitcnt lgkmcnt(4)
    v_mfma_f32_32x32x16_bf16 v[64:79], v[28:31], a[4:7], v[64:79]
    ds_read_b128 v[48:51], v22 offset:0
    s_waitcnt lgkmcnt(4)
    v_mfma_f32_32x32x16_bf16 v[64:79], v[32:35], a[8:11], v[64:79]
    ds_read_b128 v[52:55], v23 offset:0
    v_cvt_pk_bf16_f32 v96, v80, v81
    v_cvt_pk_bf16_f32 v97, v82, v83
    s_waitcnt lgkmcnt(4)
    v_mfma_f32_32x32x16_bf16 v[64:79], v[36:39], a[12:15], v[64:79]
    ds_read_b128 v[24:27], v16 offset:8192
    v_cvt_pk_bf16_f32 v98, v88, v89
    v_cvt_pk_bf16_f32 v99, v90, v91
    s_waitcnt lgkmcnt(4)
    v_mfma_f32_32x32x16_bf16 v[64:79], v[40:43], a[16:19], v[64:79]
    ds_read_b128 v[28:31], v17 offset:8192
    v_cvt_pk_bf16_f32 v100, v84, v85
    v_cvt_pk_bf16_f32 v101, v86, v87
    s_waitcnt lgkmcnt(4)
    v_mfma_f32_32x32x16_bf16 v[64:79], v[44:47], a[20:23], v[64:79]
    ds_read_b128 v[32:35], v18 offset:8192
    v_cvt_pk_bf16_f32 v102, v92, v93
    v_cvt_pk_bf16_f32 v103, v94, v95
    s_waitcnt lgkmcnt(4)
    v_mfma_f32_32x32x16_bf16 v[64:79], v[48:51], a[24:27], v[64:79]
    ds_read_b128 v[36:39], v19 offset:8192
    buffer_store_dwordx4 v[96:99], v104, s[8:11], s40 offen offset:0 sc1
    s_waitcnt lgkmcnt(4)
    v_mfma_f32_32x32x16_bf16 v[64:79], v[52:55], a[28:31], v[64:79]
    ds_read_b128 v[40:43], v20 offset:8192
    buffer_store_dwordx4 v[100:103], v104, s[8:11], s40 offen offset:512 sc1
    s_waitcnt lgkmcnt(4)
    v_mfma_f32_32x32x16_bf16 v[64:79], v[24:27], a[32:35], v[64:79]
    ds_read_b128 v[44:47], v21 offset:8192
    s_add_u32 s40, s40, s20
    s_add_u32 s24, s38, 0
    s_add_u32 m0, s39, 0
    s_nop 0
    buffer_load_dwordx4 v8, s[8:11], s24 offen sc1 lds
    s_waitcnt lgkmcnt(4)
    v_mfma_f32_32x32x16_bf16 v[64:79], v[28:31], a[36:39], v[64:79]
    ds_read_b128 v[48:51], v22 offset:8192
    s_waitcnt lgkmcnt(4)
    v_mfma_f32_32x32x16_bf16 v[64:79], v[32:35], a[40:43], v[64:79]
    ds_read_b128 v[52:55], v23 offset:8192
    s_add_u32 s24, s38, 20480
    s_add_u32 m0, s39, 4096
    s_nop 0
    buffer_load_dwordx4 v8, s[8:11], s24 offen sc1 lds
    s_waitcnt lgkmcnt(4)
    v_mfma_f32_32x32x16_bf16 v[64:79], v[36:39], a[44:47], v[64:79]
    ds_read_b128 v[24:27], v16 offset:16384
    s_waitcnt lgkmcnt(4)
    v_mfma_f32_32x32x16_bf16 v[64:79], v[40:43], a[48:51], v[64:79]
    ds_read_b128 v[28:31], v17 offset:16384
    s_add_u32 s24, s38, 256
    s_add_u32 m0, s39, 8192
    s_nop 0
    buffer_load_dwordx4 v8, s[8:11], s24 offen sc1 lds
    s_waitcnt lgkmcnt(4)
    v_mfma_f32_32x32x16_bf16 v[64:79], v[44:47], a[52:55], v[64:79]
    ds_read_b128 v[32:35], v18 offset:16384
    s_waitcnt lgkmcnt(4)
    v_mfma_f32_32x32x16_bf16 v[64:79], v[48:51], a[56:59], v[64:79]
    ds_read_b128 v[36:39], v19 offset:16384
    s_add_u32 s24, s38, 20736
    s_add_u32 m0, s39, 12288
    s_nop 0
    buffer_load_dwordx4 v8, s[8:11], s24 offen sc1 lds
    s_waitcnt lgkmcnt(4)
    v_mfma_f32_32x32x16_bf16 v[64:79], v[52:55], a[60:63], v[64:79]
    ds_read_b128 v[40:43], v20 offset:16384
    s_waitcnt lgkmcnt(4)
    v_mfma_f32_32x32x16_bf16 v[64:79], v[24:27], a[64:67], v[64:79]
    ds_read_b128 v[44:47], v21 offset:16384
    s_add_u32 s24, s38, 512
    s_add_u32 m0, s39, 16384
    s_nop 0
    buffer_load_dwordx4 v8, s[8:11], s24 offen sc1 lds
    s_waitcnt lgkmcnt(4)
    v_mfma_f32_32x32x16_bf16 v[64:79], v[28:31], a[68:71], v[64:79]
    ds_read_b128 v[48:51], v22 offset:16384
    s_waitcnt lgkmcnt(4)
    v_mfma_f32_32x32x16_bf16 v[64:79], v[32:35], a[72:75], v[64:79]
    ds_read_b128 v[52:55], v23 offset:16384
    s_add_u32 s24, s38, 20992
    s_add_u32 m0, s39, 20480
    s_nop 0
    buffer_load_dwordx4 v8, s[8:11], s24 offen sc1 lds
    s_waitcnt lgkmcnt(4)
    v_mfma_f32_32x32x16_bf16 v[64:79], v[36:39], a[76:79], v[64:79]
    ds_read_b128 v[24:27], v16 offset:24576
    s_waitcnt lgkmcnt(4)
    v_mfma_f32_32x32x16_bf16 v[64:79], v[40:43], a[80:83], v[64:79]
    ds_read_b128 v[28:31], v17 offset:24576
    s_add_u32 s24, s38, 768
    s_add_u32 m0, s39, 24576
    s_nop 0
    buffer_load_dwordx4 v8, s[8:11], s24 offen sc1 lds
    s_waitcnt lgkmcnt(4)
    v_mfma_f32_32x32x16_bf16 v[64:79], v[44:47], a[84:87], v[64:79]
    ds_read_b128 v[32:35], v18 offset:24576
    s_waitcnt lgkmcnt(4)
    v_mfma_f32_32x32x16_bf16 v[64:79], v[48:51], a[88:91], v[64:79]
    ds_read_b128 v[36:39], v19 offset:24576
    s_add_u32 s24, s38, 21248
    s_add_u32 m0, s39, 28672
    s_nop 0
    buffer_load_dwordx4 v8, s[8:11], s24 offen sc1 lds
    s_waitcnt lgkmcnt(4)
    v_mfma_f32_32x32x16_bf16 v[64:79], v[52:55], a[92:95], v[64:79]
    ds_read_b128 v[40:43], v20 offset:24576
    s_waitcnt lgkmcnt(4)
    v_mfma_f32_32x32x16_bf16 v[64:79], v[24:27], a[96:99], v[64:79]
    ds_read_b128 v[44:47], v21 offset:24576
    s_add_u32 s24, s38, 1024
    s_add_u32 m0, s39, 32768
    s_nop 0
    buffer_load_dwordx4 v8, s[8:11], s24 offen sc1 lds
    s_waitcnt lgkmcnt(4)
    v_mfma_f32_32x32x16_bf16 v[64:79], v[28:31], a[100:103], v[64:79]
    ds_read_b128 v[48:51], v22 offset:24576
    s_waitcnt lgkmcnt(4)
    v_mfma_f32_32x32x16_bf16 v[64:79], v[32:35], a[104:107], v[64:79]
    ds_read_b128 v[52:55], v23 offset:24576
    s_add_u32 s24, s38, 21504
    s_add_u32 m0, s39, 36864
    s_nop 0
    buffer_load_dwordx4 v8, s[8:11], s24 offen sc1 lds
    s_waitcnt lgkmcnt(4)
    v_mfma_f32_32x32x16_bf16 v[64:79], v[36:39], a[108:111], v[64:79]
    ds_read_b128 v[24:27], v16 offset:32768
    s_waitcnt lgkmcnt(4)
    v_mfma_f32_32x32x16_bf16 v[64:79], v[40:43], a[112:115], v[64:79]
    ds_read_b128 v[28:31], v17 offset:32768
    v_add_u32 v16, -81920, v16
    s_waitcnt lgkmcnt(4)
    v_mfma_f32_32x32x16_bf16 v[64:79], v[44:47], a[116:119], v[64:79]
    ds_read_b128 v[32:35], v18 offset:32768
    v_add_u32 v17, -81920, v17
    s_waitcnt lgkmcnt(4)
    v_mfma_f32_32x32x16_bf16 v[64:79], v[48:51], a[120:123], v[64:79]
    ds_read_b128 v[36:39], v19 offset:32768
    v_add_u32 v18, -81920, v18
    s_add_u32 s38, s38, 81920
    s_max_u32 s20, s28, 1
    s_sub_u32 s20, s20, 1
    s_waitcnt lgkmcnt(4)
    v_mfma_f32_32x32x16_bf16 v[64:79], v[52:55], a[124:127], v[64:79]
    ds_read_b128 v[40:43], v20 offset:32768
    v_add_u32 v19, -81920, v19
    v_mov_b32 v106, s20
    s_add_u32 s28, s28, 1
    s_waitcnt lgkmcnt(4)
    v_mfma_f32_32x32x16_bf16 v[64:79], v[24:27], a[128:131], v[64:79]
    ds_read_b128 v[44:47], v21 offset:32768
    v_add_u32 v20, -81920, v20
    s_waitcnt lgkmcnt(4)
    v_mfma_f32_32x32x16_bf16 v[64:79], v[28:31], a[132:135], v[64:79]
    ds_read_b128 v[48:51], v22 offset:32768
    v_add_u32 v21, -81920, v21
    s_waitcnt lgkmcnt(4)
    v_mfma_f32_32x32x16_bf16 v[64:79], v[32:35], a[136:139], v[64:79]
    ds_read_b128 v[52:55], v23 offset:32768
    v_add_u32 v22, -81920, v22
    s_waitcnt lgkmcnt(4)
    v_mfma_f32_32x32x16_bf16 v[64:79], v[36:39], a[140:143], v[64:79]
    v_add_u32 v23, -81920, v23
    s_waitcnt vmcnt(12) lgkmcnt(0)
    s_barrier
    ds_read_b128 v[24:27], v16 offset:0
    s_mov_b64 exec, s[46:47]
    buffer_store_dword v106, v105, s[8:11], s36 offen sc1
    s_mov_b64 exec, -1
    v_mfma_f32_32x32x16_bf16 v[64:79], v[40:43], a[144:147], v[64:79]
    ds_read_b128 v[28:31], v17 offset:0
    v_mfma_f32_32x32x16_bf16 v[64:79], v[44:47], a[148:151], v[64:79]
    ds_read_b128 v[32:35], v18 offset:0
    v_mfma_f32_32x32x16_bf16 v[64:79], v[48:51], a[152:155], v[64:79]
    ds_read_b128 v[36:39], v19 offset:0
    v_mfma_f32_32x32x16_bf16 v[64:79], v[52:55], a[156:159], v[64:79]
    ds_read_b128 v[40:43], v20 offset:0
    s_cmp_eq_u32 s28, 32
    s_waitcnt lgkmcnt(4)
    v_mfma_f32_32x32x16_bf16 v[80:95], v[24:27], a[0:3], 0
    ds_read_b128 v[44:47], v21 offset:0
    s_min_u32 s20, s28, 1
    s_lshl_b32 s20, s20, 19
    s_add_u32 s39, s30, 81920
    s_waitcnt lgkmcnt(4)
    v_mfma_f32_32x32x16_bf16 v[80:95], v[28:31], a[4:7], v[80:95]
    ds_read_b128 v[48:51], v22 offset:0
    s_waitcnt lgkmcnt(4)
    v_mfma_f32_32x32x16_bf16 v[80:95], v[32:35], a[8:11], v[80:95]
    ds_read_b128 v[52:55], v23 offset:0
    v_cvt_pk_bf16_f32 v96, v64, v65
    v_cvt_pk_bf16_f32 v97, v66, v67
    s_waitcnt lgkmcnt(4)
    v_mfma_f32_32x32x16_bf16 v[80:95], v[36:39], a[12:15], v[80:95]
    ds_read_b128 v[24:27], v16 offset:8192
    v_cvt_pk_bf16_f32 v98, v72, v73
    v_cvt_pk_bf16_f32 v99, v74, v75
    s_waitcnt lgkmcnt(4)
    v_mfma_f32_32x32x16_bf16 v[80:95], v[40:43], a[16:19], v[80:95]
    ds_read_b128 v[28:31], v17 offset:8192
    v_cvt_pk_bf16_f32 v100, v68, v69
    v_cvt_pk_bf16_f32 v101, v70, v71
    s_waitcnt lgkmcnt(4)
    v_mfma_f32_32x32x16_bf16 v[80:95], v[44:47], a[20:23], v[80:95]
    ds_read_b128 v[32:35], v18 offset:8192
    v_cvt_pk_bf16_f32 v102, v76, v77
    v_cvt_pk_bf16_f32 v103, v78, v79
    s_waitcnt lgkmcnt(4)
    v_mfma_f32_32x32x16_bf16 v[80:95], v[48:51], a[24:27], v[80:95]
    ds_read_b128 v[36:39], v19 offset:8192
    buffer_store_dwordx4 v[96:99], v104, s[8:11], s40 offen offset:0 sc1
    s_waitcnt lgkmcnt(4)
    v_mfma_f32_32x32x16_bf16 v[80:95], v[52:55], a[28:31], v[80:95]
    ds_read_b128 v[40:43], v20 offset:8192
    buffer_store_dwordx4 v[100:103], v104, s[8:11], s40 offen offset:512 sc1
    s_waitcnt lgkmcnt(4)
    v_mfma_f32_32x32x16_bf16 v[80:95], v[24:27], a[32:35], v[80:95]
    ds_read_b128 v[44:47], v21 offset:8192
    s_add_u32 s40, s40, s20
    s_add_u32 s24, s38, 0
    s_add_u32 m0, s39, 0
    s_nop 0
    buffer_load_dwordx4 v8, s[8:11], s24 offen sc1 lds
    s_waitcnt lgkmcnt(4)
    v_mfma_f32_32x32x16_bf16 v[80:95], v[28:31], a[36:39], v[80:95]
    ds_read_b128 v[48:51], v22 offset:8192
    s_waitcnt lgkmcnt(4)
    v_mfma_f32_32x32x16_bf16 v[80:95], v[32:35], a[40:43], v[80:95]
    ds_read_b128 v[52:55], v23 offset:8192
    s_add_u32 s24, s38, 20480
    s_add_u32 m0, s39, 4096
    s_nop 0
    buffer_load_dwordx4 v8, s[8:11], s24 offen sc1 lds
    s_waitcnt lgkmcnt(4)
    v_mfma_f32_32x32x16_bf16 v[80:95], v[36:39], a[44:47], v[80:95]
    ds_read_b128 v[24:27], v16 offset:16384
    s_waitcnt lgkmcnt(4)
    v_mfma_f32_32x32x16_bf16 v[80:95], v[40:43], a[48:51], v[80:95]
    ds_read_b128 v[28:31], v17 offset:16384
    s_add_u32 s24, s38, 256
    s_add_u32 m0, s39, 8192
    s_nop 0
    buffer_load_dwordx4 v8, s[8:11], s24 offen sc1 lds
    s_waitcnt lgkmcnt(4)
    v_mfma_f32_32x32x16_bf16 v[80:95], v[44:47], a[52:55], v[80:95]
    ds_read_b128 v[32:35], v18 offset:16384
    s_waitcnt lgkmcnt(4)
    v_mfma_f32_32x32x16_bf16 v[80:95], v[48:51], a[56:59], v[80:95]
    ds_read_b128 v[36:39], v19 offset:16384
    s_add_u32 s24, s38, 20736
    s_add_u32 m0, s39, 12288
    s_nop 0
    buffer_load_dwordx4 v8, s[8:11], s24 offen sc1 lds
    s_waitcnt lgkmcnt(4)
    v_mfma_f32_32x32x16_bf16 v[80:95], v[52:55], a[60:63], v[80:95]
    ds_read_b128 v[40:43], v20 offset:16384
    s_waitcnt lgkmcnt(4)
    v_mfma_f32_32x32x16_bf16 v[80:95], v[24:27], a[64:67], v[80:95]
    ds_read_b128 v[44:47], v21 offset:16384
    s_add_u32 s24, s38, 512
    s_add_u32 m0, s39, 16384
    s_nop 0
    buffer_load_dwordx4 v8, s[8:11], s24 offen sc1 lds
    s_waitcnt lgkmcnt(4)
    v_mfma_f32_32x32x16_bf16 v[80:95], v[28:31], a[68:71], v[80:95]
    ds_read_b128 v[48:51], v22 offset:16384
    s_waitcnt lgkmcnt(4)
    v_mfma_f32_32x32x16_bf16 v[80:95], v[32:35], a[72:75], v[80:95]
    ds_read_b128 v[52:55], v23 offset:16384
    s_add_u32 s24, s38, 20992
    s_add_u32 m0, s39, 20480
    s_nop 0
    buffer_load_dwordx4 v8, s[8:11], s24 offen sc1 lds
    s_waitcnt lgkmcnt(4)
    v_mfma_f32_32x32x16_bf16 v[80:95], v[36:39], a[76:79], v[80:95]
    ds_read_b128 v[24:27], v16 offset:24576
    s_waitcnt lgkmcnt(4)
    v_mfma_f32_32x32x16_bf16 v[80:95], v[40:43], a[80:83], v[80:95]
    ds_read_b128 v[28:31], v17 offset:24576
    s_add_u32 s24, s38, 768
    s_add_u32 m0, s39, 24576
    s_nop 0
    buffer_load_dwordx4 v8, s[8:11], s24 offen sc1 lds
    s_waitcnt lgkmcnt(4)
    v_mfma_f32_32x32x16_bf16 v[80:95], v[44:47], a[84:87], v[80:95]
    ds_read_b128 v[32:35], v18 offset:24576
    s_waitcnt lgkmcnt(4)
    v_mfma_f32_32x32x16_bf16 v[80:95], v[48:51], a[88:91], v[80:95]
    ds_read_b128 v[36:39], v19 offset:24576
    s_add_u32 s24, s38, 21248
    s_add_u32 m0, s39, 28672
    s_nop 0
    buffer_load_dwordx4 v8, s[8:11], s24 offen sc1 lds
    s_waitcnt lgkmcnt(4)
    v_mfma_f32_32x32x16_bf16 v[80:95], v[52:55], a[92:95], v[80:95]
    ds_read_b128 v[40:43], v20 offset:24576
    s_waitcnt lgkmcnt(4)
    v_mfma_f32_32x32x16_bf16 v[80:95], v[24:27], a[96:99], v[80:95]
    ds_read_b128 v[44:47], v21 offset:24576
    s_add_u32 s24, s38, 1024
    s_add_u32 m0, s39, 32768
    s_nop 0
    buffer_load_dwordx4 v8, s[8:11], s24 offen sc1 lds
    s_waitcnt lgkmcnt(4)
    v_mfma_f32_32x32x16_bf16 v[80:95], v[28:31], a[100:103], v[80:95]
    ds_read_b128 v[48:51], v22 offset:24576
    s_waitcnt lgkmcnt(4)
    v_mfma_f32_32x32x16_bf16 v[80:95], v[32:35], a[104:107], v[80:95]
    ds_read_b128 v[52:55], v23 offset:24576
    s_add_u32 s24, s38, 21504
    s_add_u32 m0, s39, 36864
    s_nop 0
    buffer_load_dwordx4 v8, s[8:11], s24 offen sc1 lds
    s_waitcnt lgkmcnt(4)
    v_mfma_f32_32x32x16_bf16 v[80:95], v[36:39], a[108:111], v[80:95]
    ds_read_b128 v[24:27], v16 offset:32768
    s_waitcnt lgkmcnt(4)
    v_mfma_f32_32x32x16_bf16 v[80:95], v[40:43], a[112:115], v[80:95]
    ds_read_b128 v[28:31], v17 offset:32768
    v_add_u32 v16, 40960, v16
    s_waitcnt lgkmcnt(4)
    v_mfma_f32_32x32x16_bf16 v[80:95], v[44:47], a[116:119], v[80:95]
    ds_read_b128 v[32:35], v18 offset:32768
    v_add_u32 v17, 40960, v17
    s_waitcnt lgkmcnt(4)
    v_mfma_f32_32x32x16_bf16 v[80:95], v[48:51], a[120:123], v[80:95]
    ds_read_b128 v[36:39], v19 offset:32768
    v_add_u32 v18, 40960, v18
    s_add_u32 s38, s38, 81920
    s_max_u32 s20, s28, 1
    s_sub_u32 s20, s20, 1
    s_waitcnt lgkmcnt(4)
    v_mfma_f32_32x32x16_bf16 v[80:95], v[52:55], a[124:127], v[80:95]
    ds_read_b128 v[40:43], v20 offset:32768
    v_add_u32 v19, 40960, v19
    v_mov_b32 v106, s20
    s_add_u32 s28, s28, 1
    s_waitcnt lgkmcnt(4)
    v_mfma_f32_32x32x16_bf16 v[80:95], v[24:27], a[128:131], v[80:95]
    ds_read_b128 v[44:47], v21 offset:32768
    v_add_u32 v20, 40960, v20
    s_waitcnt lgkmcnt(4)
    v_mfma_f32_32x32x16_bf16 v[80:95], v[28:31], a[132:135], v[80:95]
    ds_read_b128 v[48:51], v22 offset:32768
    v_add_u32 v21, 40960, v21
    s_waitcnt lgkmcnt(4)
    v_mfma_f32_32x32x16_bf16 v[80:95], v[32:35], a[136:139], v[80:95]
    ds_read_b128 v[52:55], v23 offset:32768
    v_add_u32 v22, 40960, v22
    s_waitcnt lgkmcnt(4)
    v_mfma_f32_32x32x16_bf16 v[80:95], v[36:39], a[140:143], v[80:95]
    v_add_u32 v23, 40960, v23
    s_waitcnt vmcnt(12) lgkmcnt(0)
    s_barrier
    ds_read_b128 v[24:27], v16 offset:0
    s_mov_b64 exec, s[46:47]
    buffer_store_dword v106, v105, s[8:11], s36 offen sc1
    s_mov_b64 exec, -1
    v_mfma_f32_32x32x16_bf16 v[80:95], v[40:43], a[144:147], v[80:95]
    ds_read_b128 v[28:31], v17 offset:0
    v_mfma_f32_32x32x16_bf16 v[80:95], v[44:47], a[148:151], v[80:95]
    ds_read_b128 v[32:35], v18 offset:0
    v_mfma_f32_32x32x16_bf16 v[80:95], v[48:51], a[152:155], v[80:95]
    ds_read_b128 v[36:39], v19 offset:0
    v_mfma_f32_32x32x16_bf16 v[80:95], v[52:55], a[156:159], v[80:95]
    ds_read_b128 v[40:43], v20 offset:0
    s_cmp_eq_u32 s28, 32
    s_cbranch_scc1 P_end_15
    s_waitcnt lgkmcnt(4)
    v_mfma_f32_32x32x16_bf16 v[64:79], v[24:27], a[0:3], 0
    ds_read_b128 v[44:47], v21 offset:0
    s_min_u32 s20, s28, 1
    s_lshl_b32 s20, s20, 19
    s_add_u32 s39, s30, 0
    s_waitcnt lgkmcnt(4)
    v_mfma_f32_32x32x16_bf16 v[64:79], v[28:31], a[4:7], v[64:79]
    ds_read_b128 v[48:51], v22 offset:0
    s_waitcnt lgkmcnt(4)
    v_mfma_f32_32x32x16_bf16 v[64:79], v[32:35], a[8:11], v[64:79]
    ds_read_b128 v[52:55], v23 offset:0
    v_cvt_pk_bf16_f32 v96, v80, v81
    v_cvt_pk_bf16_f32 v97, v82, v83
    s_waitcnt lgkmcnt(4)
    v_mfma_f32_32x32x16_bf16 v[64:79], v[36:39], a[12:15], v[64:79]
    ds_read_b128 v[24:27], v16 offset:8192
    v_cvt_pk_bf16_f32 v98, v88, v89
    v_cvt_pk_bf16_f32 v99, v90, v91
    s_waitcnt lgkmcnt(4)
    v_mfma_f32_32x32x16_bf16 v[64:79], v[40:43], a[16:19], v[64:79]
    ds_read_b128 v[28:31], v17 offset:8192
    v_cvt_pk_bf16_f32 v100, v84, v85
    v_cvt_pk_bf16_f32 v101, v86, v87
    s_waitcnt lgkmcnt(4)
    v_mfma_f32_32x32x16_bf16 v[64:79], v[44:47], a[20:23], v[64:79]
    ds_read_b128 v[32:35], v18 offset:8192
    v_cvt_pk_bf16_f32 v102, v92, v93
    v_cvt_pk_bf16_f32 v103, v94, v95
    s_waitcnt lgkmcnt(4)
    v_mfma_f32_32x32x16_bf16 v[64:79], v[48:51], a[24:27], v[64:79]
    ds_read_b128 v[36:39], v19 offset:8192
    buffer_store_dwordx4 v[96:99], v104, s[8:11], s40 offen offset:0 sc1
    s_waitcnt lgkmcnt(4)
    v_mfma_f32_32x32x16_bf16 v[64:79], v[52:55], a[28:31], v[64:79]
    ds_read_b128 v[40:43], v20 offset:8192
    buffer_store_dwordx4 v[100:103], v104, s[8:11], s40 offen offset:512 sc1
    s_waitcnt lgkmcnt(4)
    v_mfma_f32_32x32x16_bf16 v[64:79], v[24:27], a[32:35], v[64:79]
    ds_read_b128 v[44:47], v21 offset:8192
    s_add_u32 s40, s40, s20
    s_add_u32 s24, s38, 0
    s_add_u32 m0, s39, 0
    s_nop 0
    buffer_load_dwordx4 v8, s[8:11], s24 offen sc1 lds
    s_waitcnt lgkmcnt(4)
    v_mfma_f32_32x32x16_bf16 v[64:79], v[28:31], a[36:39], v[64:79]
    ds_read_b128 v[48:51], v22 offset:8192
    s_waitcnt lgkmcnt(4)
    v_mfma_f32_32x32x16_bf16 v[64:79], v[32:35], a[40:43], v[64:79]
    ds_read_b128 v[52:55], v23 offset:8192
    s_add_u32 s24, s38, 20480
    s_add_u32 m0, s39, 4096
    s_nop 0
    buffer_load_dwordx4 v8, s[8:11], s24 offen sc1 lds
    s_waitcnt lgkmcnt(4)
    v_mfma_f32_32x32x16_bf16 v[64:79], v[36:39], a[44:47], v[64:79]
    ds_read_b128 v[24:27], v16 offset:16384
    s_waitcnt lgkmcnt(4)
    v_mfma_f32_32x32x16_bf16 v[64:79], v[40:43], a[48:51], v[64:79]
    ds_read_b128 v[28:31], v17 offset:16384
    s_add_u32 s24, s38, 256
    s_add_u32 m0, s39, 8192
    s_nop 0
    buffer_load_dwordx4 v8, s[8:11], s24 offen sc1 lds
    s_waitcnt lgkmcnt(4)
    v_mfma_f32_32x32x16_bf16 v[64:79], v[44:47], a[52:55], v[64:79]
    ds_read_b128 v[32:35], v18 offset:16384
    s_waitcnt lgkmcnt(4)
    v_mfma_f32_32x32x16_bf16 v[64:79], v[48:51], a[56:59], v[64:79]
    ds_read_b128 v[36:39], v19 offset:16384
    s_add_u32 s24, s38, 20736
    s_add_u32 m0, s39, 12288
    s_nop 0
    buffer_load_dwordx4 v8, s[8:11], s24 offen sc1 lds
    s_waitcnt lgkmcnt(4)
    v_mfma_f32_32x32x16_bf16 v[64:79], v[52:55], a[60:63], v[64:79]
    ds_read_b128 v[40:43], v20 offset:16384
    s_waitcnt lgkmcnt(4)
    v_mfma_f32_32x32x16_bf16 v[64:79], v[24:27], a[64:67], v[64:79]
    ds_read_b128 v[44:47], v21 offset:16384
    s_add_u32 s24, s38, 512
    s_add_u32 m0, s39, 16384
    s_nop 0
    buffer_load_dwordx4 v8, s[8:11], s24 offen sc1 lds
    s_waitcnt lgkmcnt(4)
    v_mfma_f32_32x32x16_bf16 v[64:79], v[28:31], a[68:71], v[64:79]
    ds_read_b128 v[48:51], v22 offset:16384
    s_waitcnt lgkmcnt(4)
    v_mfma_f32_32x32x16_bf16 v[64:79], v[32:35], a[72:75], v[64:79]
    ds_read_b128 v[52:55], v23 offset:16384
    s_add_u32 s24, s38, 20992
    s_add_u32 m0, s39, 20480
    s_nop 0
    buffer_load_dwordx4 v8, s[8:11], s24 offen sc1 lds
    s_waitcnt lgkmcnt(4)
    v_mfma_f32_32x32x16_bf16 v[64:79], v[36:39], a[76:79], v[64:79]
    ds_read_b128 v[24:27], v16 offset:24576
    s_waitcnt lgkmcnt(4)
    v_mfma_f32_32x32x16_bf16 v[64:79], v[40:43], a[80:83], v[64:79]
    ds_read_b128 v[28:31], v17 offset:24576
    s_add_u32 s24, s38, 768
    s_add_u32 m0, s39, 24576
    s_nop 0
    buffer_load_dwordx4 v8, s[8:11], s24 offen sc1 lds
    s_waitcnt lgkmcnt(4)
    v_mfma_f32_32x32x16_bf16 v[64:79], v[44:47], a[84:87], v[64:79]
    ds_read_b128 v[32:35], v18 offset:24576
    s_waitcnt lgkmcnt(4)
    v_mfma_f32_32x32x16_bf16 v[64:79], v[48:51], a[88:91], v[64:79]
    ds_read_b128 v[36:39], v19 offset:24576
    s_add_u32 s24, s38, 21248
    s_add_u32 m0, s39, 28672
    s_nop 0
    buffer_load_dwordx4 v8, s[8:11], s24 offen sc1 lds
    s_waitcnt lgkmcnt(4)
    v_mfma_f32_32x32x16_bf16 v[64:79], v[52:55], a[92:95], v[64:79]
    ds_read_b128 v[40:43], v20 offset:24576
    s_waitcnt lgkmcnt(4)
    v_mfma_f32_32x32x16_bf16 v[64:79], v[24:27], a[96:99], v[64:79]
    ds_read_b128 v[44:47], v21 offset:24576
    s_add_u32 s24, s38, 1024
    s_add_u32 m0, s39, 32768
    s_nop 0
    buffer_load_dwordx4 v8, s[8:11], s24 offen sc1 lds
    s_waitcnt lgkmcnt(4)
    v_mfma_f32_32x32x16_bf16 v[64:79], v[28:31], a[100:103], v[64:79]
    ds_read_b128 v[48:51], v22 offset:24576
    s_waitcnt lgkmcnt(4)
    v_mfma_f32_32x32x16_bf16 v[64:79], v[32:35], a[104:107], v[64:79]
    ds_read_b128 v[52:55], v23 offset:24576
    s_add_u32 s24, s38, 21504
    s_add_u32 m0, s39, 36864
    s_nop 0
    buffer_load_dwordx4 v8, s[8:11], s24 offen sc1 lds
    s_waitcnt lgkmcnt(4)
    v_mfma_f32_32x32x16_bf16 v[64:79], v[36:39], a[108:111], v[64:79]
    ds_read_b128 v[24:27], v16 offset:32768
    s_waitcnt lgkmcnt(4)
    v_mfma_f32_32x32x16_bf16 v[64:79], v[40:43], a[112:115], v[64:79]
    ds_read_b128 v[28:31], v17 offset:32768
    v_add_u32 v16, 40960, v16
    s_waitcnt lgkmcnt(4)
    v_mfma_f32_32x32x16_bf16 v[64:79], v[44:47], a[116:119], v[64:79]
    ds_read_b128 v[32:35], v18 offset:32768
    v_add_u32 v17, 40960, v17
    s_waitcnt lgkmcnt(4)
    v_mfma_f32_32x32x16_bf16 v[64:79], v[48:51], a[120:123], v[64:79]
    ds_read_b128 v[36:39], v19 offset:32768
    v_add_u32 v18, 40960, v18
    s_add_u32 s38, s38, 81920
    s_max_u32 s20, s28, 1
    s_sub_u32 s20, s20, 1
    s_waitcnt lgkmcnt(4)
    v_mfma_f32_32x32x16_bf16 v[64:79], v[52:55], a[124:127], v[64:79]
    ds_read_b128 v[40:43], v20 offset:32768
    v_add_u32 v19, 40960, v19
    v_mov_b32 v106, s20
    s_add_u32 s28, s28, 1
    s_waitcnt lgkmcnt(4)
    v_mfma_f32_32x32x16_bf16 v[64:79], v[24:27], a[128:131], v[64:79]
    ds_read_b128 v[44:47], v21 offset:32768
    v_add_u32 v20, 40960, v20
    s_waitcnt lgkmcnt(4)
    v_mfma_f32_32x32x16_bf16 v[64:79], v[28:31], a[132:135], v[64:79]
    ds_read_b128 v[48:51], v22 offset:32768
    v_add_u32 v21, 40960, v21
    s_waitcnt lgkmcnt(4)
    v_mfma_f32_32x32x16_bf16 v[64:79], v[32:35], a[136:139], v[64:79]
    ds_read_b128 v[52:55], v23 offset:32768
    v_add_u32 v22, 40960, v22
    s_waitcnt lgkmcnt(4)
    v_mfma_f32_32x32x16_bf16 v[64:79], v[36:39], a[140:143], v[64:79]
    v_add_u32 v23, 40960, v23
    s_waitcnt vmcnt(12) lgkmcnt(0)
    s_barrier
    ds_read_b128 v[24:27], v16 offset:0
    s_mov_b64 exec, s[46:47]
    buffer_store_dword v106, v105, s[8:11], s36 offen sc1
    s_mov_b64 exec, -1
    v_mfma_f32_32x32x16_bf16 v[64:79], v[40:43], a[144:147], v[64:79]
    ds_read_b128 v[28:31], v17 offset:0
    v_mfma_f32_32x32x16_bf16 v[64:79], v[44:47], a[148:151], v[64:79]
    ds_read_b128 v[32:35], v18 offset:0
    v_mfma_f32_32x32x16_bf16 v[64:79], v[48:51], a[152:155], v[64:79]
    ds_read_b128 v[36:39], v19 offset:0
    v_mfma_f32_32x32x16_bf16 v[64:79], v[52:55], a[156:159], v[64:79]
    ds_read_b128 v[40:43], v20 offset:0
    s_cmp_eq_u32 s28, 32
    s_waitcnt lgkmcnt(4)
    v_mfma_f32_32x32x16_bf16 v[80:95], v[24:27], a[0:3], 0
    ds_read_b128 v[44:47], v21 offset:0
    s_min_u32 s20, s28, 1
    s_lshl_b32 s20, s20, 19
    s_add_u32 s39, s30, 40960
    s_waitcnt lgkmcnt(4)
    v_mfma_f32_32x32x16_bf16 v[80:95], v[28:31], a[4:7], v[80:95]
    ds_read_b128 v[48:51], v22 offset:0
    s_waitcnt lgkmcnt(4)
    v_mfma_f32_32x32x16_bf16 v[80:95], v[32:35], a[8:11], v[80:95]
    ds_read_b128 v[52:55], v23 offset:0
    v_cvt_pk_bf16_f32 v96, v64, v65
    v_cvt_pk_bf16_f32 v97, v66, v67
    s_waitcnt lgkmcnt(4)
    v_mfma_f32_32x32x16_bf16 v[80:95], v[36:39], a[12:15], v[80:95]
    ds_read_b128 v[24:27], v16 offset:8192
    v_cvt_pk_bf16_f32 v98, v72, v73
    v_cvt_pk_bf16_f32 v99, v74, v75
    s_waitcnt lgkmcnt(4)
    v_mfma_f32_32x32x16_bf16 v[80:95], v[40:43], a[16:19], v[80:95]
    ds_read_b128 v[28:31], v17 offset:8192
    v_cvt_pk_bf16_f32 v100, v68, v69
    v_cvt_pk_bf16_f32 v101, v70, v71
    s_waitcnt lgkmcnt(4)
    v_mfma_f32_32x32x16_bf16 v[80:95], v[44:47], a[20:23], v[80:95]
    ds_read_b128 v[32:35], v18 offset:8192
    v_cvt_pk_bf16_f32 v102, v76, v77
    v_cvt_pk_bf16_f32 v103, v78, v79
    s_waitcnt lgkmcnt(4)
    v_mfma_f32_32x32x16_bf16 v[80:95], v[48:51], a[24:27], v[80:95]
    ds_read_b128 v[36:39], v19 offset:8192
    buffer_store_dwordx4 v[96:99], v104, s[8:11], s40 offen offset:0 sc1
    s_waitcnt lgkmcnt(4)
    v_mfma_f32_32x32x16_bf16 v[80:95], v[52:55], a[28:31], v[80:95]
    ds_read_b128 v[40:43], v20 offset:8192
    buffer_store_dwordx4 v[100:103], v104, s[8:11], s40 offen offset:512 sc1
    s_waitcnt lgkmcnt(4)
    v_mfma_f32_32x32x16_bf16 v[80:95], v[24:27], a[32:35], v[80:95]
    ds_read_b128 v[44:47], v21 offset:8192
    s_add_u32 s40, s40, s20
    s_add_u32 s24, s38, 0
    s_add_u32 m0, s39, 0
    s_nop 0
    buffer_load_dwordx4 v8, s[8:11], s24 offen sc1 lds
    s_waitcnt lgkmcnt(4)
    v_mfma_f32_32x32x16_bf16 v[80:95], v[28:31], a[36:39], v[80:95]
    ds_read_b128 v[48:51], v22 offset:8192
    s_waitcnt lgkmcnt(4)
    v_mfma_f32_32x32x16_bf16 v[80:95], v[32:35], a[40:43], v[80:95]
    ds_read_b128 v[52:55], v23 offset:8192
    s_add_u32 s24, s38, 20480
    s_add_u32 m0, s39, 4096
    s_nop 0
    buffer_load_dwordx4 v8, s[8:11], s24 offen sc1 lds
    s_waitcnt lgkmcnt(4)
    v_mfma_f32_32x32x16_bf16 v[80:95], v[36:39], a[44:47], v[80:95]
    ds_read_b128 v[24:27], v16 offset:16384
    s_waitcnt lgkmcnt(4)
    v_mfma_f32_32x32x16_bf16 v[80:95], v[40:43], a[48:51], v[80:95]
    ds_read_b128 v[28:31], v17 offset:16384
    s_add_u32 s24, s38, 256
    s_add_u32 m0, s39, 8192
    s_nop 0
    buffer_load_dwordx4 v8, s[8:11], s24 offen sc1 lds
    s_waitcnt lgkmcnt(4)
    v_mfma_f32_32x32x16_bf16 v[80:95], v[44:47], a[52:55], v[80:95]
    ds_read_b128 v[32:35], v18 offset:16384
    s_waitcnt lgkmcnt(4)
    v_mfma_f32_32x32x16_bf16 v[80:95], v[48:51], a[56:59], v[80:95]
    ds_read_b128 v[36:39], v19 offset:16384
    s_add_u32 s24, s38, 20736
    s_add_u32 m0, s39, 12288
    s_nop 0
    buffer_load_dwordx4 v8, s[8:11], s24 offen sc1 lds
    s_waitcnt lgkmcnt(4)
    v_mfma_f32_32x32x16_bf16 v[80:95], v[52:55], a[60:63], v[80:95]
    ds_read_b128 v[40:43], v20 offset:16384
    s_waitcnt lgkmcnt(4)
    v_mfma_f32_32x32x16_bf16 v[80:95], v[24:27], a[64:67], v[80:95]
    ds_read_b128 v[44:47], v21 offset:16384
    s_add_u32 s24, s38, 512
    s_add_u32 m0, s39, 16384
    s_nop 0
    buffer_load_dwordx4 v8, s[8:11], s24 offen sc1 lds
    s_waitcnt lgkmcnt(4)
    v_mfma_f32_32x32x16_bf16 v[80:95], v[28:31], a[68:71], v[80:95]
    ds_read_b128 v[48:51], v22 offset:16384
    s_waitcnt lgkmcnt(4)
    v_mfma_f32_32x32x16_bf16 v[80:95], v[32:35], a[72:75], v[80:95]
    ds_read_b128 v[52:55], v23 offset:16384
    s_add_u32 s24, s38, 20992
    s_add_u32 m0, s39, 20480
    s_nop 0
    buffer_load_dwordx4 v8, s[8:11], s24 offen sc1 lds
    s_waitcnt lgkmcnt(4)
    v_mfma_f32_32x32x16_bf16 v[80:95], v[36:39], a[76:79], v[80:95]
    ds_read_b128 v[24:27], v16 offset:24576
    s_waitcnt lgkmcnt(4)
    v_mfma_f32_32x32x16_bf16 v[80:95], v[40:43], a[80:83], v[80:95]
    ds_read_b128 v[28:31], v17 offset:24576
    s_add_u32 s24, s38, 768
    s_add_u32 m0, s39, 24576
    s_nop 0
    buffer_load_dwordx4 v8, s[8:11], s24 offen sc1 lds
    s_waitcnt lgkmcnt(4)
    v_mfma_f32_32x32x16_bf16 v[80:95], v[44:47], a[84:87], v[80:95]
    ds_read_b128 v[32:35], v18 offset:24576
    s_waitcnt lgkmcnt(4)
    v_mfma_f32_32x32x16_bf16 v[80:95], v[48:51], a[88:91], v[80:95]
    ds_read_b128 v[36:39], v19 offset:24576
    s_add_u32 s24, s38, 21248
    s_add_u32 m0, s39, 28672
    s_nop 0
    buffer_load_dwordx4 v8, s[8:11], s24 offen sc1 lds
    s_waitcnt lgkmcnt(4)
    v_mfma_f32_32x32x16_bf16 v[80:95], v[52:55], a[92:95], v[80:95]
    ds_read_b128 v[40:43], v20 offset:24576
    s_waitcnt lgkmcnt(4)
    v_mfma_f32_32x32x16_bf16 v[80:95], v[24:27], a[96:99], v[80:95]
    ds_read_b128 v[44:47], v21 offset:24576
    s_add_u32 s24, s38, 1024
    s_add_u32 m0, s39, 32768
    s_nop 0
    buffer_load_dwordx4 v8, s[8:11], s24 offen sc1 lds
    s_waitcnt lgkmcnt(4)
    v_mfma_f32_32x32x16_bf16 v[80:95], v[28:31], a[100:103], v[80:95]
    ds_read_b128 v[48:51], v22 offset:24576
    s_waitcnt lgkmcnt(4)
    v_mfma_f32_32x32x16_bf16 v[80:95], v[32:35], a[104:107], v[80:95]
    ds_read_b128 v[52:55], v23 offset:24576
    s_add_u32 s24, s38, 21504
    s_add_u32 m0, s39, 36864
    s_nop 0
    buffer_load_dwordx4 v8, s[8:11], s24 offen sc1 lds
    s_waitcnt lgkmcnt(4)
    v_mfma_f32_32x32x16_bf16 v[80:95], v[36:39], a[108:111], v[80:95]
    ds_read_b128 v[24:27], v16 offset:32768
    s_waitcnt lgkmcnt(4)
    v_mfma_f32_32x32x16_bf16 v[80:95], v[40:43], a[112:115], v[80:95]
    ds_read_b128 v[28:31], v17 offset:32768
    v_add_u32 v16, -81920, v16
    s_waitcnt lgkmcnt(4)
    v_mfma_f32_32x32x16_bf16 v[80:95], v[44:47], a[116:119], v[80:95]
    ds_read_b128 v[32:35], v18 offset:32768
    v_add_u32 v17, -81920, v17
    s_waitcnt lgkmcnt(4)
    v_mfma_f32_32x32x16_bf16 v[80:95], v[48:51], a[120:123], v[80:95]
    ds_read_b128 v[36:39], v19 offset:32768
    v_add_u32 v18, -81920, v18
    s_add_u32 s38, s38, 81920
    s_max_u32 s20, s28, 1
    s_sub_u32 s20, s20, 1
    s_waitcnt lgkmcnt(4)
    v_mfma_f32_32x32x16_bf16 v[80:95], v[52:55], a[124:127], v[80:95]
    ds_read_b128 v[40:43], v20 offset:32768
    v_add_u32 v19, -81920, v19
    v_mov_b32 v106, s20
    s_add_u32 s28, s28, 1
    s_waitcnt lgkmcnt(4)
    v_mfma_f32_32x32x16_bf16 v[80:95], v[24:27], a[128:131], v[80:95]
    ds_read_b128 v[44:47], v21 offset:32768
    v_add_u32 v20, -81920, v20
    s_waitcnt lgkmcnt(4)
    v_mfma_f32_32x32x16_bf16 v[80:95], v[28:31], a[132:135], v[80:95]
    ds_read_b128 v[48:51], v22 offset:32768
    v_add_u32 v21, -81920, v21
    s_waitcnt lgkmcnt(4)
    v_mfma_f32_32x32x16_bf16 v[80:95], v[32:35], a[136:139], v[80:95]
    ds_read_b128 v[52:55], v23 offset:32768
    v_add_u32 v22, -81920, v22
    s_waitcnt lgkmcnt(4)
    v_mfma_f32_32x32x16_bf16 v[80:95], v[36:39], a[140:143], v[80:95]
    v_add_u32 v23, -81920, v23
    s_waitcnt vmcnt(12) lgkmcnt(0)
    s_barrier
    ds_read_b128 v[24:27], v16 offset:0
    s_mov_b64 exec, s[46:47]
    buffer_store_dword v106, v105, s[8:11], s36 offen sc1
    s_mov_b64 exec, -1
    v_mfma_f32_32x32x16_bf16 v[80:95], v[40:43], a[144:147], v[80:95]
    ds_read_b128 v[28:31], v17 offset:0
    v_mfma_f32_32x32x16_bf16 v[80:95], v[44:47], a[148:151], v[80:95]
    ds_read_b128 v[32:35], v18 offset:0
    v_mfma_f32_32x32x16_bf16 v[80:95], v[48:51], a[152:155], v[80:95]
    ds_read_b128 v[36:39], v19 offset:0
    v_mfma_f32_32x32x16_bf16 v[80:95], v[52:55], a[156:159], v[80:95]
    ds_read_b128 v[40:43], v20 offset:0
    s_cmp_eq_u32 s28, 32
    s_cbranch_scc1 P_end_15
    s_branch P_top_17
P_end_15:
    s_nop 8
    v_cvt_pk_bf16_f32 v96, v80, v81
    v_cvt_pk_bf16_f32 v97, v82, v83
    v_cvt_pk_bf16_f32 v98, v88, v89
    v_cvt_pk_bf16_f32 v99, v90, v91
    v_cvt_pk_bf16_f32 v100, v84, v85
    v_cvt_pk_bf16_f32 v101, v86, v87
    v_cvt_pk_bf16_f32 v102, v92, v93
    v_cvt_pk_bf16_f32 v103, v94, v95
    buffer_store_dwordx4 v[96:99], v104, s[8:11], s40 offen offset:0 sc1
    buffer_store_dwordx4 v[100:103], v104, s[8:11], s40 offen offset:512 sc1
    s_waitcnt lgkmcnt(0)
    s_waitcnt vmcnt(0)
    s_barrier
    s_cmp_lg_u32 s5, 0
    s_cbranch_scc1 sig_18
    v_mov_b32 v28, 32
    v_mov_b32 v29, 0
    s_mov_b64 exec, 1
    buffer_store_dword v28, v29, s[8:11], s36 offen sc1
    s_mov_b64 exec, -1
sig_18:
    v_mov_b32 v4, 0
    s_lshl_b32 s20, s3, 2
    buffer_load_dword v5, v4, s[12:15], s20 offen offset:4 sc1
    s_waitcnt vmcnt(0)
    v_readfirstlane_b32 s20, v5
    s_nop 0
    s_bfe_u32 s21, s20, 0x90006
    s_mul_i32 s21, s21, s21
    s_lshr_b32 s20, s20, 15
    s_lshl_b32 s20, s20, 5
    s_cmp_eq_u32 s20, s21
    s_cselect_b32 s45, 1, 0
    s_cmp_ge_u32 s3, 5
    s_cbranch_scc1 post_m_19
    s_sub_u32 s64, s3, 2
    s_load_dwordx2 s[76:77], s[0:1], 40
    s_waitcnt lgkmcnt(0)
    s_mov_b32 s16, s76
    s_and_b32 s17, s77, 0xffff
    s_mov_b32 s18, 0x500000
    s_mov_b32 s19, 0x20000
    s_mul_i32 s24, s4, 163840
    v_add_u32_e64 v25, 0, v0
    v_mul_u32_u24 v30, 205, v25
    v_lshrrev_b32_e64 v30, 14, v30
    v_mul_u32_u24 v31, 80, v30
    v_sub_u32 v31, v25, v31
    v_lshlrev_b32 v25, 2, v30
    v_xor_b32_e64 v31, v31, v25
    v_mul_u32_u24 v30, 1280, v30
    v_lshl_add_u32 v20, v31, 4, v30
    v_add_u32_e64 v25, 64, v0
    v_mul_u32_u24 v30, 205, v25
    v_lshrrev_b32_e64 v30, 14, v30
    v_mul_u32_u24 v31, 80, v30
    v_sub_u32 v31, v25, v31
    v_lshlrev_b32 v25, 2, v30
    v_xor_b32_e64 v31, v31, v25
    v_mul_u32_u24 v30, 1280, v30
    v_lshl_add_u32 v21, v31, 4, v30
    v_add_u32 v25, 128, v0
    v_mul_u32_u24 v30, 205, v25
    v_lshrrev_b32_e64 v30, 14, v30
    v_mul_u32_u24 v31, 80, v30
    v_sub_u32 v31, v25, v31
    v_lshlrev_b32 v25, 2, v30
    v_xor_b32_e64 v31, v31, v25
    v_mul_u32_u24 v30, 1280, v30
    v_lshl_add_u32 v22, v31, 4, v30
    v_add_u32 v25, 192, v0
    v_mul_u32_u24 v30, 205, v25
    v_lshrrev_b32_e64 v30, 14, v30
    v_mul_u32_u24 v31, 80, v30
    v_sub_u32 v31, v25, v31
    v_lshlrev_b32 v25, 2, v30
    v_xor_b32_e64 v31, v31, v25
    v_mul_u32_u24 v30, 1280, v30
    v_lshl_add_u32 v23, v31, 4, v30
    v_add_u32 v25, 256, v0
    v_mul_u32_u24 v30, 205, v25
    v_lshrrev_b32_e64 v30, 14, v30
    v_mul_u32_u24 v31, 80, v30
    v_sub_u32 v31, v25, v31
    v_lshlrev_b32 v25, 2, v30
    v_xor_b32_e64 v31, v31, v25
    v_mul_u32_u24 v30, 1280, v30
    v_lshl_add_u32 v24, v31, 4, v30
    s_mul_i32 s21, s5, 10240
    s_add_u32 s20, s21, s24
    s_barrier
    s_add_u32 s22, s20, 0
    s_add_u32 m0, s21, 0
    s_nop 0
    buffer_load_dwordx4 v20, s[16:19], s22 offen lds
    s_add_u32 m0, s21, 1024
    s_nop 0
    buffer_load_dwordx4 v21, s[16:19], s22 offen lds
    s_add_u32 m0, s21, 2048
    s_nop 0
    buffer_load_dwordx4 v22, s[16:19], s22 offen lds
    s_add_u32 m0, s21, 3072
    s_nop 0
    buffer_load_dwordx4 v23, s[16:19], s22 offen lds
    s_add_u32 m0, s21, 4096
    s_nop 0
    buffer_load_dwordx4 v24, s[16:19], s22 offen lds
    s_add_u32 s22, s20, 5120
    s_add_u32 m0, s21, 5120
    s_nop 0
    buffer_load_dwordx4 v20, s[16:19], s22 offen lds
    s_add_u32 m0, s21, 6144
    s_nop 0
    buffer_load_dwordx4 v21, s[16:19], s22 offen lds
    s_add_u32 m0, s21, 7168
    s_nop 0
    buffer_load_dwordx4 v22, s[16:19], s22 offen lds
    s_add_u32 m0, s21, 8192
    s_nop 0
    buffer_load_dwordx4 v23, s[16:19], s22 offen lds
    s_add_u32 m0, s21, 9216
    s_nop 0
    buffer_load_dwordx4 v24, s[16:19], s22 offen lds
    s_add_u32 s22, s20, 40960
    s_add_u32 m0, s21, 40960
    s_nop 0
    buffer_load_dwordx4 v20, s[16:19], s22 offen lds
    s_add_u32 m0, s21, 41984
    s_nop 0
    buffer_load_dwordx4 v21, s[16:19], s22 offen lds
    s_add_u32 m0, s21, 43008
    s_nop 0
    buffer_load_dwordx4 v22, s[16:19], s22 offen lds
    s_add_u32 m0, s21, 44032
    s_nop 0
    buffer_load_dwordx4 v23, s[16:19], s22 offen lds
    s_add_u32 m0, s21, 45056
    s_nop 0
    buffer_load_dwordx4 v24, s[16:19], s22 offen lds
    s_add_u32 s22, s20, 46080
    s_add_u32 m0, s21, 46080
    s_nop 0
    buffer_load_dwordx4 v20, s[16:19], s22 offen lds
    s_add_u32 m0, s21, 47104
    s_nop 0
    buffer_load_dwordx4 v21, s[16:19], s22 offen lds
    s_add_u32 m0, s21, 48128
    s_nop 0
    buffer_load_dwordx4 v22, s[16:19], s22 offen lds
    s_add_u32 m0, s21, 49152
    s_nop 0
    buffer_load_dwordx4 v23, s[16:19], s22 offen lds
    s_add_u32 m0, s21, 50176
    s_nop 0
    buffer_load_dwordx4 v24, s[16:19], s22 offen lds
    s_add_u32 s22, s20, 81920
    s_add_u32 m0, s21, 81920
    s_nop 0
    buffer_load_dwordx4 v20, s[16:19], s22 offen lds
    s_add_u32 m0, s21, 82944
    s_nop 0
    buffer_load_dwordx4 v21, s[16:19], s22 offen lds
    s_add_u32 m0, s21, 83968
    s_nop 0
    buffer_load_dwordx4 v22, s[16:19], s22 offen lds
    s_add_u32 m0, s21, 84992
    s_nop 0
    buffer_load_dwordx4 v23, s[16:19], s22 offen lds
    s_add_u32 m0, s21, 86016
    s_nop 0
    buffer_load_dwordx4 v24, s[16:19], s22 offen lds
    s_add_u32 s22, s20, 87040
    s_add_u32 m0, s21, 87040
    s_nop 0
    buffer_load_dwordx4 v20, s[16:19], s22 offen lds
    s_add_u32 m0, s21, 88064
    s_nop 0
    buffer_load_dwordx4 v21, s[16:19], s22 offen lds
    s_add_u32 m0, s21, 89088
    s_nop 0
    buffer_load_dwordx4 v22, s[16:19], s22 offen lds
    s_add_u32 m0, s21, 90112
    s_nop 0
    buffer_load_dwordx4 v23, s[16:19], s22 offen lds
    s_add_u32 m0, s21, 91136
    s_nop 0
    buffer_load_dwordx4 v24, s[16:19], s22 offen lds
    s_add_u32 s22, s20, 122880
    s_add_u32 m0, s21, 122880
    s_nop 0
    buffer_load_dwordx4 v20, s[16:19], s22 offen lds
    s_add_u32 m0, s21, 123904
    s_nop 0
    buffer_load_dwordx4 v21, s[16:19], s22 offen lds
    s_add_u32 m0, s21, 124928
    s_nop 0
    buffer_load_dwordx4 v22, s[16:19], s22 offen lds
    s_add_u32 m0, s21, 125952
    s_nop 0
    buffer_load_dwordx4 v23, s[16:19], s22 offen lds
    s_add_u32 m0, s21, 126976
    s_nop 0
    buffer_load_dwordx4 v24, s[16:19], s22 offen lds
    s_add_u32 s22, s20, 128000
    s_add_u32 m0, s21, 128000
    s_nop 0
    buffer_load_dwordx4 v20, s[16:19], s22 offen lds
    s_add_u32 m0, s21, 129024
    s_nop 0
    buffer_load_dwordx4 v21, s[16:19], s22 offen lds
    s_add_u32 m0, s21, 130048
    s_nop 0
    buffer_load_dwordx4 v22, s[16:19], s22 offen lds
    s_add_u32 m0, s21, 131072
    s_nop 0
    buffer_load_dwordx4 v23, s[16:19], s22 offen lds
    s_add_u32 m0, s21, 132096
    s_nop 0
    buffer_load_dwordx4 v24, s[16:19], s22 offen lds
    v_bfe_u32 v30, v0, 2, 2
    v_lshrrev_b32_e64 v31, 5, v0
    v_lshl_add_u32 v31, v31, 2, v30
    v_mul_u32_u24 v31, 1280, v31
    v_and_b32_e64 v20, 1, v0
    v_lshl_add_u32 v31, v20, 3, v31
    v_bfe_u32 v20, v0, 4, 1
    v_bfe_u32 v21, v0, 1, 1
    v_lshl_add_u32 v20, v20, 1, v21
    v_lshlrev_b32 v30, 2, v30
    s_mul_i32 s22, s5, 20
    s_add_u32 s23, s22, 0
    v_add_u32 v21, s23, v20
    v_xor_b32_e64 v21, v21, v30
    v_lshl_add_u32 v25, v21, 4, v31
    s_add_u32 s23, s22, 4
    v_add_u32 v21, s23, v20
    v_xor_b32_e64 v21, v21, v30
    v_lshl_add_u32 v26, v21, 4, v31
    s_add_u32 s23, s22, 8
    v_add_u32 v21, s23, v20
    v_xor_b32_e64 v21, v21, v30
    v_lshl_add_u32 v27, v21, 4, v31
    s_add_u32 s23, s22, 12
    v_add_u32 v21, s23, v20
    v_xor_b32_e64 v21, v21, v30
    v_lshl_add_u32 v28, v21, 4, v31
    s_add_u32 s23, s22, 16
    v_add_u32 v21, s23, v20
    v_xor_b32_e64 v21, v21, v30
    v_lshl_add_u32 v29, v21, 4, v31
    s_waitcnt vmcnt(30)
    s_barrier
    ds_read_b64_tr_b16 a[0:1], v25 offset:0
    ds_read_b64_tr_b16 a[2:3], v25 offset:20480
    ds_read_b64_tr_b16 a[4:5], v25 offset:10240
    ds_read_b64_tr_b16 a[6:7], v25 offset:30720
    v_add_u32 v25, 40960, v25
    s_waitcnt lgkmcnt(0)
    ds_read_b64_tr_b16 a[32:33], v26 offset:0
    ds_read_b64_tr_b16 a[34:35], v26 offset:20480
    ds_read_b64_tr_b16 a[36:37], v26 offset:10240
    ds_read_b64_tr_b16 a[38:39], v26 offset:30720
    v_add_u32 v26, 40960, v26
    s_waitcnt lgkmcnt(0)
    ds_read_b64_tr_b16 a[64:65], v27 offset:0
    ds_read_b64_tr_b16 a[66:67], v27 offset:20480
    ds_read_b64_tr_b16 a[68:69], v27 offset:10240
    ds_read_b64_tr_b16 a[70:71], v27 offset:30720
    v_add_u32 v27, 40960, v27
    s_waitcnt lgkmcnt(0)
    ds_read_b64_tr_b16 a[96:97], v28 offset:0
    ds_read_b64_tr_b16 a[98:99], v28 offset:20480
    ds_read_b64_tr_b16 a[100:101], v28 offset:10240
    ds_read_b64_tr_b16 a[102:103], v28 offset:30720
    v_add_u32 v28, 40960, v28
    s_waitcnt lgkmcnt(0)
    ds_read_b64_tr_b16 a[128:129], v29 offset:0
    ds_read_b64_tr_b16 a[130:131], v29 offset:20480
    ds_read_b64_tr_b16 a[132:133], v29 offset:10240
    ds_read_b64_tr_b16 a[134:135], v29 offset:30720
    v_add_u32 v29, 40960, v29
    s_waitcnt lgkmcnt(0)
    s_waitcnt vmcnt(20)
    s_barrier
    ds_read_b64_tr_b16 a[8:9], v25 offset:0
    ds_read_b64_tr_b16 a[10:11], v25 offset:20480
    ds_read_b64_tr_b16 a[12:13], v25 offset:10240
    ds_read_b64_tr_b16 a[14:15], v25 offset:30720
    v_add_u32 v25, 40960, v25
    s_waitcnt lgkmcnt(0)
    ds_read_b64_tr_b16 a[40:41], v26 offset:0
    ds_read_b64_tr_b16 a[42:43], v26 offset:20480
    ds_read_b64_tr_b16 a[44:45], v26 offset:10240
    ds_read_b64_tr_b16 a[46:47], v26 offset:30720
    v_add_u32 v26, 40960, v26
    s_waitcnt lgkmcnt(0)
    ds_read_b64_tr_b16 a[72:73], v27 offset:0
    ds_read_b64_tr_b16 a[74:75], v27 offset:20480
    ds_read_b64_tr_b16 a[76:77], v27 offset:10240
    ds_read_b64_tr_b16 a[78:79], v27 offset:30720
    v_add_u32 v27, 40960, v27
    s_waitcnt lgkmcnt(0)
    ds_read_b64_tr_b16 a[104:105], v28 offset:0
    ds_read_b64_tr_b16 a[106:107], v28 offset:20480
    ds_read_b64_tr_b16 a[108:109], v28 offset:10240
    ds_read_b64_tr_b16 a[110:111], v28 offset:30720
    v_add_u32 v28, 40960, v28
    s_waitcnt lgkmcnt(0)
    ds_read_b64_tr_b16 a[136:137], v29 offset:0
    ds_read_b64_tr_b16 a[138:139], v29 offset:20480
    ds_read_b64_tr_b16 a[140:141], v29 offset:10240
    ds_read_b64_tr_b16 a[142:143], v29 offset:30720
    v_add_u32 v29, 40960, v29
    s_waitcnt lgkmcnt(0)
    s_waitcnt vmcnt(10)
    s_barrier
    ds_read_b64_tr_b16 a[16:17], v25 offset:0
    ds_read_b64_tr_b16 a[18:19], v25 offset:20480
    ds_read_b64_tr_b16 a[20:21], v25 offset:10240
    ds_read_b64_tr_b16 a[22:23], v25 offset:30720
    v_add_u32 v25, 40960, v25
    s_waitcnt lgkmcnt(0)
    ds_read_b64_tr_b16 a[48:49], v26 offset:0
    ds_read_b64_tr_b16 a[50:51], v26 offset:20480
    ds_read_b64_tr_b16 a[52:53], v26 offset:10240
    ds_read_b64_tr_b16 a[54:55], v26 offset:30720
    v_add_u32 v26, 40960, v26
    s_waitcnt lgkmcnt(0)
    ds_read_b64_tr_b16 a[80:81], v27 offset:0
    ds_read_b64_tr_b16 a[82:83], v27 offset:20480
    ds_read_b64_tr_b16 a[84:85], v27 offset:10240
    ds_read_b64_tr_b16 a[86:87], v27 offset:30720
    v_add_u32 v27, 40960, v27
    s_waitcnt lgkmcnt(0)
    ds_read_b64_tr_b16 a[112:113], v28 offset:0
    ds_read_b64_tr_b16 a[114:115], v28 offset:20480
    ds_read_b64_tr_b16 a[116:117], v28 offset:10240
    ds_read_b64_tr_b16 a[118:119], v28 offset:30720
    v_add_u32 v28, 40960, v28
    s_waitcnt lgkmcnt(0)
    ds_read_b64_tr_b16 a[144:145], v29 offset:0
    ds_read_b64_tr_b16 a[146:147], v29 offset:20480
    ds_read_b64_tr_b16 a[148:149], v29 offset:10240
    ds_read_b64_tr_b16 a[150:151], v29 offset:30720
    v_add_u32 v29, 40960, v29
    s_waitcnt lgkmcnt(0)
    s_waitcnt vmcnt(0)
    s_barrier
    ds_read_b64_tr_b16 a[24:25], v25 offset:0
    ds_read_b64_tr_b16 a[26:27], v25 offset:20480
    ds_read_b64_tr_b16 a[28:29], v25 offset:10240
    ds_read_b64_tr_b16 a[30:31], v25 offset:30720
    s_waitcnt lgkmcnt(0)
    ds_read_b64_tr_b16 a[56:57], v26 offset:0
    ds_read_b64_tr_b16 a[58:59], v26 offset:20480
    ds_read_b64_tr_b16 a[60:61], v26 offset:10240
    ds_read_b64_tr_b16 a[62:63], v26 offset:30720
    s_waitcnt lgkmcnt(0)
    ds_read_b64_tr_b16 a[88:89], v27 offset:0
    ds_read_b64_tr_b16 a[90:91], v27 offset:20480
    ds_read_b64_tr_b16 a[92:93], v27 offset:10240
    ds_read_b64_tr_b16 a[94:95], v27 offset:30720
    s_waitcnt lgkmcnt(0)
    ds_read_b64_tr_b16 a[120:121], v28 offset:0
    ds_read_b64_tr_b16 a[122:123], v28 offset:20480
    ds_read_b64_tr_b16 a[124:125], v28 offset:10240
    ds_read_b64_tr_b16 a[126:127], v28 offset:30720
    s_waitcnt lgkmcnt(0)
    ds_read_b64_tr_b16 a[152:153], v29 offset:0
    ds_read_b64_tr_b16 a[154:155], v29 offset:20480
    ds_read_b64_tr_b16 a[156:157], v29 offset:10240
    ds_read_b64_tr_b16 a[158:159], v29 offset:30720
    s_waitcnt lgkmcnt(0)
    s_barrier
    s_mul_i32 s20, s5, 5120
    s_add_u32 s20, s20, 8192
    v_and_b32 v20, 31, v0
    v_mul_u32_u24 v20, 80, v20
    v_lshrrev_b32_e64 v21, 5, v0
    v_lshl_add_u32 v20, v21, 4, v20
    v_add_u32_e64 v2, s20, v20
    s_mov_b32 s21, 40960
    v_lshrrev_b32 v20, 2, v0
    v_and_b32 v21, 0x30, v1
    v_mul_u32_u24 v22, 80, v20
    v_add3_u32 v3, v22, v21, s20
    v_mul_lo_u32 v22, v20, s21
    v_add_u32 v4, v22, v21
    v_and_b32 v20, 15, v0
    v_mov_b32 v21, 0x3f80
    v_cmp_eq_u32 vcc, 0, v20
    s_nop 1
    v_cndmask_b32_e64 v8, 0, v21, vcc
    v_cmp_eq_u32 vcc, 1, v20
    s_nop 1
    v_cndmask_b32 v8, v8, 1.0, vcc
    v_cmp_eq_u32 vcc, 2, v20
    s_nop 1
    v_cndmask_b32_e64 v9, 0, v21, vcc
    v_cmp_eq_u32 vcc, 3, v20
    s_nop 1
    v_cndmask_b32 v9, v9, 1.0, vcc
    v_cmp_eq_u32 vcc, 4, v20
    s_nop 1
    v_cndmask_b32_e64 v10, 0, v21, vcc
    v_cmp_eq_u32 vcc, 5, v20
    s_nop 1
    v_cndmask_b32 v10, v10, 1.0, vcc
    v_cmp_eq_u32 vcc, 6, v20
    s_nop 1
    v_cndmask_b32_e64 v11, 0, v21, vcc
    v_cmp_eq_u32 vcc, 7, v20
    s_nop 1
    v_cndmask_b32 v11, v11, 1.0, vcc
    v_cmp_eq_u32 vcc, 8, v20
    s_nop 1
    v_cndmask_b32_e64 v12, 0, v21, vcc
    v_cmp_eq_u32 vcc, 9, v20
    s_nop 1
    v_cndmask_b32 v12, v12, 1.0, vcc
    v_cmp_eq_u32 vcc, 10, v20
    s_nop 1
    v_cndmask_b32_e64 v13, 0, v21, vcc
    v_cmp_eq_u32 vcc, 11, v20
    s_nop 1
    v_cndmask_b32 v13, v13, 1.0, vcc
    v_cmp_eq_u32 vcc, 12, v20
    s_nop 1
    v_cndmask_b32_e64 v14, 0, v21, vcc
    v_cmp_eq_u32 vcc, 13, v20
    s_nop 1
    v_cndmask_b32 v14, v14, 1.0, vcc
    v_cmp_eq_u32 vcc, 14, v20
    s_nop 1
    v_cndmask_b32_e64 v15, 0, v21, vcc
    v_cmp_eq_u32 vcc, 15, v20
    s_nop 1
    v_cndmask_b32 v15, v15, 1.0, vcc
    v_lshrrev_b32_e64 v20, 4, v0
    v_and_b32 v21, 0xf0, v1
    v_mul_u32_u24 v6, 1280, v20
    v_add_u32 v6, v6, v21
    v_lshrrev_b32 v7, 5, v0
    v_lshl_add_u32 v21, v7, 8, v21
    v_and_b32_e64 v20, 1, v20
    v_lshl_add_u32 v7, v20, 3, v21
    s_mov_b32 s44, 0x3727c5ac
    s_load_dwordx2 s[76:77], s[0:1], 0
    s_waitcnt lgkmcnt(0)
    s_mov_b32 s32, s76
    s_and_b32 s33, s77, 0xffff
    s_mov_b32 s34, 0x280000
    s_mov_b32 s35, 0x20000
    s_and_b32 s20, s5, 1
    s_lshr_b32 s21, s5, 1
    v_lshrrev_b32_e64 v20, 5, v0
    v_bfe_u32 v21, v0, 4, 1
    v_and_b32_e64 v22, 15, v0
    v_lshl_add_u32 v21, v21, 5, v22
    v_lshlrev_b32_e64 v21, 4, v21
    v_lshl_add_u32 v21, v20, 10, v21
    s_lshl_b32 s22, s21, 12
    s_lshl_b32 s23, s20, 8
    s_add_u32 s22, s22, s23
    v_add_u32 v5, s22, v21
    s_lshl_b32 s22, s20, 4
    v_add_u32 v22, s22, v22
    v_lshrrev_b32 v20, 4, v0
    v_lshlrev_b32 v20, 2, v20
    v_sub_u32_e64 v22, v22, v20
    v_cmp_le_i32 s[48:49], 0, v22
    v_cmp_le_i32 s[50:51], 1, v22
    v_cmp_le_i32 s[52:53], 2, v22
    v_cmp_le_i32 s[54:55], 3, v22
    v_cmp_le_i32 s[56:57], 16, v22
    v_cmp_le_i32 s[58:59], 17, v22
    v_cmp_le_i32 s[60:61], 18, v22
    v_cmp_le_i32 s[62:63], 19, v22
    s_mov_b32 s68, 0x3e0293ee
    s_mov_b32 s69, 0x3e0293ee
    s_lshl_b32 s70, s20, 10
    s_lshl_b32 s71, s21, 12
    s_lshl_b32 s72, s21, 11
    s_lshl_b32 s22, s64, 7
    s_lshl_b32 s23, s4, 2
    s_add_u32 s22, s22, s23
    s_add_u32 s40, s22, 0x2400
    s_add_u32 s41, s22, 0x2600
    s_add_u32 s47, s22, 0x2e00
    s_lshl_b32 s46, s64, 7
    s_add_u32 s46, s46, 0x2e00
    v_and_b32 v249, 31, v0
    v_lshlrev_b32 v249, 2, v249
    s_mov_b32 s27, s64
    s_mov_b32 s28, 0
    s_mov_b32 s73, 0
    s_mov_b32 s74, 0
    s_lshl_b32 s20, s4, 7
    s_add_u32 s29, s27, 2
    s_lshr_b32 s29, s29, 1
    s_min_u32 s29, s29, 32
    s_cmp_ge_u32 s73, s29
    s_cbranch_scc1 pcok_22
    v_min_u32 v246, 5, v0
    v_lshlrev_b32 v246, 2, v246
pc_21:
    buffer_load_dword v247, v246, s[8:11], s20 offen sc1
    s_waitcnt vmcnt(0)
    v_readlane_b32 s73, v247, 0
    v_readlane_b32 s7, v247, 1
    s_nop 0
    s_min_u32 s73, s73, s7
    v_readlane_b32 s7, v247, 2
    s_nop 0
    s_min_u32 s73, s73, s7
    v_readlane_b32 s7, v247, 3
    s_nop 0
    s_min_u32 s73, s73, s7
    v_readlane_b32 s7, v247, 4
    s_nop 0
    s_min_u32 s73, s73, s7
    v_readlane_b32 s7, v247, 5
    s_nop 0
    s_min_u32 s73, s73, s7
    s_cmp_ge_u32 s73, s29
    s_cbranch_scc1 pcok_22
    s_sleep 1
    s_add_u32 s6, s6, 1
    s_cmp_lt_u32 s6, 400000
    s_cbranch_scc1 pc_21
    s_branch pcok_22
pcok_22:
    s_add_u32 s20, s27, 0
    s_lshl_b32 s20, s20, 5
    s_add_u32 s20, s20, s4
    s_lshl_b32 s36, s20, 13
    s_add_u32 s36, s36, 0x100000
    s_add_u32 s98, s36, 4096
    s_add_u32 s96, s36, s70
    s_add_u32 s96, s96, 0x2000000
    s_add_u32 s97, s96, 4096
    s_add_u32 s99, s36, s71
    s_add_u32 s99, s99, 0x1000000
    buffer_load_dwordx4 v[36:39], v1, s[8:11], s36 offen offset:0 sc1 nt
    buffer_load_dwordx4 v[40:43], v1, s[8:11], s36 offen offset:1024 sc1 nt
    buffer_load_dwordx4 v[44:47], v1, s[8:11], s36 offen offset:2048 sc1 nt
    buffer_load_dwordx4 v[48:51], v1, s[8:11], s36 offen offset:3072 sc1 nt
    buffer_load_dwordx4 v[52:55], v1, s[8:11], s98 offen offset:0 sc1 nt
    buffer_load_dwordx4 v[56:59], v1, s[8:11], s98 offen offset:1024 sc1 nt
    buffer_load_dwordx4 v[60:63], v1, s[8:11], s98 offen offset:2048 sc1 nt
    buffer_load_dwordx4 v[64:67], v1, s[8:11], s98 offen offset:3072 sc1 nt
    buffer_load_dwordx4 v[20:23], v1, s[8:11], s96 offen offset:0 sc1 nt
    buffer_load_dwordx4 v[24:27], v1, s[8:11], s96 offen offset:2048 sc1 nt
    buffer_load_dwordx4 v[28:31], v1, s[8:11], s97 offen offset:0 sc1 nt
    buffer_load_dwordx4 v[32:35], v1, s[8:11], s97 offen offset:2048 sc1 nt
    buffer_load_dwordx4 v[84:87], v1, s[8:11], s99 offen offset:0 sc1 nt
    buffer_load_dwordx4 v[88:91], v1, s[8:11], s99 offen offset:1024 sc1 nt
    buffer_load_dwordx4 v[92:95], v1, s[8:11], s99 offen offset:2048 sc1 nt
    buffer_load_dwordx4 v[96:99], v1, s[8:11], s99 offen offset:3072 sc1 nt
    s_mul_i32 s38, s64, 0x140000
    s_add_u32 s38, s38, 0x5260000
    s_mul_i32 s20, s4, 40960
    s_add_u32 s20, s20, s38
    s_mul_i32 s21, s5, 10240
    s_add_u32 s20, s20, s21
    buffer_load_dwordx4 v[144:147], v1, s[8:11], s20 offen sc1
    s_add_u32 s20, s20, 1024
    buffer_load_dwordx4 v[144:147], v1, s[8:11], s20 offen sc1
    s_add_u32 s20, s20, 1024
    buffer_load_dwordx4 v[144:147], v1, s[8:11], s20 offen sc1
    s_add_u32 s20, s20, 1024
    buffer_load_dwordx4 v[144:147], v1, s[8:11], s20 offen sc1
    s_add_u32 s20, s20, 1024
    buffer_load_dwordx4 v[144:147], v1, s[8:11], s20 offen sc1
    s_add_u32 s20, s20, 1024
    buffer_load_dwordx4 v[144:147], v1, s[8:11], s20 offen sc1
    s_add_u32 s20, s20, 1024
    buffer_load_dwordx4 v[144:147], v1, s[8:11], s20 offen sc1
    s_add_u32 s20, s20, 1024
    buffer_load_dwordx4 v[144:147], v1, s[8:11], s20 offen sc1
    s_add_u32 s20, s20, 1024
    buffer_load_dwordx4 v[144:147], v1, s[8:11], s20 offen sc1
    s_add_u32 s20, s20, 1024
    buffer_load_dwordx4 v[144:147], v1, s[8:11], s20 offen sc1
    s_add_u32 s20, s20, 1024
    s_waitcnt vmcnt(0)
AT_top_23:
    s_lshl_b32 s20, s27, 5
    s_add_u32 s20, s20, s4
    s_lshl_b32 s37, s20, 12
    s_add_u32 s37, s37, 0x3100000
    v_mfma_f32_16x16x32_bf16 v[112:115], v[36:39], v[20:23], 0
    v_mfma_f32_16x16x32_bf16 v[116:119], v[40:43], v[20:23], 0
    v_mfma_f32_16x16x32_bf16 v[112:115], v[44:47], v[24:27], v[112:115]
    v_mfma_f32_16x16x32_bf16 v[116:119], v[48:51], v[24:27], v[116:119]
    v_mfma_f32_16x16x32_bf16 v[112:115], v[52:55], v[28:31], v[112:115]
    v_mfma_f32_16x16x32_bf16 v[116:119], v[56:59], v[28:31], v[116:119]
    v_mfma_f32_16x16x32_bf16 v[112:115], v[60:63], v[32:35], v[112:115]
    v_mfma_f32_16x16x32_bf16 v[116:119], v[64:67], v[32:35], v[116:119]
    s_lshl_b32 s20, s4, 7
    s_add_u32 s20, s20, 0x1000
    s_add_u32 s29, s27, 1
    s_cmp_ge_u32 s74, s29
    s_cbranch_scc1 pcok_25
    v_min_u32 v246, 1, v0
    v_lshlrev_b32 v246, 2, v246
pc_24:
    buffer_load_dword v247, v246, s[8:11], s20 offen sc1
    s_waitcnt vmcnt(0)
    v_readlane_b32 s74, v247, 0
    v_readlane_b32 s7, v247, 1
    s_nop 0
    s_min_u32 s74, s74, s7
    s_cmp_ge_u32 s74, s29
    s_cbranch_scc1 pcok_25
    s_sleep 1
    s_add_u32 s6, s6, 1
    s_cmp_lt_u32 s6, 400000
    s_cbranch_scc1 pc_24
    s_branch pcok_25
pcok_25:
    buffer_load_dword v248, v249, s[8:11], s46 offen sc1
    buffer_load_dwordx4 v[68:71], v1, s[8:11], s37 offen offset:0 sc1
    buffer_load_dwordx4 v[72:75], v1, s[8:11], s37 offen offset:1024 sc1
    buffer_load_dwordx4 v[76:79], v1, s[8:11], s37 offen offset:2048 sc1
    buffer_load_dwordx4 v[80:83], v1, s[8:11], s37 offen offset:3072 sc1
    s_add_u32 s20, s37, s72
    s_add_u32 s20, s20, 0x800000
    buffer_load_dwordx4 v[100:103], v1, s[8:11], s20 offen offset:0 sc1
    buffer_load_dwordx4 v[104:107], v1, s[8:11], s20 offen offset:1024 sc1
    v_mov_b32 v143, 0xff800000
    v_cndmask_b32 v112, v143, v112, s[48:49]
    v_cndmask_b32 v113, v143, v113, s[50:51]
    v_cndmask_b32 v114, v143, v114, s[52:53]
    v_cndmask_b32 v115, v143, v115, s[54:55]
    v_cndmask_b32 v116, v143, v116, s[56:57]
    v_cndmask_b32 v117, v143, v117, s[58:59]
    v_cndmask_b32 v118, v143, v118, s[60:61]
    v_cndmask_b32 v119, v143, v119, s[62:63]
    v_max3_f32 v142, v112, v113, v114
    v_max3_f32 v142, v142, v115, v116
    v_max3_f32 v142, v142, v117, v118
    v_max_f32 v142, v142, v119
    s_waitcnt vmcnt(5)
    v_mfma_f32_16x16x32_bf16 v[108:111], v[68:71], v[20:23], 0
    s_waitcnt vmcnt(4)
    v_mfma_f32_16x16x32_bf16 v[108:111], v[72:75], v[24:27], v[108:111]
    s_waitcnt vmcnt(3)
    v_mfma_f32_16x16x32_bf16 v[108:111], v[76:79], v[28:31], v[108:111]
    s_waitcnt vmcnt(2)
    v_mfma_f32_16x16x32_bf16 v[108:111], v[80:83], v[32:35], v[108:111]
    s_nop 7
    v_max3_f32 v142, v142, v108, v109
    v_max3_f32 v142, v142, v110, v111
    v_mov_b32 v143, v142
    s_nop 1
    v_permlane16_swap_b32 v142, v143
    v_max_f32 v142, v142, v143
    v_mov_b32 v143, v142
    s_nop 1
    v_permlane32_swap_b32 v142, v143
    v_max_f32 v142, v142, v143
    v_mul_f32_e64 v142, s68, v142
    v_pk_fma_f32 v[108:109], v[108:109], s[68:69], v[142:143] op_sel_hi:[1,1,0] neg_lo:[0,0,1] neg_hi:[0,0,1]
    v_pk_fma_f32 v[110:111], v[110:111], s[68:69], v[142:143] op_sel_hi:[1,1,0] neg_lo:[0,0,1] neg_hi:[0,0,1]
    v_pk_fma_f32 v[112:113], v[112:113], s[68:69], v[142:143] op_sel_hi:[1,1,0] neg_lo:[0,0,1] neg_hi:[0,0,1]
    v_pk_fma_f32 v[114:115], v[114:115], s[68:69], v[142:143] op_sel_hi:[1,1,0] neg_lo:[0,0,1] neg_hi:[0,0,1]
    v_pk_fma_f32 v[116:117], v[116:117], s[68:69], v[142:143] op_sel_hi:[1,1,0] neg_lo:[0,0,1] neg_hi:[0,0,1]
    v_pk_fma_f32 v[118:119], v[118:119], s[68:69], v[142:143] op_sel_hi:[1,1,0] neg_lo:[0,0,1] neg_hi:[0,0,1]
    v_exp_f32 v108, v108
    v_exp_f32 v109, v109
    v_exp_f32 v110, v110
    v_exp_f32 v111, v111
    v_exp_f32 v112, v112
    v_exp_f32 v113, v113
    v_exp_f32 v114, v114
    v_exp_f32 v115, v115
    v_exp_f32 v116, v116
    v_exp_f32 v117, v117
    v_exp_f32_e64 v118, v118
    v_exp_f32 v119, v119
    v_cvt_pk_bf16_f32 v136, v112, v113
    v_cvt_pk_bf16_f32 v137, v114, v115
    v_cvt_pk_bf16_f32 v138, v116, v117
    v_cvt_pk_bf16_f32 v139, v118, v119
    v_cvt_pk_bf16_f32 v140, v108, v109
    v_cvt_pk_bf16_f32 v141, v110, v111
    s_waitcnt vmcnt(0)
    v_mfma_f32_16x16x32_bf16 v[120:123], v[84:87], v[136:139], 0
    v_mfma_f32_16x16x32_bf16 v[124:127], v[88:91], v[136:139], 0
    v_mfma_f32_16x16x32_bf16 v[128:131], v[92:95], v[136:139], 0
    v_mfma_f32_16x16x32_bf16 v[132:135], v[96:99], v[136:139], 0
    v_mfma_f32_16x16x16_bf16 v[120:123], v[100:101], v[140:141], v[120:123]
    v_mfma_f32_16x16x16_bf16 v[124:127], v[102:103], v[140:141], v[124:127]
    v_mfma_f32_16x16x16_bf16 v[128:131], v[104:105], v[140:141], v[128:131]
    v_mfma_f32_16x16x16_bf16 v[132:135], v[106:107], v[140:141], v[132:135]
    v_pk_add_f32 v[108:109], v[108:109], v[110:111]
    v_pk_add_f32 v[112:113], v[112:113], v[114:115]
    v_pk_add_f32 v[116:117], v[116:117], v[118:119]
    v_pk_add_f32 v[112:113], v[112:113], v[116:117]
    v_add_f32 v108, v108, v109
    v_add_f32 v112, v112, v113
    v_fma_f32 v142, v108, 0.5, v112
    v_mov_b32 v143, v142
    s_nop 1
    v_permlane16_swap_b32 v142, v143
    v_add_f32 v142, v142, v143
    v_mov_b32 v143, v142
    s_nop 1
    v_permlane32_swap_b32 v142, v143
    v_add_f32 v142, v142, v143
    v_rcp_f32 v142, v142
    s_nop 0
    v_pk_mul_f32 v[120:121], v[120:121], v[142:143] op_sel_hi:[1,0]
    v_pk_mul_f32 v[122:123], v[122:123], v[142:143] op_sel_hi:[1,0]
    v_pk_mul_f32 v[124:125], v[124:125], v[142:143] op_sel_hi:[1,0]
    v_pk_mul_f32 v[126:127], v[126:127], v[142:143] op_sel_hi:[1,0]
    v_pk_mul_f32 v[128:129], v[128:129], v[142:143] op_sel_hi:[1,0]
    v_pk_mul_f32 v[130:131], v[130:131], v[142:143] op_sel_hi:[1,0]
    v_pk_mul_f32 v[132:133], v[132:133], v[142:143] op_sel_hi:[1,0]
    v_pk_mul_f32 v[134:135], v[134:135], v[142:143] op_sel_hi:[1,0]
    v_cvt_pk_bf16_f32 v208, v120, v121
    v_cvt_pk_bf16_f32 v209, v122, v123
    v_cvt_pk_bf16_f32 v210, v124, v125
    v_cvt_pk_bf16_f32 v211, v126, v127
    v_cvt_pk_bf16_f32 v212, v128, v129
    v_cvt_pk_bf16_f32 v213, v130, v131
    v_cvt_pk_bf16_f32 v214, v132, v133
    v_cvt_pk_bf16_f32 v215, v134, v135
    ds_write_b128 v5, v[208:211] offset:0
    ds_write_b128 v5, v[212:215] offset:2048
    v_cmp_gt_u32 vcc, s28, v248
    s_cbranch_vccz AT_free_26
    v_min_u32_e64 v246, 31, v0
    v_lshlrev_b32 v246, 2, v246
pg_27:
    buffer_load_dword v247, v246, s[8:11], s46 offen sc1
    s_waitcnt vmcnt(0)
    v_cmp_gt_u32 vcc, s28, v247
    s_cbranch_vccz pgok_28
    s_sleep 1
    s_add_u32 s6, s6, 1
    s_cmp_lt_u32 s6, 400000
    s_cbranch_scc1 pg_27
    s_branch pgok_28
pgok_28:
AT_free_26:
    s_mul_i32 s20, s4, 1280
    s_mul_i32 s21, s5, 320
    s_add_u32 s20, s20, s21
    s_add_u32 s20, s20, s38
    s_add_u32 s21, s20, 655360
    s_lshl_b32 s39, s27, 5
    s_add_u32 s39, s39, s4
    s_mul_i32 s39, s39, 1280
    v_mov_b32_e64 v240, 0
    v_mov_b32 v241, 0
    buffer_load_dwordx2 v[236:237], v7, s[32:35], s39 offen offset:0
    buffer_load_dwordx2 v[238:239], v7, s[32:35], s39 offen offset:512
    s_mov_b64 exec, s[42:43]
    buffer_load_dwordx2 v[240:241], v7, s[32:35], s39 offen offset:1024
    s_mov_b64 exec, -1
    s_waitcnt lgkmcnt(0)
    s_barrier
    s_cmp_lg_u32 s45, 1
    s_cbranch_scc1 ls_29
    ds_read_b128 v[144:147], v1 offset:0
    ds_read_b128 v[148:151], v1 offset:1024
    ds_read_b128 v[152:155], v1 offset:2048
    ds_read_b128 v[156:159], v1 offset:3072
    ds_read_b128 v[160:163], v1 offset:4096
    ds_read_b128 v[164:167], v1 offset:5120
    ds_read_b128 v[168:171], v1 offset:6144
    ds_read_b128 v[172:175], v1 offset:7168
    s_waitcnt lgkmcnt(7)
    v_mfma_f32_32x32x16_bf16 v[176:191], a[0:3], v[144:147], 0
    s_waitcnt lgkmcnt(6)
    v_mfma_f32_32x32x16_bf16 v[176:191], a[4:7], v[148:151], v[176:191]
    s_waitcnt lgkmcnt(5)
    v_mfma_f32_32x32x16_bf16 v[176:191], a[8:11], v[152:155], v[176:191]
    s_waitcnt lgkmcnt(4)
    v_mfma_f32_32x32x16_bf16 v[176:191], a[12:15], v[156:159], v[176:191]
    s_waitcnt lgkmcnt(3)
    v_mfma_f32_32x32x16_bf16 v[176:191], a[16:19], v[160:163], v[176:191]
    s_waitcnt lgkmcnt(2)
    v_mfma_f32_32x32x16_bf16 v[176:191], a[20:23], v[164:167], v[176:191]
    s_waitcnt lgkmcnt(1)
    v_mfma_f32_32x32x16_bf16 v[176:191], a[24:27], v[168:171], v[176:191]
    s_waitcnt lgkmcnt(0)
    v_mfma_f32_32x32x16_bf16 v[176:191], a[28:31], v[172:175], v[176:191]
    v_mfma_f32_32x32x16_bf16 v[192:207], a[32:35], v[144:147], 0
    v_mfma_f32_32x32x16_bf16 v[192:207], a[36:39], v[148:151], v[192:207]
    v_cvt_pk_bf16_f32 v208, v176, v177
    v_cvt_pk_bf16_f32 v209, v178, v179
    v_cvt_pk_bf16_f32 v210, v180, v181
    v_cvt_pk_bf16_f32 v211, v182, v183
    v_mfma_f32_32x32x16_bf16 v[192:207], a[40:43], v[152:155], v[192:207]
    v_cvt_pk_bf16_f32 v212, v184, v185
    v_cvt_pk_bf16_f32 v213, v186, v187
    v_cvt_pk_bf16_f32 v214, v188, v189
    v_cvt_pk_bf16_f32 v215, v190, v191
    v_mfma_f32_32x32x16_bf16 v[192:207], a[44:47], v[156:159], v[192:207]
    v_permlane32_swap_b32 v208, v210
    v_permlane32_swap_b32 v209, v211
    v_mfma_f32_32x32x16_bf16 v[192:207], a[48:51], v[160:163], v[192:207]
    ds_write_b128 v2, v[208:211] offset:0
    v_mfma_f32_32x32x16_bf16 v[192:207], a[52:55], v[164:167], v[192:207]
    v_permlane32_swap_b32 v212, v214
    v_permlane32_swap_b32 v213, v215
    v_mfma_f32_32x32x16_bf16 v[192:207], a[56:59], v[168:171], v[192:207]
    ds_write_b128 v2, v[212:215] offset:32
    v_mfma_f32_32x32x16_bf16 v[192:207], a[60:63], v[172:175], v[192:207]
    ds_read_b128 v[216:219], v3 offset:0
    ds_read_b128 v[220:223], v3 offset:1280
    v_mfma_f32_32x32x16_bf16 v[176:191], a[64:67], v[144:147], 0
    s_waitcnt lgkmcnt(1)
    buffer_store_dwordx4 v[216:219], v4, s[8:11], s20 offen offset:0
    v_mfma_f32_32x32x16_bf16 v[176:191], a[68:71], v[148:151], v[176:191]
    v_cvt_pk_bf16_f32 v208, v192, v193
    v_cvt_pk_bf16_f32 v209, v194, v195
    v_cvt_pk_bf16_f32 v210, v196, v197
    v_cvt_pk_bf16_f32 v211, v198, v199
    v_mfma_f32_32x32x16_bf16 v[176:191], a[72:75], v[152:155], v[176:191]
    v_cvt_pk_bf16_f32 v212, v200, v201
    v_cvt_pk_bf16_f32 v213, v202, v203
    v_cvt_pk_bf16_f32 v214, v204, v205
    v_cvt_pk_bf16_f32 v215, v206, v207
    v_mfma_f32_32x32x16_bf16 v[176:191], a[76:79], v[156:159], v[176:191]
    v_permlane32_swap_b32 v208, v210
    v_permlane32_swap_b32 v209, v211
    v_mfma_f32_32x32x16_bf16 v[176:191], a[80:83], v[160:163], v[176:191]
    ds_write_b128 v2, v[208:211] offset:2560
    v_mfma_f32_32x32x16_bf16 v[176:191], a[84:87], v[164:167], v[176:191]
    v_permlane32_swap_b32 v212, v214
    v_permlane32_swap_b32 v213, v215
    v_mfma_f32_32x32x16_bf16 v[176:191], a[88:91], v[168:171], v[176:191]
    ds_write_b128 v2, v[212:215] offset:2592
    v_mfma_f32_32x32x16_bf16 v[176:191], a[92:95], v[172:175], v[176:191]
    s_waitcnt lgkmcnt(2)
    buffer_store_dwordx4 v[220:223], v4, s[8:11], s21 offen offset:0
    ds_read_b128 v[216:219], v3 offset:2560
    ds_read_b128 v[220:223], v3 offset:3840
    v_mfma_f32_32x32x16_bf16 v[192:207], a[96:99], v[144:147], 0
    s_waitcnt lgkmcnt(1)
    buffer_store_dwordx4 v[216:219], v4, s[8:11], s20 offen offset:64
    v_mfma_f32_32x32x16_bf16 v[192:207], a[100:103], v[148:151], v[192:207]
    v_cvt_pk_bf16_f32 v208, v176, v177
    v_cvt_pk_bf16_f32 v209, v178, v179
    v_cvt_pk_bf16_f32 v210, v180, v181
    v_cvt_pk_bf16_f32 v211, v182, v183
    v_mfma_f32_32x32x16_bf16 v[192:207], a[104:107], v[152:155], v[192:207]
    v_cvt_pk_bf16_f32 v212, v184, v185
    v_cvt_pk_bf16_f32 v213, v186, v187
    v_cvt_pk_bf16_f32 v214, v188, v189
    v_cvt_pk_bf16_f32 v215, v190, v191
    v_mfma_f32_32x32x16_bf16 v[192:207], a[108:111], v[156:159], v[192:207]
    v_permlane32_swap_b32 v208, v210
    v_permlane32_swap_b32 v209, v211
    v_mfma_f32_32x32x16_bf16 v[192:207], a[112:115], v[160:163], v[192:207]
    ds_write_b128 v2, v[208:211] offset:0
    v_mfma_f32_32x32x16_bf16 v[192:207], a[116:119], v[164:167], v[192:207]
    v_permlane32_swap_b32 v212, v214
    v_permlane32_swap_b32 v213, v215
    v_mfma_f32_32x32x16_bf16 v[192:207], a[120:123], v[168:171], v[192:207]
    ds_write_b128 v2, v[212:215] offset:32
    v_mfma_f32_32x32x16_bf16 v[192:207], a[124:127], v[172:175], v[192:207]
    s_waitcnt lgkmcnt(2)
    buffer_store_dwordx4 v[220:223], v4, s[8:11], s21 offen offset:64
    ds_read_b128 v[216:219], v3 offset:0
    ds_read_b128 v[220:223], v3 offset:1280
    v_mfma_f32_32x32x16_bf16 v[176:191], a[128:131], v[144:147], 0
    s_waitcnt lgkmcnt(1)
    buffer_store_dwordx4 v[216:219], v4, s[8:11], s20 offen offset:128
    v_mfma_f32_32x32x16_bf16 v[176:191], a[132:135], v[148:151], v[176:191]
    v_cvt_pk_bf16_f32 v208, v192, v193
    v_cvt_pk_bf16_f32 v209, v194, v195
    v_cvt_pk_bf16_f32 v210, v196, v197
    v_cvt_pk_bf16_f32 v211, v198, v199
    v_mfma_f32_32x32x16_bf16 v[176:191], a[136:139], v[152:155], v[176:191]
    v_cvt_pk_bf16_f32 v212, v200, v201
    v_cvt_pk_bf16_f32 v213, v202, v203
    v_cvt_pk_bf16_f32 v214, v204, v205
    v_cvt_pk_bf16_f32 v215, v206, v207
    v_mfma_f32_32x32x16_bf16 v[176:191], a[140:143], v[156:159], v[176:191]
    v_permlane32_swap_b32 v208, v210
    v_permlane32_swap_b32 v209, v211
    v_mfma_f32_32x32x16_bf16 v[176:191], a[144:147], v[160:163], v[176:191]
    ds_write_b128 v2, v[208:211] offset:2560
    v_mfma_f32_32x32x16_bf16 v[176:191], a[148:151], v[164:167], v[176:191]
    v_permlane32_swap_b32 v212, v214
    v_permlane32_swap_b32 v213, v215
    v_mfma_f32_32x32x16_bf16 v[176:191], a[152:155], v[168:171], v[176:191]
    ds_write_b128 v2, v[212:215] offset:2592
    v_mfma_f32_32x32x16_bf16 v[176:191], a[156:159], v[172:175], v[176:191]
    s_waitcnt lgkmcnt(2)
    buffer_store_dwordx4 v[220:223], v4, s[8:11], s21 offen offset:128
    ds_read_b128 v[216:219], v3 offset:2560
    ds_read_b128 v[220:223], v3 offset:3840
    s_waitcnt lgkmcnt(1)
    buffer_store_dwordx4 v[216:219], v4, s[8:11], s20 offen offset:192
    s_waitcnt lgkmcnt(0)
    buffer_store_dwordx4 v[220:223], v4, s[8:11], s21 offen offset:192
    s_nop 3
    v_cvt_pk_bf16_f32 v208, v176, v177
    v_cvt_pk_bf16_f32 v209, v178, v179
    v_cvt_pk_bf16_f32 v210, v180, v181
    v_cvt_pk_bf16_f32 v211, v182, v183
    v_cvt_pk_bf16_f32 v212, v184, v185
    v_cvt_pk_bf16_f32 v213, v186, v187
    v_cvt_pk_bf16_f32 v214, v188, v189
    v_cvt_pk_bf16_f32 v215, v190, v191
    v_permlane32_swap_b32 v208, v210
    v_permlane32_swap_b32 v209, v211
    v_permlane32_swap_b32 v212, v214
    v_permlane32_swap_b32 v213, v215
    ds_write_b128 v2, v[208:211] offset:0
    ds_write_b128 v2, v[212:215] offset:32
    ds_read_b128 v[216:219], v3 offset:0
    ds_read_b128 v[220:223], v3 offset:1280
    s_waitcnt lgkmcnt(1)
    buffer_store_dwordx4 v[216:219], v4, s[8:11], s20 offen offset:256
    s_waitcnt lgkmcnt(0)
    buffer_store_dwordx4 v[220:223], v4, s[8:11], s21 offen offset:256
    s_branch lj_30
ls_29:
    ds_read_b128 v[144:147], v1 offset:0
    ds_read_b128 v[148:151], v1 offset:1024
    ds_read_b128 v[152:155], v1 offset:2048
    ds_read_b128 v[156:159], v1 offset:3072
    ds_read_b128 v[160:163], v1 offset:4096
    ds_read_b128 v[164:167], v1 offset:5120
    ds_read_b128 v[168:171], v1 offset:6144
    ds_read_b128 v[172:175], v1 offset:7168
    s_waitcnt lgkmcnt(7)
    v_mfma_f32_32x32x16_bf16 v[176:191], a[0:3], v[144:147], 0
    s_waitcnt lgkmcnt(6)
    v_mfma_f32_32x32x16_bf16 v[176:191], a[4:7], v[148:151], v[176:191]
    s_waitcnt lgkmcnt(5)
    v_mfma_f32_32x32x16_bf16 v[176:191], a[8:11], v[152:155], v[176:191]
    s_waitcnt lgkmcnt(4)
    v_mfma_f32_32x32x16_bf16 v[176:191], a[12:15], v[156:159], v[176:191]
    s_waitcnt lgkmcnt(3)
    v_mfma_f32_32x32x16_bf16 v[176:191], a[16:19], v[160:163], v[176:191]
    s_waitcnt lgkmcnt(2)
    v_mfma_f32_32x32x16_bf16 v[176:191], a[20:23], v[164:167], v[176:191]
    s_waitcnt lgkmcnt(1)
    v_mfma_f32_32x32x16_bf16 v[176:191], a[24:27], v[168:171], v[176:191]
    s_waitcnt lgkmcnt(0)
    v_mfma_f32_32x32x16_bf16 v[176:191], a[28:31], v[172:175], v[176:191]
    v_mfma_f32_32x32x16_bf16 v[192:207], a[32:35], v[144:147], 0
    v_mfma_f32_32x32x16_bf16 v[192:207], a[36:39], v[148:151], v[192:207]
    v_cvt_pk_bf16_f32 v208, v176, v177
    v_cvt_pk_bf16_f32 v209, v178, v179
    v_cvt_pk_bf16_f32 v210, v180, v181
    v_cvt_pk_bf16_f32 v211, v182, v183
    v_mfma_f32_32x32x16_bf16 v[192:207], a[40:43], v[152:155], v[192:207]
    v_cvt_pk_bf16_f32 v212, v184, v185
    v_cvt_pk_bf16_f32 v213, v186, v187
    v_cvt_pk_bf16_f32 v214, v188, v189
    v_cvt_pk_bf16_f32 v215, v190, v191
    v_mfma_f32_32x32x16_bf16 v[192:207], a[44:47], v[156:159], v[192:207]
    v_permlane32_swap_b32 v208, v210
    v_permlane32_swap_b32 v209, v211
    v_mfma_f32_32x32x16_bf16 v[192:207], a[48:51], v[160:163], v[192:207]
    ds_write_b128 v2, v[208:211] offset:0
    v_mfma_f32_32x32x16_bf16 v[192:207], a[52:55], v[164:167], v[192:207]
    v_permlane32_swap_b32 v212, v214
    v_permlane32_swap_b32 v213, v215
    v_mfma_f32_32x32x16_bf16 v[192:207], a[56:59], v[168:171], v[192:207]
    ds_write_b128 v2, v[212:215] offset:32
    v_mfma_f32_32x32x16_bf16 v[192:207], a[60:63], v[172:175], v[192:207]
    ds_read_b128 v[216:219], v3 offset:0
    ds_read_b128 v[220:223], v3 offset:1280
    v_mfma_f32_32x32x16_bf16 v[176:191], a[64:67], v[144:147], 0
    s_waitcnt lgkmcnt(1)
    buffer_store_dwordx4 v[216:219], v4, s[8:11], s20 offen offset:0 sc1
    v_mfma_f32_32x32x16_bf16 v[176:191], a[68:71], v[148:151], v[176:191]
    v_cvt_pk_bf16_f32 v208, v192, v193
    v_cvt_pk_bf16_f32 v209, v194, v195
    v_cvt_pk_bf16_f32 v210, v196, v197
    v_cvt_pk_bf16_f32 v211, v198, v199
    v_mfma_f32_32x32x16_bf16 v[176:191], a[72:75], v[152:155], v[176:191]
    v_cvt_pk_bf16_f32 v212, v200, v201
    v_cvt_pk_bf16_f32 v213, v202, v203
    v_cvt_pk_bf16_f32 v214, v204, v205
    v_cvt_pk_bf16_f32 v215, v206, v207
    v_mfma_f32_32x32x16_bf16 v[176:191], a[76:79], v[156:159], v[176:191]
    v_permlane32_swap_b32 v208, v210
    v_permlane32_swap_b32 v209, v211
    v_mfma_f32_32x32x16_bf16 v[176:191], a[80:83], v[160:163], v[176:191]
    ds_write_b128 v2, v[208:211] offset:2560
    v_mfma_f32_32x32x16_bf16 v[176:191], a[84:87], v[164:167], v[176:191]
    v_permlane32_swap_b32 v212, v214
    v_permlane32_swap_b32 v213, v215
    v_mfma_f32_32x32x16_bf16 v[176:191], a[88:91], v[168:171], v[176:191]
    ds_write_b128 v2, v[212:215] offset:2592
    v_mfma_f32_32x32x16_bf16 v[176:191], a[92:95], v[172:175], v[176:191]
    s_waitcnt lgkmcnt(2)
    buffer_store_dwordx4 v[220:223], v4, s[8:11], s21 offen offset:0 sc1
    ds_read_b128 v[216:219], v3 offset:2560
    ds_read_b128 v[220:223], v3 offset:3840
    v_mfma_f32_32x32x16_bf16 v[192:207], a[96:99], v[144:147], 0
    s_waitcnt lgkmcnt(1)
    buffer_store_dwordx4 v[216:219], v4, s[8:11], s20 offen offset:64 sc1
    v_mfma_f32_32x32x16_bf16 v[192:207], a[100:103], v[148:151], v[192:207]
    v_cvt_pk_bf16_f32 v208, v176, v177
    v_cvt_pk_bf16_f32 v209, v178, v179
    v_cvt_pk_bf16_f32 v210, v180, v181
    v_cvt_pk_bf16_f32 v211, v182, v183
    v_mfma_f32_32x32x16_bf16 v[192:207], a[104:107], v[152:155], v[192:207]
    v_cvt_pk_bf16_f32 v212, v184, v185
    v_cvt_pk_bf16_f32 v213, v186, v187
    v_cvt_pk_bf16_f32 v214, v188, v189
    v_cvt_pk_bf16_f32 v215, v190, v191
    v_mfma_f32_32x32x16_bf16 v[192:207], a[108:111], v[156:159], v[192:207]
    v_permlane32_swap_b32 v208, v210
    v_permlane32_swap_b32 v209, v211
    v_mfma_f32_32x32x16_bf16 v[192:207], a[112:115], v[160:163], v[192:207]
    ds_write_b128 v2, v[208:211] offset:0
    v_mfma_f32_32x32x16_bf16 v[192:207], a[116:119], v[164:167], v[192:207]
    v_permlane32_swap_b32 v212, v214
    v_permlane32_swap_b32 v213, v215
    v_mfma_f32_32x32x16_bf16 v[192:207], a[120:123], v[168:171], v[192:207]
    ds_write_b128 v2, v[212:215] offset:32
    v_mfma_f32_32x32x16_bf16 v[192:207], a[124:127], v[172:175], v[192:207]
    s_waitcnt lgkmcnt(2)
    buffer_store_dwordx4 v[220:223], v4, s[8:11], s21 offen offset:64 sc1
    ds_read_b128 v[216:219], v3 offset:0
    ds_read_b128 v[220:223], v3 offset:1280
    v_mfma_f32_32x32x16_bf16 v[176:191], a[128:131], v[144:147], 0
    s_waitcnt lgkmcnt(1)
    buffer_store_dwordx4 v[216:219], v4, s[8:11], s20 offen offset:128 sc1
    v_mfma_f32_32x32x16_bf16 v[176:191], a[132:135], v[148:151], v[176:191]
    v_cvt_pk_bf16_f32 v208, v192, v193
    v_cvt_pk_bf16_f32 v209, v194, v195
    v_cvt_pk_bf16_f32 v210, v196, v197
    v_cvt_pk_bf16_f32 v211, v198, v199
    v_mfma_f32_32x32x16_bf16 v[176:191], a[136:139], v[152:155], v[176:191]
    v_cvt_pk_bf16_f32 v212, v200, v201
    v_cvt_pk_bf16_f32 v213, v202, v203
    v_cvt_pk_bf16_f32 v214, v204, v205
    v_cvt_pk_bf16_f32 v215, v206, v207
    v_mfma_f32_32x32x16_bf16 v[176:191], a[140:143], v[156:159], v[176:191]
    v_permlane32_swap_b32 v208, v210
    v_permlane32_swap_b32 v209, v211
    v_mfma_f32_32x32x16_bf16 v[176:191], a[144:147], v[160:163], v[176:191]
    ds_write_b128 v2, v[208:211] offset:2560
    v_mfma_f32_32x32x16_bf16 v[176:191], a[148:151], v[164:167], v[176:191]
    v_permlane32_swap_b32 v212, v214
    v_permlane32_swap_b32 v213, v215
    v_mfma_f32_32x32x16_bf16 v[176:191], a[152:155], v[168:171], v[176:191]
    ds_write_b128 v2, v[212:215] offset:2592
    v_mfma_f32_32x32x16_bf16 v[176:191], a[156:159], v[172:175], v[176:191]
    s_waitcnt lgkmcnt(2)
    buffer_store_dwordx4 v[220:223], v4, s[8:11], s21 offen offset:128 sc1
    ds_read_b128 v[216:219], v3 offset:2560
    ds_read_b128 v[220:223], v3 offset:3840
    s_waitcnt lgkmcnt(1)
    buffer_store_dwordx4 v[216:219], v4, s[8:11], s20 offen offset:192 sc1
    s_waitcnt lgkmcnt(0)
    buffer_store_dwordx4 v[220:223], v4, s[8:11], s21 offen offset:192 sc1
    s_nop 3
    v_cvt_pk_bf16_f32 v208, v176, v177
    v_cvt_pk_bf16_f32 v209, v178, v179
    v_cvt_pk_bf16_f32 v210, v180, v181
    v_cvt_pk_bf16_f32 v211, v182, v183
    v_cvt_pk_bf16_f32 v212, v184, v185
    v_cvt_pk_bf16_f32 v213, v186, v187
    v_cvt_pk_bf16_f32 v214, v188, v189
    v_cvt_pk_bf16_f32 v215, v190, v191
    v_permlane32_swap_b32 v208, v210
    v_permlane32_swap_b32 v209, v211
    v_permlane32_swap_b32 v212, v214
    v_permlane32_swap_b32 v213, v215
    ds_write_b128 v2, v[208:211] offset:0
    ds_write_b128 v2, v[212:215] offset:32
    ds_read_b128 v[216:219], v3 offset:0
    ds_read_b128 v[220:223], v3 offset:1280
    s_waitcnt lgkmcnt(1)
    buffer_store_dwordx4 v[216:219], v4, s[8:11], s20 offen offset:256 sc1
    s_waitcnt lgkmcnt(0)
    buffer_store_dwordx4 v[220:223], v4, s[8:11], s21 offen offset:256 sc1
lj_30:
    s_add_u32 s28, s28, 1
    s_waitcnt vmcnt(0)
    s_barrier
    s_cmp_lg_u32 s5, 0
    s_cbranch_scc1 sig_31
    v_mov_b32 v246, s28
    v_mov_b32 v247, 0
    s_mov_b64 exec, 1
    s_cmp_lg_u32 s45, 1
    s_cbranch_scc1 ls_32
    buffer_store_dword v246, v247, s[8:11], s40 offen
    s_branch lj_33
ls_32:
    buffer_store_dword v246, v247, s[8:11], s40 offen sc1
lj_33:
    s_mov_b64 exec, -1
sig_31:
    s_cmp_eq_u32 s5, 0
    s_cbranch_scc1 AT_c_35
    s_cmp_ge_u32 s27, 61
    s_cbranch_scc1 AT_nopf_36
    s_lshl_b32 s20, s4, 7
    s_add_u32 s29, s27, 5
    s_lshr_b32 s29, s29, 1
    s_min_u32 s29, s29, 32
    s_cmp_ge_u32 s73, s29
    s_cbranch_scc1 pcok_38
    v_min_u32_e64 v246, 5, v0
    v_lshlrev_b32 v246, 2, v246
pc_37:
    buffer_load_dword v247, v246, s[8:11], s20 offen sc1
    s_waitcnt vmcnt(0)
    v_readlane_b32 s73, v247, 0
    v_readlane_b32 s7, v247, 1
    s_nop 0
    s_min_u32 s73, s73, s7
    v_readlane_b32 s7, v247, 2
    s_nop 0
    s_min_u32 s73, s73, s7
    v_readlane_b32 s7, v247, 3
    s_nop 0
    s_min_u32 s73, s73, s7
    v_readlane_b32 s7, v247, 4
    s_nop 0
    s_min_u32 s73, s73, s7
    v_readlane_b32 s7, v247, 5
    s_nop 0
    s_min_u32 s73, s73, s7
    s_cmp_ge_u32 s73, s29
    s_cbranch_scc1 pcok_38
    s_sleep 1
    s_add_u32 s6, s6, 1
    s_cmp_lt_u32 s6, 400000
    s_cbranch_scc1 pc_37
    s_branch pcok_38
pcok_38:
    s_add_u32 s20, s27, 3
    s_lshl_b32 s20, s20, 5
    s_add_u32 s20, s20, s4
    s_lshl_b32 s36, s20, 13
    s_add_u32 s36, s36, 0x100000
    s_add_u32 s98, s36, 4096
    s_add_u32 s96, s36, s70
    s_add_u32 s96, s96, 0x2000000
    s_add_u32 s97, s96, 4096
    s_add_u32 s99, s36, s71
    s_add_u32 s99, s99, 0x1000000
    buffer_load_dwordx4 v[36:39], v1, s[8:11], s36 offen offset:0 sc1 nt
    buffer_load_dwordx4 v[40:43], v1, s[8:11], s36 offen offset:1024 sc1 nt
    buffer_load_dwordx4 v[44:47], v1, s[8:11], s36 offen offset:2048 sc1 nt
    buffer_load_dwordx4 v[48:51], v1, s[8:11], s36 offen offset:3072 sc1 nt
    buffer_load_dwordx4 v[52:55], v1, s[8:11], s98 offen offset:0 sc1 nt
    buffer_load_dwordx4 v[56:59], v1, s[8:11], s98 offen offset:1024 sc1 nt
    buffer_load_dwordx4 v[60:63], v1, s[8:11], s98 offen offset:2048 sc1 nt
    buffer_load_dwordx4 v[64:67], v1, s[8:11], s98 offen offset:3072 sc1 nt
    buffer_load_dwordx4 v[20:23], v1, s[8:11], s96 offen offset:0 sc1 nt
    buffer_load_dwordx4 v[24:27], v1, s[8:11], s96 offen offset:2048 sc1 nt
    buffer_load_dwordx4 v[28:31], v1, s[8:11], s97 offen offset:0 sc1 nt
    buffer_load_dwordx4 v[32:35], v1, s[8:11], s97 offen offset:2048 sc1 nt
    buffer_load_dwordx4 v[84:87], v1, s[8:11], s99 offen offset:0 sc1 nt
    buffer_load_dwordx4 v[88:91], v1, s[8:11], s99 offen offset:1024 sc1 nt
    buffer_load_dwordx4 v[92:95], v1, s[8:11], s99 offen offset:2048 sc1 nt
    buffer_load_dwordx4 v[96:99], v1, s[8:11], s99 offen offset:3072 sc1 nt
AT_nopf_36:
    s_waitcnt vmcnt(0)
    s_branch AT_nc_34
AT_c_35:
    s_lshl_b32 s20, s64, 7
    s_add_u32 s20, s20, 0x2400
    v_min_u32 v246, 31, v0
    v_lshlrev_b32_e64 v246, 2, v246
pg_39:
    buffer_load_dword v247, v246, s[8:11], s20 offen sc1
    s_waitcnt vmcnt(0)
    v_cmp_gt_u32 vcc, s28, v247
    s_cbranch_vccz pgok_40
    s_add_u32 s6, s6, 1
    s_cmp_lt_u32 s6, 400000
    s_cbranch_scc1 pg_39
    s_branch pgok_40
pgok_40:
    s_mul_i32 s20, s4, 40960
    s_add_u32 s20, s20, s38
    s_add_u32 s21, s20, 0
    buffer_load_dwordx4 a[160:163], v6, s[8:11], s21 offen offset:0 sc1
    buffer_load_dwordx4 a[164:167], v6, s[8:11], s21 offen offset:256 sc1
    buffer_load_dwordx4 a[168:171], v6, s[8:11], s21 offen offset:512 sc1
    buffer_load_dwordx4 a[172:175], v6, s[8:11], s21 offen offset:768 sc1
    buffer_load_dwordx4 a[176:179], v6, s[8:11], s21 offen offset:1024 sc1
    s_add_u32 s21, s20, 5120
    buffer_load_dwordx4 a[180:183], v6, s[8:11], s21 offen offset:0 sc1
    buffer_load_dwordx4 a[184:187], v6, s[8:11], s21 offen offset:256 sc1
    buffer_load_dwordx4 a[188:191], v6, s[8:11], s21 offen offset:512 sc1
    buffer_load_dwordx4 a[192:195], v6, s[8:11], s21 offen offset:768 sc1
    buffer_load_dwordx4 a[196:199], v6, s[8:11], s21 offen offset:1024 sc1
    s_add_u32 s21, s20, 10240
    buffer_load_dwordx4 a[200:203], v6, s[8:11], s21 offen offset:0 sc1
    buffer_load_dwordx4 a[204:207], v6, s[8:11], s21 offen offset:256 sc1
    buffer_load_dwordx4 a[208:211], v6, s[8:11], s21 offen offset:512 sc1
    buffer_load_dwordx4 a[212:215], v6, s[8:11], s21 offen offset:768 sc1
    buffer_load_dwordx4 a[216:219], v6, s[8:11], s21 offen offset:1024 sc1
    s_add_u32 s21, s20, 15360
    buffer_load_dwordx4 a[220:223], v6, s[8:11], s21 offen offset:0 sc1
    buffer_load_dwordx4 a[224:227], v6, s[8:11], s21 offen offset:256 sc1
    buffer_load_dwordx4 a[228:231], v6, s[8:11], s21 offen offset:512 sc1
    buffer_load_dwordx4 a[232:235], v6, s[8:11], s21 offen offset:768 sc1
    buffer_load_dwordx4 a[236:239], v6, s[8:11], s21 offen offset:1024 sc1
    s_add_u32 s21, s20, 20480
    buffer_load_dwordx4 a[240:243], v6, s[8:11], s21 offen offset:0 sc1
    buffer_load_dwordx4 a[244:247], v6, s[8:11], s21 offen offset:256 sc1
    buffer_load_dwordx4 a[248:251], v6, s[8:11], s21 offen offset:512 sc1
    buffer_load_dwordx4 a[252:255], v6, s[8:11], s21 offen offset:768 sc1
    buffer_load_dwordx4 v[144:147], v6, s[8:11], s21 offen offset:1024 sc1
    s_add_u32 s21, s20, 25600
    buffer_load_dwordx4 v[148:151], v6, s[8:11], s21 offen offset:0 sc1
    buffer_load_dwordx4 v[152:155], v6, s[8:11], s21 offen offset:256 sc1
    buffer_load_dwordx4 v[156:159], v6, s[8:11], s21 offen offset:512 sc1
    buffer_load_dwordx4 v[160:163], v6, s[8:11], s21 offen offset:768 sc1
    buffer_load_dwordx4 v[164:167], v6, s[8:11], s21 offen offset:1024 sc1
    s_add_u32 s21, s20, 30720
    buffer_load_dwordx4 v[168:171], v6, s[8:11], s21 offen offset:0 sc1
    buffer_load_dwordx4 v[172:175], v6, s[8:11], s21 offen offset:256 sc1
    buffer_load_dwordx4 v[176:179], v6, s[8:11], s21 offen offset:512 sc1
    buffer_load_dwordx4 v[180:183], v6, s[8:11], s21 offen offset:768 sc1
    buffer_load_dwordx4 v[184:187], v6, s[8:11], s21 offen offset:1024 sc1
    s_add_u32 s21, s20, 35840
    buffer_load_dwordx4 v[188:191], v6, s[8:11], s21 offen offset:0 sc1
    buffer_load_dwordx4 v[192:195], v6, s[8:11], s21 offen offset:256 sc1
    buffer_load_dwordx4 v[196:199], v6, s[8:11], s21 offen offset:512 sc1
    buffer_load_dwordx4 v[200:203], v6, s[8:11], s21 offen offset:768 sc1
    buffer_load_dwordx4 v[204:207], v6, s[8:11], s21 offen offset:1024 sc1
    s_waitcnt vmcnt(39)
    v_mfma_f32_16x16x32_bf16 v[224:227], v[8:11], a[160:163], 0
    s_waitcnt vmcnt(38)
    v_mfma_f32_16x16x32_bf16 v[224:227], v[12:15], a[164:167], v[224:227]
    s_waitcnt vmcnt(37)
    v_mfma_f32_16x16x32_bf16 v[228:231], v[8:11], a[168:171], 0
    s_waitcnt vmcnt(36)
    v_mfma_f32_16x16x32_bf16 v[228:231], v[12:15], a[172:175], v[228:231]
    s_waitcnt vmcnt(35)
    v_mfma_f32_16x16x32_bf16 v[232:235], v[8:11], a[176:179], 0
    s_waitcnt vmcnt(34)
    v_mfma_f32_16x16x32_bf16 v[224:227], v[8:11], a[180:183], v[224:227]
    s_waitcnt vmcnt(33)
    v_mfma_f32_16x16x32_bf16 v[224:227], v[12:15], a[184:187], v[224:227]
    s_waitcnt vmcnt(32)
    v_mfma_f32_16x16x32_bf16 v[228:231], v[8:11], a[188:191], v[228:231]
    s_waitcnt vmcnt(31)
    v_mfma_f32_16x16x32_bf16 v[228:231], v[12:15], a[192:195], v[228:231]
    s_waitcnt vmcnt(30)
    v_mfma_f32_16x16x32_bf16 v[232:235], v[8:11], a[196:199], v[232:235]
    s_waitcnt vmcnt(29)
    v_mfma_f32_16x16x32_bf16 v[224:227], v[8:11], a[200:203], v[224:227]
    s_waitcnt vmcnt(28)
    v_mfma_f32_16x16x32_bf16 v[224:227], v[12:15], a[204:207], v[224:227]
    s_waitcnt vmcnt(27)
    v_mfma_f32_16x16x32_bf16 v[228:231], v[8:11], a[208:211], v[228:231]
    s_waitcnt vmcnt(26)
    v_mfma_f32_16x16x32_bf16 v[228:231], v[12:15], a[212:215], v[228:231]
    s_waitcnt vmcnt(25)
    v_mfma_f32_16x16x32_bf16 v[232:235], v[8:11], a[216:219], v[232:235]
    s_waitcnt vmcnt(24)
    v_mfma_f32_16x16x32_bf16 v[224:227], v[8:11], a[220:223], v[224:227]
    s_waitcnt vmcnt(23)
    v_mfma_f32_16x16x32_bf16 v[224:227], v[12:15], a[224:227], v[224:227]
    s_waitcnt vmcnt(22)
    v_mfma_f32_16x16x32_bf16 v[228:231], v[8:11], a[228:231], v[228:231]
    s_waitcnt vmcnt(21)
    v_mfma_f32_16x16x32_bf16 v[228:231], v[12:15], a[232:235], v[228:231]
    s_waitcnt vmcnt(20)
    v_mfma_f32_16x16x32_bf16 v[232:235], v[8:11], a[236:239], v[232:235]
    s_waitcnt vmcnt(19)
    v_mfma_f32_16x16x32_bf16 v[224:227], v[8:11], a[240:243], v[224:227]
    s_waitcnt vmcnt(18)
    v_mfma_f32_16x16x32_bf16 v[224:227], v[12:15], a[244:247], v[224:227]
    s_waitcnt vmcnt(17)
    v_mfma_f32_16x16x32_bf16 v[228:231], v[8:11], a[248:251], v[228:231]
    s_waitcnt vmcnt(16)
    v_mfma_f32_16x16x32_bf16 v[228:231], v[12:15], a[252:255], v[228:231]
    s_waitcnt vmcnt(15)
    v_mfma_f32_16x16x32_bf16 v[232:235], v[8:11], v[144:147], v[232:235]
    s_waitcnt vmcnt(14)
    v_mfma_f32_16x16x32_bf16 v[224:227], v[8:11], v[148:151], v[224:227]
    s_waitcnt vmcnt(13)
    v_mfma_f32_16x16x32_bf16 v[224:227], v[12:15], v[152:155], v[224:227]
    s_waitcnt vmcnt(12)
    v_mfma_f32_16x16x32_bf16 v[228:231], v[8:11], v[156:159], v[228:231]
    s_waitcnt vmcnt(11)
    v_mfma_f32_16x16x32_bf16 v[228:231], v[12:15], v[160:163], v[228:231]
    s_waitcnt vmcnt(10)
    v_mfma_f32_16x16x32_bf16 v[232:235], v[8:11], v[164:167], v[232:235]
    s_waitcnt vmcnt(9)
    v_mfma_f32_16x16x32_bf16 v[224:227], v[8:11], v[168:171], v[224:227]
    s_waitcnt vmcnt(8)
    v_mfma_f32_16x16x32_bf16 v[224:227], v[12:15], v[172:175], v[224:227]
    s_waitcnt vmcnt(7)
    v_mfma_f32_16x16x32_bf16 v[228:231], v[8:11], v[176:179], v[228:231]
    s_waitcnt vmcnt(6)
    v_mfma_f32_16x16x32_bf16 v[228:231], v[12:15], v[180:183], v[228:231]
    s_waitcnt vmcnt(5)
    v_mfma_f32_16x16x32_bf16 v[232:235], v[8:11], v[184:187], v[232:235]
    s_waitcnt vmcnt(4)
    v_mfma_f32_16x16x32_bf16 v[224:227], v[8:11], v[188:191], v[224:227]
    s_waitcnt vmcnt(3)
    v_mfma_f32_16x16x32_bf16 v[224:227], v[12:15], v[192:195], v[224:227]
    s_waitcnt vmcnt(2)
    v_mfma_f32_16x16x32_bf16 v[228:231], v[8:11], v[196:199], v[228:231]
    s_waitcnt vmcnt(1)
    v_mfma_f32_16x16x32_bf16 v[228:231], v[12:15], v[200:203], v[228:231]
    s_waitcnt vmcnt(0)
    v_mfma_f32_16x16x32_bf16 v[232:235], v[8:11], v[204:207], v[232:235]
    v_mov_b32 v246, s28
    v_mov_b32 v247, 0
    s_mov_b64 exec, 1
    s_cmp_lg_u32 s45, 1
    s_cbranch_scc1 ls_41
    buffer_store_dword v246, v247, s[8:11], s47 offen
    s_branch lj_42
ls_41:
    buffer_store_dword v246, v247, s[8:11], s47 offen sc1
lj_42:
    s_mov_b64 exec, -1
    s_cmp_ge_u32 s27, 61
    s_cbranch_scc1 AT_nopf_43
    s_lshl_b32 s20, s4, 7
    s_add_u32 s29, s27, 5
    s_lshr_b32 s29, s29, 1
    s_min_u32 s29, s29, 32
    s_cmp_ge_u32 s73, s29
    s_cbranch_scc1 pcok_45
    v_min_u32 v246, 5, v0
    v_lshlrev_b32 v246, 2, v246
pc_44:
    buffer_load_dword v247, v246, s[8:11], s20 offen sc1
    s_waitcnt vmcnt(0)
    v_readlane_b32 s73, v247, 0
    v_readlane_b32 s7, v247, 1
    s_nop 0
    s_min_u32 s73, s73, s7
    v_readlane_b32 s7, v247, 2
    s_nop 0
    s_min_u32 s73, s73, s7
    v_readlane_b32 s7, v247, 3
    s_nop 0
    s_min_u32 s73, s73, s7
    v_readlane_b32 s7, v247, 4
    s_nop 0
    s_min_u32 s73, s73, s7
    v_readlane_b32 s7, v247, 5
    s_nop 0
    s_min_u32 s73, s73, s7
    s_cmp_ge_u32 s73, s29
    s_cbranch_scc1 pcok_45
    s_sleep 1
    s_add_u32 s6, s6, 1
    s_cmp_lt_u32 s6, 400000
    s_cbranch_scc1 pc_44
    s_branch pcok_45
pcok_45:
    s_add_u32 s20, s27, 3
    s_lshl_b32 s20, s20, 5
    s_add_u32 s20, s20, s4
    s_lshl_b32 s36, s20, 13
    s_add_u32 s36, s36, 0x100000
    s_add_u32 s98, s36, 4096
    s_add_u32 s96, s36, s70
    s_add_u32 s96, s96, 0x2000000
    s_add_u32 s97, s96, 4096
    s_add_u32 s99, s36, s71
    s_add_u32 s99, s99, 0x1000000
    buffer_load_dwordx4 v[36:39], v1, s[8:11], s36 offen offset:0 sc1 nt
    buffer_load_dwordx4 v[40:43], v1, s[8:11], s36 offen offset:1024 sc1 nt
    buffer_load_dwordx4 v[44:47], v1, s[8:11], s36 offen offset:2048 sc1 nt
    buffer_load_dwordx4 v[48:51], v1, s[8:11], s36 offen offset:3072 sc1 nt
    buffer_load_dwordx4 v[52:55], v1, s[8:11], s98 offen offset:0 sc1 nt
    buffer_load_dwordx4 v[56:59], v1, s[8:11], s98 offen offset:1024 sc1 nt
    buffer_load_dwordx4 v[60:63], v1, s[8:11], s98 offen offset:2048 sc1 nt
    buffer_load_dwordx4 v[64:67], v1, s[8:11], s98 offen offset:3072 sc1 nt
    buffer_load_dwordx4 v[20:23], v1, s[8:11], s96 offen offset:0 sc1 nt
    buffer_load_dwordx4 v[24:27], v1, s[8:11], s96 offen offset:2048 sc1 nt
    buffer_load_dwordx4 v[28:31], v1, s[8:11], s97 offen offset:0 sc1 nt
    buffer_load_dwordx4 v[32:35], v1, s[8:11], s97 offen offset:2048 sc1 nt
    buffer_load_dwordx4 v[84:87], v1, s[8:11], s99 offen offset:0 sc1 nt
    buffer_load_dwordx4 v[88:91], v1, s[8:11], s99 offen offset:1024 sc1 nt
    buffer_load_dwordx4 v[92:95], v1, s[8:11], s99 offen offset:2048 sc1 nt
    buffer_load_dwordx4 v[96:99], v1, s[8:11], s99 offen offset:3072 sc1 nt
AT_nopf_43:
    v_and_b32 v109, 0xffff0000, v236
    v_lshlrev_b32_e64 v108, 16, v236
    v_and_b32 v111, 0xffff0000, v237
    v_lshlrev_b32_e64 v110, 16, v237
    v_and_b32 v113, 0xffff0000, v238
    v_lshlrev_b32_e64 v112, 16, v238
    v_and_b32 v115, 0xffff0000, v239
    v_lshlrev_b32_e64 v114, 16, v239
    v_and_b32 v117, 0xffff0000, v240
    v_lshlrev_b32_e64 v116, 16, v240
    v_and_b32 v119, 0xffff0000, v241
    v_lshlrev_b32_e64 v118, 16, v241
    v_cvt_pk_bf16_f32 v144, v224, v225
    v_cvt_pk_bf16_f32 v145, v226, v227
    v_cvt_pk_bf16_f32 v146, v228, v229
    v_cvt_pk_bf16_f32 v147, v230, v231
    v_cvt_pk_bf16_f32 v148, v232, v233
    v_cvt_pk_bf16_f32 v149, v234, v235
    v_and_b32 v225, 0xffff0000, v144
    v_lshlrev_b32_e64 v224, 16, v144
    v_and_b32 v227, 0xffff0000, v145
    v_lshlrev_b32_e64 v226, 16, v145
    v_and_b32 v229, 0xffff0000, v146
    v_lshlrev_b32_e64 v228, 16, v146
    v_and_b32 v231, 0xffff0000, v147
    v_lshlrev_b32_e64 v230, 16, v147
    v_and_b32 v233, 0xffff0000, v148
    v_lshlrev_b32_e64 v232, 16, v148
    v_and_b32 v235, 0xffff0000, v149
    v_lshlrev_b32_e64 v234, 16, v149
    v_pk_add_f32 v[108:109], v[108:109], v[224:225]
    v_pk_add_f32 v[110:111], v[110:111], v[226:227]
    v_pk_add_f32 v[112:113], v[112:113], v[228:229]
    v_pk_add_f32 v[114:115], v[114:115], v[230:231]
    v_pk_add_f32 v[116:117], v[116:117], v[232:233]
    v_pk_add_f32 v[118:119], v[118:119], v[234:235]
    v_cvt_pk_bf16_f32 v236, v108, v109
    v_cvt_pk_bf16_f32 v237, v110, v111
    v_cvt_pk_bf16_f32 v238, v112, v113
    v_cvt_pk_bf16_f32 v239, v114, v115
    v_cvt_pk_bf16_f32 v240, v116, v117
    v_cvt_pk_bf16_f32 v241, v118, v119
    s_add_u32 s20, s39, 0x48b0a00
    buffer_store_dwordx2 v[236:237], v7, s[8:11], s20 offen offset:0 sc1
    buffer_store_dwordx2 v[238:239], v7, s[8:11], s20 offen offset:512 sc1
    s_mov_b64 exec, s[42:43]
    buffer_store_dwordx2 v[240:241], v7, s[8:11], s20 offen offset:1024 sc1
    s_mov_b64 exec, -1
    v_and_b32 v109, 0xffff0000, v236
    v_lshlrev_b32_e64 v108, 16, v236
    v_and_b32 v111, 0xffff0000, v237
    v_lshlrev_b32_e64 v110, 16, v237
    v_and_b32 v113, 0xffff0000, v238
    v_lshlrev_b32_e64 v112, 16, v238
    v_and_b32 v115, 0xffff0000, v239
    v_lshlrev_b32_e64 v114, 16, v239
    v_and_b32 v117, 0xffff0000, v240
    v_lshlrev_b32_e64 v116, 16, v240
    v_and_b32 v119, 0xffff0000, v241
    v_lshlrev_b32_e64 v118, 16, v241
    v_pk_add_f32 v[128:129], v[108:109], v[110:111]
    v_pk_add_f32 v[130:131], v[112:113], v[114:115]
    v_pk_add_f32 v[132:133], v[116:117], v[118:119]
    v_pk_add_f32 v[128:129], v[128:129], v[130:131]
    v_pk_add_f32 v[128:129], v[128:129], v[132:133]
    v_add_f32 v128, v128, v129
    s_nop 1
    v_add_f32_dpp v128, v128, v128 row_ror:8 row_mask:0xf bank_mask:0xf
    s_nop 1
    v_add_f32_dpp v128, v128, v128 row_ror:4 row_mask:0xf bank_mask:0xf
    s_nop 1
    v_add_f32_dpp v128, v128, v128 row_ror:2 row_mask:0xf bank_mask:0xf
    s_nop 1
    v_add_f32_dpp v128, v128, v128 row_ror:1 row_mask:0xf bank_mask:0xf
    v_mov_b32 v129, v128
    s_nop 1
    v_permlane16_swap_b32 v128, v129
    v_add_f32 v128, v128, v129
    v_mov_b32 v129, v128
    s_nop 1
    v_permlane32_swap_b32 v128, v129
    v_add_f32_e64 v128, v128, v129
    v_mul_f32 v128, 0x3acccccd, v128
    v_cvt_pk_bf16_f32 v132, v128, v128
    v_and_b32 v132, 0xffff0000, v132
    v_sub_f32_e64 v128, v132, v128
    v_pk_add_f32 v[108:109], v[108:109], v[132:133] op_sel_hi:[1,0] neg_lo:[0,1] neg_hi:[0,1]
    v_pk_add_f32 v[110:111], v[110:111], v[132:133] op_sel_hi:[1,0] neg_lo:[0,1] neg_hi:[0,1]
    v_pk_add_f32 v[112:113], v[112:113], v[132:133] op_sel_hi:[1,0] neg_lo:[0,1] neg_hi:[0,1]
    v_pk_add_f32 v[114:115], v[114:115], v[132:133] op_sel_hi:[1,0] neg_lo:[0,1] neg_hi:[0,1]
    s_mov_b64 exec, s[42:43]
    v_pk_add_f32 v[116:117], v[116:117], v[132:133] op_sel_hi:[1,0] neg_lo:[0,1] neg_hi:[0,1]
    v_pk_add_f32 v[118:119], v[118:119], v[132:133] op_sel_hi:[1,0] neg_lo:[0,1] neg_hi:[0,1]
    s_mov_b64 exec, -1
    v_pk_mul_f32 v[130:131], v[108:109], v[108:109]
    v_pk_fma_f32 v[130:131], v[110:111], v[110:111], v[130:131]
    v_pk_fma_f32 v[130:131], v[112:113], v[112:113], v[130:131]
    v_pk_fma_f32 v[130:131], v[114:115], v[114:115], v[130:131]
    v_pk_fma_f32 v[130:131], v[116:117], v[116:117], v[130:131]
    v_pk_fma_f32 v[130:131], v[118:119], v[118:119], v[130:131]
    v_add_f32 v130, v130, v131
    s_nop 1
    v_add_f32_dpp v130, v130, v130 row_ror:8 row_mask:0xf bank_mask:0xf
    s_nop 1
    v_add_f32_dpp v130, v130, v130 row_ror:4 row_mask:0xf bank_mask:0xf
    s_nop 1
    v_add_f32_dpp v130, v130, v130 row_ror:2 row_mask:0xf bank_mask:0xf
    s_nop 1
    v_add_f32_dpp v130, v130, v130 row_ror:1 row_mask:0xf bank_mask:0xf
    v_mov_b32 v131, v130
    s_nop 1
    v_permlane16_swap_b32 v130, v131
    v_add_f32 v130, v130, v131
    v_mov_b32 v131, v130
    s_nop 1
    v_permlane32_swap_b32 v130, v131
    v_add_f32_e64 v130, v130, v131
    v_mul_f32 v130, 0x3acccccd, v130
    v_fma_f32 v130, -v128, v128, v130
    v_max_f32_e64 v131, 0, v130
    v_cvt_pk_bf16_f32 v130, v131, v131
    v_and_b32 v130, 0xffff0000, v130
    v_add_f32_e64 v130, s44, v130
    v_cvt_pk_bf16_f32 v130, v130, v130
    v_and_b32 v130, 0xffff0000, v130
    v_sqrt_f32 v130, v130
    s_nop 0
    v_cvt_pk_bf16_f32 v130, v130, v130
    v_and_b32 v130, 0xffff0000, v130
    v_rcp_f32 v130, v130
    s_nop 0
    v_pk_mul_f32 v[108:109], v[108:109], v[130:131] op_sel_hi:[1,0]
    v_pk_mul_f32 v[110:111], v[110:111], v[130:131] op_sel_hi:[1,0]
    v_pk_mul_f32 v[112:113], v[112:113], v[130:131] op_sel_hi:[1,0]
    v_pk_mul_f32 v[114:115], v[114:115], v[130:131] op_sel_hi:[1,0]
    v_pk_mul_f32 v[116:117], v[116:117], v[130:131] op_sel_hi:[1,0]
    v_pk_mul_f32 v[118:119], v[118:119], v[130:131] op_sel_hi:[1,0]
    v_cvt_pk_bf16_f32 v144, v108, v109
    v_cvt_pk_bf16_f32 v145, v110, v111
    v_cvt_pk_bf16_f32 v146, v112, v113
    v_cvt_pk_bf16_f32 v147, v114, v115
    v_cvt_pk_bf16_f32 v148, v116, v117
    v_cvt_pk_bf16_f32 v149, v118, v119
    s_add_u32 s20, s39, 0x4b40a00
    buffer_store_dwordx2 v[144:145], v7, s[8:11], s20 offen offset:0 sc1
    buffer_store_dwordx2 v[146:147], v7, s[8:11], s20 offen offset:512 sc1
    s_mov_b64 exec, s[42:43]
    buffer_store_dwordx2 v[148:149], v7, s[8:11], s20 offen offset:1024 sc1
    s_mov_b64 exec, -1
    v_and_b32 v109, 0xffff0000, v144
    v_lshlrev_b32_e64 v108, 16, v144
    v_and_b32 v111, 0xffff0000, v145
    v_lshlrev_b32_e64 v110, 16, v145
    v_and_b32 v113, 0xffff0000, v146
    v_lshlrev_b32_e64 v112, 16, v146
    v_and_b32 v115, 0xffff0000, v147
    v_lshlrev_b32_e64 v114, 16, v147
    v_and_b32 v117, 0xffff0000, v148
    v_lshlrev_b32_e64 v116, 16, v148
    v_and_b32 v119, 0xffff0000, v149
    v_lshlrev_b32 v118, 16, v149
    v_mul_f32 v128, v128, v130
    v_mul_f32 v131, v131, v130
    v_mul_f32 v131, v131, v130
    v_cvt_pk_bf16_f32 v128, v128, v128
    v_and_b32 v128, 0xffff0000, v128
    v_cvt_pk_bf16_f32 v130, v131, v131
    v_and_b32 v130, 0xffff0000, v130
    v_add_f32_e64 v130, s44, v130
    v_cvt_pk_bf16_f32 v130, v130, v130
    v_and_b32 v130, 0xffff0000, v130
    v_sqrt_f32 v130, v130
    s_nop 0
    v_cvt_pk_bf16_f32 v130, v130, v130
    v_and_b32 v130, 0xffff0000, v130
    v_rcp_f32 v130, v130
    s_nop 0
    v_mul_f32_e64 v128, v128, v130
    v_pk_fma_f32 v[108:109], v[108:109], v[130:131], v[128:129] op_sel_hi:[1,0,0]
    v_pk_fma_f32 v[110:111], v[110:111], v[130:131], v[128:129] op_sel_hi:[1,0,0]
    v_pk_fma_f32 v[112:113], v[112:113], v[130:131], v[128:129] op_sel_hi:[1,0,0]
    v_pk_fma_f32 v[114:115], v[114:115], v[130:131], v[128:129] op_sel_hi:[1,0,0]
    v_pk_fma_f32 v[116:117], v[116:117], v[130:131], v[128:129] op_sel_hi:[1,0,0]
    v_pk_fma_f32 v[118:119], v[118:119], v[130:131], v[128:129] op_sel_hi:[1,0,0]
    v_cvt_pk_bf16_f32 v150, v108, v109
    v_cvt_pk_bf16_f32 v151, v110, v111
    v_cvt_pk_bf16_f32 v152, v112, v113
    v_cvt_pk_bf16_f32 v153, v114, v115
    v_cvt_pk_bf16_f32 v154, v116, v117
    v_cvt_pk_bf16_f32 v155, v118, v119
    s_add_u32 s20, s39, 0x4390a00
    buffer_store_dwordx2 v[150:151], v7, s[8:11], s20 offen offset:0 sc1
    buffer_store_dwordx2 v[152:153], v7, s[8:11], s20 offen offset:512 sc1
    s_mov_b64 exec, s[42:43]
    buffer_store_dwordx2 v[154:155], v7, s[8:11], s20 offen offset:1024 sc1
    s_mov_b64 exec, -1
    s_waitcnt vmcnt(0)
    v_mov_b32 v246, s28
    v_mov_b32 v247, 0
    s_mov_b64 exec, 1
    buffer_store_dword v246, v247, s[8:11], s41 offen sc1
    s_mov_b64 exec, -1
AT_nc_34:
    s_add_u32 s27, s27, 3
    s_cmp_lt_u32 s27, 64
    s_cbranch_scc1 AT_top_23
    s_branch L_fin
post_m_19:
    s_sub_u32 s46, s3, 5
    s_cmp_ge_u32 s4, 19
    s_cbranch_scc1 post_r_20
    s_cmp_ge_u32 s4, 5
    s_cselect_b32 s64, 1, 0
    s_cbranch_scc1 DF_f_46
    s_mov_b32 s65, s4
    s_load_dwordx2 s[76:77], s[0:1], 64
    s_waitcnt lgkmcnt(0)
    s_mov_b32 s16, s76
    s_and_b32 s17, s77, 0xffff
    s_mov_b32 s18, 0xc8000
    s_mov_b32 s19, 0x20000
    s_lshl_b32 s23, s65, 8
    v_lshrrev_b32 v30, 4, v0
    v_and_b32 v31, 15, v0
    v_lshlrev_b32 v28, 2, v30
    v_xor_b32 v28, v28, v31
    v_lshlrev_b32 v28, 4, v28
    v_mul_u32_u24 v31, 1280, v30
    v_add_u32 v28, v28, v31
    s_mul_i32 s20, s5, 20480
    s_add_u32 s20, s20, s23
    s_lshl_b32 s21, s5, 12
    s_barrier
    s_add_u32 m0, s21, 0
    s_add_u32 s22, s20, 0
    buffer_load_dwordx4 v28, s[16:19], s22 offen lds
    s_add_u32 m0, s21, 1024
    s_add_u32 s22, s20, 5120
    buffer_load_dwordx4 v28, s[16:19], s22 offen lds
    s_add_u32 m0, s21, 2048
    s_add_u32 s22, s20, 10240
    buffer_load_dwordx4 v28, s[16:19], s22 offen lds
    s_add_u32 m0, s21, 3072
    s_add_u32 s22, s20, 15360
    buffer_load_dwordx4 v28, s[16:19], s22 offen lds
    s_add_u32 m0, s21, 16384
    s_add_u32 s22, s20, 81920
    buffer_load_dwordx4 v28, s[16:19], s22 offen lds
    s_add_u32 m0, s21, 17408
    s_add_u32 s22, s20, 87040
    buffer_load_dwordx4 v28, s[16:19], s22 offen lds
    s_add_u32 m0, s21, 18432
    s_add_u32 s22, s20, 92160
    buffer_load_dwordx4 v28, s[16:19], s22 offen lds
    s_add_u32 m0, s21, 19456
    s_add_u32 s22, s20, 97280
    buffer_load_dwordx4 v28, s[16:19], s22 offen lds
    s_add_u32 m0, s21, 32768
    s_add_u32 s22, s20, 163840
    buffer_load_dwordx4 v28, s[16:19], s22 offen lds
    s_add_u32 m0, s21, 33792
    s_add_u32 s22, s20, 168960
    buffer_load_dwordx4 v28, s[16:19], s22 offen lds
    s_add_u32 m0, s21, 34816
    s_add_u32 s22, s20, 174080
    buffer_load_dwordx4 v28, s[16:19], s22 offen lds
    s_add_u32 m0, s21, 35840
    s_add_u32 s22, s20, 179200
    buffer_load_dwordx4 v28, s[16:19], s22 offen lds
    s_add_u32 m0, s21, 49152
    s_add_u32 s22, s20, 245760
    buffer_load_dwordx4 v28, s[16:19], s22 offen lds
    s_add_u32 m0, s21, 50176
    s_add_u32 s22, s20, 250880
    buffer_load_dwordx4 v28, s[16:19], s22 offen lds
    s_add_u32 m0, s21, 51200
    s_add_u32 s22, s20, 256000
    buffer_load_dwordx4 v28, s[16:19], s22 offen lds
    s_add_u32 m0, s21, 52224
    s_add_u32 s22, s20, 261120
    buffer_load_dwordx4 v28, s[16:19], s22 offen lds
    s_add_u32 m0, s21, 65536
    s_add_u32 s22, s20, 327680
    buffer_load_dwordx4 v28, s[16:19], s22 offen lds
    s_add_u32 m0, s21, 66560
    s_add_u32 s22, s20, 332800
    buffer_load_dwordx4 v28, s[16:19], s22 offen lds
    s_add_u32 m0, s21, 67584
    s_add_u32 s22, s20, 337920
    buffer_load_dwordx4 v28, s[16:19], s22 offen lds
    s_add_u32 m0, s21, 68608
    s_add_u32 s22, s20, 343040
    buffer_load_dwordx4 v28, s[16:19], s22 offen lds
    s_add_u32 m0, s21, 81920
    s_add_u32 s22, s20, 409600
    buffer_load_dwordx4 v28, s[16:19], s22 offen lds
    s_add_u32 m0, s21, 82944
    s_add_u32 s22, s20, 414720
    buffer_load_dwordx4 v28, s[16:19], s22 offen lds
    s_add_u32 m0, s21, 83968
    s_add_u32 s22, s20, 419840
    buffer_load_dwordx4 v28, s[16:19], s22 offen lds
    s_add_u32 m0, s21, 84992
    s_add_u32 s22, s20, 424960
    buffer_load_dwordx4 v28, s[16:19], s22 offen lds
    s_add_u32 m0, s21, 98304
    s_add_u32 s22, s20, 491520
    buffer_load_dwordx4 v28, s[16:19], s22 offen lds
    s_add_u32 m0, s21, 99328
    s_add_u32 s22, s20, 496640
    buffer_load_dwordx4 v28, s[16:19], s22 offen lds
    s_add_u32 m0, s21, 100352
    s_add_u32 s22, s20, 501760
    buffer_load_dwordx4 v28, s[16:19], s22 offen lds
    s_add_u32 m0, s21, 101376
    s_add_u32 s22, s20, 506880
    buffer_load_dwordx4 v28, s[16:19], s22 offen lds
    s_add_u32 m0, s21, 114688
    s_add_u32 s22, s20, 573440
    buffer_load_dwordx4 v28, s[16:19], s22 offen lds
    s_add_u32 m0, s21, 115712
    s_add_u32 s22, s20, 578560
    buffer_load_dwordx4 v28, s[16:19], s22 offen lds
    s_add_u32 m0, s21, 116736
    s_add_u32 s22, s20, 583680
    buffer_load_dwordx4 v28, s[16:19], s22 offen lds
    s_add_u32 m0, s21, 117760
    s_add_u32 s22, s20, 588800
    buffer_load_dwordx4 v28, s[16:19], s22 offen lds
    s_add_u32 m0, s21, 131072
    s_add_u32 s22, s20, 655360
    buffer_load_dwordx4 v28, s[16:19], s22 offen lds
    s_add_u32 m0, s21, 132096
    s_add_u32 s22, s20, 660480
    buffer_load_dwordx4 v28, s[16:19], s22 offen lds
    s_add_u32 m0, s21, 133120
    s_add_u32 s22, s20, 665600
    buffer_load_dwordx4 v28, s[16:19], s22 offen lds
    s_add_u32 m0, s21, 134144
    s_add_u32 s22, s20, 670720
    buffer_load_dwordx4 v28, s[16:19], s22 offen lds
    s_add_u32 m0, s21, 147456
    s_add_u32 s22, s20, 737280
    buffer_load_dwordx4 v28, s[16:19], s22 offen lds
    s_add_u32 m0, s21, 148480
    s_add_u32 s22, s20, 742400
    buffer_load_dwordx4 v28, s[16:19], s22 offen lds
    s_add_u32 m0, s21, 149504
    s_add_u32 s22, s20, 747520
    buffer_load_dwordx4 v28, s[16:19], s22 offen lds
    s_add_u32 m0, s21, 150528
    s_add_u32 s22, s20, 752640
    buffer_load_dwordx4 v28, s[16:19], s22 offen lds
    v_bfe_u32 v31, v0, 2, 2
    v_and_b32 v29, 1, v30
    s_lshl_b32 s22, s5, 1
    v_add_u32 v29, s22, v29
    v_lshlrev_b32 v28, 1, v31
    v_xor_b32 v29, v29, v28
    v_lshlrev_b32 v29, 5, v29
    v_lshrrev_b32_e64 v30, 1, v30
    v_lshl_add_u32 v31, v30, 3, v31
    v_lshl_add_u32 v29, v31, 8, v29
    v_and_b32_e64 v30, 3, v0
    v_lshl_add_u32 v29, v30, 3, v29
    s_waitcnt vmcnt(36)
    s_barrier
    ds_read_b64_tr_b16 a[0:1], v29 offset:0
    ds_read_b64_tr_b16 a[2:3], v29 offset:1024
    ds_read_b64_tr_b16 a[4:5], v29 offset:4096
    ds_read_b64_tr_b16 a[6:7], v29 offset:5120
    ds_read_b64_tr_b16 a[8:9], v29 offset:8192
    ds_read_b64_tr_b16 a[10:11], v29 offset:9216
    ds_read_b64_tr_b16 a[12:13], v29 offset:12288
    ds_read_b64_tr_b16 a[14:15], v29 offset:13312
    s_waitcnt vmcnt(32)
    s_barrier
    ds_read_b64_tr_b16 a[16:17], v29 offset:16384
    ds_read_b64_tr_b16 a[18:19], v29 offset:17408
    ds_read_b64_tr_b16 a[20:21], v29 offset:20480
    ds_read_b64_tr_b16 a[22:23], v29 offset:21504
    ds_read_b64_tr_b16 a[24:25], v29 offset:24576
    ds_read_b64_tr_b16 a[26:27], v29 offset:25600
    ds_read_b64_tr_b16 a[28:29], v29 offset:28672
    ds_read_b64_tr_b16 a[30:31], v29 offset:29696
    s_waitcnt vmcnt(28)
    s_barrier
    ds_read_b64_tr_b16 a[32:33], v29 offset:32768
    ds_read_b64_tr_b16 a[34:35], v29 offset:33792
    ds_read_b64_tr_b16 a[36:37], v29 offset:36864
    ds_read_b64_tr_b16 a[38:39], v29 offset:37888
    ds_read_b64_tr_b16 a[40:41], v29 offset:40960
    ds_read_b64_tr_b16 a[42:43], v29 offset:41984
    ds_read_b64_tr_b16 a[44:45], v29 offset:45056
    ds_read_b64_tr_b16 a[46:47], v29 offset:46080
    s_waitcnt vmcnt(24)
    s_barrier
    ds_read_b64_tr_b16 a[48:49], v29 offset:49152
    ds_read_b64_tr_b16 a[50:51], v29 offset:50176
    ds_read_b64_tr_b16 a[52:53], v29 offset:53248
    ds_read_b64_tr_b16 a[54:55], v29 offset:54272
    ds_read_b64_tr_b16 a[56:57], v29 offset:57344
    ds_read_b64_tr_b16 a[58:59], v29 offset:58368
    ds_read_b64_tr_b16 a[60:61], v29 offset:61440
    ds_read_b64_tr_b16 a[62:63], v29 offset:62464
    v_add_u32 v29, 0x10000, v29
    s_waitcnt vmcnt(20)
    s_barrier
    ds_read_b64_tr_b16 a[64:65], v29 offset:0
    ds_read_b64_tr_b16 a[66:67], v29 offset:1024
    ds_read_b64_tr_b16 a[68:69], v29 offset:4096
    ds_read_b64_tr_b16 a[70:71], v29 offset:5120
    ds_read_b64_tr_b16 a[72:73], v29 offset:8192
    ds_read_b64_tr_b16 a[74:75], v29 offset:9216
    ds_read_b64_tr_b16 a[76:77], v29 offset:12288
    ds_read_b64_tr_b16 a[78:79], v29 offset:13312
    s_waitcnt vmcnt(16)
    s_barrier
    ds_read_b64_tr_b16 a[80:81], v29 offset:16384
    ds_read_b64_tr_b16 a[82:83], v29 offset:17408
    ds_read_b64_tr_b16 a[84:85], v29 offset:20480
    ds_read_b64_tr_b16 a[86:87], v29 offset:21504
    ds_read_b64_tr_b16 a[88:89], v29 offset:24576
    ds_read_b64_tr_b16 a[90:91], v29 offset:25600
    ds_read_b64_tr_b16 a[92:93], v29 offset:28672
    ds_read_b64_tr_b16 a[94:95], v29 offset:29696
    s_waitcnt vmcnt(12)
    s_barrier
    ds_read_b64_tr_b16 a[96:97], v29 offset:32768
    ds_read_b64_tr_b16 a[98:99], v29 offset:33792
    ds_read_b64_tr_b16 a[100:101], v29 offset:36864
    ds_read_b64_tr_b16 a[102:103], v29 offset:37888
    ds_read_b64_tr_b16 a[104:105], v29 offset:40960
    ds_read_b64_tr_b16 a[106:107], v29 offset:41984
    ds_read_b64_tr_b16 a[108:109], v29 offset:45056
    ds_read_b64_tr_b16 a[110:111], v29 offset:46080
    s_waitcnt vmcnt(8)
    s_barrier
    ds_read_b64_tr_b16 a[112:113], v29 offset:49152
    ds_read_b64_tr_b16 a[114:115], v29 offset:50176
    ds_read_b64_tr_b16 a[116:117], v29 offset:53248
    ds_read_b64_tr_b16 a[118:119], v29 offset:54272
    ds_read_b64_tr_b16 a[120:121], v29 offset:57344
    ds_read_b64_tr_b16 a[122:123], v29 offset:58368
    ds_read_b64_tr_b16 a[124:125], v29 offset:61440
    ds_read_b64_tr_b16 a[126:127], v29 offset:62464
    v_add_u32 v29, 0x10000, v29
    s_waitcnt vmcnt(4)
    s_barrier
    ds_read_b64_tr_b16 a[128:129], v29 offset:0
    ds_read_b64_tr_b16 a[130:131], v29 offset:1024
    ds_read_b64_tr_b16 a[132:133], v29 offset:4096
    ds_read_b64_tr_b16 a[134:135], v29 offset:5120
    ds_read_b64_tr_b16 a[136:137], v29 offset:8192
    ds_read_b64_tr_b16 a[138:139], v29 offset:9216
    ds_read_b64_tr_b16 a[140:141], v29 offset:12288
    ds_read_b64_tr_b16 a[142:143], v29 offset:13312
    s_waitcnt vmcnt(0)
    s_barrier
    ds_read_b64_tr_b16 a[144:145], v29 offset:16384
    ds_read_b64_tr_b16 a[146:147], v29 offset:17408
    ds_read_b64_tr_b16 a[148:149], v29 offset:20480
    ds_read_b64_tr_b16 a[150:151], v29 offset:21504
    ds_read_b64_tr_b16 a[152:153], v29 offset:24576
    ds_read_b64_tr_b16 a[154:155], v29 offset:25600
    ds_read_b64_tr_b16 a[156:157], v29 offset:28672
    ds_read_b64_tr_b16 a[158:159], v29 offset:29696
    s_waitcnt lgkmcnt(0)
    s_barrier
    s_load_dwordx2 s[76:77], s[0:1], 72
    s_waitcnt lgkmcnt(0)
    s_mov_b32 s16, s76
    s_and_b32 s17, s77, 0xffff
    s_mov_b32 s18, 0xc8000
    s_mov_b32 s19, 0x20000
    s_mov_b32 s40, 5
    s_mov_b32 s36, 0x4390000
    s_mul_i32 s37, s46, 409600
    s_add_u32 s37, s37, 0x5620000
    s_lshl_b32 s20, s65, 2
    s_add_u32 s20, s20, s5
    s_mul_i32 s20, s20, 52
    s_lshr_b32 s20, s20, 8
    s_lshl_b32 s20, s20, 2
    s_lshr_b32 s41, 0x4031, s20
    s_and_b32 s41, s41, 15
    s_mov_b32 s39, s65
    s_branch DF_j_47
DF_f_46:
    s_sub_u32 s65, s4, 5
    s_load_dwordx2 s[76:77], s[0:1], 80
    s_waitcnt lgkmcnt(0)
    s_mov_b32 s16, s76
    s_and_b32 s17, s77, 0xffff
    s_mov_b32 s18, 0x21c000
    s_mov_b32 s19, 0x20000
    s_lshl_b32 s23, s65, 8
    v_lshrrev_b32 v30, 4, v0
    v_and_b32 v31, 15, v0
    v_lshlrev_b32 v28, 2, v30
    v_xor_b32 v28, v28, v31
    v_lshlrev_b32 v28, 4, v28
    v_mul_u32_u24 v31, 3456, v30
    v_add_u32 v28, v28, v31
    s_mul_i32 s20, s5, 55296
    s_add_u32 s20, s20, s23
    s_lshl_b32 s21, s5, 12
    s_barrier
    s_add_u32 m0, s21, 0
    s_add_u32 s22, s20, 0
    buffer_load_dwordx4 v28, s[16:19], s22 offen lds
    s_add_u32 m0, s21, 1024
    s_add_u32 s22, s20, 13824
    buffer_load_dwordx4 v28, s[16:19], s22 offen lds
    s_add_u32 m0, s21, 2048
    s_add_u32 s22, s20, 27648
    buffer_load_dwordx4 v28, s[16:19], s22 offen lds
    s_add_u32 m0, s21, 3072
    s_add_u32 s22, s20, 41472
    buffer_load_dwordx4 v28, s[16:19], s22 offen lds
    s_add_u32 m0, s21, 16384
    s_add_u32 s22, s20, 221184
    buffer_load_dwordx4 v28, s[16:19], s22 offen lds
    s_add_u32 m0, s21, 17408
    s_add_u32 s22, s20, 235008
    buffer_load_dwordx4 v28, s[16:19], s22 offen lds
    s_add_u32 m0, s21, 18432
    s_add_u32 s22, s20, 248832
    buffer_load_dwordx4 v28, s[16:19], s22 offen lds
    s_add_u32 m0, s21, 19456
    s_add_u32 s22, s20, 262656
    buffer_load_dwordx4 v28, s[16:19], s22 offen lds
    s_add_u32 m0, s21, 32768
    s_add_u32 s22, s20, 442368
    buffer_load_dwordx4 v28, s[16:19], s22 offen lds
    s_add_u32 m0, s21, 33792
    s_add_u32 s22, s20, 456192
    buffer_load_dwordx4 v28, s[16:19], s22 offen lds
    s_add_u32 m0, s21, 34816
    s_add_u32 s22, s20, 470016
    buffer_load_dwordx4 v28, s[16:19], s22 offen lds
    s_add_u32 m0, s21, 35840
    s_add_u32 s22, s20, 483840
    buffer_load_dwordx4 v28, s[16:19], s22 offen lds
    s_add_u32 m0, s21, 49152
    s_add_u32 s22, s20, 663552
    buffer_load_dwordx4 v28, s[16:19], s22 offen lds
    s_add_u32 m0, s21, 50176
    s_add_u32 s22, s20, 677376
    buffer_load_dwordx4 v28, s[16:19], s22 offen lds
    s_add_u32 m0, s21, 51200
    s_add_u32 s22, s20, 691200
    buffer_load_dwordx4 v28, s[16:19], s22 offen lds
    s_add_u32 m0, s21, 52224
    s_add_u32 s22, s20, 705024
    buffer_load_dwordx4 v28, s[16:19], s22 offen lds
    s_add_u32 m0, s21, 65536
    s_add_u32 s22, s20, 884736
    buffer_load_dwordx4 v28, s[16:19], s22 offen lds
    s_add_u32 m0, s21, 66560
    s_add_u32 s22, s20, 898560
    buffer_load_dwordx4 v28, s[16:19], s22 offen lds
    s_add_u32 m0, s21, 67584
    s_add_u32 s22, s20, 912384
    buffer_load_dwordx4 v28, s[16:19], s22 offen lds
    s_add_u32 m0, s21, 68608
    s_add_u32 s22, s20, 926208
    buffer_load_dwordx4 v28, s[16:19], s22 offen lds
    s_add_u32 m0, s21, 81920
    s_add_u32 s22, s20, 1105920
    buffer_load_dwordx4 v28, s[16:19], s22 offen lds
    s_add_u32 m0, s21, 82944
    s_add_u32 s22, s20, 1119744
    buffer_load_dwordx4 v28, s[16:19], s22 offen lds
    s_add_u32 m0, s21, 83968
    s_add_u32 s22, s20, 1133568
    buffer_load_dwordx4 v28, s[16:19], s22 offen lds
    s_add_u32 m0, s21, 84992
    s_add_u32 s22, s20, 1147392
    buffer_load_dwordx4 v28, s[16:19], s22 offen lds
    s_add_u32 m0, s21, 98304
    s_add_u32 s22, s20, 1327104
    buffer_load_dwordx4 v28, s[16:19], s22 offen lds
    s_add_u32 m0, s21, 99328
    s_add_u32 s22, s20, 1340928
    buffer_load_dwordx4 v28, s[16:19], s22 offen lds
    s_add_u32 m0, s21, 100352
    s_add_u32 s22, s20, 1354752
    buffer_load_dwordx4 v28, s[16:19], s22 offen lds
    s_add_u32 m0, s21, 101376
    s_add_u32 s22, s20, 1368576
    buffer_load_dwordx4 v28, s[16:19], s22 offen lds
    s_add_u32 m0, s21, 114688
    s_add_u32 s22, s20, 1548288
    buffer_load_dwordx4 v28, s[16:19], s22 offen lds
    s_add_u32 m0, s21, 115712
    s_add_u32 s22, s20, 1562112
    buffer_load_dwordx4 v28, s[16:19], s22 offen lds
    s_add_u32 m0, s21, 116736
    s_add_u32 s22, s20, 1575936
    buffer_load_dwordx4 v28, s[16:19], s22 offen lds
    s_add_u32 m0, s21, 117760
    s_add_u32 s22, s20, 1589760
    buffer_load_dwordx4 v28, s[16:19], s22 offen lds
    s_add_u32 m0, s21, 131072
    s_add_u32 s22, s20, 1769472
    buffer_load_dwordx4 v28, s[16:19], s22 offen lds
    s_add_u32 m0, s21, 132096
    s_add_u32 s22, s20, 1783296
    buffer_load_dwordx4 v28, s[16:19], s22 offen lds
    s_add_u32 m0, s21, 133120
    s_add_u32 s22, s20, 1797120
    buffer_load_dwordx4 v28, s[16:19], s22 offen lds
    s_add_u32 m0, s21, 134144
    s_add_u32 s22, s20, 1810944
    buffer_load_dwordx4 v28, s[16:19], s22 offen lds
    s_add_u32 m0, s21, 147456
    s_add_u32 s22, s20, 1990656
    buffer_load_dwordx4 v28, s[16:19], s22 offen lds
    s_add_u32 m0, s21, 148480
    s_add_u32 s22, s20, 2004480
    buffer_load_dwordx4 v28, s[16:19], s22 offen lds
    s_add_u32 m0, s21, 149504
    s_add_u32 s22, s20, 2018304
    buffer_load_dwordx4 v28, s[16:19], s22 offen lds
    s_add_u32 m0, s21, 150528
    s_add_u32 s22, s20, 2032128
    buffer_load_dwordx4 v28, s[16:19], s22 offen lds
    v_bfe_u32 v31, v0, 2, 2
    v_and_b32 v29, 1, v30
    s_lshl_b32 s22, s5, 1
    v_add_u32 v29, s22, v29
    v_lshlrev_b32 v28, 1, v31
    v_xor_b32 v29, v29, v28
    v_lshlrev_b32 v29, 5, v29
    v_lshrrev_b32_e64 v30, 1, v30
    v_lshl_add_u32 v31, v30, 3, v31
    v_lshl_add_u32 v29, v31, 8, v29
    v_and_b32_e64 v30, 3, v0
    v_lshl_add_u32 v29, v30, 3, v29
    s_waitcnt vmcnt(36)
    s_barrier
    ds_read_b64_tr_b16 a[0:1], v29 offset:0
    ds_read_b64_tr_b16 a[2:3], v29 offset:1024
    ds_read_b64_tr_b16 a[4:5], v29 offset:4096
    ds_read_b64_tr_b16 a[6:7], v29 offset:5120
    ds_read_b64_tr_b16 a[8:9], v29 offset:8192
    ds_read_b64_tr_b16 a[10:11], v29 offset:9216
    ds_read_b64_tr_b16 a[12:13], v29 offset:12288
    ds_read_b64_tr_b16 a[14:15], v29 offset:13312
    s_waitcnt vmcnt(32)
    s_barrier
    ds_read_b64_tr_b16 a[16:17], v29 offset:16384
    ds_read_b64_tr_b16 a[18:19], v29 offset:17408
    ds_read_b64_tr_b16 a[20:21], v29 offset:20480
    ds_read_b64_tr_b16 a[22:23], v29 offset:21504
    ds_read_b64_tr_b16 a[24:25], v29 offset:24576
    ds_read_b64_tr_b16 a[26:27], v29 offset:25600
    ds_read_b64_tr_b16 a[28:29], v29 offset:28672
    ds_read_b64_tr_b16 a[30:31], v29 offset:29696
    s_waitcnt vmcnt(28)
    s_barrier
    ds_read_b64_tr_b16 a[32:33], v29 offset:32768
    ds_read_b64_tr_b16 a[34:35], v29 offset:33792
    ds_read_b64_tr_b16 a[36:37], v29 offset:36864
    ds_read_b64_tr_b16 a[38:39], v29 offset:37888
    ds_read_b64_tr_b16 a[40:41], v29 offset:40960
    ds_read_b64_tr_b16 a[42:43], v29 offset:41984
    ds_read_b64_tr_b16 a[44:45], v29 offset:45056
    ds_read_b64_tr_b16 a[46:47], v29 offset:46080
    s_waitcnt vmcnt(24)
    s_barrier
    ds_read_b64_tr_b16 a[48:49], v29 offset:49152
    ds_read_b64_tr_b16 a[50:51], v29 offset:50176
    ds_read_b64_tr_b16 a[52:53], v29 offset:53248
    ds_read_b64_tr_b16 a[54:55], v29 offset:54272
    ds_read_b64_tr_b16 a[56:57], v29 offset:57344
    ds_read_b64_tr_b16 a[58:59], v29 offset:58368
    ds_read_b64_tr_b16 a[60:61], v29 offset:61440
    ds_read_b64_tr_b16 a[62:63], v29 offset:62464
    v_add_u32 v29, 0x10000, v29
    s_waitcnt vmcnt(20)
    s_barrier
    ds_read_b64_tr_b16 a[64:65], v29 offset:0
    ds_read_b64_tr_b16 a[66:67], v29 offset:1024
    ds_read_b64_tr_b16 a[68:69], v29 offset:4096
    ds_read_b64_tr_b16 a[70:71], v29 offset:5120
    ds_read_b64_tr_b16 a[72:73], v29 offset:8192
    ds_read_b64_tr_b16 a[74:75], v29 offset:9216
    ds_read_b64_tr_b16 a[76:77], v29 offset:12288
    ds_read_b64_tr_b16 a[78:79], v29 offset:13312
    s_waitcnt vmcnt(16)
    s_barrier
    ds_read_b64_tr_b16 a[80:81], v29 offset:16384
    ds_read_b64_tr_b16 a[82:83], v29 offset:17408
    ds_read_b64_tr_b16 a[84:85], v29 offset:20480
    ds_read_b64_tr_b16 a[86:87], v29 offset:21504
    ds_read_b64_tr_b16 a[88:89], v29 offset:24576
    ds_read_b64_tr_b16 a[90:91], v29 offset:25600
    ds_read_b64_tr_b16 a[92:93], v29 offset:28672
    ds_read_b64_tr_b16 a[94:95], v29 offset:29696
    s_waitcnt vmcnt(12)
    s_barrier
    ds_read_b64_tr_b16 a[96:97], v29 offset:32768
    ds_read_b64_tr_b16 a[98:99], v29 offset:33792
    ds_read_b64_tr_b16 a[100:101], v29 offset:36864
    ds_read_b64_tr_b16 a[102:103], v29 offset:37888
    ds_read_b64_tr_b16 a[104:105], v29 offset:40960
    ds_read_b64_tr_b16 a[106:107], v29 offset:41984
    ds_read_b64_tr_b16 a[108:109], v29 offset:45056
    ds_read_b64_tr_b16 a[110:111], v29 offset:46080
    s_waitcnt vmcnt(8)
    s_barrier
    ds_read_b64_tr_b16 a[112:113], v29 offset:49152
    ds_read_b64_tr_b16 a[114:115], v29 offset:50176
    ds_read_b64_tr_b16 a[116:117], v29 offset:53248
    ds_read_b64_tr_b16 a[118:119], v29 offset:54272
    ds_read_b64_tr_b16 a[120:121], v29 offset:57344
    ds_read_b64_tr_b16 a[122:123], v29 offset:58368
    ds_read_b64_tr_b16 a[124:125], v29 offset:61440
    ds_read_b64_tr_b16 a[126:127], v29 offset:62464
    v_add_u32 v29, 0x10000, v29
    s_waitcnt vmcnt(4)
    s_barrier
    ds_read_b64_tr_b16 a[128:129], v29 offset:0
    ds_read_b64_tr_b16 a[130:131], v29 offset:1024
    ds_read_b64_tr_b16 a[132:133], v29 offset:4096
    ds_read_b64_tr_b16 a[134:135], v29 offset:5120
    ds_read_b64_tr_b16 a[136:137], v29 offset:8192
    ds_read_b64_tr_b16 a[138:139], v29 offset:9216
    ds_read_b64_tr_b16 a[140:141], v29 offset:12288
    ds_read_b64_tr_b16 a[142:143], v29 offset:13312
    s_waitcnt vmcnt(0)
    s_barrier
    ds_read_b64_tr_b16 a[144:145], v29 offset:16384
    ds_read_b64_tr_b16 a[146:147], v29 offset:17408
    ds_read_b64_tr_b16 a[148:149], v29 offset:20480
    ds_read_b64_tr_b16 a[150:151], v29 offset:21504
    ds_read_b64_tr_b16 a[152:153], v29 offset:24576
    ds_read_b64_tr_b16 a[154:155], v29 offset:25600
    ds_read_b64_tr_b16 a[156:157], v29 offset:28672
    ds_read_b64_tr_b16 a[158:159], v29 offset:29696
    s_waitcnt lgkmcnt(0)
    s_barrier
    s_load_dwordx2 s[76:77], s[0:1], 88
    s_waitcnt lgkmcnt(0)
    s_mov_b32 s16, s76
    s_and_b32 s17, s77, 0xffff
    s_mov_b32 s18, 0x21c000
    s_mov_b32 s19, 0x20000
    s_mov_b32 s40, 14
    s_mul_i32 s36, s46, 81920
    s_add_u32 s36, s36, 0x5a94000
    s_mul_i32 s37, s46, 1146880
    s_add_u32 s37, s37, 0x574c000
    s_mov_b32 s41, 2
    s_add_u32 s39, s65, 8
DF_j_47:
    s_mul_i32 s24, s65, 163840
    v_add_u32 v33, 0, v0
    v_mul_u32_u24 v38, 205, v33
    v_lshrrev_b32_e64 v38, 14, v38
    v_mul_u32_u24 v39, 80, v38
    v_sub_u32 v39, v33, v39
    v_lshlrev_b32 v33, 2, v38
    v_xor_b32_e64 v39, v39, v33
    v_mul_u32_u24 v38, 1280, v38
    v_lshl_add_u32 v28, v39, 4, v38
    v_add_u32_e64 v33, 64, v0
    v_mul_u32_u24 v38, 205, v33
    v_lshrrev_b32_e64 v38, 14, v38
    v_mul_u32_u24 v39, 80, v38
    v_sub_u32 v39, v33, v39
    v_lshlrev_b32 v33, 2, v38
    v_xor_b32_e64 v39, v39, v33
    v_mul_u32_u24 v38, 1280, v38
    v_lshl_add_u32 v29, v39, 4, v38
    v_add_u32 v33, 128, v0
    v_mul_u32_u24 v38, 205, v33
    v_lshrrev_b32_e64 v38, 14, v38
    v_mul_u32_u24 v39, 80, v38
    v_sub_u32 v39, v33, v39
    v_lshlrev_b32 v33, 2, v38
    v_xor_b32_e64 v39, v39, v33
    v_mul_u32_u24 v38, 1280, v38
    v_lshl_add_u32 v30, v39, 4, v38
    v_add_u32 v33, 192, v0
    v_mul_u32_u24 v38, 205, v33
    v_lshrrev_b32_e64 v38, 14, v38
    v_mul_u32_u24 v39, 80, v38
    v_sub_u32 v39, v33, v39
    v_lshlrev_b32 v33, 2, v38
    v_xor_b32_e64 v39, v39, v33
    v_mul_u32_u24 v38, 1280, v38
    v_lshl_add_u32 v31, v39, 4, v38
    v_add_u32 v33, 256, v0
    v_mul_u32_u24 v38, 205, v33
    v_lshrrev_b32_e64 v38, 14, v38
    v_mul_u32_u24 v39, 80, v38
    v_sub_u32 v39, v33, v39
    v_lshlrev_b32 v33, 2, v38
    v_xor_b32_e64 v39, v39, v33
    v_mul_u32_u24 v38, 1280, v38
    v_lshl_add_u32 v32, v39, 4, v38
    s_mul_i32 s21, s5, 10240
    s_add_u32 s20, s21, s24
    s_barrier
    s_add_u32 s22, s20, 0
    s_add_u32 m0, s21, 0
    s_nop 0
    buffer_load_dwordx4 v28, s[16:19], s22 offen lds
    s_add_u32 m0, s21, 1024
    s_nop 0
    buffer_load_dwordx4 v29, s[16:19], s22 offen lds
    s_add_u32 m0, s21, 2048
    s_nop 0
    buffer_load_dwordx4 v30, s[16:19], s22 offen lds
    s_add_u32 m0, s21, 3072
    s_nop 0
    buffer_load_dwordx4 v31, s[16:19], s22 offen lds
    s_add_u32 m0, s21, 4096
    s_nop 0
    buffer_load_dwordx4 v32, s[16:19], s22 offen lds
    s_add_u32 s22, s20, 5120
    s_add_u32 m0, s21, 5120
    s_nop 0
    buffer_load_dwordx4 v28, s[16:19], s22 offen lds
    s_add_u32 m0, s21, 6144
    s_nop 0
    buffer_load_dwordx4 v29, s[16:19], s22 offen lds
    s_add_u32 m0, s21, 7168
    s_nop 0
    buffer_load_dwordx4 v30, s[16:19], s22 offen lds
    s_add_u32 m0, s21, 8192
    s_nop 0
    buffer_load_dwordx4 v31, s[16:19], s22 offen lds
    s_add_u32 m0, s21, 9216
    s_nop 0
    buffer_load_dwordx4 v32, s[16:19], s22 offen lds
    s_add_u32 s22, s20, 40960
    s_add_u32 m0, s21, 40960
    s_nop 0
    buffer_load_dwordx4 v28, s[16:19], s22 offen lds
    s_add_u32 m0, s21, 41984
    s_nop 0
    buffer_load_dwordx4 v29, s[16:19], s22 offen lds
    s_add_u32 m0, s21, 43008
    s_nop 0
    buffer_load_dwordx4 v30, s[16:19], s22 offen lds
    s_add_u32 m0, s21, 44032
    s_nop 0
    buffer_load_dwordx4 v31, s[16:19], s22 offen lds
    s_add_u32 m0, s21, 45056
    s_nop 0
    buffer_load_dwordx4 v32, s[16:19], s22 offen lds
    s_add_u32 s22, s20, 46080
    s_add_u32 m0, s21, 46080
    s_nop 0
    buffer_load_dwordx4 v28, s[16:19], s22 offen lds
    s_add_u32 m0, s21, 47104
    s_nop 0
    buffer_load_dwordx4 v29, s[16:19], s22 offen lds
    s_add_u32 m0, s21, 48128
    s_nop 0
    buffer_load_dwordx4 v30, s[16:19], s22 offen lds
    s_add_u32 m0, s21, 49152
    s_nop 0
    buffer_load_dwordx4 v31, s[16:19], s22 offen lds
    s_add_u32 m0, s21, 50176
    s_nop 0
    buffer_load_dwordx4 v32, s[16:19], s22 offen lds
    s_add_u32 s22, s20, 81920
    s_add_u32 m0, s21, 81920
    s_nop 0
    buffer_load_dwordx4 v28, s[16:19], s22 offen lds
    s_add_u32 m0, s21, 82944
    s_nop 0
    buffer_load_dwordx4 v29, s[16:19], s22 offen lds
    s_add_u32 m0, s21, 83968
    s_nop 0
    buffer_load_dwordx4 v30, s[16:19], s22 offen lds
    s_add_u32 m0, s21, 84992
    s_nop 0
    buffer_load_dwordx4 v31, s[16:19], s22 offen lds
    s_add_u32 m0, s21, 86016
    s_nop 0
    buffer_load_dwordx4 v32, s[16:19], s22 offen lds
    s_add_u32 s22, s20, 87040
    s_add_u32 m0, s21, 87040
    s_nop 0
    buffer_load_dwordx4 v28, s[16:19], s22 offen lds
    s_add_u32 m0, s21, 88064
    s_nop 0
    buffer_load_dwordx4 v29, s[16:19], s22 offen lds
    s_add_u32 m0, s21, 89088
    s_nop 0
    buffer_load_dwordx4 v30, s[16:19], s22 offen lds
    s_add_u32 m0, s21, 90112
    s_nop 0
    buffer_load_dwordx4 v31, s[16:19], s22 offen lds
    s_add_u32 m0, s21, 91136
    s_nop 0
    buffer_load_dwordx4 v32, s[16:19], s22 offen lds
    s_add_u32 s22, s20, 122880
    s_add_u32 m0, s21, 122880
    s_nop 0
    buffer_load_dwordx4 v28, s[16:19], s22 offen lds
    s_add_u32 m0, s21, 123904
    s_nop 0
    buffer_load_dwordx4 v29, s[16:19], s22 offen lds
    s_add_u32 m0, s21, 124928
    s_nop 0
    buffer_load_dwordx4 v30, s[16:19], s22 offen lds
    s_add_u32 m0, s21, 125952
    s_nop 0
    buffer_load_dwordx4 v31, s[16:19], s22 offen lds
    s_add_u32 m0, s21, 126976
    s_nop 0
    buffer_load_dwordx4 v32, s[16:19], s22 offen lds
    s_add_u32 s22, s20, 128000
    s_add_u32 m0, s21, 128000
    s_nop 0
    buffer_load_dwordx4 v28, s[16:19], s22 offen lds
    s_add_u32 m0, s21, 129024
    s_nop 0
    buffer_load_dwordx4 v29, s[16:19], s22 offen lds
    s_add_u32 m0, s21, 130048
    s_nop 0
    buffer_load_dwordx4 v30, s[16:19], s22 offen lds
    s_add_u32 m0, s21, 131072
    s_nop 0
    buffer_load_dwordx4 v31, s[16:19], s22 offen lds
    s_add_u32 m0, s21, 132096
    s_nop 0
    buffer_load_dwordx4 v32, s[16:19], s22 offen lds
    v_bfe_u32 v38, v0, 2, 2
    v_lshrrev_b32_e64 v39, 5, v0
    v_lshl_add_u32 v39, v39, 2, v38
    v_mul_u32_u24 v39, 1280, v39
    v_and_b32_e64 v28, 1, v0
    v_lshl_add_u32 v39, v28, 3, v39
    v_bfe_u32 v28, v0, 4, 1
    v_bfe_u32 v29, v0, 1, 1
    v_lshl_add_u32 v28, v28, 1, v29
    v_lshlrev_b32 v38, 2, v38
    s_mul_i32 s22, s5, 20
    s_add_u32 s23, s22, 0
    v_add_u32 v29, s23, v28
    v_xor_b32_e64 v29, v29, v38
    v_lshl_add_u32 v33, v29, 4, v39
    s_add_u32 s23, s22, 4
    v_add_u32 v29, s23, v28
    v_xor_b32_e64 v29, v29, v38
    v_lshl_add_u32 v34, v29, 4, v39
    s_add_u32 s23, s22, 8
    v_add_u32 v29, s23, v28
    v_xor_b32_e64 v29, v29, v38
    v_lshl_add_u32 v35, v29, 4, v39
    s_add_u32 s23, s22, 12
    v_add_u32 v29, s23, v28
    v_xor_b32_e64 v29, v29, v38
    v_lshl_add_u32 v36, v29, 4, v39
    s_add_u32 s23, s22, 16
    v_add_u32 v29, s23, v28
    v_xor_b32_e64 v29, v29, v38
    v_lshl_add_u32 v37, v29, 4, v39
    s_waitcnt vmcnt(30)
    s_barrier
    ds_read_b64_tr_b16 a[160:161], v33 offset:0
    ds_read_b64_tr_b16 a[162:163], v33 offset:10240
    ds_read_b64_tr_b16 a[164:165], v33 offset:20480
    ds_read_b64_tr_b16 a[166:167], v33 offset:30720
    v_add_u32 v33, 40960, v33
    s_waitcnt lgkmcnt(0)
    ds_read_b64_tr_b16 a[192:193], v34 offset:0
    ds_read_b64_tr_b16 a[194:195], v34 offset:10240
    ds_read_b64_tr_b16 a[196:197], v34 offset:20480
    ds_read_b64_tr_b16 a[198:199], v34 offset:30720
    v_add_u32 v34, 40960, v34
    s_waitcnt lgkmcnt(0)
    ds_read_b64_tr_b16 a[224:225], v35 offset:0
    ds_read_b64_tr_b16 a[226:227], v35 offset:10240
    ds_read_b64_tr_b16 a[228:229], v35 offset:20480
    ds_read_b64_tr_b16 a[230:231], v35 offset:30720
    v_add_u32 v35, 40960, v35
    s_waitcnt lgkmcnt(0)
    ds_read_b64_tr_b16 v[192:193], v36 offset:0
    ds_read_b64_tr_b16 v[194:195], v36 offset:10240
    ds_read_b64_tr_b16 v[196:197], v36 offset:20480
    ds_read_b64_tr_b16 v[198:199], v36 offset:30720
    v_add_u32 v36, 40960, v36
    s_waitcnt lgkmcnt(0)
    ds_read_b64_tr_b16 v[224:225], v37 offset:0
    ds_read_b64_tr_b16 v[226:227], v37 offset:10240
    ds_read_b64_tr_b16 v[228:229], v37 offset:20480
    ds_read_b64_tr_b16 v[230:231], v37 offset:30720
    v_add_u32 v37, 40960, v37
    s_waitcnt lgkmcnt(0)
    s_waitcnt vmcnt(20)
    s_barrier
    ds_read_b64_tr_b16 a[168:169], v33 offset:0
    ds_read_b64_tr_b16 a[170:171], v33 offset:10240
    ds_read_b64_tr_b16 a[172:173], v33 offset:20480
    ds_read_b64_tr_b16 a[174:175], v33 offset:30720
    v_add_u32 v33, 40960, v33
    s_waitcnt lgkmcnt(0)
    ds_read_b64_tr_b16 a[200:201], v34 offset:0
    ds_read_b64_tr_b16 a[202:203], v34 offset:10240
    ds_read_b64_tr_b16 a[204:205], v34 offset:20480
    ds_read_b64_tr_b16 a[206:207], v34 offset:30720
    v_add_u32 v34, 40960, v34
    s_waitcnt lgkmcnt(0)
    ds_read_b64_tr_b16 a[232:233], v35 offset:0
    ds_read_b64_tr_b16 a[234:235], v35 offset:10240
    ds_read_b64_tr_b16 a[236:237], v35 offset:20480
    ds_read_b64_tr_b16 a[238:239], v35 offset:30720
    v_add_u32 v35, 40960, v35
    s_waitcnt lgkmcnt(0)
    ds_read_b64_tr_b16 v[200:201], v36 offset:0
    ds_read_b64_tr_b16 v[202:203], v36 offset:10240
    ds_read_b64_tr_b16 v[204:205], v36 offset:20480
    ds_read_b64_tr_b16 v[206:207], v36 offset:30720
    v_add_u32 v36, 40960, v36
    s_waitcnt lgkmcnt(0)
    ds_read_b64_tr_b16 v[232:233], v37 offset:0
    ds_read_b64_tr_b16 v[234:235], v37 offset:10240
    ds_read_b64_tr_b16 v[236:237], v37 offset:20480
    ds_read_b64_tr_b16 v[238:239], v37 offset:30720
    v_add_u32 v37, 40960, v37
    s_waitcnt lgkmcnt(0)
    s_waitcnt vmcnt(10)
    s_barrier
    ds_read_b64_tr_b16 a[176:177], v33 offset:0
    ds_read_b64_tr_b16 a[178:179], v33 offset:10240
    ds_read_b64_tr_b16 a[180:181], v33 offset:20480
    ds_read_b64_tr_b16 a[182:183], v33 offset:30720
    v_add_u32 v33, 40960, v33
    s_waitcnt lgkmcnt(0)
    ds_read_b64_tr_b16 a[208:209], v34 offset:0
    ds_read_b64_tr_b16 a[210:211], v34 offset:10240
    ds_read_b64_tr_b16 a[212:213], v34 offset:20480
    ds_read_b64_tr_b16 a[214:215], v34 offset:30720
    v_add_u32 v34, 40960, v34
    s_waitcnt lgkmcnt(0)
    ds_read_b64_tr_b16 a[240:241], v35 offset:0
    ds_read_b64_tr_b16 a[242:243], v35 offset:10240
    ds_read_b64_tr_b16 a[244:245], v35 offset:20480
    ds_read_b64_tr_b16 a[246:247], v35 offset:30720
    v_add_u32 v35, 40960, v35
    s_waitcnt lgkmcnt(0)
    ds_read_b64_tr_b16 v[208:209], v36 offset:0
    ds_read_b64_tr_b16 v[210:211], v36 offset:10240
    ds_read_b64_tr_b16 v[212:213], v36 offset:20480
    ds_read_b64_tr_b16 v[214:215], v36 offset:30720
    v_add_u32 v36, 40960, v36
    s_waitcnt lgkmcnt(0)
    ds_read_b64_tr_b16 v[240:241], v37 offset:0
    ds_read_b64_tr_b16 v[242:243], v37 offset:10240
    ds_read_b64_tr_b16 v[244:245], v37 offset:20480
    ds_read_b64_tr_b16 v[246:247], v37 offset:30720
    v_add_u32 v37, 40960, v37
    s_waitcnt lgkmcnt(0)
    s_waitcnt vmcnt(0)
    s_barrier
    ds_read_b64_tr_b16 a[184:185], v33 offset:0
    ds_read_b64_tr_b16 a[186:187], v33 offset:10240
    ds_read_b64_tr_b16 a[188:189], v33 offset:20480
    ds_read_b64_tr_b16 a[190:191], v33 offset:30720
    s_waitcnt lgkmcnt(0)
    ds_read_b64_tr_b16 a[216:217], v34 offset:0
    ds_read_b64_tr_b16 a[218:219], v34 offset:10240
    ds_read_b64_tr_b16 a[220:221], v34 offset:20480
    ds_read_b64_tr_b16 a[222:223], v34 offset:30720
    s_waitcnt lgkmcnt(0)
    ds_read_b64_tr_b16 a[248:249], v35 offset:0
    ds_read_b64_tr_b16 a[250:251], v35 offset:10240
    ds_read_b64_tr_b16 a[252:253], v35 offset:20480
    ds_read_b64_tr_b16 a[254:255], v35 offset:30720
    s_waitcnt lgkmcnt(0)
    ds_read_b64_tr_b16 v[216:217], v36 offset:0
    ds_read_b64_tr_b16 v[218:219], v36 offset:10240
    ds_read_b64_tr_b16 v[220:221], v36 offset:20480
    ds_read_b64_tr_b16 v[222:223], v36 offset:30720
    s_waitcnt lgkmcnt(0)
    ds_read_b64_tr_b16 v[248:249], v37 offset:0
    ds_read_b64_tr_b16 v[250:251], v37 offset:10240
    ds_read_b64_tr_b16 v[252:253], v37 offset:20480
    ds_read_b64_tr_b16 v[254:255], v37 offset:30720
    s_waitcnt lgkmcnt(0)
    s_barrier
    s_mul_i32 s20, s5, 5120
    s_add_u32 s20, s20, 54272
    v_and_b32 v28, 31, v0
    v_mul_u32_u24 v28, 80, v28
    v_lshrrev_b32_e64 v29, 5, v0
    v_lshl_add_u32 v28, v29, 4, v28
    v_add_u32_e64 v2, s20, v28
    s_mul_i32 s21, s40, 1280
    v_lshrrev_b32 v28, 2, v0
    v_and_b32 v29, 0x30, v1
    v_mul_u32_u24 v30, 80, v28
    v_add3_u32 v3, v30, v29, s20
    v_mul_lo_u32 v30, v28, s21
    v_add_u32 v4, v30, v29
    s_lshl_b32 s20, s5, 2
    v_lshrrev_b32 v28, 4, v0
    v_and_b32 v29, 15, v0
    v_add_u32 v30, s20, v28
    v_xor_b32 v29, v29, v30
    v_mul_u32_u24 v28, 1280, v28
    v_lshl_add_u32 v5, v29, 4, v28
    v_and_b32 v28, 31, v0
    v_add_u32 v28, s41, v28
    v_and_b32 v29, 15, v28
    v_lshrrev_b32 v30, 5, v0
    v_xor_b32 v29, v29, v30
    v_lshlrev_b32 v28, 8, v28
    v_xor_b32_e64 v30, 0, v29
    v_lshl_add_u32 v8, v30, 4, v28
    v_xor_b32_e64 v30, 2, v29
    v_lshl_add_u32 v9, v30, 4, v28
    v_xor_b32_e64 v30, 4, v29
    v_lshl_add_u32 v10, v30, 4, v28
    v_xor_b32_e64 v30, 6, v29
    v_lshl_add_u32 v11, v30, 4, v28
    v_xor_b32_e64 v30, 8, v29
    v_lshl_add_u32 v12, v30, 4, v28
    v_xor_b32_e64 v30, 10, v29
    v_lshl_add_u32 v13, v30, 4, v28
    v_xor_b32_e64 v30, 12, v29
    v_lshl_add_u32 v14, v30, 4, v28
    v_xor_b32 v30, 14, v29
    v_lshl_add_u32 v15, v30, 4, v28
    s_lshl_b32 s20, s5, 11
    s_add_u32 s20, s20, 46080
    v_add_u32 v6, s20, v1
    s_lshl_b32 s39, s39, 2
    s_lshl_b32 s20, s46, 7
    s_add_u32 s39, s39, s20
    s_add_u32 s39, s39, 0x2800
    s_mul_i32 s38, s40, 40960
    s_mul_i32 s20, s5, 5120
    s_add_u32 s36, s36, s20
    s_lshl_b32 s30, s5, 10
    s_mul_i32 s20, s65, 1280
    s_mul_i32 s21, s5, 320
    s_add_u32 s20, s20, s21
    s_add_u32 s37, s37, s20
    s_mov_b32 s68, 0xbdd2d3e8
    s_mov_b32 s69, 0xbdd2d3e8
    v_mov_b32 v132, 0xc0135761
    v_mov_b32 v133, 0xc0135761
    s_mov_b32 s27, s46
    s_mov_b32 s28, 0
DF_top_48:
    s_cmp_eq_u32 s64, 1
    s_cbranch_scc1 DF_pf_49
    s_max_u32 s29, s28, 1
    s_sub_u32 s29, s29, 1
    s_lshl_b32 s20, s46, 7
    s_add_u32 s20, s20, 0x2c00
    v_min_u32 v28, 31, v0
    v_lshlrev_b32_e64 v28, 2, v28
pg_52:
    buffer_load_dword v29, v28, s[8:11], s20 offen sc1
    s_waitcnt vmcnt(0)
    v_cmp_gt_u32 vcc, s29, v29
    s_cbranch_vccz pgok_53
    s_add_u32 s6, s6, 1
    s_cmp_lt_u32 s6, 400000
    s_cbranch_scc1 pg_52
    s_branch pgok_53
pgok_53:
    s_mov_b32 s25, s27
    s_add_u32 s21, s27, 1
    s_min_u32 s21, s21, 63
    v_min_u32 v28, 47, v0
    v_lshrrev_b32 v29, 4, v28
    v_sub_u32 v29, s21, v29
    v_add_u32 v29, 3, v29
    v_mul_u32_u24 v29, 43, v29
    v_lshrrev_b32 v29, 7, v29
    v_lshlrev_b32 v28, 3, v28
    s_mov_b32 s20, 0x2600
DF_pz_54:
    buffer_load_dwordx2 v[30:31], v28, s[8:11], s20 offen sc1
    s_waitcnt vmcnt(0)
    v_min_u32 v30, v30, v31
    v_cmp_gt_u32 vcc, v29, v30
    s_cbranch_vccz DF_go_50
    s_sleep 1
    s_add_u32 s6, s6, 1
    s_cmp_lt_u32 s6, 400000
    s_cbranch_scc1 DF_pz_54
    s_branch DF_go_50
DF_pf_49:
    s_and_b32 s25, s28, 1
    s_add_u32 s29, s28, 1
    s_lshl_b32 s20, s46, 7
    s_add_u32 s20, s20, 0x2c00
    v_min_u32 v28, 31, v0
    v_lshlrev_b32_e64 v28, 2, v28
pg_55:
    buffer_load_dword v29, v28, s[8:11], s20 offen sc1
    s_waitcnt vmcnt(0)
    v_cmp_gt_u32 vcc, s29, v29
    s_cbranch_vccz pgok_56
    s_add_u32 s6, s6, 1
    s_cmp_lt_u32 s6, 400000
    s_cbranch_scc1 pg_55
    s_branch pgok_56
pgok_56:
DF_go_50:
    s_mul_i32 s25, s25, 40960
    s_add_u32 s25, s25, s36
    s_cmp_lg_u32 s5, 0
    s_cbranch_scc1 DF_n9_51
    s_add_u32 s24, s25, 40960
    s_add_u32 m0, s30, 8192
    s_nop 0
    buffer_load_dwordx4 v5, s[8:11], s24 offen sc1 lds
    s_add_u32 s24, s25, 41216
    s_add_u32 m0, s30, 17408
    s_nop 0
    buffer_load_dwordx4 v5, s[8:11], s24 offen sc1 lds
    s_add_u32 s24, s25, 41472
    s_add_u32 m0, s30, 26624
    s_nop 0
    buffer_load_dwordx4 v5, s[8:11], s24 offen sc1 lds
    s_add_u32 s24, s25, 41728
    s_add_u32 m0, s30, 35840
    s_nop 0
    buffer_load_dwordx4 v5, s[8:11], s24 offen sc1 lds
    s_add_u32 s24, s25, 41984
    s_add_u32 m0, s30, 45056
    s_nop 0
    buffer_load_dwordx4 v5, s[8:11], s24 offen sc1 lds
DF_n9_51:
    s_add_u32 s24, s25, 0
    s_add_u32 m0, s30, 0
    s_nop 0
    buffer_load_dwordx4 v5, s[8:11], s24 offen sc1 lds
    s_add_u32 s24, s25, 20480
    s_add_u32 m0, s30, 4096
    s_nop 0
    buffer_load_dwordx4 v5, s[8:11], s24 offen sc1 lds
    s_add_u32 s24, s25, 256
    s_add_u32 m0, s30, 9216
    s_nop 0
    buffer_load_dwordx4 v5, s[8:11], s24 offen sc1 lds
    s_add_u32 s24, s25, 20736
    s_add_u32 m0, s30, 13312
    s_nop 0
    buffer_load_dwordx4 v5, s[8:11], s24 offen sc1 lds
    s_add_u32 s24, s25, 512
    s_add_u32 m0, s30, 18432
    s_nop 0
    buffer_load_dwordx4 v5, s[8:11], s24 offen sc1 lds
    s_add_u32 s24, s25, 20992
    s_add_u32 m0, s30, 22528
    s_nop 0
    buffer_load_dwordx4 v5, s[8:11], s24 offen sc1 lds
    s_and_b32 s20, s28, 1
    s_mul_i32 s20, s20, s38
    s_add_u32 s20, s20, s37
    s_lshr_b32 s21, s38, 1
    s_add_u32 s21, s21, s20
    s_waitcnt vmcnt(4)
    s_barrier
    ds_read_b128 v[28:31], v8 offset:0
    ds_read_b128 v[32:35], v9 offset:0
    ds_read_b128 v[36:39], v10 offset:0
    ds_read_b128 v[40:43], v11 offset:0
    ds_read_b128 v[44:47], v12 offset:0
    s_waitcnt lgkmcnt(4)
    v_mfma_f32_32x32x16_bf16 v[60:75], a[0:3], v[28:31], 0
    s_add_u32 s24, s25, 768
    s_add_u32 m0, s30, 27648
    s_nop 0
    buffer_load_dwordx4 v5, s[8:11], s24 offen sc1 lds
    ds_read_b128 v[48:51], v13 offset:0
    s_waitcnt lgkmcnt(4)
    v_mfma_f32_32x32x16_bf16 v[60:75], a[4:7], v[32:35], v[60:75]
    s_add_u32 s24, s25, 21248
    s_add_u32 m0, s30, 31744
    s_nop 0
    buffer_load_dwordx4 v5, s[8:11], s24 offen sc1 lds
    ds_read_b128 v[52:55], v14 offset:0
    s_waitcnt lgkmcnt(4)
    v_mfma_f32_32x32x16_bf16 v[60:75], a[8:11], v[36:39], v[60:75]
    ds_read_b128 v[56:59], v15 offset:0
    s_waitcnt lgkmcnt(4)
    v_mfma_f32_32x32x16_bf16 v[60:75], a[12:15], v[40:43], v[60:75]
    s_waitcnt vmcnt(4)
    s_barrier
    ds_read_b128 v[28:31], v8 offset:9216
    s_waitcnt lgkmcnt(4)
    v_mfma_f32_32x32x16_bf16 v[60:75], a[16:19], v[44:47], v[60:75]
    s_add_u32 s24, s25, 1024
    s_add_u32 m0, s30, 36864
    s_nop 0
    buffer_load_dwordx4 v5, s[8:11], s24 offen sc1 lds
    ds_read_b128 v[32:35], v9 offset:9216
    s_waitcnt lgkmcnt(4)
    v_mfma_f32_32x32x16_bf16 v[60:75], a[20:23], v[48:51], v[60:75]
    s_add_u32 s24, s25, 21504
    s_add_u32 m0, s30, 40960
    s_nop 0
    buffer_load_dwordx4 v5, s[8:11], s24 offen sc1 lds
    ds_read_b128 v[36:39], v10 offset:9216
    s_waitcnt lgkmcnt(4)
    v_mfma_f32_32x32x16_bf16 v[60:75], a[24:27], v[52:55], v[60:75]
    ds_read_b128 v[40:43], v11 offset:9216
    s_waitcnt lgkmcnt(4)
    v_mfma_f32_32x32x16_bf16 v[60:75], a[28:31], v[56:59], v[60:75]
    ds_read_b128 v[44:47], v12 offset:9216
    s_waitcnt lgkmcnt(4)
    v_mfma_f32_32x32x16_bf16 v[60:75], a[32:35], v[28:31], v[60:75]
    ds_read_b128 v[48:51], v13 offset:9216
    s_waitcnt lgkmcnt(4)
    v_mfma_f32_32x32x16_bf16 v[60:75], a[36:39], v[32:35], v[60:75]
    ds_read_b128 v[52:55], v14 offset:9216
    s_waitcnt lgkmcnt(4)
    v_mfma_f32_32x32x16_bf16 v[60:75], a[40:43], v[36:39], v[60:75]
    ds_read_b128 v[56:59], v15 offset:9216
    s_waitcnt lgkmcnt(4)
    v_mfma_f32_32x32x16_bf16 v[60:75], a[44:47], v[40:43], v[60:75]
    s_waitcnt vmcnt(4)
    s_barrier
    ds_read_b128 v[28:31], v8 offset:18432
    s_waitcnt lgkmcnt(4)
    v_mfma_f32_32x32x16_bf16 v[60:75], a[48:51], v[44:47], v[60:75]
    ds_read_b128 v[32:35], v9 offset:18432
    s_waitcnt lgkmcnt(4)
    v_mfma_f32_32x32x16_bf16 v[60:75], a[52:55], v[48:51], v[60:75]
    ds_read_b128 v[36:39], v10 offset:18432
    s_waitcnt lgkmcnt(4)
    v_mfma_f32_32x32x16_bf16 v[60:75], a[56:59], v[52:55], v[60:75]
    ds_read_b128 v[40:43], v11 offset:18432
    s_waitcnt lgkmcnt(4)
    v_mfma_f32_32x32x16_bf16 v[60:75], a[60:63], v[56:59], v[60:75]
    ds_read_b128 v[44:47], v12 offset:18432
    s_waitcnt lgkmcnt(4)
    v_mfma_f32_32x32x16_bf16 v[60:75], a[64:67], v[28:31], v[60:75]
    ds_read_b128 v[48:51], v13 offset:18432
    s_waitcnt lgkmcnt(4)
    v_mfma_f32_32x32x16_bf16 v[60:75], a[68:71], v[32:35], v[60:75]
    ds_read_b128 v[52:55], v14 offset:18432
    s_waitcnt lgkmcnt(4)
    v_mfma_f32_32x32x16_bf16 v[60:75], a[72:75], v[36:39], v[60:75]
    ds_read_b128 v[56:59], v15 offset:18432
    s_waitcnt lgkmcnt(4)
    v_mfma_f32_32x32x16_bf16 v[60:75], a[76:79], v[40:43], v[60:75]
    s_waitcnt vmcnt(2)
    s_barrier
    ds_read_b128 v[28:31], v8 offset:27648
    s_waitcnt lgkmcnt(4)
    v_mfma_f32_32x32x16_bf16 v[60:75], a[80:83], v[44:47], v[60:75]
    ds_read_b128 v[32:35], v9 offset:27648
    s_waitcnt lgkmcnt(4)
    v_mfma_f32_32x32x16_bf16 v[60:75], a[84:87], v[48:51], v[60:75]
    ds_read_b128 v[36:39], v10 offset:27648
    s_waitcnt lgkmcnt(4)
    v_mfma_f32_32x32x16_bf16 v[60:75], a[88:91], v[52:55], v[60:75]
    ds_read_b128 v[40:43], v11 offset:27648
    s_waitcnt lgkmcnt(4)
    v_mfma_f32_32x32x16_bf16 v[60:75], a[92:95], v[56:59], v[60:75]
    ds_read_b128 v[44:47], v12 offset:27648
    s_waitcnt lgkmcnt(4)
    v_mfma_f32_32x32x16_bf16 v[60:75], a[96:99], v[28:31], v[60:75]
    ds_read_b128 v[48:51], v13 offset:27648
    s_waitcnt lgkmcnt(4)
    v_mfma_f32_32x32x16_bf16 v[60:75], a[100:103], v[32:35], v[60:75]
    ds_read_b128 v[52:55], v14 offset:27648
    s_waitcnt lgkmcnt(4)
    v_mfma_f32_32x32x16_bf16 v[60:75], a[104:107], v[36:39], v[60:75]
    ds_read_b128 v[56:59], v15 offset:27648
    s_waitcnt lgkmcnt(4)
    v_mfma_f32_32x32x16_bf16 v[60:75], a[108:111], v[40:43], v[60:75]
    s_waitcnt vmcnt(0)
    s_barrier
    ds_read_b128 v[28:31], v8 offset:36864
    s_waitcnt lgkmcnt(4)
    v_mfma_f32_32x32x16_bf16 v[60:75], a[112:115], v[44:47], v[60:75]
    ds_read_b128 v[32:35], v9 offset:36864
    s_waitcnt lgkmcnt(4)
    v_mfma_f32_32x32x16_bf16 v[60:75], a[116:119], v[48:51], v[60:75]
    ds_read_b128 v[36:39], v10 offset:36864
    s_waitcnt lgkmcnt(4)
    v_mfma_f32_32x32x16_bf16 v[60:75], a[120:123], v[52:55], v[60:75]
    ds_read_b128 v[40:43], v11 offset:36864
    s_waitcnt lgkmcnt(4)
    v_mfma_f32_32x32x16_bf16 v[60:75], a[124:127], v[56:59], v[60:75]
    ds_read_b128 v[44:47], v12 offset:36864
    s_waitcnt lgkmcnt(4)
    v_mfma_f32_32x32x16_bf16 v[60:75], a[128:131], v[28:31], v[60:75]
    ds_read_b128 v[48:51], v13 offset:36864
    s_waitcnt lgkmcnt(4)
    v_mfma_f32_32x32x16_bf16 v[60:75], a[132:135], v[32:35], v[60:75]
    ds_read_b128 v[52:55], v14 offset:36864
    s_waitcnt lgkmcnt(4)
    v_mfma_f32_32x32x16_bf16 v[60:75], a[136:139], v[36:39], v[60:75]
    ds_read_b128 v[56:59], v15 offset:36864
    s_waitcnt lgkmcnt(4)
    v_mfma_f32_32x32x16_bf16 v[60:75], a[140:143], v[40:43], v[60:75]
    s_waitcnt lgkmcnt(3)
    v_mfma_f32_32x32x16_bf16 v[60:75], a[144:147], v[44:47], v[60:75]
    s_waitcnt lgkmcnt(2)
    v_mfma_f32_32x32x16_bf16 v[60:75], a[148:151], v[48:51], v[60:75]
    s_waitcnt lgkmcnt(1)
    v_mfma_f32_32x32x16_bf16 v[60:75], a[152:155], v[52:55], v[60:75]
    s_waitcnt lgkmcnt(0)
    v_mfma_f32_32x32x16_bf16 v[60:75], a[156:159], v[56:59], v[60:75]
    s_nop 11
    v_pk_mul_f32 v[76:77], v[60:61], v[60:61]
    v_pk_mul_f32 v[78:79], v[62:63], v[62:63]
    v_pk_mul_f32 v[80:81], v[64:65], v[64:65]
    v_pk_mul_f32 v[82:83], v[66:67], v[66:67]
    v_pk_mul_f32 v[84:85], v[68:69], v[68:69]
    v_pk_mul_f32 v[86:87], v[70:71], v[70:71]
    v_pk_mul_f32 v[88:89], v[72:73], v[72:73]
    v_pk_mul_f32 v[90:91], v[74:75], v[74:75]
    v_pk_fma_f32 v[76:77], v[76:77], s[68:69], v[132:133]
    v_pk_fma_f32 v[78:79], v[78:79], s[68:69], v[132:133]
    v_pk_fma_f32 v[80:81], v[80:81], s[68:69], v[132:133]
    v_pk_fma_f32 v[82:83], v[82:83], s[68:69], v[132:133]
    v_pk_fma_f32 v[84:85], v[84:85], s[68:69], v[132:133]
    v_pk_fma_f32 v[86:87], v[86:87], s[68:69], v[132:133]
    v_pk_fma_f32 v[88:89], v[88:89], s[68:69], v[132:133]
    v_pk_fma_f32 v[90:91], v[90:91], s[68:69], v[132:133]
    v_pk_mul_f32 v[76:77], v[76:77], v[60:61]
    v_pk_mul_f32 v[78:79], v[78:79], v[62:63]
    v_pk_mul_f32 v[80:81], v[80:81], v[64:65]
    v_pk_mul_f32 v[82:83], v[82:83], v[66:67]
    v_pk_mul_f32 v[84:85], v[84:85], v[68:69]
    v_pk_mul_f32 v[86:87], v[86:87], v[70:71]
    v_pk_mul_f32 v[88:89], v[88:89], v[72:73]
    v_pk_mul_f32 v[90:91], v[90:91], v[74:75]
    v_exp_f32 v76, v76
    v_exp_f32 v77, v77
    v_exp_f32 v78, v78
    v_exp_f32 v79, v79
    v_exp_f32 v80, v80
    v_exp_f32 v81, v81
    v_exp_f32 v82, v82
    v_exp_f32 v83, v83
    v_exp_f32 v84, v84
    v_exp_f32 v85, v85
    v_exp_f32 v86, v86
    v_exp_f32 v87, v87
    v_exp_f32 v88, v88
    v_exp_f32 v89, v89
    v_exp_f32 v90, v90
    v_exp_f32 v91, v91
    v_add_f32 v76, 1.0, v76
    v_add_f32 v77, 1.0, v77
    v_add_f32 v78, 1.0, v78
    v_add_f32 v79, 1.0, v79
    v_add_f32 v80, 1.0, v80
    v_add_f32 v81, 1.0, v81
    v_add_f32 v82, 1.0, v82
    v_add_f32 v83, 1.0, v83
    v_add_f32 v84, 1.0, v84
    v_add_f32 v85, 1.0, v85
    v_add_f32 v86, 1.0, v86
    v_add_f32 v87, 1.0, v87
    v_add_f32 v88, 1.0, v88
    v_add_f32 v89, 1.0, v89
    v_add_f32 v90, 1.0, v90
    v_add_f32 v91, 1.0, v91
    v_rcp_f32 v76, v76
    v_rcp_f32 v77, v77
    v_rcp_f32 v78, v78
    v_rcp_f32 v79, v79
    v_rcp_f32 v80, v80
    v_rcp_f32 v81, v81
    v_rcp_f32 v82, v82
    v_rcp_f32 v83, v83
    v_rcp_f32 v84, v84
    v_rcp_f32 v85, v85
    v_rcp_f32 v86, v86
    v_rcp_f32 v87, v87
    v_rcp_f32 v88, v88
    v_rcp_f32 v89, v89
    v_rcp_f32_e64 v90, v90
    v_rcp_f32 v91, v91
    v_pk_mul_f32 v[76:77], v[76:77], v[60:61]
    v_pk_mul_f32 v[78:79], v[78:79], v[62:63]
    v_pk_mul_f32 v[80:81], v[80:81], v[64:65]
    v_pk_mul_f32 v[82:83], v[82:83], v[66:67]
    v_pk_mul_f32 v[84:85], v[84:85], v[68:69]
    v_pk_mul_f32 v[86:87], v[86:87], v[70:71]
    v_pk_mul_f32 v[88:89], v[88:89], v[72:73]
    v_pk_mul_f32 v[90:91], v[90:91], v[74:75]
    v_cvt_pk_bf16_f32 v136, v76, v77
    v_cvt_pk_bf16_f32 v137, v78, v79
    v_cvt_pk_bf16_f32 v138, v80, v81
    v_cvt_pk_bf16_f32 v139, v82, v83
    v_cvt_pk_bf16_f32 v140, v84, v85
    v_cvt_pk_bf16_f32 v141, v86, v87
    v_cvt_pk_bf16_f32 v142, v88, v89
    v_cvt_pk_bf16_f32 v143, v90, v91
    ds_write_b128 v6, v[136:139] offset:0
    ds_write_b128 v6, v[140:143] offset:1024
    s_waitcnt lgkmcnt(0)
    s_barrier
    s_cmp_lg_u32 s45, 1
    s_cbranch_scc1 ls_58
    ds_read_b128 v[100:103], v1 offset:46080
    ds_read_b128 v[104:107], v1 offset:47104
    ds_read_b128 v[108:111], v1 offset:48128
    ds_read_b128 v[112:115], v1 offset:49152
    ds_read_b128 v[116:119], v1 offset:50176
    ds_read_b128 v[120:123], v1 offset:51200
    ds_read_b128 v[124:127], v1 offset:52224
    ds_read_b128 v[128:131], v1 offset:53248
    s_waitcnt lgkmcnt(7)
    v_mfma_f32_32x32x16_bf16 v[60:75], a[160:163], v[100:103], 0
    s_waitcnt lgkmcnt(6)
    v_mfma_f32_32x32x16_bf16 v[60:75], a[164:167], v[104:107], v[60:75]
    s_waitcnt lgkmcnt(5)
    v_mfma_f32_32x32x16_bf16 v[60:75], a[168:171], v[108:111], v[60:75]
    s_waitcnt lgkmcnt(4)
    v_mfma_f32_32x32x16_bf16 v[60:75], a[172:175], v[112:115], v[60:75]
    s_waitcnt lgkmcnt(3)
    v_mfma_f32_32x32x16_bf16 v[60:75], a[176:179], v[116:119], v[60:75]
    s_waitcnt lgkmcnt(2)
    v_mfma_f32_32x32x16_bf16 v[60:75], a[180:183], v[120:123], v[60:75]
    s_waitcnt lgkmcnt(1)
    v_mfma_f32_32x32x16_bf16 v[60:75], a[184:187], v[124:127], v[60:75]
    s_waitcnt lgkmcnt(0)
    v_mfma_f32_32x32x16_bf16 v[60:75], a[188:191], v[128:131], v[60:75]
    v_mfma_f32_32x32x16_bf16 v[76:91], a[192:195], v[100:103], 0
    v_mfma_f32_32x32x16_bf16 v[76:91], a[196:199], v[104:107], v[76:91]
    v_cvt_pk_bf16_f32 v136, v60, v61
    v_cvt_pk_bf16_f32 v137, v62, v63
    v_cvt_pk_bf16_f32 v138, v64, v65
    v_cvt_pk_bf16_f32 v139, v66, v67
    v_mfma_f32_32x32x16_bf16 v[76:91], a[200:203], v[108:111], v[76:91]
    v_cvt_pk_bf16_f32 v140, v68, v69
    v_cvt_pk_bf16_f32 v141, v70, v71
    v_cvt_pk_bf16_f32 v142, v72, v73
    v_cvt_pk_bf16_f32 v143, v74, v75
    v_mfma_f32_32x32x16_bf16 v[76:91], a[204:207], v[112:115], v[76:91]
    v_permlane32_swap_b32 v136, v138
    v_permlane32_swap_b32 v137, v139
    v_mfma_f32_32x32x16_bf16 v[76:91], a[208:211], v[116:119], v[76:91]
    ds_write_b128 v2, v[136:139] offset:0
    v_mfma_f32_32x32x16_bf16 v[76:91], a[212:215], v[120:123], v[76:91]
    v_permlane32_swap_b32 v140, v142
    v_permlane32_swap_b32 v141, v143
    v_mfma_f32_32x32x16_bf16 v[76:91], a[216:219], v[124:127], v[76:91]
    ds_write_b128 v2, v[140:143] offset:32
    v_mfma_f32_32x32x16_bf16 v[76:91], a[220:223], v[128:131], v[76:91]
    ds_read_b128 v[144:147], v3 offset:0
    ds_read_b128 v[148:151], v3 offset:1280
    v_mfma_f32_32x32x16_bf16 v[60:75], a[224:227], v[100:103], 0
    s_waitcnt lgkmcnt(1)
    buffer_store_dwordx4 v[144:147], v4, s[8:11], s20 offen offset:0
    v_mfma_f32_32x32x16_bf16 v[60:75], a[228:231], v[104:107], v[60:75]
    v_cvt_pk_bf16_f32 v136, v76, v77
    v_cvt_pk_bf16_f32 v137, v78, v79
    v_cvt_pk_bf16_f32 v138, v80, v81
    v_cvt_pk_bf16_f32 v139, v82, v83
    v_mfma_f32_32x32x16_bf16 v[60:75], a[232:235], v[108:111], v[60:75]
    v_cvt_pk_bf16_f32 v140, v84, v85
    v_cvt_pk_bf16_f32 v141, v86, v87
    v_cvt_pk_bf16_f32 v142, v88, v89
    v_cvt_pk_bf16_f32 v143, v90, v91
    v_mfma_f32_32x32x16_bf16 v[60:75], a[236:239], v[112:115], v[60:75]
    v_permlane32_swap_b32 v136, v138
    v_permlane32_swap_b32 v137, v139
    v_mfma_f32_32x32x16_bf16 v[60:75], a[240:243], v[116:119], v[60:75]
    ds_write_b128 v2, v[136:139] offset:2560
    v_mfma_f32_32x32x16_bf16 v[60:75], a[244:247], v[120:123], v[60:75]
    v_permlane32_swap_b32 v140, v142
    v_permlane32_swap_b32 v141, v143
    v_mfma_f32_32x32x16_bf16 v[60:75], a[248:251], v[124:127], v[60:75]
    ds_write_b128 v2, v[140:143] offset:2592
    v_mfma_f32_32x32x16_bf16 v[60:75], a[252:255], v[128:131], v[60:75]
    s_waitcnt lgkmcnt(2)
    buffer_store_dwordx4 v[148:151], v4, s[8:11], s21 offen offset:0
    ds_read_b128 v[144:147], v3 offset:2560
    ds_read_b128 v[148:151], v3 offset:3840
    v_mfma_f32_32x32x16_bf16 v[76:91], v[192:195], v[100:103], 0
    s_waitcnt lgkmcnt(1)
    buffer_store_dwordx4 v[144:147], v4, s[8:11], s20 offen offset:64
    v_mfma_f32_32x32x16_bf16 v[76:91], v[196:199], v[104:107], v[76:91]
    v_cvt_pk_bf16_f32 v136, v60, v61
    v_cvt_pk_bf16_f32 v137, v62, v63
    v_cvt_pk_bf16_f32 v138, v64, v65
    v_cvt_pk_bf16_f32 v139, v66, v67
    v_mfma_f32_32x32x16_bf16 v[76:91], v[200:203], v[108:111], v[76:91]
    v_cvt_pk_bf16_f32 v140, v68, v69
    v_cvt_pk_bf16_f32 v141, v70, v71
    v_cvt_pk_bf16_f32 v142, v72, v73
    v_cvt_pk_bf16_f32 v143, v74, v75
    v_mfma_f32_32x32x16_bf16 v[76:91], v[204:207], v[112:115], v[76:91]
    v_permlane32_swap_b32 v136, v138
    v_permlane32_swap_b32 v137, v139
    v_mfma_f32_32x32x16_bf16 v[76:91], v[208:211], v[116:119], v[76:91]
    ds_write_b128 v2, v[136:139] offset:0
    v_mfma_f32_32x32x16_bf16 v[76:91], v[212:215], v[120:123], v[76:91]
    v_permlane32_swap_b32 v140, v142
    v_permlane32_swap_b32 v141, v143
    v_mfma_f32_32x32x16_bf16 v[76:91], v[216:219], v[124:127], v[76:91]
    ds_write_b128 v2, v[140:143] offset:32
    v_mfma_f32_32x32x16_bf16 v[76:91], v[220:223], v[128:131], v[76:91]
    s_waitcnt lgkmcnt(2)
    buffer_store_dwordx4 v[148:151], v4, s[8:11], s21 offen offset:64
    ds_read_b128 v[144:147], v3 offset:0
    ds_read_b128 v[148:151], v3 offset:1280
    v_mfma_f32_32x32x16_bf16 v[60:75], v[224:227], v[100:103], 0
    s_waitcnt lgkmcnt(1)
    buffer_store_dwordx4 v[144:147], v4, s[8:11], s20 offen offset:128
    v_mfma_f32_32x32x16_bf16 v[60:75], v[228:231], v[104:107], v[60:75]
    v_cvt_pk_bf16_f32 v136, v76, v77
    v_cvt_pk_bf16_f32 v137, v78, v79
    v_cvt_pk_bf16_f32 v138, v80, v81
    v_cvt_pk_bf16_f32 v139, v82, v83
    v_mfma_f32_32x32x16_bf16 v[60:75], v[232:235], v[108:111], v[60:75]
    v_cvt_pk_bf16_f32 v140, v84, v85
    v_cvt_pk_bf16_f32 v141, v86, v87
    v_cvt_pk_bf16_f32 v142, v88, v89
    v_cvt_pk_bf16_f32 v143, v90, v91
    v_mfma_f32_32x32x16_bf16 v[60:75], v[236:239], v[112:115], v[60:75]
    v_permlane32_swap_b32 v136, v138
    v_permlane32_swap_b32 v137, v139
    v_mfma_f32_32x32x16_bf16 v[60:75], v[240:243], v[116:119], v[60:75]
    ds_write_b128 v2, v[136:139] offset:2560
    v_mfma_f32_32x32x16_bf16 v[60:75], v[244:247], v[120:123], v[60:75]
    v_permlane32_swap_b32 v140, v142
    v_permlane32_swap_b32 v141, v143
    v_mfma_f32_32x32x16_bf16 v[60:75], v[248:251], v[124:127], v[60:75]
    ds_write_b128 v2, v[140:143] offset:2592
    v_mfma_f32_32x32x16_bf16 v[60:75], v[252:255], v[128:131], v[60:75]
    s_waitcnt lgkmcnt(2)
    buffer_store_dwordx4 v[148:151], v4, s[8:11], s21 offen offset:128
    ds_read_b128 v[144:147], v3 offset:2560
    ds_read_b128 v[148:151], v3 offset:3840
    s_waitcnt lgkmcnt(1)
    buffer_store_dwordx4 v[144:147], v4, s[8:11], s20 offen offset:192
    s_waitcnt lgkmcnt(0)
    buffer_store_dwordx4 v[148:151], v4, s[8:11], s21 offen offset:192
    s_nop 3
    v_cvt_pk_bf16_f32 v136, v60, v61
    v_cvt_pk_bf16_f32 v137, v62, v63
    v_cvt_pk_bf16_f32 v138, v64, v65
    v_cvt_pk_bf16_f32 v139, v66, v67
    v_cvt_pk_bf16_f32 v140, v68, v69
    v_cvt_pk_bf16_f32 v141, v70, v71
    v_cvt_pk_bf16_f32 v142, v72, v73
    v_cvt_pk_bf16_f32 v143, v74, v75
    v_permlane32_swap_b32 v136, v138
    v_permlane32_swap_b32 v137, v139
    v_permlane32_swap_b32 v140, v142
    v_permlane32_swap_b32 v141, v143
    ds_write_b128 v2, v[136:139] offset:0
    ds_write_b128 v2, v[140:143] offset:32
    ds_read_b128 v[144:147], v3 offset:0
    ds_read_b128 v[148:151], v3 offset:1280
    s_waitcnt lgkmcnt(1)
    buffer_store_dwordx4 v[144:147], v4, s[8:11], s20 offen offset:256
    s_waitcnt lgkmcnt(0)
    buffer_store_dwordx4 v[148:151], v4, s[8:11], s21 offen offset:256
    s_branch lj_59
ls_58:
    ds_read_b128 v[100:103], v1 offset:46080
    ds_read_b128 v[104:107], v1 offset:47104
    ds_read_b128 v[108:111], v1 offset:48128
    ds_read_b128 v[112:115], v1 offset:49152
    ds_read_b128 v[116:119], v1 offset:50176
    ds_read_b128 v[120:123], v1 offset:51200
    ds_read_b128 v[124:127], v1 offset:52224
    ds_read_b128 v[128:131], v1 offset:53248
    s_waitcnt lgkmcnt(7)
    v_mfma_f32_32x32x16_bf16 v[60:75], a[160:163], v[100:103], 0
    s_waitcnt lgkmcnt(6)
    v_mfma_f32_32x32x16_bf16 v[60:75], a[164:167], v[104:107], v[60:75]
    s_waitcnt lgkmcnt(5)
    v_mfma_f32_32x32x16_bf16 v[60:75], a[168:171], v[108:111], v[60:75]
    s_waitcnt lgkmcnt(4)
    v_mfma_f32_32x32x16_bf16 v[60:75], a[172:175], v[112:115], v[60:75]
    s_waitcnt lgkmcnt(3)
    v_mfma_f32_32x32x16_bf16 v[60:75], a[176:179], v[116:119], v[60:75]
    s_waitcnt lgkmcnt(2)
    v_mfma_f32_32x32x16_bf16 v[60:75], a[180:183], v[120:123], v[60:75]
    s_waitcnt lgkmcnt(1)
    v_mfma_f32_32x32x16_bf16 v[60:75], a[184:187], v[124:127], v[60:75]
    s_waitcnt lgkmcnt(0)
    v_mfma_f32_32x32x16_bf16 v[60:75], a[188:191], v[128:131], v[60:75]
    v_mfma_f32_32x32x16_bf16 v[76:91], a[192:195], v[100:103], 0
    v_mfma_f32_32x32x16_bf16 v[76:91], a[196:199], v[104:107], v[76:91]
    v_cvt_pk_bf16_f32 v136, v60, v61
    v_cvt_pk_bf16_f32 v137, v62, v63
    v_cvt_pk_bf16_f32 v138, v64, v65
    v_cvt_pk_bf16_f32 v139, v66, v67
    v_mfma_f32_32x32x16_bf16 v[76:91], a[200:203], v[108:111], v[76:91]
    v_cvt_pk_bf16_f32 v140, v68, v69
    v_cvt_pk_bf16_f32 v141, v70, v71
    v_cvt_pk_bf16_f32 v142, v72, v73
    v_cvt_pk_bf16_f32 v143, v74, v75
    v_mfma_f32_32x32x16_bf16 v[76:91], a[204:207], v[112:115], v[76:91]
    v_permlane32_swap_b32 v136, v138
    v_permlane32_swap_b32 v137, v139
    v_mfma_f32_32x32x16_bf16 v[76:91], a[208:211], v[116:119], v[76:91]
    ds_write_b128 v2, v[136:139] offset:0
    v_mfma_f32_32x32x16_bf16 v[76:91], a[212:215], v[120:123], v[76:91]
    v_permlane32_swap_b32 v140, v142
    v_permlane32_swap_b32 v141, v143
    v_mfma_f32_32x32x16_bf16 v[76:91], a[216:219], v[124:127], v[76:91]
    ds_write_b128 v2, v[140:143] offset:32
    v_mfma_f32_32x32x16_bf16 v[76:91], a[220:223], v[128:131], v[76:91]
    ds_read_b128 v[144:147], v3 offset:0
    ds_read_b128 v[148:151], v3 offset:1280
    v_mfma_f32_32x32x16_bf16 v[60:75], a[224:227], v[100:103], 0
    s_waitcnt lgkmcnt(1)
    buffer_store_dwordx4 v[144:147], v4, s[8:11], s20 offen offset:0 sc1
    v_mfma_f32_32x32x16_bf16 v[60:75], a[228:231], v[104:107], v[60:75]
    v_cvt_pk_bf16_f32 v136, v76, v77
    v_cvt_pk_bf16_f32 v137, v78, v79
    v_cvt_pk_bf16_f32 v138, v80, v81
    v_cvt_pk_bf16_f32 v139, v82, v83
    v_mfma_f32_32x32x16_bf16 v[60:75], a[232:235], v[108:111], v[60:75]
    v_cvt_pk_bf16_f32 v140, v84, v85
    v_cvt_pk_bf16_f32 v141, v86, v87
    v_cvt_pk_bf16_f32 v142, v88, v89
    v_cvt_pk_bf16_f32 v143, v90, v91
    v_mfma_f32_32x32x16_bf16 v[60:75], a[236:239], v[112:115], v[60:75]
    v_permlane32_swap_b32 v136, v138
    v_permlane32_swap_b32 v137, v139
    v_mfma_f32_32x32x16_bf16 v[60:75], a[240:243], v[116:119], v[60:75]
    ds_write_b128 v2, v[136:139] offset:2560
    v_mfma_f32_32x32x16_bf16 v[60:75], a[244:247], v[120:123], v[60:75]
    v_permlane32_swap_b32 v140, v142
    v_permlane32_swap_b32 v141, v143
    v_mfma_f32_32x32x16_bf16 v[60:75], a[248:251], v[124:127], v[60:75]
    ds_write_b128 v2, v[140:143] offset:2592
    v_mfma_f32_32x32x16_bf16 v[60:75], a[252:255], v[128:131], v[60:75]
    s_waitcnt lgkmcnt(2)
    buffer_store_dwordx4 v[148:151], v4, s[8:11], s21 offen offset:0 sc1
    ds_read_b128 v[144:147], v3 offset:2560
    ds_read_b128 v[148:151], v3 offset:3840
    v_mfma_f32_32x32x16_bf16 v[76:91], v[192:195], v[100:103], 0
    s_waitcnt lgkmcnt(1)
    buffer_store_dwordx4 v[144:147], v4, s[8:11], s20 offen offset:64 sc1
    v_mfma_f32_32x32x16_bf16 v[76:91], v[196:199], v[104:107], v[76:91]
    v_cvt_pk_bf16_f32 v136, v60, v61
    v_cvt_pk_bf16_f32 v137, v62, v63
    v_cvt_pk_bf16_f32 v138, v64, v65
    v_cvt_pk_bf16_f32 v139, v66, v67
    v_mfma_f32_32x32x16_bf16 v[76:91], v[200:203], v[108:111], v[76:91]
    v_cvt_pk_bf16_f32 v140, v68, v69
    v_cvt_pk_bf16_f32 v141, v70, v71
    v_cvt_pk_bf16_f32 v142, v72, v73
    v_cvt_pk_bf16_f32 v143, v74, v75
    v_mfma_f32_32x32x16_bf16 v[76:91], v[204:207], v[112:115], v[76:91]
    v_permlane32_swap_b32 v136, v138
    v_permlane32_swap_b32 v137, v139
    v_mfma_f32_32x32x16_bf16 v[76:91], v[208:211], v[116:119], v[76:91]
    ds_write_b128 v2, v[136:139] offset:0
    v_mfma_f32_32x32x16_bf16 v[76:91], v[212:215], v[120:123], v[76:91]
    v_permlane32_swap_b32 v140, v142
    v_permlane32_swap_b32 v141, v143
    v_mfma_f32_32x32x16_bf16 v[76:91], v[216:219], v[124:127], v[76:91]
    ds_write_b128 v2, v[140:143] offset:32
    v_mfma_f32_32x32x16_bf16 v[76:91], v[220:223], v[128:131], v[76:91]
    s_waitcnt lgkmcnt(2)
    buffer_store_dwordx4 v[148:151], v4, s[8:11], s21 offen offset:64 sc1
    ds_read_b128 v[144:147], v3 offset:0
    ds_read_b128 v[148:151], v3 offset:1280
    v_mfma_f32_32x32x16_bf16 v[60:75], v[224:227], v[100:103], 0
    s_waitcnt lgkmcnt(1)
    buffer_store_dwordx4 v[144:147], v4, s[8:11], s20 offen offset:128 sc1
    v_mfma_f32_32x32x16_bf16 v[60:75], v[228:231], v[104:107], v[60:75]
    v_cvt_pk_bf16_f32 v136, v76, v77
    v_cvt_pk_bf16_f32 v137, v78, v79
    v_cvt_pk_bf16_f32 v138, v80, v81
    v_cvt_pk_bf16_f32 v139, v82, v83
    v_mfma_f32_32x32x16_bf16 v[60:75], v[232:235], v[108:111], v[60:75]
    v_cvt_pk_bf16_f32 v140, v84, v85
    v_cvt_pk_bf16_f32 v141, v86, v87
    v_cvt_pk_bf16_f32 v142, v88, v89
    v_cvt_pk_bf16_f32 v143, v90, v91
    v_mfma_f32_32x32x16_bf16 v[60:75], v[236:239], v[112:115], v[60:75]
    v_permlane32_swap_b32 v136, v138
    v_permlane32_swap_b32 v137, v139
    v_mfma_f32_32x32x16_bf16 v[60:75], v[240:243], v[116:119], v[60:75]
    ds_write_b128 v2, v[136:139] offset:2560
    v_mfma_f32_32x32x16_bf16 v[60:75], v[244:247], v[120:123], v[60:75]
    v_permlane32_swap_b32 v140, v142
    v_permlane32_swap_b32 v141, v143
    v_mfma_f32_32x32x16_bf16 v[60:75], v[248:251], v[124:127], v[60:75]
    ds_write_b128 v2, v[140:143] offset:2592
    v_mfma_f32_32x32x16_bf16 v[60:75], v[252:255], v[128:131], v[60:75]
    s_waitcnt lgkmcnt(2)
    buffer_store_dwordx4 v[148:151], v4, s[8:11], s21 offen offset:128 sc1
    ds_read_b128 v[144:147], v3 offset:2560
    ds_read_b128 v[148:151], v3 offset:3840
    s_waitcnt lgkmcnt(1)
    buffer_store_dwordx4 v[144:147], v4, s[8:11], s20 offen offset:192 sc1
    s_waitcnt lgkmcnt(0)
    buffer_store_dwordx4 v[148:151], v4, s[8:11], s21 offen offset:192 sc1
    s_nop 3
    v_cvt_pk_bf16_f32 v136, v60, v61
    v_cvt_pk_bf16_f32 v137, v62, v63
    v_cvt_pk_bf16_f32 v138, v64, v65
    v_cvt_pk_bf16_f32 v139, v66, v67
    v_cvt_pk_bf16_f32 v140, v68, v69
    v_cvt_pk_bf16_f32 v141, v70, v71
    v_cvt_pk_bf16_f32 v142, v72, v73
    v_cvt_pk_bf16_f32 v143, v74, v75
    v_permlane32_swap_b32 v136, v138
    v_permlane32_swap_b32 v137, v139
    v_permlane32_swap_b32 v140, v142
    v_permlane32_swap_b32 v141, v143
    ds_write_b128 v2, v[136:139] offset:0
    ds_write_b128 v2, v[140:143] offset:32
    ds_read_b128 v[144:147], v3 offset:0
    ds_read_b128 v[148:151], v3 offset:1280
    s_waitcnt lgkmcnt(1)
    buffer_store_dwordx4 v[144:147], v4, s[8:11], s20 offen offset:256 sc1
    s_waitcnt lgkmcnt(0)
    buffer_store_dwordx4 v[148:151], v4, s[8:11], s21 offen offset:256 sc1
lj_59:
    s_add_u32 s28, s28, 1
    s_waitcnt vmcnt(0)
    s_barrier
    s_cmp_lg_u32 s5, 0
    s_cbranch_scc1 sig_60
    v_mov_b32 v28, s28
    v_mov_b32 v29, 0
    s_mov_b64 exec, 1
    s_cmp_lg_u32 s45, 1
    s_cbranch_scc1 ls_61
    buffer_store_dword v28, v29, s[8:11], s39 offen
    s_branch lj_62
ls_61:
    buffer_store_dword v28, v29, s[8:11], s39 offen sc1
lj_62:
    s_mov_b64 exec, -1
sig_60:
    s_add_u32 s27, s27, 3
    s_cmp_lt_u32 s27, 64
    s_cbranch_scc1 DF_top_48
    s_branch L_fin
post_r_20:
    s_cmp_ge_u32 s5, 3
    s_cbranch_scc1 L_fin
    s_sub_u32 s47, s4, 19
    s_mul_i32 s47, s47, 3
    s_add_u32 s47, s47, s5
    s_cmp_ge_u32 s47, 32
    s_cbranch_scc1 L_fin
    v_and_b32 v16, 15, v0
    v_mov_b32 v17, 0x3f80
    v_cmp_eq_u32 vcc, 0, v16
    s_nop 1
    v_cndmask_b32_e64 v4, 0, v17, vcc
    v_cmp_eq_u32 vcc, 1, v16
    s_nop 1
    v_cndmask_b32 v4, v4, 1.0, vcc
    v_cmp_eq_u32 vcc, 2, v16
    s_nop 1
    v_cndmask_b32_e64 v5, 0, v17, vcc
    v_cmp_eq_u32 vcc, 3, v16
    s_nop 1
    v_cndmask_b32 v5, v5, 1.0, vcc
    v_cmp_eq_u32 vcc, 4, v16
    s_nop 1
    v_cndmask_b32_e64 v6, 0, v17, vcc
    v_cmp_eq_u32 vcc, 5, v16
    s_nop 1
    v_cndmask_b32 v6, v6, 1.0, vcc
    v_cmp_eq_u32 vcc, 6, v16
    s_nop 1
    v_cndmask_b32_e64 v7, 0, v17, vcc
    v_cmp_eq_u32 vcc, 7, v16
    s_nop 1
    v_cndmask_b32 v7, v7, 1.0, vcc
    v_cmp_eq_u32 vcc, 8, v16
    s_nop 1
    v_cndmask_b32_e64 v8, 0, v17, vcc
    v_cmp_eq_u32 vcc, 9, v16
    s_nop 1
    v_cndmask_b32 v8, v8, 1.0, vcc
    v_cmp_eq_u32 vcc, 10, v16
    s_nop 1
    v_cndmask_b32_e64 v9, 0, v17, vcc
    v_cmp_eq_u32 vcc, 11, v16
    s_nop 1
    v_cndmask_b32 v9, v9, 1.0, vcc
    v_cmp_eq_u32 vcc, 12, v16
    s_nop 1
    v_cndmask_b32_e64 v10, 0, v17, vcc
    v_cmp_eq_u32 vcc, 13, v16
    s_nop 1
    v_cndmask_b32 v10, v10, 1.0, vcc
    v_cmp_eq_u32 vcc, 14, v16
    s_nop 1
    v_cndmask_b32_e64 v11, 0, v17, vcc
    v_cmp_eq_u32 vcc, 15, v16
    s_nop 1
    v_cndmask_b32 v11, v11, 1.0, vcc
    v_lshrrev_b32_e64 v16, 4, v0
    v_and_b32 v17, 0xf0, v1
    v_mul_u32_u24 v2, 1280, v16
    v_add_u32 v2, v2, v17
    v_lshrrev_b32 v12, 5, v0
    v_lshl_add_u32 v17, v12, 8, v17
    v_and_b32_e64 v16, 1, v16
    v_lshl_add_u32 v12, v16, 3, v17
    s_mov_b32 s44, 0x3727c5ac
    v_lshrrev_b32_e64 v16, 4, v0
    v_mov_b32 v17, 0x7fff0000
    v_cmp_gt_u32 vcc, 1, v16
    s_nop 1
    v_cndmask_b32_e64 v3, v17, v2, vcc
    v_cmp_gt_u32 vcc, 2, v16
    s_nop 1
    v_cndmask_b32 v13, v17, v2, vcc
    s_load_dwordx2 s[76:77], s[0:1], 96
    s_waitcnt lgkmcnt(0)
    s_mov_b32 s32, s76
    s_and_b32 s33, s77, 0xffff
    s_mov_b32 s34, 0x280000
    s_mov_b32 s35, 0x20000
    s_lshl_b32 s20, s46, 5
    s_add_u32 s20, s20, s47
    s_lshl_b32 s38, s20, 2
    s_add_u32 s41, s38, 0x2600
    s_add_u32 s38, s38, 0x2c00
    s_mul_i32 s36, s20, 1280
    s_lshl_b32 s20, s46, 6
    s_add_u32 s20, s20, s47
    s_mul_i32 s37, s20, 6400
    s_add_u32 s37, s37, 0x5620000
    s_mul_i32 s39, s20, 17920
    s_add_u32 s39, s39, 0x574c000
    s_mul_i32 s64, s20, 1280
    s_add_u32 s64, s64, 0x5a94a00
    s_add_u32 s21, s37, 0
    buffer_load_dwordx4 v[76:79], v1, s[8:11], s21 offen sc1
    s_add_u32 s21, s37, 1024
    buffer_load_dwordx4 v[76:79], v1, s[8:11], s21 offen sc1
    s_add_u32 s21, s37, 2048
    buffer_load_dwordx4 v[76:79], v1, s[8:11], s21 offen sc1
    s_add_u32 s21, s37, 3072
    buffer_load_dwordx4 v[76:79], v1, s[8:11], s21 offen sc1
    s_add_u32 s21, s37, 4096
    buffer_load_dwordx4 v[76:79], v1, s[8:11], s21 offen sc1
    s_add_u32 s21, s37, 5120
    buffer_load_dwordx4 v[76:79], v1, s[8:11], s21 offen sc1
    s_add_u32 s21, s37, 6144
    buffer_load_dwordx4 v[76:79], v1, s[8:11], s21 offen sc1
    s_add_u32 s21, s37, 204800
    buffer_load_dwordx4 v[76:79], v1, s[8:11], s21 offen sc1
    s_add_u32 s21, s37, 205824
    buffer_load_dwordx4 v[76:79], v1, s[8:11], s21 offen sc1
    s_add_u32 s21, s37, 206848
    buffer_load_dwordx4 v[76:79], v1, s[8:11], s21 offen sc1
    s_add_u32 s21, s37, 207872
    buffer_load_dwordx4 v[76:79], v1, s[8:11], s21 offen sc1
    s_add_u32 s21, s37, 208896
    buffer_load_dwordx4 v[76:79], v1, s[8:11], s21 offen sc1
    s_add_u32 s21, s37, 209920
    buffer_load_dwordx4 v[76:79], v1, s[8:11], s21 offen sc1
    s_add_u32 s21, s37, 210944
    buffer_load_dwordx4 v[76:79], v1, s[8:11], s21 offen sc1
    s_add_u32 s21, s39, 0
    buffer_load_dwordx4 v[76:79], v1, s[8:11], s21 offen sc1
    s_add_u32 s21, s39, 1024
    buffer_load_dwordx4 v[76:79], v1, s[8:11], s21 offen sc1
    s_add_u32 s21, s39, 2048
    buffer_load_dwordx4 v[76:79], v1, s[8:11], s21 offen sc1
    s_add_u32 s21, s39, 3072
    buffer_load_dwordx4 v[76:79], v1, s[8:11], s21 offen sc1
    s_add_u32 s21, s39, 4096
    buffer_load_dwordx4 v[76:79], v1, s[8:11], s21 offen sc1
    s_add_u32 s21, s39, 5120
    buffer_load_dwordx4 v[76:79], v1, s[8:11], s21 offen sc1
    s_add_u32 s21, s39, 6144
    buffer_load_dwordx4 v[76:79], v1, s[8:11], s21 offen sc1
    s_add_u32 s21, s39, 7168
    buffer_load_dwordx4 v[76:79], v1, s[8:11], s21 offen sc1
    s_add_u32 s21, s39, 8192
    buffer_load_dwordx4 v[76:79], v1, s[8:11], s21 offen sc1
    s_add_u32 s21, s39, 9216
    buffer_load_dwordx4 v[76:79], v1, s[8:11], s21 offen sc1
    s_add_u32 s21, s39, 10240
    buffer_load_dwordx4 v[76:79], v1, s[8:11], s21 offen sc1
    s_add_u32 s21, s39, 11264
    buffer_load_dwordx4 v[76:79], v1, s[8:11], s21 offen sc1
    s_add_u32 s21, s39, 12288
    buffer_load_dwordx4 v[76:79], v1, s[8:11], s21 offen sc1
    s_add_u32 s21, s39, 13312
    buffer_load_dwordx4 v[76:79], v1, s[8:11], s21 offen sc1
    s_add_u32 s21, s39, 14336
    buffer_load_dwordx4 v[76:79], v1, s[8:11], s21 offen sc1
    s_add_u32 s21, s39, 15360
    buffer_load_dwordx4 v[76:79], v1, s[8:11], s21 offen sc1
    s_add_u32 s21, s39, 16384
    buffer_load_dwordx4 v[76:79], v1, s[8:11], s21 offen sc1
    s_add_u32 s21, s39, 17408
    buffer_load_dwordx4 v[76:79], v1, s[8:11], s21 offen sc1
    s_add_u32 s21, s39, 573440
    buffer_load_dwordx4 v[76:79], v1, s[8:11], s21 offen sc1
    s_add_u32 s21, s39, 574464
    buffer_load_dwordx4 v[76:79], v1, s[8:11], s21 offen sc1
    s_add_u32 s21, s39, 575488
    buffer_load_dwordx4 v[76:79], v1, s[8:11], s21 offen sc1
    s_add_u32 s21, s39, 576512
    buffer_load_dwordx4 v[76:79], v1, s[8:11], s21 offen sc1
    s_add_u32 s21, s39, 577536
    buffer_load_dwordx4 v[76:79], v1, s[8:11], s21 offen sc1
    s_add_u32 s21, s39, 578560
    buffer_load_dwordx4 v[76:79], v1, s[8:11], s21 offen sc1
    s_add_u32 s21, s39, 579584
    buffer_load_dwordx4 v[76:79], v1, s[8:11], s21 offen sc1
    s_add_u32 s21, s39, 580608
    buffer_load_dwordx4 v[76:79], v1, s[8:11], s21 offen sc1
    s_add_u32 s21, s39, 581632
    buffer_load_dwordx4 v[76:79], v1, s[8:11], s21 offen sc1
    s_add_u32 s21, s39, 582656
    buffer_load_dwordx4 v[76:79], v1, s[8:11], s21 offen sc1
    s_add_u32 s21, s39, 583680
    buffer_load_dwordx4 v[76:79], v1, s[8:11], s21 offen sc1
    s_add_u32 s21, s39, 584704
    buffer_load_dwordx4 v[76:79], v1, s[8:11], s21 offen sc1
    s_add_u32 s21, s39, 585728
    buffer_load_dwordx4 v[76:79], v1, s[8:11], s21 offen sc1
    s_add_u32 s21, s39, 586752
    buffer_load_dwordx4 v[76:79], v1, s[8:11], s21 offen sc1
    s_add_u32 s21, s39, 587776
    buffer_load_dwordx4 v[76:79], v1, s[8:11], s21 offen sc1
    s_add_u32 s21, s39, 588800
    buffer_load_dwordx4 v[76:79], v1, s[8:11], s21 offen sc1
    s_add_u32 s21, s39, 589824
    buffer_load_dwordx4 v[76:79], v1, s[8:11], s21 offen sc1
    s_add_u32 s21, s39, 590848
    buffer_load_dwordx4 v[76:79], v1, s[8:11], s21 offen sc1
    s_add_u32 s21, s64, 0
    buffer_load_dwordx4 v[76:79], v1, s[8:11], s21 offen sc1
    s_add_u32 s21, s64, 1024
    buffer_load_dwordx4 v[76:79], v1, s[8:11], s21 offen sc1
    s_add_u32 s21, s64, 40960
    buffer_load_dwordx4 v[76:79], v1, s[8:11], s21 offen sc1
    s_add_u32 s21, s64, 41984
    buffer_load_dwordx4 v[76:79], v1, s[8:11], s21 offen sc1
    s_mov_b32 s65, 204800
    s_mov_b32 s66, 573440
    s_mov_b32 s68, 40960
    s_lshl_b32 s40, s46, 7
    s_add_u32 s40, s40, 0x2800
    s_mov_b32 s27, s46
    s_mov_b32 s28, 1
row_top_63:
    v_min_u32_e64 v16, 0, v0
    v_lshlrev_b32 v16, 2, v16
pg_67:
    buffer_load_dword v17, v16, s[8:11], s41 offen sc1
    s_waitcnt vmcnt(0)
    v_cmp_gt_u32 vcc, s28, v17
    s_cbranch_vccz pgok_68
    s_sleep 4
    s_add_u32 s6, s6, 1
    s_cmp_lt_u32 s6, 400000
    s_cbranch_scc1 pg_67
    s_branch pgok_68
pgok_68:
    s_add_u32 s20, s36, 0x4b40a00
    v_mov_b32 v44, 0
    v_mov_b32 v45, 0
    buffer_load_dwordx2 v[40:41], v12, s[8:11], s20 offen offset:0 sc1
    buffer_load_dwordx2 v[42:43], v12, s[8:11], s20 offen offset:512 sc1
    s_mov_b64 exec, s[42:43]
    buffer_load_dwordx2 v[44:45], v12, s[8:11], s20 offen offset:1024 sc1
    s_mov_b64 exec, -1
    s_add_u32 s20, s36, 0x48b0a00
    v_mov_b32 v50, 0
    v_mov_b32 v51, 0
    buffer_load_dwordx2 v[46:47], v12, s[8:11], s20 offen offset:0 sc1
    buffer_load_dwordx2 v[48:49], v12, s[8:11], s20 offen offset:512 sc1
    s_mov_b64 exec, s[42:43]
    buffer_load_dwordx2 v[50:51], v12, s[8:11], s20 offen offset:1024 sc1
    s_mov_b64 exec, -1
    v_min_u32_e64 v16, 4, v0
    v_lshlrev_b32 v16, 2, v16
pg_69:
    buffer_load_dword v17, v16, s[8:11], s40 offen sc1
    s_waitcnt vmcnt(0)
    v_cmp_gt_u32 vcc, s28, v17
    s_cbranch_vccz pgok_70
    s_add_u32 s6, s6, 1
    s_cmp_lt_u32 s6, 400000
    s_cbranch_scc1 pg_69
    s_branch pgok_70
pgok_70:
    s_add_u32 s21, s37, 0
    buffer_load_dwordx4 v[76:79], v2, s[8:11], s21 offen offset:0 sc1
    buffer_load_dwordx4 v[80:83], v2, s[8:11], s21 offen offset:256 sc1
    buffer_load_dwordx4 v[84:87], v2, s[8:11], s21 offen offset:512 sc1
    buffer_load_dwordx4 v[88:91], v2, s[8:11], s21 offen offset:768 sc1
    buffer_load_dwordx4 v[92:95], v2, s[8:11], s21 offen offset:1024 sc1
    s_add_u32 s21, s37, 5120
    buffer_load_dwordx4 v[96:99], v3, s[8:11], s21 offen offset:0 sc1
    buffer_load_dwordx4 v[100:103], v3, s[8:11], s21 offen offset:256 sc1
    buffer_load_dwordx4 v[104:107], v3, s[8:11], s21 offen offset:512 sc1
    buffer_load_dwordx4 v[108:111], v3, s[8:11], s21 offen offset:768 sc1
    buffer_load_dwordx4 v[112:115], v3, s[8:11], s21 offen offset:1024 sc1
    s_waitcnt vmcnt(9)
    v_mfma_f32_16x16x32_bf16 v[16:19], v[4:7], v[76:79], 0
    s_waitcnt vmcnt(8)
    v_mfma_f32_16x16x32_bf16 v[16:19], v[8:11], v[80:83], v[16:19]
    s_waitcnt vmcnt(7)
    v_mfma_f32_16x16x32_bf16 v[20:23], v[4:7], v[84:87], 0
    s_waitcnt vmcnt(6)
    v_mfma_f32_16x16x32_bf16 v[20:23], v[8:11], v[88:91], v[20:23]
    s_waitcnt vmcnt(5)
    v_mfma_f32_16x16x32_bf16 v[24:27], v[4:7], v[92:95], 0
    s_waitcnt vmcnt(4)
    v_mfma_f32_16x16x32_bf16 v[16:19], v[4:7], v[96:99], v[16:19]
    s_waitcnt vmcnt(3)
    v_mfma_f32_16x16x32_bf16 v[16:19], v[8:11], v[100:103], v[16:19]
    s_waitcnt vmcnt(2)
    v_mfma_f32_16x16x32_bf16 v[20:23], v[4:7], v[104:107], v[20:23]
    s_waitcnt vmcnt(1)
    v_mfma_f32_16x16x32_bf16 v[20:23], v[8:11], v[108:111], v[20:23]
    s_waitcnt vmcnt(0)
    v_mfma_f32_16x16x32_bf16 v[24:27], v[4:7], v[112:115], v[24:27]
    v_and_b32 v29, 0xffff0000, v40
    v_lshlrev_b32_e64 v28, 16, v40
    v_and_b32 v31, 0xffff0000, v41
    v_lshlrev_b32_e64 v30, 16, v41
    v_and_b32 v33, 0xffff0000, v42
    v_lshlrev_b32_e64 v32, 16, v42
    v_and_b32 v35, 0xffff0000, v43
    v_lshlrev_b32_e64 v34, 16, v43
    v_and_b32 v37, 0xffff0000, v44
    v_lshlrev_b32_e64 v36, 16, v44
    v_and_b32 v39, 0xffff0000, v45
    v_lshlrev_b32_e64 v38, 16, v45
    v_cvt_pk_bf16_f32 v76, v16, v17
    v_cvt_pk_bf16_f32 v77, v18, v19
    v_cvt_pk_bf16_f32 v78, v20, v21
    v_cvt_pk_bf16_f32 v79, v22, v23
    v_cvt_pk_bf16_f32 v80, v24, v25
    v_cvt_pk_bf16_f32 v81, v26, v27
    v_and_b32 v17, 0xffff0000, v76
    v_lshlrev_b32_e64 v16, 16, v76
    v_and_b32 v19, 0xffff0000, v77
    v_lshlrev_b32_e64 v18, 16, v77
    v_and_b32 v21, 0xffff0000, v78
    v_lshlrev_b32_e64 v20, 16, v78
    v_and_b32 v23, 0xffff0000, v79
    v_lshlrev_b32_e64 v22, 16, v79
    v_and_b32 v25, 0xffff0000, v80
    v_lshlrev_b32_e64 v24, 16, v80
    v_and_b32 v27, 0xffff0000, v81
    v_lshlrev_b32_e64 v26, 16, v81
    v_pk_add_f32 v[28:29], v[28:29], v[16:17]
    v_pk_add_f32 v[30:31], v[30:31], v[18:19]
    v_pk_add_f32 v[32:33], v[32:33], v[20:21]
    v_pk_add_f32 v[34:35], v[34:35], v[22:23]
    v_pk_add_f32 v[36:37], v[36:37], v[24:25]
    v_pk_add_f32 v[38:39], v[38:39], v[26:27]
    v_cvt_pk_bf16_f32 v40, v28, v29
    v_cvt_pk_bf16_f32 v41, v30, v31
    v_cvt_pk_bf16_f32 v42, v32, v33
    v_cvt_pk_bf16_f32 v43, v34, v35
    v_cvt_pk_bf16_f32 v44, v36, v37
    v_cvt_pk_bf16_f32 v45, v38, v39
    v_and_b32 v29, 0xffff0000, v40
    v_lshlrev_b32_e64 v28, 16, v40
    v_and_b32 v31, 0xffff0000, v41
    v_lshlrev_b32_e64 v30, 16, v41
    v_and_b32 v33, 0xffff0000, v42
    v_lshlrev_b32_e64 v32, 16, v42
    v_and_b32 v35, 0xffff0000, v43
    v_lshlrev_b32_e64 v34, 16, v43
    v_and_b32 v37, 0xffff0000, v44
    v_lshlrev_b32_e64 v36, 16, v44
    v_and_b32 v39, 0xffff0000, v45
    v_lshlrev_b32_e64 v38, 16, v45
    v_pk_add_f32 v[70:71], v[28:29], v[30:31]
    v_pk_add_f32 v[72:73], v[32:33], v[34:35]
    v_pk_add_f32 v[74:75], v[36:37], v[38:39]
    v_pk_add_f32 v[70:71], v[70:71], v[72:73]
    v_pk_add_f32 v[70:71], v[70:71], v[74:75]
    v_add_f32 v70, v70, v71
    s_nop 1
    v_add_f32_dpp v70, v70, v70 row_ror:8 row_mask:0xf bank_mask:0xf
    s_nop 1
    v_add_f32_dpp v70, v70, v70 row_ror:4 row_mask:0xf bank_mask:0xf
    s_nop 1
    v_add_f32_dpp v70, v70, v70 row_ror:2 row_mask:0xf bank_mask:0xf
    s_nop 1
    v_add_f32_dpp v70, v70, v70 row_ror:1 row_mask:0xf bank_mask:0xf
    v_mov_b32 v71, v70
    s_nop 1
    v_permlane16_swap_b32 v70, v71
    v_add_f32 v70, v70, v71
    v_mov_b32 v71, v70
    s_nop 1
    v_permlane32_swap_b32 v70, v71
    v_add_f32_e64 v70, v70, v71
    v_mul_f32 v70, 0x3acccccd, v70
    v_cvt_pk_bf16_f32 v74, v70, v70
    v_and_b32 v74, 0xffff0000, v74
    v_sub_f32_e64 v70, v74, v70
    v_pk_add_f32 v[28:29], v[28:29], v[74:75] op_sel_hi:[1,0] neg_lo:[0,1] neg_hi:[0,1]
    v_pk_add_f32 v[30:31], v[30:31], v[74:75] op_sel_hi:[1,0] neg_lo:[0,1] neg_hi:[0,1]
    v_pk_add_f32 v[32:33], v[32:33], v[74:75] op_sel_hi:[1,0] neg_lo:[0,1] neg_hi:[0,1]
    v_pk_add_f32 v[34:35], v[34:35], v[74:75] op_sel_hi:[1,0] neg_lo:[0,1] neg_hi:[0,1]
    s_mov_b64 exec, s[42:43]
    v_pk_add_f32 v[36:37], v[36:37], v[74:75] op_sel_hi:[1,0] neg_lo:[0,1] neg_hi:[0,1]
    v_pk_add_f32 v[38:39], v[38:39], v[74:75] op_sel_hi:[1,0] neg_lo:[0,1] neg_hi:[0,1]
    s_mov_b64 exec, -1
    v_pk_mul_f32 v[72:73], v[28:29], v[28:29]
    v_pk_fma_f32 v[72:73], v[30:31], v[30:31], v[72:73]
    v_pk_fma_f32 v[72:73], v[32:33], v[32:33], v[72:73]
    v_pk_fma_f32 v[72:73], v[34:35], v[34:35], v[72:73]
    v_pk_fma_f32 v[72:73], v[36:37], v[36:37], v[72:73]
    v_pk_fma_f32 v[72:73], v[38:39], v[38:39], v[72:73]
    v_add_f32 v72, v72, v73
    s_nop 1
    v_add_f32_dpp v72, v72, v72 row_ror:8 row_mask:0xf bank_mask:0xf
    s_nop 1
    v_add_f32_dpp v72, v72, v72 row_ror:4 row_mask:0xf bank_mask:0xf
    s_nop 1
    v_add_f32_dpp v72, v72, v72 row_ror:2 row_mask:0xf bank_mask:0xf
    s_nop 1
    v_add_f32_dpp v72, v72, v72 row_ror:1 row_mask:0xf bank_mask:0xf
    v_mov_b32 v73, v72
    s_nop 1
    v_permlane16_swap_b32 v72, v73
    v_add_f32 v72, v72, v73
    v_mov_b32 v73, v72
    s_nop 1
    v_permlane32_swap_b32 v72, v73
    v_add_f32_e64 v72, v72, v73
    v_mul_f32 v72, 0x3acccccd, v72
    v_fma_f32 v72, -v70, v70, v72
    v_max_f32_e64 v73, 0, v72
    v_cvt_pk_bf16_f32 v72, v73, v73
    v_and_b32 v72, 0xffff0000, v72
    v_add_f32_e64 v72, s44, v72
    v_cvt_pk_bf16_f32 v72, v72, v72
    v_and_b32 v72, 0xffff0000, v72
    v_sqrt_f32 v72, v72
    s_nop 0
    v_cvt_pk_bf16_f32 v72, v72, v72
    v_and_b32 v72, 0xffff0000, v72
    v_rcp_f32 v72, v72
    s_nop 0
    v_pk_mul_f32 v[28:29], v[28:29], v[72:73] op_sel_hi:[1,0]
    v_pk_mul_f32 v[30:31], v[30:31], v[72:73] op_sel_hi:[1,0]
    v_pk_mul_f32 v[32:33], v[32:33], v[72:73] op_sel_hi:[1,0]
    v_pk_mul_f32 v[34:35], v[34:35], v[72:73] op_sel_hi:[1,0]
    v_pk_mul_f32 v[36:37], v[36:37], v[72:73] op_sel_hi:[1,0]
    v_pk_mul_f32 v[38:39], v[38:39], v[72:73] op_sel_hi:[1,0]
    v_cvt_pk_bf16_f32 v52, v28, v29
    v_cvt_pk_bf16_f32 v53, v30, v31
    v_cvt_pk_bf16_f32 v54, v32, v33
    v_cvt_pk_bf16_f32 v55, v34, v35
    v_cvt_pk_bf16_f32 v56, v36, v37
    v_cvt_pk_bf16_f32 v57, v38, v39
    s_cmp_lg_u32 s45, 1
    s_cbranch_scc1 ls_71
    buffer_store_dwordx2 v[52:53], v12, s[8:11], s64 offen offset:0
    buffer_store_dwordx2 v[54:55], v12, s[8:11], s64 offen offset:512
    s_mov_b64 exec, s[42:43]
    buffer_store_dwordx2 v[56:57], v12, s[8:11], s64 offen offset:1024
    s_mov_b64 exec, -1
    s_branch lj_72
ls_71:
    buffer_store_dwordx2 v[52:53], v12, s[8:11], s64 offen offset:0 sc1
    buffer_store_dwordx2 v[54:55], v12, s[8:11], s64 offen offset:512 sc1
    s_mov_b64 exec, s[42:43]
    buffer_store_dwordx2 v[56:57], v12, s[8:11], s64 offen offset:1024 sc1
    s_mov_b64 exec, -1
lj_72:
    s_waitcnt vmcnt(0)
    v_mov_b32 v16, s28
    v_mov_b32 v17, 0
    s_mov_b64 exec, 1
    s_cmp_lg_u32 s45, 1
    s_cbranch_scc1 ls_73
    buffer_store_dword v16, v17, s[8:11], s38 offen
    s_branch lj_74
ls_73:
    buffer_store_dword v16, v17, s[8:11], s38 offen sc1
lj_74:
    s_mov_b64 exec, -1
    s_cmp_eq_u32 s28, 1
    s_cbranch_scc1 row_nog_65
row_g_64:
    s_sub_u32 s29, s28, 1
    s_add_u32 s20, s40, 32
    v_min_u32 v16, 13, v0
    v_lshlrev_b32 v16, 2, v16
pg_75:
    buffer_load_dword v17, v16, s[8:11], s20 offen sc1
    s_waitcnt vmcnt(0)
    v_cmp_gt_u32 vcc, s29, v17
    s_cbranch_vccz pgok_76
    s_add_u32 s6, s6, 1
    s_cmp_lt_u32 s6, 400000
    s_cbranch_scc1 pg_75
    s_branch pgok_76
pgok_76:
    s_add_u32 s21, s39, 0
    buffer_load_dwordx4 v[76:79], v2, s[8:11], s21 offen offset:0 sc1
    buffer_load_dwordx4 v[80:83], v2, s[8:11], s21 offen offset:256 sc1
    buffer_load_dwordx4 v[84:87], v2, s[8:11], s21 offen offset:512 sc1
    buffer_load_dwordx4 v[88:91], v2, s[8:11], s21 offen offset:768 sc1
    buffer_load_dwordx4 v[92:95], v2, s[8:11], s21 offen offset:1024 sc1
    s_add_u32 s21, s39, 5120
    buffer_load_dwordx4 v[96:99], v2, s[8:11], s21 offen offset:0 sc1
    buffer_load_dwordx4 v[100:103], v2, s[8:11], s21 offen offset:256 sc1
    buffer_load_dwordx4 v[104:107], v2, s[8:11], s21 offen offset:512 sc1
    buffer_load_dwordx4 v[108:111], v2, s[8:11], s21 offen offset:768 sc1
    buffer_load_dwordx4 v[112:115], v2, s[8:11], s21 offen offset:1024 sc1
    s_add_u32 s21, s39, 10240
    buffer_load_dwordx4 v[116:119], v2, s[8:11], s21 offen offset:0 sc1
    buffer_load_dwordx4 v[120:123], v2, s[8:11], s21 offen offset:256 sc1
    buffer_load_dwordx4 v[124:127], v2, s[8:11], s21 offen offset:512 sc1
    buffer_load_dwordx4 v[128:131], v2, s[8:11], s21 offen offset:768 sc1
    buffer_load_dwordx4 v[132:135], v2, s[8:11], s21 offen offset:1024 sc1
    s_add_u32 s21, s39, 15360
    buffer_load_dwordx4 v[136:139], v13, s[8:11], s21 offen offset:0 sc1
    buffer_load_dwordx4 v[140:143], v13, s[8:11], s21 offen offset:256 sc1
    buffer_load_dwordx4 v[144:147], v13, s[8:11], s21 offen offset:512 sc1
    buffer_load_dwordx4 v[148:151], v13, s[8:11], s21 offen offset:768 sc1
    buffer_load_dwordx4 v[152:155], v13, s[8:11], s21 offen offset:1024 sc1
    s_waitcnt vmcnt(19)
    v_mfma_f32_16x16x32_bf16 v[16:19], v[4:7], v[76:79], 0
    s_waitcnt vmcnt(18)
    v_mfma_f32_16x16x32_bf16 v[16:19], v[8:11], v[80:83], v[16:19]
    s_waitcnt vmcnt(17)
    v_mfma_f32_16x16x32_bf16 v[20:23], v[4:7], v[84:87], 0
    s_waitcnt vmcnt(16)
    v_mfma_f32_16x16x32_bf16 v[20:23], v[8:11], v[88:91], v[20:23]
    s_waitcnt vmcnt(15)
    v_mfma_f32_16x16x32_bf16 v[24:27], v[4:7], v[92:95], 0
    s_waitcnt vmcnt(14)
    v_mfma_f32_16x16x32_bf16 v[16:19], v[4:7], v[96:99], v[16:19]
    s_waitcnt vmcnt(13)
    v_mfma_f32_16x16x32_bf16 v[16:19], v[8:11], v[100:103], v[16:19]
    s_waitcnt vmcnt(12)
    v_mfma_f32_16x16x32_bf16 v[20:23], v[4:7], v[104:107], v[20:23]
    s_waitcnt vmcnt(11)
    v_mfma_f32_16x16x32_bf16 v[20:23], v[8:11], v[108:111], v[20:23]
    s_waitcnt vmcnt(10)
    v_mfma_f32_16x16x32_bf16 v[24:27], v[4:7], v[112:115], v[24:27]
    s_waitcnt vmcnt(9)
    v_mfma_f32_16x16x32_bf16 v[16:19], v[4:7], v[116:119], v[16:19]
    s_waitcnt vmcnt(8)
    v_mfma_f32_16x16x32_bf16 v[16:19], v[8:11], v[120:123], v[16:19]
    s_waitcnt vmcnt(7)
    v_mfma_f32_16x16x32_bf16 v[20:23], v[4:7], v[124:127], v[20:23]
    s_waitcnt vmcnt(6)
    v_mfma_f32_16x16x32_bf16 v[20:23], v[8:11], v[128:131], v[20:23]
    s_waitcnt vmcnt(5)
    v_mfma_f32_16x16x32_bf16 v[24:27], v[4:7], v[132:135], v[24:27]
    s_waitcnt vmcnt(4)
    v_mfma_f32_16x16x32_bf16 v[16:19], v[4:7], v[136:139], v[16:19]
    s_waitcnt vmcnt(3)
    v_mfma_f32_16x16x32_bf16 v[16:19], v[8:11], v[140:143], v[16:19]
    s_waitcnt vmcnt(2)
    v_mfma_f32_16x16x32_bf16 v[20:23], v[4:7], v[144:147], v[20:23]
    s_waitcnt vmcnt(1)
    v_mfma_f32_16x16x32_bf16 v[20:23], v[8:11], v[148:151], v[20:23]
    s_waitcnt vmcnt(0)
    v_mfma_f32_16x16x32_bf16 v[24:27], v[4:7], v[152:155], v[24:27]
    v_and_b32 v29, 0xffff0000, v58
    v_lshlrev_b32_e64 v28, 16, v58
    v_and_b32 v31, 0xffff0000, v59
    v_lshlrev_b32_e64 v30, 16, v59
    v_and_b32 v33, 0xffff0000, v60
    v_lshlrev_b32_e64 v32, 16, v60
    v_and_b32 v35, 0xffff0000, v61
    v_lshlrev_b32_e64 v34, 16, v61
    v_and_b32 v37, 0xffff0000, v62
    v_lshlrev_b32_e64 v36, 16, v62
    v_and_b32 v39, 0xffff0000, v63
    v_lshlrev_b32_e64 v38, 16, v63
    v_cvt_pk_bf16_f32 v76, v16, v17
    v_cvt_pk_bf16_f32 v77, v18, v19
    v_cvt_pk_bf16_f32 v78, v20, v21
    v_cvt_pk_bf16_f32 v79, v22, v23
    v_cvt_pk_bf16_f32 v80, v24, v25
    v_cvt_pk_bf16_f32 v81, v26, v27
    v_and_b32 v17, 0xffff0000, v76
    v_lshlrev_b32_e64 v16, 16, v76
    v_and_b32 v19, 0xffff0000, v77
    v_lshlrev_b32_e64 v18, 16, v77
    v_and_b32 v21, 0xffff0000, v78
    v_lshlrev_b32_e64 v20, 16, v78
    v_and_b32 v23, 0xffff0000, v79
    v_lshlrev_b32_e64 v22, 16, v79
    v_and_b32 v25, 0xffff0000, v80
    v_lshlrev_b32_e64 v24, 16, v80
    v_and_b32 v27, 0xffff0000, v81
    v_lshlrev_b32_e64 v26, 16, v81
    v_pk_add_f32 v[28:29], v[28:29], v[16:17]
    v_pk_add_f32 v[30:31], v[30:31], v[18:19]
    v_pk_add_f32 v[32:33], v[32:33], v[20:21]
    v_pk_add_f32 v[34:35], v[34:35], v[22:23]
    v_pk_add_f32 v[36:37], v[36:37], v[24:25]
    v_pk_add_f32 v[38:39], v[38:39], v[26:27]
    v_cvt_pk_bf16_f32 v58, v28, v29
    v_cvt_pk_bf16_f32 v59, v30, v31
    v_cvt_pk_bf16_f32 v60, v32, v33
    v_cvt_pk_bf16_f32 v61, v34, v35
    v_cvt_pk_bf16_f32 v62, v36, v37
    v_cvt_pk_bf16_f32 v63, v38, v39
    v_and_b32 v29, 0xffff0000, v58
    v_lshlrev_b32_e64 v28, 16, v58
    v_and_b32 v31, 0xffff0000, v59
    v_lshlrev_b32_e64 v30, 16, v59
    v_and_b32 v33, 0xffff0000, v60
    v_lshlrev_b32_e64 v32, 16, v60
    v_and_b32 v35, 0xffff0000, v61
    v_lshlrev_b32_e64 v34, 16, v61
    v_and_b32 v37, 0xffff0000, v62
    v_lshlrev_b32_e64 v36, 16, v62
    v_and_b32 v39, 0xffff0000, v63
    v_lshlrev_b32_e64 v38, 16, v63
    v_and_b32 v17, 0xffff0000, v64
    v_lshlrev_b32_e64 v16, 16, v64
    v_and_b32 v19, 0xffff0000, v65
    v_lshlrev_b32_e64 v18, 16, v65
    v_and_b32 v21, 0xffff0000, v66
    v_lshlrev_b32_e64 v20, 16, v66
    v_and_b32 v23, 0xffff0000, v67
    v_lshlrev_b32_e64 v22, 16, v67
    v_and_b32 v25, 0xffff0000, v68
    v_lshlrev_b32_e64 v24, 16, v68
    v_and_b32 v27, 0xffff0000, v69
    v_lshlrev_b32_e64 v26, 16, v69
    v_pk_add_f32 v[28:29], v[28:29], v[16:17]
    v_pk_add_f32 v[30:31], v[30:31], v[18:19]
    v_pk_add_f32 v[32:33], v[32:33], v[20:21]
    v_pk_add_f32 v[34:35], v[34:35], v[22:23]
    v_pk_add_f32 v[36:37], v[36:37], v[24:25]
    v_pk_add_f32 v[38:39], v[38:39], v[26:27]
    v_cvt_pk_bf16_f32 v52, v28, v29
    v_cvt_pk_bf16_f32 v53, v30, v31
    v_cvt_pk_bf16_f32 v54, v32, v33
    v_cvt_pk_bf16_f32 v55, v34, v35
    v_cvt_pk_bf16_f32 v56, v36, v37
    v_cvt_pk_bf16_f32 v57, v38, v39
    s_sub_u32 s20, s36, 122880
    buffer_store_dwordx2 v[52:53], v12, s[32:35], s20 offen offset:0
    buffer_store_dwordx2 v[54:55], v12, s[32:35], s20 offen offset:512
    s_mov_b64 exec, s[42:43]
    buffer_store_dwordx2 v[56:57], v12, s[32:35], s20 offen offset:1024
    s_mov_b64 exec, -1
    s_add_u32 s39, s39, s66
    s_sub_u32 s66, 0, s66
    s_cmp_ge_u32 s27, 64
    s_cbranch_scc1 row_end_66
row_nog_65:
    v_mov_b32 v58, v40
    v_mov_b32 v59, v41
    v_mov_b32 v60, v42
    v_mov_b32 v61, v43
    v_mov_b32 v62, v44
    v_mov_b32 v63, v45
    v_mov_b32 v64, v46
    v_mov_b32 v65, v47
    v_mov_b32 v66, v48
    v_mov_b32 v67, v49
    v_mov_b32 v68, v50
    v_mov_b32 v69, v51
    s_add_u32 s36, s36, 122880
    s_add_u32 s37, s37, s65
    s_sub_u32 s65, 0, s65
    s_add_u32 s64, s64, s68
    s_sub_u32 s68, 0, s68
    s_add_u32 s28, s28, 1
    s_add_u32 s27, s27, 3
    s_cmp_lt_u32 s27, 64
    s_cbranch_scc1 row_top_63
    s_branch row_g_64
row_end_66:
    s_branch L_fin
L_R:
    v_and_b32 v92, 63, v0
    v_lshlrev_b32 v19, 4, v92
    v_mov_b32 v24, 0
    v_mov_b32 v25, 0
    v_mov_b32 v26, 0
    v_mov_b32 v27, 0
    s_mul_i32 s40, s3, 0x28000
    s_add_u32 s40, s40, 0x40000
    s_lshl_b32 s41, s5, 5
    s_add_u32 s41, s41, s4
    s_lshl_b32 s42, s41, 11
    s_add_u32 s29, s40, s42
    s_lshl_b32 s42, s4, 6
    s_add_u32 s27, s40, s42
    s_lshl_b32 s42, s5, 11
    s_add_u32 s28, s27, s42
    s_add_u32 s28, s28, 0x20000
    s_cmp_ge_u32 s41, 80
    s_cbranch_scc1 R_noclr_77
    buffer_store_dwordx4 v[24:27], v19, s[8:11], s29 offen offset:0 sc1
    buffer_store_dwordx4 v[24:27], v19, s[8:11], s29 offen offset:1024 sc1
R_noclr_77:
    s_lshr_b32 s42, s41, 4
    s_lshl_b32 s42, s42, 10
    s_bfe_u32 s43, s41, 0x20002
    s_lshl_b32 s43, s43, 5
    s_add_u32 s42, s42, s43
    s_and_b32 s43, s41, 3
    s_lshl_b32 s43, s43, 8
    s_add_u32 s42, s42, s43
    s_lshl_b32 s43, s3, 15
    s_add_u32 s43, s43, 0x20000
    s_add_u32 s30, s43, s42
    s_xor_b32 s32, s43, 0x4000
    s_lshl_b32 s41, s3, 15
    s_add_u32 s31, s41, s42
    s_add_u32 s31, s31, 0x10000
    s_xor_b32 s41, s41, 0x8000
    s_add_u32 s33, s41, 0x10000
    s_cmp_lg_u32 s5, 3
    s_cbranch_scc1 R_w3clr_78
    s_lshl_b32 s38, s4, 7
    s_lshl_b32 s40, s3, 2
    s_add_u32 s38, s38, s40
    s_add_u32 s38, s38, 0x1000
    buffer_store_dword v24, v24, s[8:11], s38 offen sc1
    s_cmp_ge_u32 s4, 6
    s_cbranch_scc1 R_w3clr_78
    s_lshl_b32 s40, s3, 15
    s_lshl_b32 s41, s4, 13
    s_add_u32 s40, s40, s41
    s_add_u32 s40, s40, 0xe000
    s_cmp_eq_u32 s4, 0
    s_cselect_b32 s40, s43, s40
    s_cmp_eq_u32 s4, 5
    s_cselect_b32 s40, s32, s40
    s_add_u32 s41, s40, 0x1000
    buffer_store_dwordx4 v[24:27], v19, s[8:11], s40 offen offset:0 sc1
    buffer_store_dwordx4 v[24:27], v19, s[8:11], s40 offen offset:1024 sc1
    buffer_store_dwordx4 v[24:27], v19, s[8:11], s40 offen offset:2048 sc1
    buffer_store_dwordx4 v[24:27], v19, s[8:11], s40 offen offset:3072 sc1
    buffer_store_dwordx4 v[24:27], v19, s[8:11], s41 offen offset:0 sc1
    buffer_store_dwordx4 v[24:27], v19, s[8:11], s41 offen offset:1024 sc1
    buffer_store_dwordx4 v[24:27], v19, s[8:11], s41 offen offset:2048 sc1
    buffer_store_dwordx4 v[24:27], v19, s[8:11], s41 offen offset:3072 sc1
R_w3clr_78:
    s_load_dwordx4 s[60:63], s[0:1], 16
    s_load_dwordx4 s[64:67], s[0:1], 32
    s_load_dwordx2 s[68:69], s[0:1], 8
    v_lshrrev_b32 v93, 4, v92
    v_and_b32 v94, 15, v92
    v_and_b32 v95, 1, v93
    v_lshlrev_b32 v95, 1, v95
    v_xor_b32 v94, v94, v95
    s_lshl_b32 s40, s5, 4
    v_add_u32 v93, s40, v93
    v_xor_b32 v95, 0, v94
    v_lshlrev_b32 v95, 4, v95
    v_add_u32 v91, 0, v93
    v_lshl_add_u32 v28, v91, 13, v95
    v_xor_b32 v95, 4, v94
    v_lshlrev_b32 v95, 4, v95
    v_add_u32_e64 v91, 4, v93
    v_lshl_add_u32 v29, v91, 13, v95
    v_xor_b32 v95, 8, v94
    v_lshlrev_b32 v95, 4, v95
    v_add_u32_e64 v91, 8, v93
    v_lshl_add_u32 v30, v91, 13, v95
    v_xor_b32 v95, 12, v94
    v_lshlrev_b32 v95, 4, v95
    v_add_u32_e64 v91, 12, v93
    v_lshl_add_u32 v31, v91, 13, v95
    v_lshrrev_b32 v93, 4, v92
    v_and_b32 v94, 15, v92
    s_and_b32 s41, s5, 1
    s_lshl_b32 s41, s41, 2
    v_add_u32 v95, s41, v93
    v_lshlrev_b32 v95, 1, v95
    v_xor_b32 v94, v94, v95
    v_lshlrev_b32 v94, 4, v94
    v_add_u32 v93, s40, v93
    v_add_u32 v91, 0, v93
    v_lshl_add_u32 v49, v91, 13, v94
    v_add_u32_e64 v91, 4, v93
    v_lshl_add_u32 v50, v91, 13, v94
    v_add_u32_e64 v91, 8, v93
    v_lshl_add_u32 v51, v91, 13, v94
    v_add_u32_e64 v91, 12, v93
    v_lshl_add_u32 v52, v91, 13, v94
    v_lshrrev_b32_e64 v34, 4, v92
    v_bfe_u32 v35, v92, 2, 2
    v_and_b32 v36, 3, v92
    v_lshrrev_b32 v93, 1, v34
    v_lshlrev_b32 v93, 4, v93
    v_and_b32 v94, 1, v34
    v_lshl_add_u32 v93, v94, 2, v93
    v_and_b32 v95, 1, v35
    v_add_u32 v93, v93, v95
    v_lshrrev_b32_e64 v91, 1, v35
    v_lshl_add_u32 v93, v91, 3, v93
    v_lshl_add_u32 v95, v94, 1, v95
    v_lshl_add_u32 v95, v91, 2, v95
    s_lshl_b32 s40, s5, 1
    v_xor_b32 v95, s40, v95
    v_lshlrev_b32_e64 v95, 5, v95
    v_lshl_add_u32 v95, v93, 8, v95
    v_lshl_add_u32 v32, v36, 3, v95
    v_xor_b32 v33, 32, v32
    v_and_b32 v93, 1, v34
    v_lshrrev_b32_e64 v94, 1, v35
    v_lshl_add_u32 v93, v94, 1, v93
    v_and_b32_e64 v94, 1, v35
    v_lshl_add_u32 v95, v94, 2, v93
    v_lshl_add_u32 v93, v94, 4, v93
    v_lshrrev_b32_e64 v94, 1, v34
    v_lshl_add_u32 v93, v94, 2, v93
    v_xor_b32 v95, s40, v95
    v_lshlrev_b32 v95, 5, v95
    v_lshl_add_u32 v95, v93, 8, v95
    v_lshl_add_u32 v54, v36, 3, v95
    v_xor_b32_e64 v55, 32, v54
    s_mov_b32 s40, 0xcccd
    v_add_u32_e64 v93, 0, v92
    v_mul_lo_u32 v94, v93, s40
    v_lshrrev_b32 v94, 21, v94
    v_mul_u32_u24 v95, 40, v94
    v_sub_u32 v95, v93, v95
    v_lshlrev_b32 v42, 4, v95
    v_mul_u32_u24 v37, 1280, v94
    v_add_u32_e64 v93, 64, v92
    v_mul_lo_u32 v94, v93, s40
    v_lshrrev_b32 v94, 21, v94
    v_mul_u32_u24 v95, 40, v94
    v_sub_u32 v95, v93, v95
    v_lshlrev_b32 v43, 4, v95
    v_mul_u32_u24 v38, 1280, v94
    v_add_u32 v93, 128, v92
    v_mul_lo_u32 v94, v93, s40
    v_lshrrev_b32 v94, 21, v94
    v_mul_u32_u24 v95, 40, v94
    v_sub_u32 v95, v93, v95
    v_lshlrev_b32 v44, 4, v95
    v_mul_u32_u24 v39, 1280, v94
    v_add_u32 v93, 192, v92
    v_mul_lo_u32 v94, v93, s40
    v_lshrrev_b32 v94, 21, v94
    v_mul_u32_u24 v95, 40, v94
    v_sub_u32 v95, v93, v95
    v_lshlrev_b32 v45, 4, v95
    v_mul_u32_u24 v40, 1280, v94
    v_add_u32 v93, 256, v92
    v_mul_lo_u32 v94, v93, s40
    v_lshrrev_b32 v94, 21, v94
    v_mul_u32_u24 v95, 40, v94
    v_sub_u32 v95, v93, v95
    v_lshlrev_b32 v46, 4, v95
    v_mul_u32_u24 v41, 1280, v94
    s_waitcnt lgkmcnt(0)
    s_lshl_b32 s70, s4, 8
    s_mul_i32 s71, s3, 5
    s_lshl_b32 s72, s5, 12
    s_mov_b32 s16, s68
    s_and_b32 s17, s69, 0xffff
    s_mov_b32 s18, 0x2800
    s_mov_b32 s19, 0x20000
    v_and_b32 v93, 7, v92
    v_mul_u32_u24 v93, 1280, v93
    v_lshrrev_b32_e64 v94, 3, v92
    v_lshl_add_u32 v93, v94, 2, v93
    s_lshl_b32 s43, s5, 10
    v_add_u32 v20, s43, v19
    v_lshrrev_b32_e64 v53, 2, v20
    v_bfe_u32 v94, v92, 2, 3
    v_mul_u32_u24 v94, 1280, v94
    v_lshrrev_b32_e64 v95, 5, v92
    v_lshl_add_u32 v94, v95, 4, v94
    v_and_b32_e64 v95, 3, v92
    v_lshl_add_u32 v94, v95, 2, v94
    s_mul_i32 s40, s3, 640
    s_sub_u32 s41, 640, s40
    s_mul_i32 s42, s5, 160
    s_add_u32 s40, s40, s42
    s_add_u32 s41, s41, s42
    buffer_load_ushort v0, v93, s[16:19], s40 offen offset:0
    buffer_load_ushort v1, v93, s[16:19], s40 offen offset:32
    buffer_load_ushort v2, v93, s[16:19], s40 offen offset:64
    buffer_load_ushort v3, v93, s[16:19], s40 offen offset:96
    buffer_load_ushort v4, v93, s[16:19], s40 offen offset:2
    buffer_load_ushort v5, v93, s[16:19], s40 offen offset:34
    buffer_load_ushort v6, v93, s[16:19], s40 offen offset:66
    buffer_load_ushort v7, v93, s[16:19], s40 offen offset:98
    buffer_load_ushort v8, v93, s[16:19], s41 offen offset:0
    buffer_load_ushort v9, v93, s[16:19], s41 offen offset:32
    buffer_load_ushort v10, v93, s[16:19], s41 offen offset:64
    buffer_load_ushort v11, v93, s[16:19], s41 offen offset:96
    buffer_load_ushort v12, v93, s[16:19], s41 offen offset:2
    buffer_load_ushort v13, v93, s[16:19], s41 offen offset:34
    buffer_load_ushort v14, v93, s[16:19], s41 offen offset:66
    buffer_load_ushort v15, v93, s[16:19], s41 offen offset:98
    buffer_load_dword v80, v94, s[16:19], s40 offen offset:128
    buffer_load_dword v81, v94, s[16:19], s41 offen offset:128
    s_mov_b32 s16, s66
    s_and_b32 s17, s67, 0xffff
    s_mov_b32 s18, 0x500000
    s_mov_b32 s19, 0x20000
    s_mul_i32 s40, s4, 163840
    s_mul_i32 s41, s5, 40960
    s_add_u32 s40, s40, s41
    s_mul_i32 s41, s3, 640
    s_add_u32 s40, s40, s41
    s_mul_i32 s41, s5, 20480
    s_add_u32 s41, s41, 81920
    s_lshl_b32 s42, s5, 1
    s_add_u32 s42, s42, 0
    s_and_b32 s42, s42, 3
    s_lshl_b32 s42, s42, 5
    v_xor_b32 v93, s42, v42
    v_add_u32 v93, v93, v37
    s_mov_b32 m0, s41
    s_add_u32 s41, s41, 1024
    buffer_load_dwordx4 v93, s[16:19], s40 offen lds
    v_xor_b32_e64 v93, s42, v43
    v_add_u32 v93, v93, v38
    s_mov_b32 m0, s41
    s_add_u32 s41, s41, 1024
    buffer_load_dwordx4 v93, s[16:19], s40 offen lds
    v_xor_b32_e64 v93, s42, v44
    v_add_u32 v93, v93, v39
    s_mov_b32 m0, s41
    s_add_u32 s41, s41, 1024
    buffer_load_dwordx4 v93, s[16:19], s40 offen lds
    v_xor_b32_e64 v93, s42, v45
    v_add_u32 v93, v93, v40
    s_mov_b32 m0, s41
    s_add_u32 s41, s41, 1024
    buffer_load_dwordx4 v93, s[16:19], s40 offen lds
    v_xor_b32_e64 v93, s42, v46
    v_add_u32 v93, v93, v41
    s_mov_b32 m0, s41
    s_add_u32 s41, s41, 1024
    buffer_load_dwordx4 v93, s[16:19], s40 offen lds
    s_add_u32 s40, s40, 10240
    s_lshl_b32 s42, s5, 1
    s_add_u32 s42, s42, 0
    s_and_b32 s42, s42, 3
    s_lshl_b32 s42, s42, 5
    v_xor_b32_e64 v93, s42, v42
    v_add_u32 v93, v93, v37
    s_mov_b32 m0, s41
    s_add_u32 s41, s41, 1024
    buffer_load_dwordx4 v93, s[16:19], s40 offen lds
    v_xor_b32_e64 v93, s42, v43
    v_add_u32 v93, v93, v38
    s_mov_b32 m0, s41
    s_add_u32 s41, s41, 1024
    buffer_load_dwordx4 v93, s[16:19], s40 offen lds
    v_xor_b32_e64 v93, s42, v44
    v_add_u32 v93, v93, v39
    s_mov_b32 m0, s41
    s_add_u32 s41, s41, 1024
    buffer_load_dwordx4 v93, s[16:19], s40 offen lds
    v_xor_b32_e64 v93, s42, v45
    v_add_u32 v93, v93, v40
    s_mov_b32 m0, s41
    s_add_u32 s41, s41, 1024
    buffer_load_dwordx4 v93, s[16:19], s40 offen lds
    v_xor_b32_e64 v93, s42, v46
    v_add_u32 v93, v93, v41
    s_mov_b32 m0, s41
    s_add_u32 s41, s41, 1024
    buffer_load_dwordx4 v93, s[16:19], s40 offen lds
    s_add_u32 s40, s40, 10240
    s_lshl_b32 s42, s5, 1
    s_add_u32 s42, s42, 1
    s_and_b32 s42, s42, 3
    s_lshl_b32 s42, s42, 5
    v_xor_b32_e64 v93, s42, v42
    v_add_u32 v93, v93, v37
    s_mov_b32 m0, s41
    s_add_u32 s41, s41, 1024
    buffer_load_dwordx4 v93, s[16:19], s40 offen lds
    v_xor_b32_e64 v93, s42, v43
    v_add_u32 v93, v93, v38
    s_mov_b32 m0, s41
    s_add_u32 s41, s41, 1024
    buffer_load_dwordx4 v93, s[16:19], s40 offen lds
    v_xor_b32_e64 v93, s42, v44
    v_add_u32 v93, v93, v39
    s_mov_b32 m0, s41
    s_add_u32 s41, s41, 1024
    buffer_load_dwordx4 v93, s[16:19], s40 offen lds
    v_xor_b32_e64 v93, s42, v45
    v_add_u32 v93, v93, v40
    s_mov_b32 m0, s41
    s_add_u32 s41, s41, 1024
    buffer_load_dwordx4 v93, s[16:19], s40 offen lds
    v_xor_b32_e64 v93, s42, v46
    v_add_u32 v93, v93, v41
    s_mov_b32 m0, s41
    s_add_u32 s41, s41, 1024
    buffer_load_dwordx4 v93, s[16:19], s40 offen lds
    s_add_u32 s40, s40, 10240
    s_lshl_b32 s42, s5, 1
    s_add_u32 s42, s42, 1
    s_and_b32 s42, s42, 3
    s_lshl_b32 s42, s42, 5
    v_xor_b32_e64 v93, s42, v42
    v_add_u32 v93, v93, v37
    s_mov_b32 m0, s41
    s_add_u32 s41, s41, 1024
    buffer_load_dwordx4 v93, s[16:19], s40 offen lds
    v_xor_b32_e64 v93, s42, v43
    v_add_u32 v93, v93, v38
    s_mov_b32 m0, s41
    s_add_u32 s41, s41, 1024
    buffer_load_dwordx4 v93, s[16:19], s40 offen lds
    v_xor_b32_e64 v93, s42, v44
    v_add_u32 v93, v93, v39
    s_mov_b32 m0, s41
    s_add_u32 s41, s41, 1024
    buffer_load_dwordx4 v93, s[16:19], s40 offen lds
    v_xor_b32_e64 v93, s42, v45
    v_add_u32 v93, v93, v40
    s_mov_b32 m0, s41
    s_add_u32 s41, s41, 1024
    buffer_load_dwordx4 v93, s[16:19], s40 offen lds
    v_xor_b32_e64 v93, s42, v46
    v_add_u32 v93, v93, v41
    s_mov_b32 m0, s41
    s_add_u32 s41, s41, 1024
    buffer_load_dwordx4 v93, s[16:19], s40 offen lds
    s_add_u32 s40, s40, 10240
    s_mul_i32 s73, s3, 2621440
    s_sub_u32 s74, 2621440, s73
    s_add_u32 s73, s73, s70
    s_add_u32 s74, s74, s70
    s_mov_b32 s16, s60
    s_and_b32 s17, s61, 0xffff
    s_mov_b32 s18, 0x500000
    s_mov_b32 s19, 0x20000
    s_add_u32 s40, s73, 655360
    s_add_u32 m0, s72, 0
    s_nop 0
    buffer_load_dwordx4 v49, s[16:19], s40 offen lds
    s_add_u32 m0, s72, 1024
    s_nop 0
    buffer_load_dwordx4 v50, s[16:19], s40 offen lds
    s_add_u32 m0, s72, 2048
    s_nop 0
    buffer_load_dwordx4 v51, s[16:19], s40 offen lds
    s_add_u32 m0, s72, 3072
    s_nop 0
    buffer_load_dwordx4 v52, s[16:19], s40 offen lds
    s_add_u32 s40, s73, 1310720
    s_add_u32 m0, s72, 16384
    s_nop 0
    buffer_load_dwordx4 v49, s[16:19], s40 offen lds
    s_add_u32 m0, s72, 17408
    s_nop 0
    buffer_load_dwordx4 v50, s[16:19], s40 offen lds
    s_add_u32 m0, s72, 18432
    s_nop 0
    buffer_load_dwordx4 v51, s[16:19], s40 offen lds
    s_add_u32 m0, s72, 19456
    s_nop 0
    buffer_load_dwordx4 v52, s[16:19], s40 offen lds
    s_add_u32 s40, s73, 524288
    s_lshl_b32 s41, s5, 19
    s_add_u32 s40, s40, s41
    s_add_u32 m0, s72, 32768
    s_nop 0
    buffer_load_dwordx4 v28, s[16:19], s40 offen lds
    s_add_u32 m0, s72, 33792
    s_nop 0
    buffer_load_dwordx4 v29, s[16:19], s40 offen lds
    s_add_u32 m0, s72, 34816
    s_nop 0
    buffer_load_dwordx4 v30, s[16:19], s40 offen lds
    s_add_u32 m0, s72, 35840
    s_nop 0
    buffer_load_dwordx4 v31, s[16:19], s40 offen lds
    s_add_u32 s40, s74, 0
    s_add_u32 m0, s72, 49152
    s_nop 0
    buffer_load_dwordx4 v49, s[16:19], s40 offen lds
    s_add_u32 m0, s72, 50176
    s_nop 0
    buffer_load_dwordx4 v50, s[16:19], s40 offen lds
    s_add_u32 m0, s72, 51200
    s_nop 0
    buffer_load_dwordx4 v51, s[16:19], s40 offen lds
    s_add_u32 m0, s72, 52224
    s_nop 0
    buffer_load_dwordx4 v52, s[16:19], s40 offen lds
    s_add_u32 s40, s74, 655360
    s_add_u32 m0, s72, 65536
    s_nop 0
    buffer_load_dwordx4 v49, s[16:19], s40 offen lds
    s_add_u32 m0, s72, 66560
    s_nop 0
    buffer_load_dwordx4 v50, s[16:19], s40 offen lds
    s_add_u32 m0, s72, 67584
    s_nop 0
    buffer_load_dwordx4 v51, s[16:19], s40 offen lds
    s_add_u32 m0, s72, 68608
    s_nop 0
    buffer_load_dwordx4 v52, s[16:19], s40 offen lds
    s_waitcnt vmcnt(40)
    s_barrier
    s_cmp_lg_u32 s5, 3
    s_cbranch_scc1 arr_79
    s_mov_b64 exec, 1
    v_mov_b32 v89, 0
    s_cmp_lg_u32 s2, 7
    s_cbranch_scc1 cal_80
    s_waitcnt vmcnt(0)
    s_mov_b32 s80, -1
    s_mov_b32 s81, -1
    s_mov_b32 s86, 0x11c00
    s_mov_b32 s87, 0x13c00
    s_memtime s[82:83]
    s_waitcnt lgkmcnt(0)
    buffer_store_dword v89, v89, s[8:11], s86 offen sc1
    s_waitcnt vmcnt(0)
    s_memtime s[84:85]
    s_waitcnt lgkmcnt(0)
    s_sub_u32 s84, s84, s82
    s_min_u32 s80, s80, s84
    s_memtime s[82:83]
    s_waitcnt lgkmcnt(0)
    buffer_store_dword v89, v89, s[8:11], s87 offen sc1
    s_waitcnt vmcnt(0)
    s_memtime s[84:85]
    s_waitcnt lgkmcnt(0)
    s_sub_u32 s84, s84, s82
    s_min_u32 s81, s81, s84
    s_memtime s[82:83]
    s_waitcnt lgkmcnt(0)
    buffer_store_dword v89, v89, s[8:11], s86 offen sc1
    s_waitcnt vmcnt(0)
    s_memtime s[84:85]
    s_waitcnt lgkmcnt(0)
    s_sub_u32 s84, s84, s82
    s_min_u32 s80, s80, s84
    s_memtime s[82:83]
    s_waitcnt lgkmcnt(0)
    buffer_store_dword v89, v89, s[8:11], s87 offen sc1
    s_waitcnt vmcnt(0)
    s_memtime s[84:85]
    s_waitcnt lgkmcnt(0)
    s_sub_u32 s84, s84, s82
    s_min_u32 s81, s81, s84
    s_memtime s[82:83]
    s_waitcnt lgkmcnt(0)
    buffer_store_dword v89, v89, s[8:11], s86 offen sc1
    s_waitcnt vmcnt(0)
    s_memtime s[84:85]
    s_waitcnt lgkmcnt(0)
    s_sub_u32 s84, s84, s82
    s_min_u32 s80, s80, s84
    s_memtime s[82:83]
    s_waitcnt lgkmcnt(0)
    buffer_store_dword v89, v89, s[8:11], s87 offen sc1
    s_waitcnt vmcnt(0)
    s_memtime s[84:85]
    s_waitcnt lgkmcnt(0)
    s_sub_u32 s84, s84, s82
    s_min_u32 s81, s81, s84
    s_memtime s[82:83]
    s_waitcnt lgkmcnt(0)
    buffer_store_dword v89, v89, s[8:11], s86 offen sc1
    s_waitcnt vmcnt(0)
    s_memtime s[84:85]
    s_waitcnt lgkmcnt(0)
    s_sub_u32 s84, s84, s82
    s_min_u32 s80, s80, s84
    s_memtime s[82:83]
    s_waitcnt lgkmcnt(0)
    buffer_store_dword v89, v89, s[8:11], s87 offen sc1
    s_waitcnt vmcnt(0)
    s_memtime s[84:85]
    s_waitcnt lgkmcnt(0)
    s_sub_u32 s84, s84, s82
    s_min_u32 s81, s81, s84
    s_memtime s[82:83]
    s_waitcnt lgkmcnt(0)
    buffer_store_dword v89, v89, s[8:11], s86 offen sc1
    s_waitcnt vmcnt(0)
    s_memtime s[84:85]
    s_waitcnt lgkmcnt(0)
    s_sub_u32 s84, s84, s82
    s_min_u32 s80, s80, s84
    s_memtime s[82:83]
    s_waitcnt lgkmcnt(0)
    buffer_store_dword v89, v89, s[8:11], s87 offen sc1
    s_waitcnt vmcnt(0)
    s_memtime s[84:85]
    s_waitcnt lgkmcnt(0)
    s_sub_u32 s84, s84, s82
    s_min_u32 s81, s81, s84
    s_memtime s[82:83]
    s_waitcnt lgkmcnt(0)
    buffer_store_dword v89, v89, s[8:11], s86 offen sc1
    s_waitcnt vmcnt(0)
    s_memtime s[84:85]
    s_waitcnt lgkmcnt(0)
    s_sub_u32 s84, s84, s82
    s_min_u32 s80, s80, s84
    s_memtime s[82:83]
    s_waitcnt lgkmcnt(0)
    buffer_store_dword v89, v89, s[8:11], s87 offen sc1
    s_waitcnt vmcnt(0)
    s_memtime s[84:85]
    s_waitcnt lgkmcnt(0)
    s_sub_u32 s84, s84, s82
    s_min_u32 s81, s81, s84
    s_cmp_lt_u32 s81, s80
    s_cselect_b32 s84, 0x2000, 0
    s_getreg_b32 s85, hwreg(HW_REG_XCC_ID)
    s_lshl_b32 s85, s85, 11
    s_xor_b32 s84, s84, s85
    v_mov_b32_e64 v88, s84
    buffer_store_dword v88, v89, s[12:15], 0 offen offset:40 sc1
    v_mov_b32_e64 v88, s80
    buffer_store_dword v88, v89, s[12:15], 0 offen offset:48 sc1
    v_mov_b32_e64 v88, s81
    buffer_store_dword v88, v89, s[12:15], 0 offen offset:52 sc1
    s_waitcnt vmcnt(0)
cal_80:
    s_getreg_b32 s7, hwreg(HW_REG_XCC_ID)
    s_and_b32 s7, s7, 15
    v_mov_b32 v88, s7
    v_mul_u32_u24_e64 v88, s7, v88
    v_lshlrev_b32 v88, 15, v88
    s_lshl_b32 s7, s7, 6
    v_add3_u32 v88, v88, s7, 1
    s_lshl_b32 s7, s3, 2
    buffer_atomic_add v88, v89, s[12:15], s7 offen offset:4
    s_mov_b64 exec, -1
arr_79:
    v_lshl_or_b32 v76, v1, 16, v0
    v_lshl_or_b32 v77, v3, 16, v2
    v_lshl_or_b32 v78, v5, 16, v4
    v_lshl_or_b32 v79, v7, 16, v6
    v_lshl_or_b32 v84, v9, 16, v8
    v_lshl_or_b32 v85, v11, 16, v10
    v_lshl_or_b32 v86, v13, 16, v12
    v_lshl_or_b32 v87, v15, 16, v14
    v_add_u32 v53, 4, v53
    s_lshl_b32 s75, s2, 13
    s_add_u32 s75, s75, 0x5060000
    buffer_store_dwordx4 v[84:87], v20, s[8:11], s75 offen sc1
    buffer_store_dword v81, v53, s[8:11], s75 offen offset:4092 sc1
    s_waitcnt vmcnt(20)
    s_barrier
    v_lshrrev_b32 v93, 1, v35
    v_and_b32 v94, 1, v34
    v_lshl_add_u32 v91, v93, 1, v94
    v_lshlrev_b32 v93, 4, v91
    v_lshrrev_b32 v94, 1, v34
    v_lshl_add_u32 v93, v94, 2, v93
    v_and_b32 v94, 1, v35
    v_add_u32 v93, v93, v94
    v_mul_u32_u24 v93, 640, v93
    v_lshl_add_u32 v93, v36, 3, v93
    v_add_u32 v93, 81920, v93
    s_mul_i32 s40, s5, 5
    s_add_u32 s41, s40, 0
    v_xor_b32_e64 v94, s41, v91
    v_lshl_add_u32 v94, v94, 5, v93
    ds_read_b64_tr_b16 v[176:177], v94 offset:0
    ds_read_b64_tr_b16 v[178:179], v94 offset:1280
    ds_read_b64_tr_b16 v[180:181], v94 offset:5120
    ds_read_b64_tr_b16 v[182:183], v94 offset:6400
    ds_read_b64_tr_b16 v[216:217], v94 offset:40960
    ds_read_b64_tr_b16 v[218:219], v94 offset:42240
    ds_read_b64_tr_b16 v[220:221], v94 offset:46080
    ds_read_b64_tr_b16 v[222:223], v94 offset:47360
    s_waitcnt lgkmcnt(0)
    s_add_u32 s41, s40, 1
    v_xor_b32_e64 v94, s41, v91
    v_lshl_add_u32 v94, v94, 5, v93
    ds_read_b64_tr_b16 v[184:185], v94 offset:0
    ds_read_b64_tr_b16 v[186:187], v94 offset:1280
    ds_read_b64_tr_b16 v[188:189], v94 offset:5120
    ds_read_b64_tr_b16 v[190:191], v94 offset:6400
    ds_read_b64_tr_b16 v[224:225], v94 offset:40960
    ds_read_b64_tr_b16 v[226:227], v94 offset:42240
    ds_read_b64_tr_b16 v[228:229], v94 offset:46080
    ds_read_b64_tr_b16 v[230:231], v94 offset:47360
    s_waitcnt lgkmcnt(0)
    s_add_u32 s41, s40, 2
    v_xor_b32_e64 v94, s41, v91
    v_lshl_add_u32 v94, v94, 5, v93
    ds_read_b64_tr_b16 v[192:193], v94 offset:0
    ds_read_b64_tr_b16 v[194:195], v94 offset:1280
    ds_read_b64_tr_b16 v[196:197], v94 offset:5120
    ds_read_b64_tr_b16 v[198:199], v94 offset:6400
    ds_read_b64_tr_b16 v[232:233], v94 offset:40960
    ds_read_b64_tr_b16 v[234:235], v94 offset:42240
    ds_read_b64_tr_b16 v[236:237], v94 offset:46080
    ds_read_b64_tr_b16 v[238:239], v94 offset:47360
    s_waitcnt lgkmcnt(0)
    s_add_u32 s41, s40, 3
    v_xor_b32_e64 v94, s41, v91
    v_lshl_add_u32 v94, v94, 5, v93
    ds_read_b64_tr_b16 v[200:201], v94 offset:0
    ds_read_b64_tr_b16 v[202:203], v94 offset:1280
    ds_read_b64_tr_b16 v[204:205], v94 offset:5120
    ds_read_b64_tr_b16 v[206:207], v94 offset:6400
    ds_read_b64_tr_b16 v[240:241], v94 offset:40960
    ds_read_b64_tr_b16 v[242:243], v94 offset:42240
    ds_read_b64_tr_b16 v[244:245], v94 offset:46080
    ds_read_b64_tr_b16 v[246:247], v94 offset:47360
    s_waitcnt lgkmcnt(0)
    s_add_u32 s41, s40, 4
    v_xor_b32_e64 v94, s41, v91
    v_lshl_add_u32 v94, v94, 5, v93
    ds_read_b64_tr_b16 v[208:209], v94 offset:0
    ds_read_b64_tr_b16 v[210:211], v94 offset:1280
    ds_read_b64_tr_b16 v[212:213], v94 offset:5120
    ds_read_b64_tr_b16 v[214:215], v94 offset:6400
    ds_read_b64_tr_b16 v[248:249], v94 offset:40960
    ds_read_b64_tr_b16 v[250:251], v94 offset:42240
    ds_read_b64_tr_b16 v[252:253], v94 offset:46080
    ds_read_b64_tr_b16 v[254:255], v94 offset:47360
    s_waitcnt lgkmcnt(0)
    s_barrier
    s_add_u32 s40, s74, 1310720
    s_add_u32 m0, s72, 81920
    s_nop 0
    buffer_load_dwordx4 v49, s[16:19], s40 offen lds
    s_add_u32 m0, s72, 82944
    s_nop 0
    buffer_load_dwordx4 v50, s[16:19], s40 offen lds
    s_add_u32 m0, s72, 83968
    s_nop 0
    buffer_load_dwordx4 v51, s[16:19], s40 offen lds
    s_add_u32 m0, s72, 84992
    s_nop 0
    buffer_load_dwordx4 v52, s[16:19], s40 offen lds
    s_add_u32 s40, s74, 524288
    s_lshl_b32 s41, s5, 19
    s_add_u32 s40, s40, s41
    s_add_u32 m0, s72, 98304
    s_nop 0
    buffer_load_dwordx4 v28, s[16:19], s40 offen lds
    s_add_u32 m0, s72, 99328
    s_nop 0
    buffer_load_dwordx4 v29, s[16:19], s40 offen lds
    s_add_u32 m0, s72, 100352
    s_nop 0
    buffer_load_dwordx4 v30, s[16:19], s40 offen lds
    s_add_u32 m0, s72, 101376
    s_nop 0
    buffer_load_dwordx4 v31, s[16:19], s40 offen lds
    s_mov_b32 s16, s62
    s_and_b32 s17, s63, 0xffff
    s_mov_b32 s18, 0x500000
    s_mov_b32 s19, 0x20000
    s_add_u32 s40, s73, 0
    s_add_u32 m0, s72, 114688
    s_nop 0
    buffer_load_dwordx4 v49, s[16:19], s40 offen lds
    s_add_u32 m0, s72, 115712
    s_nop 0
    buffer_load_dwordx4 v50, s[16:19], s40 offen lds
    s_add_u32 m0, s72, 116736
    s_nop 0
    buffer_load_dwordx4 v51, s[16:19], s40 offen lds
    s_add_u32 m0, s72, 117760
    s_nop 0
    buffer_load_dwordx4 v52, s[16:19], s40 offen lds
    s_add_u32 s40, s73, 1310720
    s_add_u32 m0, s72, 131072
    s_nop 0
    buffer_load_dwordx4 v49, s[16:19], s40 offen lds
    s_add_u32 m0, s72, 132096
    s_nop 0
    buffer_load_dwordx4 v50, s[16:19], s40 offen lds
    s_add_u32 m0, s72, 133120
    s_nop 0
    buffer_load_dwordx4 v51, s[16:19], s40 offen lds
    s_add_u32 m0, s72, 134144
    s_nop 0
    buffer_load_dwordx4 v52, s[16:19], s40 offen lds
    s_add_u32 s40, s73, 1966080
    s_add_u32 m0, s72, 147456
    s_nop 0
    buffer_load_dwordx4 v49, s[16:19], s40 offen lds
    s_add_u32 m0, s72, 148480
    s_nop 0
    buffer_load_dwordx4 v50, s[16:19], s40 offen lds
    s_add_u32 m0, s72, 149504
    s_nop 0
    buffer_load_dwordx4 v51, s[16:19], s40 offen lds
    s_add_u32 m0, s72, 150528
    s_nop 0
    buffer_load_dwordx4 v52, s[16:19], s40 offen lds
    s_lshl_b32 s40, s4, 2
    s_add_u32 s40, s40, s5
    s_lshl_b32 s34, s40, 11
    s_add_u32 s34, s34, 0x100000
    s_lshl_b32 s35, s40, 10
    s_mul_i32 s41, s3, 0x800000
    s_add_u32 s35, s35, s41
    s_add_u32 s35, s35, 0x3100000
    s_lshl_b32 s36, s4, 13
    s_add_u32 s36, s36, 0x180000
    s_lshl_b32 s37, s4, 7
    s_add_u32 s37, s37, 0x8
    s_add_u32 s51, s34, 0x1000000
    s_waitcnt vmcnt(36)
    s_barrier
    v_add_u32_e64 v47, 0, v54
    v_add_u32 v48, 0, v55
    ds_read_b64_tr_b16 a[0:1], v47 offset:0
    ds_read_b64_tr_b16 a[2:3], v47 offset:8192
    ds_read_b64_tr_b16 a[4:5], v47 offset:2048
    ds_read_b64_tr_b16 a[6:7], v47 offset:10240
    ds_read_b64_tr_b16 a[8:9], v48 offset:0
    ds_read_b64_tr_b16 a[10:11], v48 offset:8192
    ds_read_b64_tr_b16 a[12:13], v48 offset:2048
    ds_read_b64_tr_b16 a[14:15], v48 offset:10240
    s_waitcnt lgkmcnt(0)
    s_waitcnt vmcnt(32)
    s_barrier
    s_add_u32 s40, s74, 0
    s_add_u32 m0, s72, 0
    s_nop 0
    buffer_load_dwordx4 v49, s[16:19], s40 offen lds
    s_add_u32 m0, s72, 1024
    s_nop 0
    buffer_load_dwordx4 v50, s[16:19], s40 offen lds
    s_add_u32 m0, s72, 2048
    s_nop 0
    buffer_load_dwordx4 v51, s[16:19], s40 offen lds
    s_add_u32 m0, s72, 3072
    s_nop 0
    buffer_load_dwordx4 v52, s[16:19], s40 offen lds
    v_add_u32 v47, 16384, v54
    v_add_u32 v48, 16384, v55
    ds_read_b64_tr_b16 a[16:17], v47 offset:0
    ds_read_b64_tr_b16 a[18:19], v47 offset:8192
    ds_read_b64_tr_b16 a[20:21], v47 offset:2048
    ds_read_b64_tr_b16 a[22:23], v47 offset:10240
    ds_read_b64_tr_b16 a[24:25], v48 offset:0
    ds_read_b64_tr_b16 a[26:27], v48 offset:8192
    ds_read_b64_tr_b16 a[28:29], v48 offset:2048
    ds_read_b64_tr_b16 a[30:31], v48 offset:10240
    s_waitcnt lgkmcnt(0)
    s_waitcnt vmcnt(32)
    s_barrier
    s_add_u32 s40, s74, 1310720
    s_add_u32 m0, s72, 16384
    s_nop 0
    buffer_load_dwordx4 v49, s[16:19], s40 offen lds
    s_add_u32 m0, s72, 17408
    s_nop 0
    buffer_load_dwordx4 v50, s[16:19], s40 offen lds
    s_add_u32 m0, s72, 18432
    s_nop 0
    buffer_load_dwordx4 v51, s[16:19], s40 offen lds
    s_add_u32 m0, s72, 19456
    s_nop 0
    buffer_load_dwordx4 v52, s[16:19], s40 offen lds
    v_add_u32 v47, 32768, v32
    v_add_u32 v48, 32768, v33
    ds_read_b64_tr_b16 a[32:33], v47 offset:0
    ds_read_b64_tr_b16 a[34:35], v47 offset:512
    ds_read_b64_tr_b16 a[36:37], v47 offset:8192
    ds_read_b64_tr_b16 a[38:39], v47 offset:8704
    ds_read_b64_tr_b16 a[40:41], v48 offset:0
    ds_read_b64_tr_b16 a[42:43], v48 offset:512
    ds_read_b64_tr_b16 a[44:45], v48 offset:8192
    ds_read_b64_tr_b16 a[46:47], v48 offset:8704
    s_waitcnt lgkmcnt(0)
    s_waitcnt vmcnt(32)
    s_barrier
    s_add_u32 s40, s74, 1966080
    s_add_u32 m0, s72, 32768
    s_nop 0
    buffer_load_dwordx4 v49, s[16:19], s40 offen lds
    s_add_u32 m0, s72, 33792
    s_nop 0
    buffer_load_dwordx4 v50, s[16:19], s40 offen lds
    s_add_u32 m0, s72, 34816
    s_nop 0
    buffer_load_dwordx4 v51, s[16:19], s40 offen lds
    s_add_u32 m0, s72, 35840
    s_nop 0
    buffer_load_dwordx4 v52, s[16:19], s40 offen lds
    v_add_u32 v47, 49152, v54
    v_add_u32 v48, 49152, v55
    ds_read_b64_tr_b16 a[48:49], v47 offset:0
    ds_read_b64_tr_b16 a[50:51], v47 offset:8192
    ds_read_b64_tr_b16 a[52:53], v47 offset:2048
    ds_read_b64_tr_b16 a[54:55], v47 offset:10240
    ds_read_b64_tr_b16 a[56:57], v48 offset:0
    ds_read_b64_tr_b16 a[58:59], v48 offset:8192
    ds_read_b64_tr_b16 a[60:61], v48 offset:2048
    ds_read_b64_tr_b16 a[62:63], v48 offset:10240
    s_waitcnt lgkmcnt(0)
    s_waitcnt vmcnt(32)
    s_barrier
    s_mov_b32 s16, s64
    s_and_b32 s17, s65, 0xffff
    s_mov_b32 s18, 0x500000
    s_mov_b32 s19, 0x20000
    s_add_u32 s40, s73, 0
    s_add_u32 m0, s72, 49152
    s_nop 0
    buffer_load_dwordx4 v49, s[16:19], s40 offen lds
    s_add_u32 m0, s72, 50176
    s_nop 0
    buffer_load_dwordx4 v50, s[16:19], s40 offen lds
    s_add_u32 m0, s72, 51200
    s_nop 0
    buffer_load_dwordx4 v51, s[16:19], s40 offen lds
    s_add_u32 m0, s72, 52224
    s_nop 0
    buffer_load_dwordx4 v52, s[16:19], s40 offen lds
    v_add_u32 v47, 65536, v54
    v_add_u32 v48, 65536, v55
    ds_read_b64_tr_b16 a[64:65], v47 offset:0
    ds_read_b64_tr_b16 a[66:67], v47 offset:8192
    ds_read_b64_tr_b16 a[68:69], v47 offset:2048
    ds_read_b64_tr_b16 a[70:71], v47 offset:10240
    ds_read_b64_tr_b16 a[72:73], v48 offset:0
    ds_read_b64_tr_b16 a[74:75], v48 offset:8192
    ds_read_b64_tr_b16 a[76:77], v48 offset:2048
    ds_read_b64_tr_b16 a[78:79], v48 offset:10240
    s_waitcnt lgkmcnt(0)
    s_waitcnt vmcnt(32)
    s_barrier
    s_add_u32 s40, s73, 655360
    s_add_u32 m0, s72, 65536
    s_nop 0
    buffer_load_dwordx4 v49, s[16:19], s40 offen lds
    s_add_u32 m0, s72, 66560
    s_nop 0
    buffer_load_dwordx4 v50, s[16:19], s40 offen lds
    s_add_u32 m0, s72, 67584
    s_nop 0
    buffer_load_dwordx4 v51, s[16:19], s40 offen lds
    s_add_u32 m0, s72, 68608
    s_nop 0
    buffer_load_dwordx4 v52, s[16:19], s40 offen lds
    v_add_u32 v47, 81920, v54
    v_add_u32 v48, 81920, v55
    ds_read_b64_tr_b16 a[80:81], v47 offset:0
    ds_read_b64_tr_b16 a[82:83], v47 offset:8192
    ds_read_b64_tr_b16 a[84:85], v47 offset:2048
    ds_read_b64_tr_b16 a[86:87], v47 offset:10240
    ds_read_b64_tr_b16 a[88:89], v48 offset:0
    ds_read_b64_tr_b16 a[90:91], v48 offset:8192
    ds_read_b64_tr_b16 a[92:93], v48 offset:2048
    ds_read_b64_tr_b16 a[94:95], v48 offset:10240
    s_waitcnt lgkmcnt(0)
    s_waitcnt vmcnt(32)
    s_barrier
    s_add_u32 s40, s73, 1966080
    s_add_u32 m0, s72, 81920
    s_nop 0
    buffer_load_dwordx4 v49, s[16:19], s40 offen lds
    s_add_u32 m0, s72, 82944
    s_nop 0
    buffer_load_dwordx4 v50, s[16:19], s40 offen lds
    s_add_u32 m0, s72, 83968
    s_nop 0
    buffer_load_dwordx4 v51, s[16:19], s40 offen lds
    s_add_u32 m0, s72, 84992
    s_nop 0
    buffer_load_dwordx4 v52, s[16:19], s40 offen lds
    v_add_u32 v47, 98304, v32
    v_add_u32 v48, 98304, v33
    ds_read_b64_tr_b16 a[96:97], v47 offset:0
    ds_read_b64_tr_b16 a[98:99], v47 offset:512
    ds_read_b64_tr_b16 a[100:101], v47 offset:8192
    ds_read_b64_tr_b16 a[102:103], v47 offset:8704
    ds_read_b64_tr_b16 a[104:105], v48 offset:0
    ds_read_b64_tr_b16 a[106:107], v48 offset:512
    ds_read_b64_tr_b16 a[108:109], v48 offset:8192
    ds_read_b64_tr_b16 a[110:111], v48 offset:8704
    s_waitcnt lgkmcnt(0)
    s_waitcnt vmcnt(32)
    s_barrier
    s_add_u32 s40, s73, 524288
    s_lshl_b32 s41, s5, 19
    s_add_u32 s40, s40, s41
    s_add_u32 m0, s72, 98304
    s_nop 0
    buffer_load_dwordx4 v28, s[16:19], s40 offen lds
    s_add_u32 m0, s72, 99328
    s_nop 0
    buffer_load_dwordx4 v29, s[16:19], s40 offen lds
    s_add_u32 m0, s72, 100352
    s_nop 0
    buffer_load_dwordx4 v30, s[16:19], s40 offen lds
    s_add_u32 m0, s72, 101376
    s_nop 0
    buffer_load_dwordx4 v31, s[16:19], s40 offen lds
    v_add_u32 v47, 114688, v54
    v_add_u32 v48, 114688, v55
    ds_read_b64_tr_b16 a[112:113], v47 offset:0
    ds_read_b64_tr_b16 a[114:115], v47 offset:8192
    ds_read_b64_tr_b16 a[116:117], v47 offset:2048
    ds_read_b64_tr_b16 a[118:119], v47 offset:10240
    ds_read_b64_tr_b16 a[120:121], v48 offset:0
    ds_read_b64_tr_b16 a[122:123], v48 offset:8192
    ds_read_b64_tr_b16 a[124:125], v48 offset:2048
    ds_read_b64_tr_b16 a[126:127], v48 offset:10240
    s_waitcnt lgkmcnt(0)
    s_waitcnt vmcnt(32)
    s_barrier
    s_add_u32 s40, s74, 0
    s_add_u32 m0, s72, 114688
    s_nop 0
    buffer_load_dwordx4 v49, s[16:19], s40 offen lds
    s_add_u32 m0, s72, 115712
    s_nop 0
    buffer_load_dwordx4 v50, s[16:19], s40 offen lds
    s_add_u32 m0, s72, 116736
    s_nop 0
    buffer_load_dwordx4 v51, s[16:19], s40 offen lds
    s_add_u32 m0, s72, 117760
    s_nop 0
    buffer_load_dwordx4 v52, s[16:19], s40 offen lds
    v_add_u32 v47, 131072, v54
    v_add_u32 v48, 131072, v55
    ds_read_b64_tr_b16 a[128:129], v47 offset:0
    ds_read_b64_tr_b16 a[130:131], v47 offset:8192
    ds_read_b64_tr_b16 a[132:133], v47 offset:2048
    ds_read_b64_tr_b16 a[134:135], v47 offset:10240
    ds_read_b64_tr_b16 a[136:137], v48 offset:0
    ds_read_b64_tr_b16 a[138:139], v48 offset:8192
    ds_read_b64_tr_b16 a[140:141], v48 offset:2048
    ds_read_b64_tr_b16 a[142:143], v48 offset:10240
    s_waitcnt lgkmcnt(0)
    s_waitcnt vmcnt(32)
    s_barrier
    s_add_u32 s40, s74, 655360
    s_add_u32 m0, s72, 131072
    s_nop 0
    buffer_load_dwordx4 v49, s[16:19], s40 offen lds
    s_add_u32 m0, s72, 132096
    s_nop 0
    buffer_load_dwordx4 v50, s[16:19], s40 offen lds
    s_add_u32 m0, s72, 133120
    s_nop 0
    buffer_load_dwordx4 v51, s[16:19], s40 offen lds
    s_add_u32 m0, s72, 134144
    s_nop 0
    buffer_load_dwordx4 v52, s[16:19], s40 offen lds
    v_add_u32 v47, 147456, v54
    v_add_u32 v48, 147456, v55
    ds_read_b64_tr_b16 a[144:145], v47 offset:0
    ds_read_b64_tr_b16 a[146:147], v47 offset:8192
    ds_read_b64_tr_b16 a[148:149], v47 offset:2048
    ds_read_b64_tr_b16 a[150:151], v47 offset:10240
    ds_read_b64_tr_b16 a[152:153], v48 offset:0
    ds_read_b64_tr_b16 a[154:155], v48 offset:8192
    ds_read_b64_tr_b16 a[156:157], v48 offset:2048
    ds_read_b64_tr_b16 a[158:159], v48 offset:10240
    s_waitcnt lgkmcnt(0)
    s_waitcnt vmcnt(32)
    s_barrier
    s_add_u32 s40, s74, 1310720
    s_add_u32 m0, s72, 147456
    s_nop 0
    buffer_load_dwordx4 v49, s[16:19], s40 offen lds
    s_add_u32 m0, s72, 148480
    s_nop 0
    buffer_load_dwordx4 v50, s[16:19], s40 offen lds
    s_add_u32 m0, s72, 149504
    s_nop 0
    buffer_load_dwordx4 v51, s[16:19], s40 offen lds
    s_add_u32 m0, s72, 150528
    s_nop 0
    buffer_load_dwordx4 v52, s[16:19], s40 offen lds
    v_add_u32_e64 v47, 0, v54
    v_add_u32 v48, 0, v55
    ds_read_b64_tr_b16 a[160:161], v47 offset:0
    ds_read_b64_tr_b16 a[162:163], v47 offset:8192
    ds_read_b64_tr_b16 a[164:165], v47 offset:2048
    ds_read_b64_tr_b16 a[166:167], v47 offset:10240
    ds_read_b64_tr_b16 a[168:169], v48 offset:0
    ds_read_b64_tr_b16 a[170:171], v48 offset:8192
    ds_read_b64_tr_b16 a[172:173], v48 offset:2048
    ds_read_b64_tr_b16 a[174:175], v48 offset:10240
    s_waitcnt lgkmcnt(0)
    s_waitcnt vmcnt(32)
    s_barrier
    s_add_u32 s40, s74, 1966080
    s_add_u32 m0, s72, 0
    s_nop 0
    buffer_load_dwordx4 v49, s[16:19], s40 offen lds
    s_add_u32 m0, s72, 1024
    s_nop 0
    buffer_load_dwordx4 v50, s[16:19], s40 offen lds
    s_add_u32 m0, s72, 2048
    s_nop 0
    buffer_load_dwordx4 v51, s[16:19], s40 offen lds
    s_add_u32 m0, s72, 3072
    s_nop 0
    buffer_load_dwordx4 v52, s[16:19], s40 offen lds
    v_add_u32 v47, 16384, v54
    v_add_u32 v48, 16384, v55
    ds_read_b64_tr_b16 a[176:177], v47 offset:0
    ds_read_b64_tr_b16 a[178:179], v47 offset:8192
    ds_read_b64_tr_b16 a[180:181], v47 offset:2048
    ds_read_b64_tr_b16 a[182:183], v47 offset:10240
    ds_read_b64_tr_b16 a[184:185], v48 offset:0
    ds_read_b64_tr_b16 a[186:187], v48 offset:8192
    ds_read_b64_tr_b16 a[188:189], v48 offset:2048
    ds_read_b64_tr_b16 a[190:191], v48 offset:10240
    s_waitcnt lgkmcnt(0)
    s_waitcnt vmcnt(32)
    s_barrier
    s_mov_b32 s16, s60
    s_and_b32 s17, s61, 0xffff
    s_mov_b32 s18, 0x500000
    s_mov_b32 s19, 0x20000
    s_add_u32 s40, s73, 0
    s_add_u32 m0, s72, 16384
    s_nop 0
    buffer_load_dwordx4 v49, s[16:19], s40 offen lds
    s_add_u32 m0, s72, 17408
    s_nop 0
    buffer_load_dwordx4 v50, s[16:19], s40 offen lds
    s_add_u32 m0, s72, 18432
    s_nop 0
    buffer_load_dwordx4 v51, s[16:19], s40 offen lds
    s_add_u32 m0, s72, 19456
    s_nop 0
    buffer_load_dwordx4 v52, s[16:19], s40 offen lds
    v_add_u32 v47, 32768, v54
    v_add_u32 v48, 32768, v55
    ds_read_b64_tr_b16 a[192:193], v47 offset:0
    ds_read_b64_tr_b16 a[194:195], v47 offset:8192
    ds_read_b64_tr_b16 a[196:197], v47 offset:2048
    ds_read_b64_tr_b16 a[198:199], v47 offset:10240
    ds_read_b64_tr_b16 a[200:201], v48 offset:0
    ds_read_b64_tr_b16 a[202:203], v48 offset:8192
    ds_read_b64_tr_b16 a[204:205], v48 offset:2048
    ds_read_b64_tr_b16 a[206:207], v48 offset:10240
    s_waitcnt lgkmcnt(0)
    s_waitcnt vmcnt(32)
    s_barrier
    s_mov_b32 s16, s62
    s_and_b32 s17, s63, 0xffff
    s_mov_b32 s18, 0x500000
    s_mov_b32 s19, 0x20000
    s_add_u32 s40, s73, 655360
    s_add_u32 m0, s72, 32768
    s_nop 0
    buffer_load_dwordx4 v49, s[16:19], s40 offen lds
    s_add_u32 m0, s72, 33792
    s_nop 0
    buffer_load_dwordx4 v50, s[16:19], s40 offen lds
    s_add_u32 m0, s72, 34816
    s_nop 0
    buffer_load_dwordx4 v51, s[16:19], s40 offen lds
    s_add_u32 m0, s72, 35840
    s_nop 0
    buffer_load_dwordx4 v52, s[16:19], s40 offen lds
    v_add_u32 v47, 49152, v54
    v_add_u32 v48, 49152, v55
    ds_read_b64_tr_b16 a[208:209], v47 offset:0
    ds_read_b64_tr_b16 a[210:211], v47 offset:8192
    ds_read_b64_tr_b16 a[212:213], v47 offset:2048
    ds_read_b64_tr_b16 a[214:215], v47 offset:10240
    ds_read_b64_tr_b16 a[216:217], v48 offset:0
    ds_read_b64_tr_b16 a[218:219], v48 offset:8192
    ds_read_b64_tr_b16 a[220:221], v48 offset:2048
    ds_read_b64_tr_b16 a[222:223], v48 offset:10240
    s_waitcnt lgkmcnt(0)
    s_waitcnt vmcnt(32)
    s_barrier
    s_mov_b32 s16, s60
    s_and_b32 s17, s61, 0xffff
    s_mov_b32 s18, 0x500000
    s_mov_b32 s19, 0x20000
    s_add_u32 s40, s73, 1966080
    s_add_u32 m0, s72, 49152
    s_nop 0
    buffer_load_dwordx4 v49, s[16:19], s40 offen lds
    s_add_u32 m0, s72, 50176
    s_nop 0
    buffer_load_dwordx4 v50, s[16:19], s40 offen lds
    s_add_u32 m0, s72, 51200
    s_nop 0
    buffer_load_dwordx4 v51, s[16:19], s40 offen lds
    s_add_u32 m0, s72, 52224
    s_nop 0
    buffer_load_dwordx4 v52, s[16:19], s40 offen lds
    v_add_u32 v47, 65536, v54
    v_add_u32 v48, 65536, v55
    ds_read_b64_tr_b16 a[224:225], v47 offset:0
    ds_read_b64_tr_b16 a[226:227], v47 offset:8192
    ds_read_b64_tr_b16 a[228:229], v47 offset:2048
    ds_read_b64_tr_b16 a[230:231], v47 offset:10240
    ds_read_b64_tr_b16 a[232:233], v48 offset:0
    ds_read_b64_tr_b16 a[234:235], v48 offset:8192
    ds_read_b64_tr_b16 a[236:237], v48 offset:2048
    ds_read_b64_tr_b16 a[238:239], v48 offset:10240
    s_waitcnt lgkmcnt(0)
    s_waitcnt vmcnt(32)
    s_barrier
    s_mov_b32 s16, s62
    s_and_b32 s17, s63, 0xffff
    s_mov_b32 s18, 0x500000
    s_mov_b32 s19, 0x20000
    s_add_u32 s40, s73, 524288
    s_lshl_b32 s41, s5, 19
    s_add_u32 s40, s40, s41
    s_add_u32 m0, s72, 65536
    s_nop 0
    buffer_load_dwordx4 v28, s[16:19], s40 offen lds
    s_add_u32 m0, s72, 66560
    s_nop 0
    buffer_load_dwordx4 v29, s[16:19], s40 offen lds
    s_add_u32 m0, s72, 67584
    s_nop 0
    buffer_load_dwordx4 v30, s[16:19], s40 offen lds
    s_add_u32 m0, s72, 68608
    s_nop 0
    buffer_load_dwordx4 v31, s[16:19], s40 offen lds
    v_add_u32 v47, 81920, v54
    v_add_u32 v48, 81920, v55
    ds_read_b64_tr_b16 a[240:241], v47 offset:0
    ds_read_b64_tr_b16 a[242:243], v47 offset:8192
    ds_read_b64_tr_b16 a[244:245], v47 offset:2048
    ds_read_b64_tr_b16 a[246:247], v47 offset:10240
    ds_read_b64_tr_b16 a[248:249], v48 offset:0
    ds_read_b64_tr_b16 a[250:251], v48 offset:8192
    ds_read_b64_tr_b16 a[252:253], v48 offset:2048
    ds_read_b64_tr_b16 a[254:255], v48 offset:10240
    s_waitcnt lgkmcnt(0)
    s_waitcnt vmcnt(32)
    s_barrier
    s_mov_b32 s16, s64
    s_and_b32 s17, s65, 0xffff
    s_mov_b32 s18, 0x500000
    s_mov_b32 s19, 0x20000
    s_add_u32 s40, s73, 1310720
    s_add_u32 m0, s72, 81920
    s_nop 0
    buffer_load_dwordx4 v49, s[16:19], s40 offen lds
    s_add_u32 m0, s72, 82944
    s_nop 0
    buffer_load_dwordx4 v50, s[16:19], s40 offen lds
    s_add_u32 m0, s72, 83968
    s_nop 0
    buffer_load_dwordx4 v51, s[16:19], s40 offen lds
    s_add_u32 m0, s72, 84992
    s_nop 0
    buffer_load_dwordx4 v52, s[16:19], s40 offen lds
    v_add_u32 v47, 98304, v32
    v_add_u32 v48, 98304, v33
    ds_read_b64_tr_b16 v[96:97], v47 offset:0
    ds_read_b64_tr_b16 v[98:99], v47 offset:512
    ds_read_b64_tr_b16 v[100:101], v47 offset:8192
    ds_read_b64_tr_b16 v[102:103], v47 offset:8704
    ds_read_b64_tr_b16 v[104:105], v48 offset:0
    ds_read_b64_tr_b16 v[106:107], v48 offset:512
    ds_read_b64_tr_b16 v[108:109], v48 offset:8192
    ds_read_b64_tr_b16 v[110:111], v48 offset:8704
    s_waitcnt lgkmcnt(0)
    s_waitcnt vmcnt(32)
    s_barrier
    s_mov_b32 s16, s60
    s_and_b32 s17, s61, 0xffff
    s_mov_b32 s18, 0x500000
    s_mov_b32 s19, 0x20000
    s_add_u32 s40, s74, 1966080
    s_add_u32 m0, s72, 98304
    s_nop 0
    buffer_load_dwordx4 v49, s[16:19], s40 offen lds
    s_add_u32 m0, s72, 99328
    s_nop 0
    buffer_load_dwordx4 v50, s[16:19], s40 offen lds
    s_add_u32 m0, s72, 100352
    s_nop 0
    buffer_load_dwordx4 v51, s[16:19], s40 offen lds
    s_add_u32 m0, s72, 101376
    s_nop 0
    buffer_load_dwordx4 v52, s[16:19], s40 offen lds
    v_add_u32 v47, 114688, v54
    v_add_u32 v48, 114688, v55
    ds_read_b64_tr_b16 v[112:113], v47 offset:0
    ds_read_b64_tr_b16 v[114:115], v47 offset:8192
    ds_read_b64_tr_b16 v[116:117], v47 offset:2048
    ds_read_b64_tr_b16 v[118:119], v47 offset:10240
    ds_read_b64_tr_b16 v[120:121], v48 offset:0
    ds_read_b64_tr_b16 v[122:123], v48 offset:8192
    ds_read_b64_tr_b16 v[124:125], v48 offset:2048
    ds_read_b64_tr_b16 v[126:127], v48 offset:10240
    s_waitcnt lgkmcnt(0)
    s_waitcnt vmcnt(32)
    s_barrier
    s_mov_b32 s16, s62
    s_and_b32 s17, s63, 0xffff
    s_mov_b32 s18, 0x500000
    s_mov_b32 s19, 0x20000
    s_add_u32 s40, s74, 655360
    s_add_u32 m0, s72, 114688
    s_nop 0
    buffer_load_dwordx4 v49, s[16:19], s40 offen lds
    s_add_u32 m0, s72, 115712
    s_nop 0
    buffer_load_dwordx4 v50, s[16:19], s40 offen lds
    s_add_u32 m0, s72, 116736
    s_nop 0
    buffer_load_dwordx4 v51, s[16:19], s40 offen lds
    s_add_u32 m0, s72, 117760
    s_nop 0
    buffer_load_dwordx4 v52, s[16:19], s40 offen lds
    v_add_u32 v47, 131072, v54
    v_add_u32 v48, 131072, v55
    ds_read_b64_tr_b16 v[128:129], v47 offset:0
    ds_read_b64_tr_b16 v[130:131], v47 offset:8192
    ds_read_b64_tr_b16 v[132:133], v47 offset:2048
    ds_read_b64_tr_b16 v[134:135], v47 offset:10240
    ds_read_b64_tr_b16 v[136:137], v48 offset:0
    ds_read_b64_tr_b16 v[138:139], v48 offset:8192
    ds_read_b64_tr_b16 v[140:141], v48 offset:2048
    ds_read_b64_tr_b16 v[142:143], v48 offset:10240
    s_waitcnt lgkmcnt(0)
    s_waitcnt vmcnt(32)
    s_barrier
    s_add_u32 s40, s74, 524288
    s_lshl_b32 s41, s5, 19
    s_add_u32 s40, s40, s41
    s_add_u32 m0, s72, 131072
    s_nop 0
    buffer_load_dwordx4 v28, s[16:19], s40 offen lds
    s_add_u32 m0, s72, 132096
    s_nop 0
    buffer_load_dwordx4 v29, s[16:19], s40 offen lds
    s_add_u32 m0, s72, 133120
    s_nop 0
    buffer_load_dwordx4 v30, s[16:19], s40 offen lds
    s_add_u32 m0, s72, 134144
    s_nop 0
    buffer_load_dwordx4 v31, s[16:19], s40 offen lds
    v_add_u32 v47, 147456, v54
    v_add_u32 v48, 147456, v55
    ds_read_b64_tr_b16 v[144:145], v47 offset:0
    ds_read_b64_tr_b16 v[146:147], v47 offset:8192
    ds_read_b64_tr_b16 v[148:149], v47 offset:2048
    ds_read_b64_tr_b16 v[150:151], v47 offset:10240
    ds_read_b64_tr_b16 v[152:153], v48 offset:0
    ds_read_b64_tr_b16 v[154:155], v48 offset:8192
    ds_read_b64_tr_b16 v[156:157], v48 offset:2048
    ds_read_b64_tr_b16 v[158:159], v48 offset:10240
    s_waitcnt lgkmcnt(0)
    s_waitcnt vmcnt(32)
    s_barrier
    s_mov_b32 s16, s64
    s_and_b32 s17, s65, 0xffff
    s_mov_b32 s18, 0x500000
    s_mov_b32 s19, 0x20000
    s_add_u32 s40, s74, 524288
    s_lshl_b32 s41, s5, 19
    s_add_u32 s40, s40, s41
    s_add_u32 m0, s72, 147456
    s_nop 0
    buffer_load_dwordx4 v28, s[16:19], s40 offen lds
    s_add_u32 m0, s72, 148480
    s_nop 0
    buffer_load_dwordx4 v29, s[16:19], s40 offen lds
    s_add_u32 m0, s72, 149504
    s_nop 0
    buffer_load_dwordx4 v30, s[16:19], s40 offen lds
    s_add_u32 m0, s72, 150528
    s_nop 0
    buffer_load_dwordx4 v31, s[16:19], s40 offen lds
    v_lshrrev_b32 v7, 2, v19
    v_mov_b32_e64 v6, 0
    buffer_load_dword v4, v7, s[12:15], 0 offen sc1
    buffer_load_dwordx4 v[0:3], v6, s[8:11], s37 offen sc1
    v_lshlrev_b32_e64 v6, 3, v19
    s_sub_u32 s40, s36, 0x80000
    s_add_u32 s41, s40, 0x1000000
    buffer_load_dword v5, v6, s[8:11], s40 offen sc1
    buffer_load_dword v5, v6, s[8:11], s41 offen sc1
    s_sub_u32 s40, s36, 0x40000
    s_add_u32 s41, s40, 0x1000000
    buffer_load_dword v5, v6, s[8:11], s40 offen sc1
    buffer_load_dword v5, v6, s[8:11], s41 offen sc1
    buffer_load_dwordx4 v[8:11], v19, s[8:11], s51 offen offset:0 sc1
    buffer_load_dwordx4 v[12:15], v19, s[8:11], s51 offen offset:1024 sc1
    v_add_u32_e64 v47, 0, v54
    v_add_u32 v48, 0, v55
    ds_read_b64_tr_b16 v[160:161], v47 offset:0
    ds_read_b64_tr_b16 v[162:163], v47 offset:8192
    ds_read_b64_tr_b16 v[164:165], v47 offset:2048
    ds_read_b64_tr_b16 v[166:167], v47 offset:10240
    ds_read_b64_tr_b16 v[168:169], v48 offset:0
    ds_read_b64_tr_b16 v[170:171], v48 offset:8192
    ds_read_b64_tr_b16 v[172:173], v48 offset:2048
    ds_read_b64_tr_b16 v[174:175], v48 offset:10240
    s_waitcnt lgkmcnt(0)
    s_waitcnt vmcnt(40)
    s_barrier
    v_add_u32 v47, 16384, v54
    v_add_u32 v48, 16384, v55
    ds_read_b64_tr_b16 v[56:57], v47 offset:0
    ds_read_b64_tr_b16 v[58:59], v47 offset:8192
    ds_read_b64_tr_b16 v[60:61], v47 offset:2048
    ds_read_b64_tr_b16 v[62:63], v47 offset:10240
    ds_read_b64_tr_b16 v[64:65], v48 offset:0
    ds_read_b64_tr_b16 v[66:67], v48 offset:8192
    ds_read_b64_tr_b16 v[68:69], v48 offset:2048
    ds_read_b64_tr_b16 v[70:71], v48 offset:10240
    s_waitcnt lgkmcnt(0)
    s_barrier
    s_add_u32 s40, s72, 16384
    v_add_u32 v47, s40, v19
    ds_write_b128 v47, v[56:59] offset:0
    ds_write_b128 v47, v[60:63] offset:1024
    ds_write_b128 v47, v[64:67] offset:2048
    ds_write_b128 v47, v[68:71] offset:3072
    s_waitcnt lgkmcnt(0)
    s_waitcnt vmcnt(36)
    s_barrier
    v_add_u32 v47, 32768, v54
    v_add_u32 v48, 32768, v55
    ds_read_b64_tr_b16 v[56:57], v47 offset:0
    ds_read_b64_tr_b16 v[58:59], v47 offset:8192
    ds_read_b64_tr_b16 v[60:61], v47 offset:2048
    ds_read_b64_tr_b16 v[62:63], v47 offset:10240
    ds_read_b64_tr_b16 v[64:65], v48 offset:0
    ds_read_b64_tr_b16 v[66:67], v48 offset:8192
    ds_read_b64_tr_b16 v[68:69], v48 offset:2048
    ds_read_b64_tr_b16 v[70:71], v48 offset:10240
    s_waitcnt lgkmcnt(0)
    s_barrier
    s_add_u32 s40, s72, 32768
    v_add_u32 v47, s40, v19
    ds_write_b128 v47, v[56:59] offset:0
    ds_write_b128 v47, v[60:63] offset:1024
    ds_write_b128 v47, v[64:67] offset:2048
    ds_write_b128 v47, v[68:71] offset:3072
    s_waitcnt lgkmcnt(0)
    s_waitcnt vmcnt(32)
    s_barrier
    v_add_u32 v47, 49152, v54
    v_add_u32 v48, 49152, v55
    ds_read_b64_tr_b16 v[56:57], v47 offset:0
    ds_read_b64_tr_b16 v[58:59], v47 offset:8192
    ds_read_b64_tr_b16 v[60:61], v47 offset:2048
    ds_read_b64_tr_b16 v[62:63], v47 offset:10240
    ds_read_b64_tr_b16 v[64:65], v48 offset:0
    ds_read_b64_tr_b16 v[66:67], v48 offset:8192
    ds_read_b64_tr_b16 v[68:69], v48 offset:2048
    ds_read_b64_tr_b16 v[70:71], v48 offset:10240
    s_waitcnt lgkmcnt(0)
    s_barrier
    s_add_u32 s40, s72, 49152
    v_add_u32 v47, s40, v19
    ds_write_b128 v47, v[56:59] offset:0
    ds_write_b128 v47, v[60:63] offset:1024
    ds_write_b128 v47, v[64:67] offset:2048
    ds_write_b128 v47, v[68:71] offset:3072
    s_waitcnt lgkmcnt(0)
    s_waitcnt vmcnt(28)
    s_barrier
    v_add_u32 v47, 65536, v32
    v_add_u32 v48, 65536, v33
    ds_read_b64_tr_b16 v[56:57], v47 offset:0
    ds_read_b64_tr_b16 v[58:59], v47 offset:512
    ds_read_b64_tr_b16 v[60:61], v47 offset:8192
    ds_read_b64_tr_b16 v[62:63], v47 offset:8704
    ds_read_b64_tr_b16 v[64:65], v48 offset:0
    ds_read_b64_tr_b16 v[66:67], v48 offset:512
    ds_read_b64_tr_b16 v[68:69], v48 offset:8192
    ds_read_b64_tr_b16 v[70:71], v48 offset:8704
    s_waitcnt lgkmcnt(0)
    s_barrier
    s_add_u32 s40, s72, 65536
    v_add_u32 v47, s40, v19
    ds_write_b128 v47, v[56:59] offset:0
    ds_write_b128 v47, v[60:63] offset:1024
    ds_write_b128 v47, v[64:67] offset:2048
    ds_write_b128 v47, v[68:71] offset:3072
    s_waitcnt lgkmcnt(0)
    s_waitcnt vmcnt(24)
    s_barrier
    v_add_u32 v47, 81920, v54
    v_add_u32 v48, 81920, v55
    ds_read_b64_tr_b16 v[56:57], v47 offset:0
    ds_read_b64_tr_b16 v[58:59], v47 offset:8192
    ds_read_b64_tr_b16 v[60:61], v47 offset:2048
    ds_read_b64_tr_b16 v[62:63], v47 offset:10240
    ds_read_b64_tr_b16 v[64:65], v48 offset:0
    ds_read_b64_tr_b16 v[66:67], v48 offset:8192
    ds_read_b64_tr_b16 v[68:69], v48 offset:2048
    ds_read_b64_tr_b16 v[70:71], v48 offset:10240
    s_waitcnt lgkmcnt(0)
    s_barrier
    s_add_u32 s40, s72, 81920
    v_add_u32 v47, s40, v19
    ds_write_b128 v47, v[56:59] offset:0
    ds_write_b128 v47, v[60:63] offset:1024
    ds_write_b128 v47, v[64:67] offset:2048
    ds_write_b128 v47, v[68:71] offset:3072
    s_waitcnt lgkmcnt(0)
    s_waitcnt vmcnt(20)
    s_barrier
    v_add_u32 v47, 98304, v54
    v_add_u32 v48, 98304, v55
    ds_read_b64_tr_b16 v[56:57], v47 offset:0
    ds_read_b64_tr_b16 v[58:59], v47 offset:8192
    ds_read_b64_tr_b16 v[60:61], v47 offset:2048
    ds_read_b64_tr_b16 v[62:63], v47 offset:10240
    ds_read_b64_tr_b16 v[64:65], v48 offset:0
    ds_read_b64_tr_b16 v[66:67], v48 offset:8192
    ds_read_b64_tr_b16 v[68:69], v48 offset:2048
    ds_read_b64_tr_b16 v[70:71], v48 offset:10240
    s_waitcnt lgkmcnt(0)
    s_barrier
    s_add_u32 s40, s72, 98304
    v_add_u32 v47, s40, v19
    ds_write_b128 v47, v[56:59] offset:0
    ds_write_b128 v47, v[60:63] offset:1024
    ds_write_b128 v47, v[64:67] offset:2048
    ds_write_b128 v47, v[68:71] offset:3072
    s_waitcnt lgkmcnt(0)
    s_waitcnt vmcnt(16)
    s_barrier
    v_add_u32 v47, 114688, v54
    v_add_u32 v48, 114688, v55
    ds_read_b64_tr_b16 v[56:57], v47 offset:0
    ds_read_b64_tr_b16 v[58:59], v47 offset:8192
    ds_read_b64_tr_b16 v[60:61], v47 offset:2048
    ds_read_b64_tr_b16 v[62:63], v47 offset:10240
    ds_read_b64_tr_b16 v[64:65], v48 offset:0
    ds_read_b64_tr_b16 v[66:67], v48 offset:8192
    ds_read_b64_tr_b16 v[68:69], v48 offset:2048
    ds_read_b64_tr_b16 v[70:71], v48 offset:10240
    s_waitcnt lgkmcnt(0)
    s_barrier
    s_add_u32 s40, s72, 114688
    v_add_u32 v47, s40, v19
    ds_write_b128 v47, v[56:59] offset:0
    ds_write_b128 v47, v[60:63] offset:1024
    ds_write_b128 v47, v[64:67] offset:2048
    ds_write_b128 v47, v[68:71] offset:3072
    s_waitcnt lgkmcnt(0)
    s_waitcnt vmcnt(12)
    s_barrier
    v_add_u32 v47, 131072, v32
    v_add_u32 v48, 131072, v33
    ds_read_b64_tr_b16 v[56:57], v47 offset:0
    ds_read_b64_tr_b16 v[58:59], v47 offset:512
    ds_read_b64_tr_b16 v[60:61], v47 offset:8192
    ds_read_b64_tr_b16 v[62:63], v47 offset:8704
    ds_read_b64_tr_b16 v[64:65], v48 offset:0
    ds_read_b64_tr_b16 v[66:67], v48 offset:512
    ds_read_b64_tr_b16 v[68:69], v48 offset:8192
    ds_read_b64_tr_b16 v[70:71], v48 offset:8704
    s_waitcnt lgkmcnt(0)
    s_barrier
    s_add_u32 s40, s72, 131072
    v_add_u32 v47, s40, v19
    ds_write_b128 v47, v[56:59] offset:0
    ds_write_b128 v47, v[60:63] offset:1024
    ds_write_b128 v47, v[64:67] offset:2048
    ds_write_b128 v47, v[68:71] offset:3072
    s_waitcnt lgkmcnt(0)
    s_waitcnt vmcnt(8)
    s_barrier
    v_add_u32 v47, 147456, v32
    v_add_u32 v48, 147456, v33
    ds_read_b64_tr_b16 v[56:57], v47 offset:0
    ds_read_b64_tr_b16 v[58:59], v47 offset:512
    ds_read_b64_tr_b16 v[60:61], v47 offset:8192
    ds_read_b64_tr_b16 v[62:63], v47 offset:8704
    ds_read_b64_tr_b16 v[64:65], v48 offset:0
    ds_read_b64_tr_b16 v[66:67], v48 offset:512
    ds_read_b64_tr_b16 v[68:69], v48 offset:8192
    ds_read_b64_tr_b16 v[70:71], v48 offset:8704
    s_waitcnt lgkmcnt(0)
    s_barrier
    s_add_u32 s40, s72, 147456
    v_add_u32_e64 v47, s40, v19
    ds_write_b128 v47, v[56:59] offset:0
    ds_write_b128 v47, v[60:63] offset:1024
    ds_write_b128 v47, v[64:67] offset:2048
    ds_write_b128 v47, v[68:71] offset:3072
    s_waitcnt lgkmcnt(0)
    ds_write_b128 v20, v[76:79]
    ds_write_b32 v53, v80 offset:4092
    v_and_b32 v93, 7, v92
    v_bfe_u32 v94, v92, 4, 1
    v_lshlrev_b32 v94, 2, v94
    v_sub_u32 v93, v93, v94
    v_mov_b32 v94, 0x3f80
    v_mov_b32 v95, 0x3f800000
    v_cmp_eq_u32 vcc, 0, v93
    s_nop 1
    v_cndmask_b32 v16, 0, v94, vcc
    v_cmp_eq_u32 vcc, 1, v93
    s_nop 1
    v_cndmask_b32 v16, v16, v95, vcc
    v_cmp_eq_u32 vcc, 2, v93
    s_nop 1
    v_cndmask_b32 v17, 0, v94, vcc
    v_cmp_eq_u32 vcc, 3, v93
    s_nop 1
    v_cndmask_b32_e64 v17, v17, v95, vcc
    s_mov_b32 s44, 0xff00ff00
    s_mov_b32 s45, 0xff00ff00
    s_mov_b32 s46, 0x00ff00ff
    s_mov_b32 s47, 0x00ff00ff
    s_mov_b32 s48, 0x00330033
    s_mov_b32 s49, 0x00330033
    v_mov_b32 v93, 0x4444
    v_mov_b32 v94, 0xeeee
    v_cndmask_b32 v18, v93, v94, s[44:45]
    s_mov_b32 s40, 0xcccccccc
    s_mov_b32 s41, 0xcccccccc
    v_cndmask_b32 v93, v93, v94, s[40:41]
    v_lshl_add_u32 v18, v93, 16, v18
    s_add_u32 s40, s72, 16384
    v_add_u32 v21, s40, v19
    s_lshr_b32 s40, s5, 1
    s_lshl_b32 s40, s40, 10
    s_and_b32 s41, s5, 1
    s_lshl_b32 s41, s41, 5
    s_add_u32 s40, s40, s41
    s_add_u32 s40, s40, 5120
    v_and_b32 v93, 0x60, v19
    v_and_b32 v94, 0x310, v19
    v_lshl_add_u32 v93, v93, 1, v94
    v_add_u32 v22, s40, v93
    v_lshrrev_b32 v93, 2, v92
    s_lshl_b32 s40, s5, 4
    v_add_u32 v93, s40, v93
    v_and_b32_e64 v94, 0x30, v19
    v_lshl_add_u32 v23, v93, 11, v94
    s_mov_b32 s60, 0x03030303
    s_mov_b32 s61, 0x03030303
    s_mov_b32 s62, 0x0c0c0c0c
    s_mov_b32 s63, 0x0c0c0c0c
    s_mov_b32 s64, 0x30303030
    s_mov_b32 s65, 0x30303030
    s_mov_b32 s66, 0xc0c0c0c0
    s_mov_b32 s67, 0xc0c0c0c0
    s_mov_b32 s76, 0xaaaaaaaa
    s_mov_b32 s77, 0xaaaaaaaa
    s_mov_b32 s50, 0x3e0293ee
    s_mov_b32 s20, 0
    s_mov_b32 s21, 0
    s_mov_b32 m0, 14336
    s_mov_b32 s22, 0
    s_mov_b32 s52, 0
    s_mov_b32 s54, s50
    s_mov_b32 s55, s50
    s_waitcnt vmcnt(0)
    v_and_b32 v5, 63, v4
    v_cmp_eq_u32 vcc, 32, v5
    v_min_u32 v0, v0, v2
    v_min3_u32 v0, v0, v1, v3
    v_lshlrev_b32_e64 v0, 1, v0
    s_and_b32 s40, vcc_lo, 0x1fe
    v_readfirstlane_b32 s79, v0
    s_cmp_lg_u32 s40, 0x1fe
    s_cbranch_scc1 R_slow_81
    s_cmp_gt_u32 s79, 2
    s_cbranch_scc1 R_go_82
R_slow_81:
    v_mbcnt_lo_u32_b32 v89, -1, 0
    v_and_b32 v89, 7, v89
    v_lshlrev_b32 v89, 2, v89
wa_83:
    buffer_load_dword v88, v89, s[12:15], 0 offen offset:4 sc1
    s_waitcnt vmcnt(0)
    v_and_b32 v88, 63, v88
    v_cmp_ne_u32 vcc, 32, v88
    s_cbranch_vccz waok_84
    s_sleep 2
    s_add_u32 s6, s6, 1
    s_cmp_lt_u32 s6, 400000
    s_cbranch_scc1 wa_83
    s_branch waok_84
waok_84:
    s_mov_b32 s79, 0
    s_add_u32 s40, s20, 2
    s_min_u32 s40, s40, 63
fp_85:
    s_cmp_lt_u32 s40, s79
    s_cbranch_scc1 fpok_86
    v_mov_b32 v52, 0
    buffer_load_dwordx4 v[48:51], v52, s[8:11], s37 offen sc1
    s_waitcnt vmcnt(0)
    v_min_u32 v48, v48, v50
    v_min3_u32 v48, v48, v49, v51
    v_lshlrev_b32 v48, 1, v48
    s_nop 0
    v_readfirstlane_b32 s79, v48
    s_add_u32 s6, s6, 1
    s_cmp_lt_u32 s6, 400000
    s_cbranch_scc1 fp_85
    s_branch fpok_86
fpok_86:
    buffer_load_dword v4, v7, s[12:15], 0 offen sc1
    v_lshlrev_b32_e64 v6, 3, v19
    s_sub_u32 s40, s36, 0x80000
    s_add_u32 s41, s40, 0x1000000
    buffer_load_dword v5, v6, s[8:11], s40 offen sc1
    buffer_load_dword v5, v6, s[8:11], s41 offen sc1
    s_sub_u32 s40, s36, 0x40000
    s_add_u32 s41, s40, 0x1000000
    buffer_load_dword v5, v6, s[8:11], s40 offen sc1
    buffer_load_dword v5, v6, s[8:11], s41 offen sc1
    buffer_load_dwordx4 v[8:11], v19, s[8:11], s51 offen offset:0 sc1
    buffer_load_dwordx4 v[12:15], v19, s[8:11], s51 offen offset:1024 sc1
    s_waitcnt vmcnt(0)
R_go_82:
    s_add_u32 s40, s3, 1
    v_readlane_b32 s40, v4, s40
    v_readlane_b32 s42, v4, 10
    s_bfe_u32 s41, s40, 0x90006
    s_mul_i32 s41, s41, s41
    s_lshr_b32 s40, s40, 15
    s_lshl_b32 s40, s40, 5
    s_cmp_eq_u32 s40, s41
    s_cselect_b32 s39, 1, 0
    v_readlane_b32 s43, v4, 1
    s_nop 0
    s_xor_b32 s42, s42, s43
    s_and_b32 s42, s42, 0x2000
    s_add_u32 s31, s31, s42
    s_add_u32 s56, s33, s42
    s_mov_b32 s33, s75
    v_mov_b32 v48, v84
    v_mov_b32 v49, v85
    v_mov_b32 v50, v86
    v_mov_b32 v51, v87
    v_mov_b32 v52, v81
    v_lshrrev_b32 v53, 2, v20
    v_add_u32 v53, 4, v53
    v_mov_b32 v24, 0
    v_mov_b32 v25, 0
    v_mov_b32 v26, 0
    v_mov_b32 v27, 0
    v_mov_b32 v28, 0
    v_mov_b32 v29, 0
    v_mov_b32 v30, 0
    v_mov_b32 v31, 0
    v_mov_b32 v32, 0
    v_mov_b32 v33, 0
    v_mov_b32 v34, 0
    v_mov_b32 v35, 0
    v_mov_b32 v36, 0
    v_mov_b32 v37, 0
    v_mov_b32 v38, 0
    v_mov_b32 v39, 0
    v_mov_b32 v40, 0
    v_mov_b32 v41, 0
    v_mov_b32 v42, 0
    v_mov_b32 v43, 0
    v_mov_b32 v44, 0
    v_mov_b32 v45, 0
    v_mov_b32 v46, 0
    v_mov_b32 v47, 0
    v_mov_b32 v92, 0
    v_mov_b32 v93, 0
    v_mov_b32 v94, 0
    v_mov_b32_e64 v95, 0
    ds_read_b128 v[76:79], v21 offset:0
    ds_read_b128 v[80:83], v21 offset:1024
    ds_read_b128 v[84:87], v21 offset:2048
    ds_read_b128 v[88:91], v21 offset:3072
    s_waitcnt vmcnt(0) lgkmcnt(0)
    s_barrier
    s_cmp_lg_u32 s39, 1
    s_cbranch_scc1 R_safe_104
    s_cmp_eq_u32 s3, 1
    s_cbranch_scc1 R_s11_101
R_s10_100:
    s_cmp_eq_u32 s5, 2
    s_cbranch_scc1 R_v10h_89
    s_cmp_eq_u32 s5, 3
    s_cbranch_scc1 R_v10w3_90
    s_branch R_v10r_88
R_s11_101:
    s_cmp_eq_u32 s5, 2
    s_cbranch_scc1 R_v11h_92
    s_cmp_eq_u32 s5, 3
    s_cbranch_scc1 R_v11w3_93
    s_branch R_v11r_91
R_safe_104:
    s_cmp_eq_u32 s3, 1
    s_cbranch_scc1 R_s01_103
R_s00_102:
    s_cmp_eq_u32 s5, 2
    s_cbranch_scc1 R_v00h_95
    s_cmp_eq_u32 s5, 3
    s_cbranch_scc1 R_v00w3_96
    s_branch R_v00r_94
R_s01_103:
    s_cmp_eq_u32 s5, 2
    s_cbranch_scc1 R_v01h_98
    s_cmp_eq_u32 s5, 3
    s_cbranch_scc1 R_v01w3_99
    s_branch R_v01r_97
R_v10r_88:
    s_branch R_ent_106
.p2align 6
R_top_105:
    buffer_load_dwordx4 v[0:3], v20, s[8:11], s32 offen sc1
    buffer_load_dword v4, v53, s[8:11], s32 offen offset:4092 sc1
    s_nop 15
    s_nop 8
    buffer_load_dwordx4 v[48:51], v20, s[8:11], s32 offen sc1
    buffer_load_dword v52, v53, s[8:11], s32 offen offset:4092 sc1
R_pa_109:
    s_waitcnt vmcnt(2)
    ds_write_b128 v20, v[0:3]
    ds_write_b32 v53, v4 offset:4092
    v_bitop3_b32 v56, v0, v1, s22 bitop3:0x7e
    v_bitop3_b32 v57, v2, v3, s22 bitop3:0x7e
    v_bitop3_b32 v56, v4, v56, s22 bitop3:0xde
    v_bitop3_b32 v56, v56, v57, 1 bitop3:0xa8
    v_cmp_ne_u32 vcc, 0, v56
    s_cbranch_vccnz R_par_111
R_paok_110:
    buffer_load_dwordx4 v[48:51], v20, s[8:11], s33 offen sc1
    buffer_load_dword v52, v53, s[8:11], s33 offen offset:4092 sc1
    s_waitcnt lgkmcnt(0)
    s_barrier
R_ent_106:
    ds_read_b128 v[56:59], v19 offset:0
    ds_read_b128 v[60:63], v19 offset:1024
    ds_read_b128 v[64:67], v19 offset:2048
    ds_read_b128 v[68:71], v19 offset:3072
    ds_read_b128 v[72:75], v19 offset:4096
    s_waitcnt lgkmcnt(4)
    v_smfmac_f32_16x16x64_bf16 v[24:27], v[56:59], v[76:83], v18
    ds_read_b128 v[76:79], v21 offset:16384
    s_xor_b32 s21, s21, 1
    buffer_load_dwordx4 v[0:3], v19, s[8:11], s34 offen offset:0 sc1
    v_smfmac_f32_16x16x64_bf16 v[28:31], v[56:59], v[84:91], v18
    ds_read_b128 v[80:83], v21 offset:17408
    s_min_u32 s40, s20, 1
    buffer_load_dwordx4 v[4:7], v19, s[8:11], s34 offen offset:1024 sc1
    v_smfmac_f32_16x16x64_bf16 v[32:35], v[56:59], a[112:119], v18
    ds_read_b128 v[84:87], v21 offset:18432
    s_lshl_b32 s41, s40, 17
    v_smfmac_f32_16x16x64_bf16 v[36:39], v[56:59], a[120:127], v18
    ds_read_b128 v[88:91], v21 offset:19456
    s_waitcnt lgkmcnt(7)
    v_smfmac_f32_16x16x64_bf16 v[24:27], v[60:63], a[0:7], v18
    buffer_load_dwordx4 v[8:11], v20, s[8:11], s33 offen sc1
    v_smfmac_f32_16x16x64_bf16 v[28:31], v[60:63], a[8:15], v18
    buffer_load_dword v12, v53, s[8:11], s33 offen offset:4092 sc1
    s_waitcnt lgkmcnt(2)
    v_smfmac_f32_16x16x64_bf16 v[32:35], v[60:63], v[76:83], v18
    ds_read_b128 v[76:79], v21 offset:32768
    s_waitcnt lgkmcnt(1)
    v_smfmac_f32_16x16x64_bf16 v[36:39], v[60:63], v[84:91], v18
    ds_read_b128 v[80:83], v21 offset:33792
    v_smfmac_f32_16x16x64_bf16 v[24:27], v[64:67], a[16:23], v18
    ds_read_b128 v[84:87], v21 offset:34816
    v_smfmac_f32_16x16x64_bf16 v[28:31], v[64:67], a[24:31], v18
    ds_read_b128 v[88:91], v21 offset:35840
    v_smfmac_f32_16x16x64_bf16 v[32:35], v[64:67], a[128:135], v18
    v_smfmac_f32_16x16x64_bf16 v[36:39], v[64:67], a[136:143], v18
    s_waitcnt lgkmcnt(2)
    v_smfmac_f32_16x16x64_bf16 v[24:27], v[68:71], v[76:83], v18
    ds_read_b128 v[76:79], v21 offset:49152
    s_waitcnt lgkmcnt(1)
    v_smfmac_f32_16x16x64_bf16 v[28:31], v[68:71], v[84:91], v18
    ds_read_b128 v[80:83], v21 offset:50176
    v_smfmac_f32_16x16x64_bf16 v[32:35], v[68:71], a[144:151], v18
    ds_read_b128 v[84:87], v21 offset:51200
    v_smfmac_f32_16x16x64_bf16 v[36:39], v[68:71], a[152:159], v18
    ds_read_b128 v[88:91], v21 offset:52224
    v_smfmac_f32_16x16x64_bf16 v[24:27], v[72:75], a[32:39], v18
    v_add_u32 v21, 0x10000, v21
    buffer_store_dwordx4 v[92:95], v19, s[8:11], s35 offen sc1
    v_smfmac_f32_16x16x64_bf16 v[28:31], v[72:75], a[40:47], v18
    s_add_u32 s35, s35, s41
    s_add_u32 s51, s34, 0x1000000
    s_waitcnt lgkmcnt(2)
    v_smfmac_f32_16x16x64_bf16 v[32:35], v[72:75], v[76:83], v18
    ds_read_b128 v[76:79], v21 offset:0
    s_add_u32 s34, s34, 0x40000
    s_waitcnt lgkmcnt(1)
    v_smfmac_f32_16x16x64_bf16 v[36:39], v[72:75], v[84:91], v18
    ds_read_b128 v[80:83], v21 offset:1024
    v_smfmac_f32_16x16x64_bf16 v[40:43], v[56:59], a[208:215], v18
    ds_read_b128 v[84:87], v21 offset:2048
    v_smfmac_f32_16x16x64_bf16 v[44:47], v[56:59], a[216:223], v18
    ds_read_b128 v[88:91], v21 offset:3072
    s_waitcnt vmcnt(3)
    ds_write_b128 v20, v[48:51] offset:5120
    ds_write_b32 v53, v52 offset:9212
    v_smfmac_f32_16x16x64_bf16 v[40:43], v[60:63], a[224:231], v18
    v_bitop3_b32 v54, v48, v49, s22 bitop3:0x7e
    v_bitop3_b32 v55, v50, v51, s22 bitop3:0x7e
    v_smfmac_f32_16x16x64_bf16 v[44:47], v[60:63], a[232:239], v18
    v_bitop3_b32 v54, v52, v54, s22 bitop3:0xde
    v_bitop3_b32 v54, v54, v55, s52 bitop3:0xa8
    s_waitcnt lgkmcnt(4)
    v_smfmac_f32_16x16x64_bf16 v[40:43], v[64:67], v[76:83], v18
    v_cmp_ne_u32_e64 vcc, 0, v54
    s_waitcnt lgkmcnt(2)
    v_smfmac_f32_16x16x64_bf16 v[44:47], v[64:67], v[84:91], v18
    s_cbranch_vccnz R_pcr_114
R_pcok_113:
    s_waitcnt lgkmcnt(0)
    s_barrier
    ds_read_b128 v[56:59], v19 offset:5120
    ds_read_b128 v[60:63], v19 offset:6144
    v_smfmac_f32_16x16x64_bf16 v[40:43], v[68:71], a[240:247], v18
    ds_read_b128 v[64:67], v19 offset:7168
    v_smfmac_f32_16x16x64_bf16 v[44:47], v[68:71], a[248:255], v18
    ds_read_b128 v[68:71], v19 offset:8192
    v_smfmac_f32_16x16x64_bf16 v[40:43], v[72:75], v[96:103], v18
    v_smfmac_f32_16x16x64_bf16 v[44:47], v[72:75], v[104:111], v18
    ds_read_b128 v[72:75], v19 offset:9216
    s_waitcnt lgkmcnt(4)
    v_smfmac_f32_16x16x64_bf16 v[24:27], v[56:59], a[48:55], v18
    ds_read_b128 v[76:79], v21 offset:16384
    s_andn2_b32 s40, 1, s20
    v_smfmac_f32_16x16x64_bf16 v[28:31], v[56:59], a[56:63], v18
    ds_read_b128 v[80:83], v21 offset:17408
    s_xor_b32 s22, s22, s40
    s_waitcnt lgkmcnt(5)
    v_smfmac_f32_16x16x64_bf16 v[24:27], v[60:63], a[64:71], v18
    ds_read_b128 v[84:87], v21 offset:18432
    s_mov_b32 s52, 1
    v_smfmac_f32_16x16x64_bf16 v[28:31], v[60:63], a[72:79], v18
    ds_read_b128 v[88:91], v21 offset:19456
    s_min_u32 s40, s20, 1
    s_waitcnt lgkmcnt(6)
    v_smfmac_f32_16x16x64_bf16 v[24:27], v[64:67], a[80:87], v18
    buffer_load_dwordx4 v[8:11], v19, s[8:11], s51 offen offset:0 sc1
    v_smfmac_f32_16x16x64_bf16 v[28:31], v[64:67], a[88:95], v18
    buffer_load_dwordx4 v[12:15], v19, s[8:11], s51 offen offset:1024 sc1
    s_mov_b32 s33, s56
    s_waitcnt lgkmcnt(2)
    v_smfmac_f32_16x16x64_bf16 v[24:27], v[68:71], v[76:83], v18
    ds_read_b128 v[76:79], v21 offset:32768
    s_xor_b32 s56, s56, 0x4000
    s_waitcnt lgkmcnt(1)
    v_smfmac_f32_16x16x64_bf16 v[28:31], v[68:71], v[84:91], v18
    ds_read_b128 v[80:83], v21 offset:33792
    s_xor_b32 s32, s32, 0x4000
    v_smfmac_f32_16x16x64_bf16 v[24:27], v[72:75], a[96:103], v18
    ds_read_b128 v[84:87], v21 offset:34816
    v_smfmac_f32_16x16x64_bf16 v[28:31], v[72:75], a[104:111], v18
    ds_read_b128 v[88:91], v21 offset:35840
    v_smfmac_f32_16x16x64_bf16 v[32:35], v[56:59], a[160:167], v18
    v_smfmac_f32_16x16x64_bf16 v[36:39], v[56:59], a[168:175], v18
    s_waitcnt lgkmcnt(2)
    v_smfmac_f32_16x16x64_bf16 v[32:35], v[60:63], v[76:83], v18
    ds_read_b128 v[76:79], v21 offset:49152
    s_waitcnt lgkmcnt(1)
    v_smfmac_f32_16x16x64_bf16 v[36:39], v[60:63], v[84:91], v18
    ds_read_b128 v[80:83], v21 offset:50176
    v_cvt_pk_bf16_f32 v48, v24, v25
    v_smfmac_f32_16x16x64_bf16 v[32:35], v[64:67], a[176:183], v18
    ds_read_b128 v[84:87], v21 offset:51200
    v_cvt_pk_bf16_f32 v49, v26, v27
    v_smfmac_f32_16x16x64_bf16 v[36:39], v[64:67], a[184:191], v18
    ds_read_b128 v[88:91], v21 offset:52224
    v_cvt_pk_bf16_f32 v50, v28, v29
    v_smfmac_f32_16x16x64_bf16 v[32:35], v[68:71], a[192:199], v18
    v_cvt_pk_bf16_f32 v51, v30, v31
    v_smfmac_f32_16x16x64_bf16 v[36:39], v[68:71], a[200:207], v18
    v_add_u32 v21, 0x10000, v21
    s_waitcnt lgkmcnt(2)
    v_smfmac_f32_16x16x64_bf16 v[32:35], v[72:75], v[76:83], v18
    ds_read_b128 v[76:79], v21 offset:0
    s_waitcnt lgkmcnt(1)
    v_smfmac_f32_16x16x64_bf16 v[36:39], v[72:75], v[84:91], v18
    ds_read_b128 v[80:83], v21 offset:1024
    v_mfma_f32_16x16x16_bf16 v[24:27], v[48:49], v[16:17], 0
    ds_read_b128 v[84:87], v21 offset:2048
    v_mfma_f32_16x16x16_bf16 v[28:31], v[50:51], v[16:17], 0
    ds_read_b128 v[88:91], v21 offset:3072
    v_cvt_pk_bf16_f32 v52, v32, v33
    v_cvt_pk_bf16_f32 v53, v34, v35
    v_cvt_pk_bf16_f32 v54, v36, v37
    v_cvt_pk_bf16_f32 v55, v38, v39
    v_mfma_f32_16x16x16_bf16 v[32:35], v[52:53], v[16:17], 0
    v_cvt_pk_bf16_f32 v48, v24, v25
    v_mfma_f32_16x16x16_bf16 v[36:39], v[54:55], v[16:17], 0
    v_cvt_pk_bf16_f32 v49, v26, v27
    v_cvt_pk_bf16_f32 v50, v28, v29
    v_cvt_pk_bf16_f32 v51, v30, v31
    s_nop 1
    v_mfma_f32_16x16x32_bf16 v[24:27], v[0:3], v[48:51], 0
    v_mfma_f32_16x16x32_bf16 v[28:31], v[4:7], v[48:51], 0
    v_cvt_pk_bf16_f32 v92, v32, v33
    v_cvt_pk_bf16_f32 v93, v34, v35
    v_cvt_pk_bf16_f32 v94, v36, v37
    v_cvt_pk_bf16_f32 v95, v38, v39
    s_nop 1
    v_mfma_f32_16x16x32_bf16 v[32:35], v[92:95], v[48:51], 0
    s_nop 2
    v_cndmask_b32 v24, v24, v28, s[44:45]
    v_cndmask_b32 v25, v25, v29, s[44:45]
    v_cndmask_b32 v26, v26, v30, s[44:45]
    v_cndmask_b32 v27, v27, v31, s[44:45]
    ds_write_b128 v20, v[24:27] offset:10240
    v_cndmask_b32 v32, v32, v34, s[44:45]
    v_cndmask_b32 v33, v33, v35, s[44:45]
    ds_write_b64 v20, v[32:33] offset:0
    v_smfmac_f32_16x16x64_bf16 v[40:43], v[56:59], v[112:119], v18
    v_xor_b32 v52, 0x400, v20
    v_smfmac_f32_16x16x64_bf16 v[44:47], v[56:59], v[120:127], v18
    v_xor_b32 v54, 0x800, v20
    v_smfmac_f32_16x16x64_bf16 v[40:43], v[60:63], v[128:135], v18
    v_xor_b32 v34, 0xc00, v20
    v_smfmac_f32_16x16x64_bf16 v[44:47], v[60:63], v[136:143], v18
    v_smfmac_f32_16x16x64_bf16 v[40:43], v[64:67], v[144:151], v18
    s_cmp_eq_u32 s20, 63
    s_cbranch_scc1 R_exit_107
    s_waitcnt lgkmcnt(0)
    s_barrier
    ds_read_b128 v[28:31], v52 offset:10240
    ds_read_b64 v[52:53], v52 offset:0
    v_smfmac_f32_16x16x64_bf16 v[44:47], v[64:67], v[152:159], v18
    ds_read_b128 v[36:39], v54 offset:10240
    v_smfmac_f32_16x16x64_bf16 v[40:43], v[68:71], v[160:167], v18
    ds_read_b64 v[54:55], v54 offset:0
    v_smfmac_f32_16x16x64_bf16 v[44:47], v[68:71], v[168:175], v18
    ds_read_b128 v[48:51], v34 offset:10240
    v_smfmac_f32_16x16x64_bf16 v[40:43], v[72:75], v[76:83], v18
    ds_read_b64 v[34:35], v34 offset:0
    v_smfmac_f32_16x16x64_bf16 v[44:47], v[72:75], v[84:91], v18
    s_waitcnt lgkmcnt(5)
    v_pk_add_f32 v[24:25], v[24:25], v[28:29]
    v_pk_add_f32 v[26:27], v[26:27], v[30:31]
    s_waitcnt lgkmcnt(4)
    v_pk_add_f32 v[32:33], v[32:33], v[52:53]
    s_waitcnt lgkmcnt(1)
    v_pk_add_f32 v[36:37], v[36:37], v[48:49]
    v_pk_add_f32 v[38:39], v[38:39], v[50:51]
    s_waitcnt lgkmcnt(0)
    v_pk_add_f32 v[54:55], v[54:55], v[34:35]
    v_pk_add_f32 v[24:25], v[24:25], v[36:37]
    v_pk_add_f32 v[26:27], v[26:27], v[38:39]
    v_pk_add_f32 v[32:33], v[32:33], v[54:55]
    v_max3_f32 v34, v24, v25, v26
    v_max3_f32 v34, v34, v27, v32
    v_max_f32_e64 v34, v34, v33
    v_cvt_pk_bf16_f32 v76, v40, v41
    v_cvt_pk_bf16_f32 v77, v42, v43
    v_max_f32_dpp v34, v34, v34 row_ror:8 row_mask:0xf bank_mask:0xf
    v_mov_b32_e64 v35, v34
    v_cvt_pk_bf16_f32 v78, v44, v45
    v_cvt_pk_bf16_f32 v79, v46, v47
    v_permlane16_swap_b32 v34, v35
    v_max_f32 v34, v34, v35
    v_mov_b32 v35, v34
    v_mov_b32 v56, 0
    v_mov_b32 v57, 0
    v_permlane32_swap_b32 v34, v35
    v_max_f32 v34, v34, v35
    v_mul_f32 v34, s50, v34
    v_pk_fma_f32 v[24:25], v[24:25], s[54:55], v[34:35] op_sel_hi:[1,1,0] neg_lo:[0,0,1] neg_hi:[0,0,1]
    v_pk_fma_f32 v[26:27], v[26:27], s[54:55], v[34:35] op_sel_hi:[1,1,0] neg_lo:[0,0,1] neg_hi:[0,0,1]
    v_pk_fma_f32 v[32:33], v[32:33], s[54:55], v[34:35] op_sel_hi:[1,1,0] neg_lo:[0,0,1] neg_hi:[0,0,1]
    v_exp_f32 v24, v24
    v_exp_f32 v25, v25
    v_exp_f32 v26, v26
    v_exp_f32 v27, v27
    v_exp_f32 v32, v32
    v_exp_f32 v33, v33
    v_cvt_pk_bf16_f32 v48, v24, v25
    v_cvt_pk_bf16_f32 v49, v26, v27
    v_cvt_pk_bf16_f32 v52, v32, v33
    v_mov_b32_dpp v50, v48 row_ror:8 row_mask:0xf bank_mask:0xf
    v_mov_b32_dpp v51, v49 row_ror:8 row_mask:0xf bank_mask:0xf
    v_mov_b32_dpp v53, v52 row_ror:8 row_mask:0xf bank_mask:0xf
    v_pk_add_f32 v[24:25], v[24:25], v[26:27]
    s_waitcnt vmcnt(0)
    v_mfma_f32_16x16x32_bf16 v[28:31], v[8:11], v[48:51], 0
    v_add_f32 v32, v32, v33
    v_add_f32_e64 v24, v24, v25
    v_mfma_f32_16x16x32_bf16 v[36:39], v[12:15], v[48:51], 0
    v_fma_f32 v34, v32, 0.5, v24
    v_mfma_f32_16x16x16_bf16 v[28:31], v[76:77], v[52:53], v[28:31]
    v_mov_b32_e64 v58, 0
    v_add_f32_dpp v34, v34, v34 row_ror:8 row_mask:0xf bank_mask:0xf
    v_mfma_f32_16x16x16_bf16 v[36:39], v[78:79], v[52:53], v[36:39]
    v_mov_b32 v35, v34
    v_mov_b32 v59, 0
    v_mov_b32 v60, 0
    v_permlane16_swap_b32 v34, v35
    v_add_f32 v34, v34, v35
    v_mov_b32 v35, v34
    v_mov_b32 v61, 0
    v_mov_b32 v62, 0
    v_permlane32_swap_b32 v34, v35
    v_add_f32 v34, v34, v35
    v_rcp_f32 v34, v34
    s_mov_b64 exec, s[46:47]
    v_pk_mul_f32 v[28:29], v[28:29], v[34:35] op_sel_hi:[1,0]
    v_pk_mul_f32 v[30:31], v[30:31], v[34:35] op_sel_hi:[1,0]
    v_pk_mul_f32 v[36:37], v[36:37], v[34:35] op_sel_hi:[1,0]
    v_pk_mul_f32 v[38:39], v[38:39], v[34:35] op_sel_hi:[1,0]
    v_cvt_pk_bf16_f32 v24, v28, v29
    v_cvt_pk_bf16_f32 v25, v30, v31
    v_cvt_pk_bf16_f32 v26, v36, v37
    v_cvt_pk_bf16_f32 v27, v38, v39
    ds_write_b128 v22, v[24:27]
    s_mov_b64 exec, -1
    v_mov_b32 v63, 0
    v_mov_b32 v64, 0
    v_mov_b32 v65, 0
    v_mov_b32 v66, 0
    v_mov_b32 v67, 0
    v_mov_b32 v68, 0
    v_mov_b32 v69, 0
    v_mov_b32 v70, 0
    v_mov_b32 v71, 0
    v_mov_b32 v72, 0
    v_mov_b32 v73, 0
    v_mov_b32 v74, 0
    v_mov_b32 v75, 0
    s_waitcnt lgkmcnt(0)
    s_barrier
    ds_read_b128 v[48:51], v19 offset:5120
    ds_read_b128 v[52:55], v19 offset:6144
    v_subrev_u32 v21, 0x20000, v21
    v_lshrrev_b32_e64 v24, 8, v19
    v_bfe_u32 v25, v19, 2, 6
    v_lshl_add_u32 v24, v24, 13, v25
    s_waitcnt lgkmcnt(1)
    v_smfmac_f32_16x16x64_bf16 v[56:59], v[48:51], v[176:183], v18 abid:1
    s_waitcnt lgkmcnt(0)
    v_smfmac_f32_16x16x64_bf16 v[56:59], v[52:55], v[216:223], v18 abid:1
    v_smfmac_f32_16x16x64_bf16 v[60:63], v[48:51], v[184:191], v18 abid:1
    v_smfmac_f32_16x16x64_bf16 v[60:63], v[52:55], v[224:231], v18 abid:1
    v_add_f32_e64 v56, v56, v58
    v_smfmac_f32_16x16x64_bf16 v[64:67], v[48:51], v[192:199], v18 abid:1
    v_add_f32_e64 v57, v57, v59
    v_smfmac_f32_16x16x64_bf16 v[64:67], v[52:55], v[232:239], v18 abid:1
    v_cvt_pk_bf16_f32 v28, v56, v57
    v_add_f32_e64 v60, v60, v62
    v_smfmac_f32_16x16x64_bf16 v[68:71], v[48:51], v[200:207], v18 abid:1
    v_add_f32_e64 v61, v61, v63
    v_bfi_b32 v28, 1, s21, v28
    v_smfmac_f32_16x16x64_bf16 v[68:71], v[52:55], v[240:247], v18 abid:1
    v_cvt_pk_bf16_f32 v29, v60, v61
    v_add_f32_e64 v64, v64, v66
    v_smfmac_f32_16x16x64_bf16 v[72:75], v[48:51], v[208:215], v18 abid:1
    v_add_f32_e64 v65, v65, v67
    v_smfmac_f32_16x16x64_bf16 v[72:75], v[52:55], v[248:255], v18 abid:1
    v_add_f32_e64 v68, v68, v70
    v_add_f32 v69, v69, v71
    v_cvt_pk_bf16_f32 v30, v64, v65
    v_cvt_pk_bf16_f32 v31, v68, v69
    buffer_store_dwordx4 v[28:31], v23, s[8:11], s27 offen
    s_nop 2
    v_pk_add_f32 v[72:73], v[72:73], v[74:75]
    v_cvt_pk_bf16_f32 v72, v72, v73
    v_bfi_b32 v72, 1, s21, v72
    buffer_store_dword v72, v24, s[8:11], s28 offen
    s_cmp_lt_u32 s20, 58
    s_cbranch_scc1 R_noearly_116
    buffer_store_dwordx4 v[92:95], v19, s[8:11], s35 offen sc1
R_noearly_116:
    v_mov_b32 v24, 0
    v_mov_b32 v25, 0
    v_mov_b32 v26, 0
    v_mov_b32 v27, 0
    v_mov_b32 v28, 0
    v_mov_b32 v29, 0
    v_mov_b32 v30, 0
    v_mov_b32 v31, 0
    v_mov_b32 v32, 0
    v_mov_b32 v33, 0
    v_mov_b32 v34, 0
    v_mov_b32 v35, 0
    v_mov_b32 v36, 0
    v_mov_b32 v37, 0
    v_mov_b32 v38, 0
    v_mov_b32 v39, 0
    v_mov_b32 v40, 0
    v_mov_b32 v41, 0
    v_mov_b32 v42, 0
    v_mov_b32 v43, 0
    v_mov_b32 v44, 0
    v_mov_b32 v45, 0
    v_mov_b32 v46, 0
    v_mov_b32 v47, 0
    ds_read_b128 v[76:79], v21 offset:0
    buffer_load_dwordx4 v[56:59], v19, s[8:11], s29 offen offset:0 sc1
    buffer_load_dwordx4 v[60:63], v19, s[8:11], s29 offen offset:1024 sc1
    ds_read_b128 v[80:83], v21 offset:1024
    ds_read_b128 v[84:87], v21 offset:2048
    ds_read_b128 v[88:91], v21 offset:3072
    v_lshrrev_b32_e64 v53, 2, v20
    v_add_u32 v53, 4, v53
    s_add_u32 s20, s20, 1
    v_mov_b32 v54, 0xfffe0000
    v_lshrrev_b32_e64 v48, 2, v19
    v_and_b32 v48, 0x80, v48
    v_and_or_b32 v55, v19, 16, v48
    v_lshrrev_b32_e64 v48, 5, v19
    v_and_or_b32 v55, v48, 8, v55
    v_lshrrev_b32_e64 v48, 4, v19
    v_and_or_b32 v55, v48, 4, v55
    v_mov_b32 v48, 0x3f80
    v_cndmask_b32 v48, v48, 1.0, s[76:77]
    v_cndmask_b32 v64, 0, v48, s[60:61]
    v_cndmask_b32 v65, 0, v48, s[62:63]
    v_cndmask_b32 v66, 0, v48, s[64:65]
    v_cndmask_b32 v67, 0, v48, s[66:67]
    s_lshl_b32 s26, s22, 16
    s_sub_u32 s24, 0x10000, s26
    s_nop 7
    buffer_load_dwordx4 v[0:3], v19, s[8:11], s29 offen offset:0 sc1
    buffer_load_dwordx4 v[4:7], v19, s[8:11], s29 offen offset:1024 sc1
R_pi_119:
    s_waitcnt vmcnt(3)
    v_mfma_f32_16x16x32_bf16 v[68:71], v[56:59], v[64:67], 0
    s_waitcnt vmcnt(2)
    v_mfma_f32_16x16x32_bf16 v[68:71], v[60:63], v[64:67], v[68:71]
    v_bitop3_b32 v48, v56, v60, s21 bitop3:0x7e
    v_and_b32 v48, 1, v48
    v_cmp_ne_u32 vcc, 0, v48
    s_cbranch_vccnz R_pir_121
R_piok_120:
    s_nop 3
    v_permlane32_swap_b32 v68, v70
    v_permlane32_swap_b32 v69, v71
    v_pk_add_f32 v[68:69], v[68:69], v[70:71]
    s_nop 1
    v_permlane16_swap_b32 v68, v69
    v_add_f32_e64 v68, v68, v69
    v_add_u32 v70, s24, v68
    v_bfi_b32 v70, v54, v70, s26
    v_mov_b32_dpp v69, v68 row_shl:2 row_mask:0xf bank_mask:0xf
    s_mov_b64 exec, s[48:49]
    v_cvt_pk_bf16_f32 v70, v70, v69
    buffer_store_dword v70, v55, s[8:11], s30 offen
    buffer_store_dword v70, v55, s[8:11], s31 offen sc1
    s_mov_b64 exec, -1
    s_xor_b32 s31, s31, 0x4000
    s_xor_b32 s30, s30, 0x4000
    s_barrier
    s_nop 15
    s_nop 15
    s_nop 15
    s_nop 11
    s_branch R_top_105
R_par_111:
    buffer_load_dwordx4 v[0:3], v20, s[8:11], s32 offen sc1
    buffer_load_dword v4, v53, s[8:11], s32 offen offset:4092 sc1
    s_waitcnt vmcnt(2)
    ds_write_b128 v20, v[48:51]
    ds_write_b32 v53, v52 offset:4092
    v_bitop3_b32 v56, v48, v49, s22 bitop3:0x7e
    v_bitop3_b32 v57, v50, v51, s22 bitop3:0x7e
    v_bitop3_b32 v56, v52, v56, s22 bitop3:0xde
    v_bitop3_b32 v56, v56, v57, 1 bitop3:0xa8
    v_cmp_ne_u32 vcc, 0, v56
    s_cbranch_vccz R_paok_110
    buffer_load_dwordx4 v[48:51], v20, s[8:11], s32 offen sc1
    buffer_load_dword v52, v53, s[8:11], s32 offen offset:4092 sc1
    s_add_u32 s6, s6, 1
    s_cmp_lt_u32 s6, 400000
    s_cbranch_scc1 R_pa_109
    s_branch R_paok_110
R_pcr_114:
    s_waitcnt vmcnt(1)
    ds_write_b128 v20, v[8:11] offset:5120
    ds_write_b32 v53, v12 offset:9212
    v_bitop3_b32 v54, v8, v9, s22 bitop3:0x7e
    v_bitop3_b32 v55, v10, v11, s22 bitop3:0x7e
    v_bitop3_b32 v54, v12, v54, s22 bitop3:0xde
    v_bitop3_b32 v54, v54, v55, s52 bitop3:0xa8
    v_cmp_ne_u32_e64 vcc, 0, v54
    s_cbranch_vccz R_pcok_113
R_pcr2_123:
    s_add_u32 s6, s6, 1
    s_cmp_lt_u32 s6, 400000
    s_cbranch_scc1 R_pc2_115
    s_branch R_pcok_113
R_pc2_115:
    s_waitcnt lgkmcnt(0)
    buffer_load_dwordx4 v[48:51], v20, s[8:11], s33 offen sc1
    buffer_load_dword v52, v53, s[8:11], s33 offen offset:4092 sc1
    s_waitcnt vmcnt(0)
    ds_write_b128 v20, v[48:51] offset:5120
    ds_write_b32 v53, v52 offset:9212
    v_bitop3_b32 v54, v48, v49, s22 bitop3:0x7e
    v_bitop3_b32 v55, v50, v51, s22 bitop3:0x7e
    v_bitop3_b32 v54, v52, v54, s22 bitop3:0xde
    v_bitop3_b32 v54, v54, v55, s52 bitop3:0xa8
    v_cmp_ne_u32_e64 vcc, 0, v54
    s_cbranch_vccnz R_pcr2_123
    s_branch R_pcok_113
R_pir_121:
    buffer_load_dwordx4 v[56:59], v19, s[8:11], s29 offen offset:0 sc1
    buffer_load_dwordx4 v[60:63], v19, s[8:11], s29 offen offset:1024 sc1
    s_waitcnt vmcnt(3)
    v_mfma_f32_16x16x32_bf16 v[68:71], v[0:3], v[64:67], 0
    s_waitcnt vmcnt(2)
    v_mfma_f32_16x16x32_bf16 v[68:71], v[4:7], v[64:67], v[68:71]
    v_bitop3_b32 v48, v0, v4, s21 bitop3:0x7e
    v_and_b32_e64 v48, 1, v48
    v_cmp_ne_u32 vcc, 0, v48
    s_cbranch_vccz R_piok_120
    buffer_load_dwordx4 v[0:3], v19, s[8:11], s29 offen offset:0 sc1
    buffer_load_dwordx4 v[4:7], v19, s[8:11], s29 offen offset:1024 sc1
    s_add_u32 s6, s6, 1
    s_cmp_lt_u32 s6, 400000
    s_cbranch_scc1 R_pi_119
    s_branch R_piok_120
R_exit_107:
    s_waitcnt lgkmcnt(0)
    buffer_store_dwordx4 v[92:95], v19, s[8:11], s35 offen sc1
    s_branch R_end_87
R_v10h_89:
    s_branch R_ent_125
.p2align 6
R_top_124:
    buffer_load_dwordx4 v[0:3], v20, s[8:11], s32 offen sc1
    buffer_load_dword v4, v53, s[8:11], s32 offen offset:4092 sc1
    s_nop 15
    s_nop 8
    buffer_load_dwordx4 v[48:51], v20, s[8:11], s32 offen sc1
    buffer_load_dword v52, v53, s[8:11], s32 offen offset:4092 sc1
R_pa_128:
    s_waitcnt vmcnt(2)
    ds_write_b128 v20, v[0:3]
    ds_write_b32 v53, v4 offset:4092
    v_bitop3_b32 v56, v0, v1, s22 bitop3:0x7e
    v_bitop3_b32 v57, v2, v3, s22 bitop3:0x7e
    v_bitop3_b32 v56, v4, v56, s22 bitop3:0xde
    v_bitop3_b32 v56, v56, v57, 1 bitop3:0xa8
    v_cmp_ne_u32 vcc, 0, v56
    s_cbranch_vccnz R_par_130
R_paok_129:
    buffer_load_dwordx4 v[48:51], v20, s[8:11], s33 offen sc1
    buffer_load_dword v52, v53, s[8:11], s33 offen offset:4092 sc1
    s_waitcnt lgkmcnt(0)
    s_barrier
R_ent_125:
    ds_read_b128 v[56:59], v19 offset:0
    ds_read_b128 v[60:63], v19 offset:1024
    ds_read_b128 v[64:67], v19 offset:2048
    ds_read_b128 v[68:71], v19 offset:3072
    ds_read_b128 v[72:75], v19 offset:4096
    s_waitcnt lgkmcnt(4)
    v_smfmac_f32_16x16x64_bf16 v[24:27], v[56:59], v[76:83], v18
    ds_read_b128 v[76:79], v21 offset:16384
    s_xor_b32 s21, s21, 1
    buffer_load_dwordx4 v[0:3], v19, s[8:11], s34 offen offset:0 sc1
    v_smfmac_f32_16x16x64_bf16 v[28:31], v[56:59], v[84:91], v18
    ds_read_b128 v[80:83], v21 offset:17408
    s_min_u32 s40, s20, 1
    buffer_load_dwordx4 v[4:7], v19, s[8:11], s34 offen offset:1024 sc1
    v_smfmac_f32_16x16x64_bf16 v[32:35], v[56:59], a[112:119], v18
    ds_read_b128 v[84:87], v21 offset:18432
    s_lshl_b32 s41, s40, 17
    v_smfmac_f32_16x16x64_bf16 v[36:39], v[56:59], a[120:127], v18
    ds_read_b128 v[88:91], v21 offset:19456
    s_waitcnt lgkmcnt(7)
    v_smfmac_f32_16x16x64_bf16 v[24:27], v[60:63], a[0:7], v18
    buffer_load_dwordx4 v[8:11], v20, s[8:11], s33 offen sc1
    v_smfmac_f32_16x16x64_bf16 v[28:31], v[60:63], a[8:15], v18
    buffer_load_dword v12, v53, s[8:11], s33 offen offset:4092 sc1
    s_waitcnt lgkmcnt(2)
    v_smfmac_f32_16x16x64_bf16 v[32:35], v[60:63], v[76:83], v18
    ds_read_b128 v[76:79], v21 offset:32768
    s_waitcnt lgkmcnt(1)
    v_smfmac_f32_16x16x64_bf16 v[36:39], v[60:63], v[84:91], v18
    ds_read_b128 v[80:83], v21 offset:33792
    v_smfmac_f32_16x16x64_bf16 v[24:27], v[64:67], a[16:23], v18
    ds_read_b128 v[84:87], v21 offset:34816
    v_smfmac_f32_16x16x64_bf16 v[28:31], v[64:67], a[24:31], v18
    ds_read_b128 v[88:91], v21 offset:35840
    v_smfmac_f32_16x16x64_bf16 v[32:35], v[64:67], a[128:135], v18
    v_smfmac_f32_16x16x64_bf16 v[36:39], v[64:67], a[136:143], v18
    s_waitcnt lgkmcnt(2)
    v_smfmac_f32_16x16x64_bf16 v[24:27], v[68:71], v[76:83], v18
    ds_read_b128 v[76:79], v21 offset:49152
    s_waitcnt lgkmcnt(1)
    v_smfmac_f32_16x16x64_bf16 v[28:31], v[68:71], v[84:91], v18
    ds_read_b128 v[80:83], v21 offset:50176
    v_smfmac_f32_16x16x64_bf16 v[32:35], v[68:71], a[144:151], v18
    ds_read_b128 v[84:87], v21 offset:51200
    v_smfmac_f32_16x16x64_bf16 v[36:39], v[68:71], a[152:159], v18
    ds_read_b128 v[88:91], v21 offset:52224
    v_smfmac_f32_16x16x64_bf16 v[24:27], v[72:75], a[32:39], v18
    v_add_u32 v21, 0x10000, v21
    buffer_store_dwordx4 v[92:95], v19, s[8:11], s35 offen sc1
    v_smfmac_f32_16x16x64_bf16 v[28:31], v[72:75], a[40:47], v18
    s_add_u32 s35, s35, s41
    s_add_u32 s51, s34, 0x1000000
    s_waitcnt lgkmcnt(2)
    v_smfmac_f32_16x16x64_bf16 v[32:35], v[72:75], v[76:83], v18
    ds_read_b128 v[76:79], v21 offset:0
    s_add_u32 s34, s34, 0x40000
    s_waitcnt lgkmcnt(1)
    v_smfmac_f32_16x16x64_bf16 v[36:39], v[72:75], v[84:91], v18
    ds_read_b128 v[80:83], v21 offset:1024
    v_smfmac_f32_16x16x64_bf16 v[40:43], v[56:59], a[208:215], v18
    ds_read_b128 v[84:87], v21 offset:2048
    v_smfmac_f32_16x16x64_bf16 v[44:47], v[56:59], a[216:223], v18
    ds_read_b128 v[88:91], v21 offset:3072
    s_waitcnt vmcnt(3)
    ds_write_b128 v20, v[48:51] offset:5120
    ds_write_b32 v53, v52 offset:9212
    v_smfmac_f32_16x16x64_bf16 v[40:43], v[60:63], a[224:231], v18
    v_bitop3_b32 v54, v48, v49, s22 bitop3:0x7e
    v_bitop3_b32 v55, v50, v51, s22 bitop3:0x7e
    v_smfmac_f32_16x16x64_bf16 v[44:47], v[60:63], a[232:239], v18
    v_bitop3_b32 v54, v52, v54, s22 bitop3:0xde
    v_bitop3_b32 v54, v54, v55, s52 bitop3:0xa8
    s_waitcnt lgkmcnt(4)
    v_smfmac_f32_16x16x64_bf16 v[40:43], v[64:67], v[76:83], v18
    v_cmp_ne_u32_e64 vcc, 0, v54
    s_waitcnt lgkmcnt(2)
    v_smfmac_f32_16x16x64_bf16 v[44:47], v[64:67], v[84:91], v18
    s_cbranch_vccnz R_pcr_133
R_pcok_132:
    s_waitcnt lgkmcnt(0)
    s_barrier
    ds_read_b128 v[56:59], v19 offset:5120
    ds_read_b128 v[60:63], v19 offset:6144
    v_smfmac_f32_16x16x64_bf16 v[40:43], v[68:71], a[240:247], v18
    ds_read_b128 v[64:67], v19 offset:7168
    v_smfmac_f32_16x16x64_bf16 v[44:47], v[68:71], a[248:255], v18
    ds_read_b128 v[68:71], v19 offset:8192
    v_smfmac_f32_16x16x64_bf16 v[40:43], v[72:75], v[96:103], v18
    v_smfmac_f32_16x16x64_bf16 v[44:47], v[72:75], v[104:111], v18
    ds_read_b128 v[72:75], v19 offset:9216
    s_waitcnt lgkmcnt(4)
    v_smfmac_f32_16x16x64_bf16 v[24:27], v[56:59], a[48:55], v18
    ds_read_b128 v[76:79], v21 offset:16384
    s_andn2_b32 s40, 1, s20
    v_smfmac_f32_16x16x64_bf16 v[28:31], v[56:59], a[56:63], v18
    ds_read_b128 v[80:83], v21 offset:17408
    s_xor_b32 s22, s22, s40
    s_waitcnt lgkmcnt(5)
    v_smfmac_f32_16x16x64_bf16 v[24:27], v[60:63], a[64:71], v18
    ds_read_b128 v[84:87], v21 offset:18432
    s_mov_b32 s52, 1
    v_smfmac_f32_16x16x64_bf16 v[28:31], v[60:63], a[72:79], v18
    ds_read_b128 v[88:91], v21 offset:19456
    s_min_u32 s40, s20, 1
    s_waitcnt lgkmcnt(6)
    v_smfmac_f32_16x16x64_bf16 v[24:27], v[64:67], a[80:87], v18
    buffer_load_dwordx4 v[8:11], v19, s[8:11], s51 offen offset:0 sc1
    v_smfmac_f32_16x16x64_bf16 v[28:31], v[64:67], a[88:95], v18
    buffer_load_dwordx4 v[12:15], v19, s[8:11], s51 offen offset:1024 sc1
    s_mov_b32 s33, s56
    s_waitcnt lgkmcnt(2)
    v_smfmac_f32_16x16x64_bf16 v[24:27], v[68:71], v[76:83], v18
    ds_read_b128 v[76:79], v21 offset:32768
    s_xor_b32 s56, s56, 0x4000
    s_waitcnt lgkmcnt(1)
    v_smfmac_f32_16x16x64_bf16 v[28:31], v[68:71], v[84:91], v18
    ds_read_b128 v[80:83], v21 offset:33792
    s_xor_b32 s32, s32, 0x4000
    v_smfmac_f32_16x16x64_bf16 v[24:27], v[72:75], a[96:103], v18
    ds_read_b128 v[84:87], v21 offset:34816
    v_smfmac_f32_16x16x64_bf16 v[28:31], v[72:75], a[104:111], v18
    ds_read_b128 v[88:91], v21 offset:35840
    v_smfmac_f32_16x16x64_bf16 v[32:35], v[56:59], a[160:167], v18
    v_smfmac_f32_16x16x64_bf16 v[36:39], v[56:59], a[168:175], v18
    s_waitcnt lgkmcnt(2)
    v_smfmac_f32_16x16x64_bf16 v[32:35], v[60:63], v[76:83], v18
    ds_read_b128 v[76:79], v21 offset:49152
    s_waitcnt lgkmcnt(1)
    v_smfmac_f32_16x16x64_bf16 v[36:39], v[60:63], v[84:91], v18
    ds_read_b128 v[80:83], v21 offset:50176
    v_cvt_pk_bf16_f32 v48, v24, v25
    v_smfmac_f32_16x16x64_bf16 v[32:35], v[64:67], a[176:183], v18
    ds_read_b128 v[84:87], v21 offset:51200
    v_cvt_pk_bf16_f32 v49, v26, v27
    v_smfmac_f32_16x16x64_bf16 v[36:39], v[64:67], a[184:191], v18
    ds_read_b128 v[88:91], v21 offset:52224
    v_cvt_pk_bf16_f32 v50, v28, v29
    v_smfmac_f32_16x16x64_bf16 v[32:35], v[68:71], a[192:199], v18
    v_cvt_pk_bf16_f32 v51, v30, v31
    v_smfmac_f32_16x16x64_bf16 v[36:39], v[68:71], a[200:207], v18
    v_add_u32 v21, 0x10000, v21
    s_waitcnt lgkmcnt(2)
    v_smfmac_f32_16x16x64_bf16 v[32:35], v[72:75], v[76:83], v18
    ds_read_b128 v[76:79], v21 offset:0
    s_waitcnt lgkmcnt(1)
    v_smfmac_f32_16x16x64_bf16 v[36:39], v[72:75], v[84:91], v18
    ds_read_b128 v[80:83], v21 offset:1024
    v_mfma_f32_16x16x16_bf16 v[24:27], v[48:49], v[16:17], 0
    ds_read_b128 v[84:87], v21 offset:2048
    v_mfma_f32_16x16x16_bf16 v[28:31], v[50:51], v[16:17], 0
    ds_read_b128 v[88:91], v21 offset:3072
    v_cvt_pk_bf16_f32 v52, v32, v33
    v_cvt_pk_bf16_f32 v53, v34, v35
    v_cvt_pk_bf16_f32 v54, v36, v37
    v_cvt_pk_bf16_f32 v55, v38, v39
    v_mfma_f32_16x16x16_bf16 v[32:35], v[52:53], v[16:17], 0
    v_cvt_pk_bf16_f32 v48, v24, v25
    v_mfma_f32_16x16x16_bf16 v[36:39], v[54:55], v[16:17], 0
    v_cvt_pk_bf16_f32 v49, v26, v27
    v_cvt_pk_bf16_f32 v50, v28, v29
    v_cvt_pk_bf16_f32 v51, v30, v31
    s_nop 1
    v_mfma_f32_16x16x32_bf16 v[24:27], v[0:3], v[48:51], 0
    v_mfma_f32_16x16x32_bf16 v[28:31], v[4:7], v[48:51], 0
    v_cvt_pk_bf16_f32 v92, v32, v33
    v_cvt_pk_bf16_f32 v93, v34, v35
    v_cvt_pk_bf16_f32 v94, v36, v37
    v_cvt_pk_bf16_f32 v95, v38, v39
    s_nop 1
    v_mfma_f32_16x16x32_bf16 v[32:35], v[92:95], v[48:51], 0
    s_nop 2
    v_cndmask_b32 v24, v24, v28, s[44:45]
    v_cndmask_b32 v25, v25, v29, s[44:45]
    v_cndmask_b32 v26, v26, v30, s[44:45]
    v_cndmask_b32 v27, v27, v31, s[44:45]
    ds_write_b128 v20, v[24:27] offset:10240
    v_cndmask_b32 v32, v32, v34, s[44:45]
    v_cndmask_b32 v33, v33, v35, s[44:45]
    ds_write_b64 v20, v[32:33] offset:0
    v_smfmac_f32_16x16x64_bf16 v[40:43], v[56:59], v[112:119], v18
    v_xor_b32 v52, 0x400, v20
    v_smfmac_f32_16x16x64_bf16 v[44:47], v[56:59], v[120:127], v18
    v_xor_b32 v54, 0x800, v20
    v_smfmac_f32_16x16x64_bf16 v[40:43], v[60:63], v[128:135], v18
    v_xor_b32 v34, 0xc00, v20
    v_smfmac_f32_16x16x64_bf16 v[44:47], v[60:63], v[136:143], v18
    v_smfmac_f32_16x16x64_bf16 v[40:43], v[64:67], v[144:151], v18
    s_cmp_eq_u32 s20, 63
    s_cbranch_scc1 R_exit_126
    s_waitcnt lgkmcnt(0)
    s_barrier
    ds_read_b128 v[28:31], v52 offset:10240
    ds_read_b64 v[52:53], v52 offset:0
    v_smfmac_f32_16x16x64_bf16 v[44:47], v[64:67], v[152:159], v18
    ds_read_b128 v[36:39], v54 offset:10240
    v_smfmac_f32_16x16x64_bf16 v[40:43], v[68:71], v[160:167], v18
    ds_read_b64 v[54:55], v54 offset:0
    v_smfmac_f32_16x16x64_bf16 v[44:47], v[68:71], v[168:175], v18
    ds_read_b128 v[48:51], v34 offset:10240
    v_smfmac_f32_16x16x64_bf16 v[40:43], v[72:75], v[76:83], v18
    ds_read_b64 v[34:35], v34 offset:0
    v_smfmac_f32_16x16x64_bf16 v[44:47], v[72:75], v[84:91], v18
    s_waitcnt lgkmcnt(5)
    v_pk_add_f32 v[24:25], v[24:25], v[28:29]
    v_pk_add_f32 v[26:27], v[26:27], v[30:31]
    s_waitcnt lgkmcnt(4)
    v_pk_add_f32 v[32:33], v[32:33], v[52:53]
    s_waitcnt lgkmcnt(1)
    v_pk_add_f32 v[36:37], v[36:37], v[48:49]
    v_pk_add_f32 v[38:39], v[38:39], v[50:51]
    s_waitcnt lgkmcnt(0)
    v_pk_add_f32 v[54:55], v[54:55], v[34:35]
    v_pk_add_f32 v[24:25], v[24:25], v[36:37]
    v_pk_add_f32 v[26:27], v[26:27], v[38:39]
    v_pk_add_f32 v[32:33], v[32:33], v[54:55]
    v_max3_f32 v34, v24, v25, v26
    v_max3_f32 v34, v34, v27, v32
    v_max_f32_e64 v34, v34, v33
    v_cvt_pk_bf16_f32 v76, v40, v41
    v_cvt_pk_bf16_f32 v77, v42, v43
    v_max_f32_dpp v34, v34, v34 row_ror:8 row_mask:0xf bank_mask:0xf
    v_mov_b32_e64 v35, v34
    v_cvt_pk_bf16_f32 v78, v44, v45
    v_cvt_pk_bf16_f32 v79, v46, v47
    v_permlane16_swap_b32 v34, v35
    v_max_f32 v34, v34, v35
    v_mov_b32 v35, v34
    v_mov_b32 v56, 0
    v_mov_b32 v57, 0
    v_permlane32_swap_b32 v34, v35
    v_max_f32 v34, v34, v35
    v_mul_f32 v34, s50, v34
    v_pk_fma_f32 v[24:25], v[24:25], s[54:55], v[34:35] op_sel_hi:[1,1,0] neg_lo:[0,0,1] neg_hi:[0,0,1]
    v_pk_fma_f32 v[26:27], v[26:27], s[54:55], v[34:35] op_sel_hi:[1,1,0] neg_lo:[0,0,1] neg_hi:[0,0,1]
    v_pk_fma_f32 v[32:33], v[32:33], s[54:55], v[34:35] op_sel_hi:[1,1,0] neg_lo:[0,0,1] neg_hi:[0,0,1]
    v_exp_f32 v24, v24
    v_exp_f32 v25, v25
    v_exp_f32 v26, v26
    v_exp_f32 v27, v27
    v_exp_f32 v32, v32
    v_exp_f32 v33, v33
    v_cvt_pk_bf16_f32 v48, v24, v25
    v_cvt_pk_bf16_f32 v49, v26, v27
    v_cvt_pk_bf16_f32 v52, v32, v33
    v_mov_b32_dpp v50, v48 row_ror:8 row_mask:0xf bank_mask:0xf
    v_mov_b32_dpp v51, v49 row_ror:8 row_mask:0xf bank_mask:0xf
    v_mov_b32_dpp v53, v52 row_ror:8 row_mask:0xf bank_mask:0xf
    v_pk_add_f32 v[24:25], v[24:25], v[26:27]
    s_waitcnt vmcnt(0)
    v_mfma_f32_16x16x32_bf16 v[28:31], v[8:11], v[48:51], 0
    v_add_f32 v32, v32, v33
    v_add_f32_e64 v24, v24, v25
    v_mfma_f32_16x16x32_bf16 v[36:39], v[12:15], v[48:51], 0
    v_fma_f32 v34, v32, 0.5, v24
    v_mfma_f32_16x16x16_bf16 v[28:31], v[76:77], v[52:53], v[28:31]
    v_mov_b32_e64 v58, 0
    v_add_f32_dpp v34, v34, v34 row_ror:8 row_mask:0xf bank_mask:0xf
    v_mfma_f32_16x16x16_bf16 v[36:39], v[78:79], v[52:53], v[36:39]
    v_mov_b32 v35, v34
    v_mov_b32 v59, 0
    v_mov_b32 v60, 0
    v_permlane16_swap_b32 v34, v35
    v_add_f32 v34, v34, v35
    v_mov_b32 v35, v34
    v_mov_b32 v61, 0
    v_mov_b32 v62, 0
    v_permlane32_swap_b32 v34, v35
    v_add_f32 v34, v34, v35
    v_rcp_f32 v34, v34
    s_mov_b64 exec, s[46:47]
    v_pk_mul_f32 v[28:29], v[28:29], v[34:35] op_sel_hi:[1,0]
    v_pk_mul_f32 v[30:31], v[30:31], v[34:35] op_sel_hi:[1,0]
    v_pk_mul_f32 v[36:37], v[36:37], v[34:35] op_sel_hi:[1,0]
    v_pk_mul_f32 v[38:39], v[38:39], v[34:35] op_sel_hi:[1,0]
    v_cvt_pk_bf16_f32 v24, v28, v29
    v_cvt_pk_bf16_f32 v25, v30, v31
    v_cvt_pk_bf16_f32 v26, v36, v37
    v_cvt_pk_bf16_f32 v27, v38, v39
    ds_write_b128 v22, v[24:27]
    s_mov_b64 exec, -1
    v_mov_b32 v63, 0
    v_mov_b32 v64, 0
    v_mov_b32 v65, 0
    v_mov_b32 v66, 0
    v_mov_b32 v67, 0
    v_mov_b32 v68, 0
    v_mov_b32 v69, 0
    v_mov_b32 v70, 0
    v_mov_b32 v71, 0
    v_mov_b32 v72, 0
    v_mov_b32 v73, 0
    v_mov_b32 v74, 0
    v_mov_b32 v75, 0
    s_waitcnt lgkmcnt(0)
    s_barrier
    ds_read_b128 v[48:51], v19 offset:5120
    ds_read_b128 v[52:55], v19 offset:6144
    v_subrev_u32 v21, 0x20000, v21
    v_lshrrev_b32_e64 v24, 8, v19
    v_bfe_u32 v25, v19, 2, 6
    v_lshl_add_u32 v24, v24, 13, v25
    s_waitcnt lgkmcnt(1)
    v_smfmac_f32_16x16x64_bf16 v[56:59], v[48:51], v[176:183], v18 abid:1
    s_waitcnt lgkmcnt(0)
    v_smfmac_f32_16x16x64_bf16 v[56:59], v[52:55], v[216:223], v18 abid:1
    v_smfmac_f32_16x16x64_bf16 v[60:63], v[48:51], v[184:191], v18 abid:1
    v_smfmac_f32_16x16x64_bf16 v[60:63], v[52:55], v[224:231], v18 abid:1
    v_add_f32_e64 v56, v56, v58
    v_smfmac_f32_16x16x64_bf16 v[64:67], v[48:51], v[192:199], v18 abid:1
    v_add_f32_e64 v57, v57, v59
    v_smfmac_f32_16x16x64_bf16 v[64:67], v[52:55], v[232:239], v18 abid:1
    v_cvt_pk_bf16_f32 v28, v56, v57
    v_add_f32_e64 v60, v60, v62
    v_smfmac_f32_16x16x64_bf16 v[68:71], v[48:51], v[200:207], v18 abid:1
    v_add_f32_e64 v61, v61, v63
    v_bfi_b32 v28, 1, s21, v28
    v_smfmac_f32_16x16x64_bf16 v[68:71], v[52:55], v[240:247], v18 abid:1
    v_cvt_pk_bf16_f32 v29, v60, v61
    v_add_f32_e64 v64, v64, v66
    v_smfmac_f32_16x16x64_bf16 v[72:75], v[48:51], v[208:215], v18 abid:1
    v_add_f32_e64 v65, v65, v67
    v_smfmac_f32_16x16x64_bf16 v[72:75], v[52:55], v[248:255], v18 abid:1
    v_add_f32_e64 v68, v68, v70
    v_add_f32 v69, v69, v71
    v_cvt_pk_bf16_f32 v30, v64, v65
    v_cvt_pk_bf16_f32 v31, v68, v69
    buffer_store_dwordx4 v[28:31], v23, s[8:11], s27 offen
    s_nop 2
    v_pk_add_f32 v[72:73], v[72:73], v[74:75]
    v_cvt_pk_bf16_f32 v72, v72, v73
    v_bfi_b32 v72, 1, s21, v72
    buffer_store_dword v72, v24, s[8:11], s28 offen
    s_cmp_lt_u32 s20, 58
    s_cbranch_scc1 R_noearly_135
    buffer_store_dwordx4 v[92:95], v19, s[8:11], s35 offen sc1
R_noearly_135:
    s_cmp_ge_u32 s4, 16
    s_cbranch_scc1 R_nored_136
    v_mov_b32 v24, 0
    v_mov_b32 v25, 0
    v_mov_b32 v26, 0
    v_mov_b32 v27, 0
    v_mov_b32 v28, 0
    v_mov_b32 v29, 0
    v_mov_b32 v30, 0
    v_mov_b32 v31, 0
    v_mov_b32 v32, 0
    v_mov_b32 v33, 0
    v_mov_b32 v34, 0
    v_mov_b32 v35, 0
    v_mov_b32 v36, 0
    v_mov_b32 v37, 0
    v_mov_b32 v38, 0
    v_mov_b32 v39, 0
    v_mov_b32 v40, 0
    v_mov_b32 v41, 0
    v_mov_b32 v42, 0
    v_mov_b32 v43, 0
    v_mov_b32 v44, 0
    v_mov_b32 v45, 0
    v_mov_b32 v46, 0
    v_mov_b32 v47, 0
    ds_read_b128 v[76:79], v21 offset:0
    buffer_load_dwordx4 v[56:59], v19, s[8:11], s29 offen offset:0 sc1
    buffer_load_dwordx4 v[60:63], v19, s[8:11], s29 offen offset:1024 sc1
    ds_read_b128 v[80:83], v21 offset:1024
    ds_read_b128 v[84:87], v21 offset:2048
    ds_read_b128 v[88:91], v21 offset:3072
    v_lshrrev_b32_e64 v53, 2, v20
    v_add_u32 v53, 4, v53
    s_add_u32 s20, s20, 1
    v_mov_b32 v54, 0xfffe0000
    v_lshrrev_b32_e64 v48, 2, v19
    v_and_b32 v48, 0x80, v48
    v_and_or_b32 v55, v19, 16, v48
    v_lshrrev_b32_e64 v48, 5, v19
    v_and_or_b32 v55, v48, 8, v55
    v_lshrrev_b32_e64 v48, 4, v19
    v_and_or_b32 v55, v48, 4, v55
    v_mov_b32 v48, 0x3f80
    v_cndmask_b32 v48, v48, 1.0, s[76:77]
    v_cndmask_b32 v64, 0, v48, s[60:61]
    v_cndmask_b32 v65, 0, v48, s[62:63]
    v_cndmask_b32 v66, 0, v48, s[64:65]
    v_cndmask_b32 v67, 0, v48, s[66:67]
    s_lshl_b32 s26, s22, 16
    s_sub_u32 s24, 0x10000, s26
    s_nop 7
    buffer_load_dwordx4 v[0:3], v19, s[8:11], s29 offen offset:0 sc1
    buffer_load_dwordx4 v[4:7], v19, s[8:11], s29 offen offset:1024 sc1
R_pi_138:
    s_waitcnt vmcnt(3)
    v_mfma_f32_16x16x32_bf16 v[68:71], v[56:59], v[64:67], 0
    v_bitop3_b32 v48, v56, v57, s21 bitop3:0x7e
    v_bitop3_b32 v49, v58, v59, s21 bitop3:0x7e
    s_waitcnt vmcnt(2)
    v_mfma_f32_16x16x32_bf16 v[68:71], v[60:63], v[64:67], v[68:71]
    v_bitop3_b32 v50, v60, v61, s21 bitop3:0x7e
    v_bitop3_b32 v51, v62, v63, s21 bitop3:0x7e
    v_or3_b32 v48, v48, v50, v51
    v_bitop3_b32 v48, v48, v49, 1 bitop3:0xa8
    v_cmp_ne_u32_e64 vcc, 0, v48
    s_cbranch_vccnz R_pir_140
R_piok_139:
    s_nop 1
    v_permlane32_swap_b32 v68, v70
    v_permlane32_swap_b32 v69, v71
    v_pk_add_f32 v[68:69], v[68:69], v[70:71]
    s_nop 1
    v_permlane16_swap_b32 v68, v69
    v_add_f32 v68, v68, v69
    v_add_u32 v70, s24, v68
    v_bfi_b32 v70, v54, v70, s26
    v_mov_b32_dpp v69, v68 row_shl:2 row_mask:0xf bank_mask:0xf
    s_mov_b64 exec, s[48:49]
    v_cvt_pk_bf16_f32 v70, v70, v69
    buffer_store_dword v70, v55, s[8:11], s30 offen
    buffer_store_dword v70, v55, s[8:11], s31 offen sc1
    s_mov_b64 exec, -1
    s_xor_b32 s31, s31, 0x4000
    s_xor_b32 s30, s30, 0x4000
    s_branch R_join_137
R_nored_136:
    v_mov_b32 v24, 0
    v_mov_b32 v25, 0
    v_mov_b32 v26, 0
    v_mov_b32 v27, 0
    v_mov_b32 v28, 0
    v_mov_b32 v29, 0
    v_mov_b32 v30, 0
    v_mov_b32 v31, 0
    v_mov_b32 v32, 0
    v_mov_b32 v33, 0
    v_mov_b32 v34, 0
    v_mov_b32 v35, 0
    v_mov_b32 v36, 0
    v_mov_b32 v37, 0
    v_mov_b32 v38, 0
    v_mov_b32 v39, 0
    v_mov_b32 v40, 0
    v_mov_b32 v41, 0
    v_mov_b32 v42, 0
    v_mov_b32 v43, 0
    v_mov_b32 v44, 0
    v_mov_b32 v45, 0
    v_mov_b32 v46, 0
    v_mov_b32_e64 v47, 0
    ds_read_b128 v[76:79], v21 offset:0
    ds_read_b128 v[80:83], v21 offset:1024
    ds_read_b128 v[84:87], v21 offset:2048
    ds_read_b128 v[88:91], v21 offset:3072
    v_lshrrev_b32 v53, 2, v20
    v_add_u32 v53, 4, v53
    s_add_u32 s20, s20, 1
R_join_137:
    s_barrier
    s_nop 15
    s_nop 15
    s_nop 15
    s_nop 11
    s_branch R_top_124
R_par_130:
    buffer_load_dwordx4 v[0:3], v20, s[8:11], s32 offen sc1
    buffer_load_dword v4, v53, s[8:11], s32 offen offset:4092 sc1
    s_waitcnt vmcnt(2)
    ds_write_b128 v20, v[48:51]
    ds_write_b32 v53, v52 offset:4092
    v_bitop3_b32 v56, v48, v49, s22 bitop3:0x7e
    v_bitop3_b32 v57, v50, v51, s22 bitop3:0x7e
    v_bitop3_b32 v56, v52, v56, s22 bitop3:0xde
    v_bitop3_b32 v56, v56, v57, 1 bitop3:0xa8
    v_cmp_ne_u32 vcc, 0, v56
    s_cbranch_vccz R_paok_129
    buffer_load_dwordx4 v[48:51], v20, s[8:11], s32 offen sc1
    buffer_load_dword v52, v53, s[8:11], s32 offen offset:4092 sc1
    s_add_u32 s6, s6, 1
    s_cmp_lt_u32 s6, 400000
    s_cbranch_scc1 R_pa_128
    s_branch R_paok_129
R_pcr_133:
    s_waitcnt vmcnt(1)
    ds_write_b128 v20, v[8:11] offset:5120
    ds_write_b32 v53, v12 offset:9212
    v_bitop3_b32 v54, v8, v9, s22 bitop3:0x7e
    v_bitop3_b32 v55, v10, v11, s22 bitop3:0x7e
    v_bitop3_b32 v54, v12, v54, s22 bitop3:0xde
    v_bitop3_b32 v54, v54, v55, s52 bitop3:0xa8
    v_cmp_ne_u32_e64 vcc, 0, v54
    s_cbranch_vccz R_pcok_132
R_pcr2_142:
    s_add_u32 s6, s6, 1
    s_cmp_lt_u32 s6, 400000
    s_cbranch_scc1 R_pc2_134
    s_branch R_pcok_132
R_pc2_134:
    s_waitcnt lgkmcnt(0)
    buffer_load_dwordx4 v[48:51], v20, s[8:11], s33 offen sc1
    buffer_load_dword v52, v53, s[8:11], s33 offen offset:4092 sc1
    s_waitcnt vmcnt(0)
    ds_write_b128 v20, v[48:51] offset:5120
    ds_write_b32 v53, v52 offset:9212
    v_bitop3_b32 v54, v48, v49, s22 bitop3:0x7e
    v_bitop3_b32 v55, v50, v51, s22 bitop3:0x7e
    v_bitop3_b32 v54, v52, v54, s22 bitop3:0xde
    v_bitop3_b32 v54, v54, v55, s52 bitop3:0xa8
    v_cmp_ne_u32_e64 vcc, 0, v54
    s_cbranch_vccnz R_pcr2_142
    s_branch R_pcok_132
R_pir_140:
    buffer_load_dwordx4 v[56:59], v19, s[8:11], s29 offen offset:0 sc1
    buffer_load_dwordx4 v[60:63], v19, s[8:11], s29 offen offset:1024 sc1
    s_waitcnt vmcnt(3)
    v_mfma_f32_16x16x32_bf16 v[68:71], v[0:3], v[64:67], 0
    v_bitop3_b32 v48, v0, v1, s21 bitop3:0x7e
    v_bitop3_b32 v49, v2, v3, s21 bitop3:0x7e
    s_waitcnt vmcnt(2)
    v_mfma_f32_16x16x32_bf16 v[68:71], v[4:7], v[64:67], v[68:71]
    v_bitop3_b32 v50, v4, v5, s21 bitop3:0x7e
    v_bitop3_b32 v51, v6, v7, s21 bitop3:0x7e
    v_or3_b32 v48, v48, v50, v51
    v_bitop3_b32 v48, v48, v49, 1 bitop3:0xa8
    v_cmp_ne_u32 vcc, 0, v48
    s_cbranch_vccz R_piok_139
    buffer_load_dwordx4 v[0:3], v19, s[8:11], s29 offen offset:0 sc1
    buffer_load_dwordx4 v[4:7], v19, s[8:11], s29 offen offset:1024 sc1
    s_add_u32 s6, s6, 1
    s_cmp_lt_u32 s6, 400000
    s_cbranch_scc1 R_pi_138
    s_branch R_piok_139
R_exit_126:
    s_waitcnt lgkmcnt(0)
    buffer_store_dwordx4 v[92:95], v19, s[8:11], s35 offen sc1
    s_branch R_end_87
R_v10w3_90:
    s_branch R_ent_144
.p2align 6
R_top_143:
    buffer_load_dwordx4 v[0:3], v20, s[8:11], s32 offen sc1
    buffer_load_dword v4, v53, s[8:11], s32 offen offset:4092 sc1
    s_nop 15
    s_nop 8
    buffer_load_dwordx4 v[48:51], v20, s[8:11], s32 offen sc1
    buffer_load_dword v52, v53, s[8:11], s32 offen offset:4092 sc1
R_pa_147:
    s_waitcnt vmcnt(2)
    ds_write_b128 v20, v[0:3]
    ds_write_b32 v53, v4 offset:4092
    v_bitop3_b32 v56, v0, v1, s22 bitop3:0x7e
    v_bitop3_b32 v57, v2, v3, s22 bitop3:0x7e
    v_bitop3_b32 v56, v4, v56, s22 bitop3:0xde
    v_bitop3_b32 v56, v56, v57, 1 bitop3:0xa8
    v_cmp_ne_u32 vcc, 0, v56
    s_cbranch_vccnz R_par_149
R_paok_148:
    buffer_load_dwordx4 v[48:51], v20, s[8:11], s33 offen sc1
    buffer_load_dword v52, v53, s[8:11], s33 offen offset:4092 sc1
    s_waitcnt lgkmcnt(0)
    s_barrier
R_ent_144:
    ds_read_b128 v[56:59], v19 offset:0
    ds_read_b128 v[60:63], v19 offset:1024
    ds_read_b128 v[64:67], v19 offset:2048
    ds_read_b128 v[68:71], v19 offset:3072
    ds_read_b128 v[72:75], v19 offset:4096
    s_waitcnt lgkmcnt(4)
    v_smfmac_f32_16x16x64_bf16 v[24:27], v[56:59], v[76:83], v18
    ds_read_b128 v[76:79], v21 offset:16384
    s_xor_b32 s21, s21, 1
    buffer_load_dwordx4 v[0:3], v19, s[8:11], s34 offen offset:0 sc1
    v_smfmac_f32_16x16x64_bf16 v[28:31], v[56:59], v[84:91], v18
    ds_read_b128 v[80:83], v21 offset:17408
    s_min_u32 s40, s20, 1
    buffer_load_dwordx4 v[4:7], v19, s[8:11], s34 offen offset:1024 sc1
    v_smfmac_f32_16x16x64_bf16 v[32:35], v[56:59], a[112:119], v18
    ds_read_b128 v[84:87], v21 offset:18432
    s_lshl_b32 s41, s40, 17
    v_smfmac_f32_16x16x64_bf16 v[36:39], v[56:59], a[120:127], v18
    ds_read_b128 v[88:91], v21 offset:19456
    s_waitcnt lgkmcnt(7)
    v_smfmac_f32_16x16x64_bf16 v[24:27], v[60:63], a[0:7], v18
    buffer_load_dwordx4 v[8:11], v20, s[8:11], s33 offen sc1
    v_smfmac_f32_16x16x64_bf16 v[28:31], v[60:63], a[8:15], v18
    buffer_load_dword v12, v53, s[8:11], s33 offen offset:4092 sc1
    s_waitcnt lgkmcnt(2)
    v_smfmac_f32_16x16x64_bf16 v[32:35], v[60:63], v[76:83], v18
    ds_read_b128 v[76:79], v21 offset:32768
    s_waitcnt lgkmcnt(1)
    v_smfmac_f32_16x16x64_bf16 v[36:39], v[60:63], v[84:91], v18
    ds_read_b128 v[80:83], v21 offset:33792
    v_smfmac_f32_16x16x64_bf16 v[24:27], v[64:67], a[16:23], v18
    ds_read_b128 v[84:87], v21 offset:34816
    v_smfmac_f32_16x16x64_bf16 v[28:31], v[64:67], a[24:31], v18
    ds_read_b128 v[88:91], v21 offset:35840
    v_smfmac_f32_16x16x64_bf16 v[32:35], v[64:67], a[128:135], v18
    v_smfmac_f32_16x16x64_bf16 v[36:39], v[64:67], a[136:143], v18
    s_waitcnt lgkmcnt(2)
    v_smfmac_f32_16x16x64_bf16 v[24:27], v[68:71], v[76:83], v18
    ds_read_b128 v[76:79], v21 offset:49152
    s_waitcnt lgkmcnt(1)
    v_smfmac_f32_16x16x64_bf16 v[28:31], v[68:71], v[84:91], v18
    ds_read_b128 v[80:83], v21 offset:50176
    v_smfmac_f32_16x16x64_bf16 v[32:35], v[68:71], a[144:151], v18
    ds_read_b128 v[84:87], v21 offset:51200
    v_smfmac_f32_16x16x64_bf16 v[36:39], v[68:71], a[152:159], v18
    ds_read_b128 v[88:91], v21 offset:52224
    v_smfmac_f32_16x16x64_bf16 v[24:27], v[72:75], a[32:39], v18
    v_add_u32 v21, 0x10000, v21
    buffer_store_dwordx4 v[92:95], v19, s[8:11], s35 offen sc1
    v_smfmac_f32_16x16x64_bf16 v[28:31], v[72:75], a[40:47], v18
    s_add_u32 s35, s35, s41
    s_add_u32 s51, s34, 0x1000000
    s_waitcnt lgkmcnt(2)
    v_smfmac_f32_16x16x64_bf16 v[32:35], v[72:75], v[76:83], v18
    ds_read_b128 v[76:79], v21 offset:0
    s_add_u32 s34, s34, 0x40000
    s_waitcnt lgkmcnt(1)
    v_smfmac_f32_16x16x64_bf16 v[36:39], v[72:75], v[84:91], v18
    ds_read_b128 v[80:83], v21 offset:1024
    v_smfmac_f32_16x16x64_bf16 v[40:43], v[56:59], a[208:215], v18
    ds_read_b128 v[84:87], v21 offset:2048
    v_smfmac_f32_16x16x64_bf16 v[44:47], v[56:59], a[216:223], v18
    ds_read_b128 v[88:91], v21 offset:3072
    s_waitcnt vmcnt(3)
    ds_write_b128 v20, v[48:51] offset:5120
    ds_write_b32 v53, v52 offset:9212
    v_smfmac_f32_16x16x64_bf16 v[40:43], v[60:63], a[224:231], v18
    v_bitop3_b32 v54, v48, v49, s22 bitop3:0x7e
    v_bitop3_b32 v55, v50, v51, s22 bitop3:0x7e
    v_smfmac_f32_16x16x64_bf16 v[44:47], v[60:63], a[232:239], v18
    v_bitop3_b32 v54, v52, v54, s22 bitop3:0xde
    v_bitop3_b32 v54, v54, v55, s52 bitop3:0xa8
    s_waitcnt lgkmcnt(4)
    v_smfmac_f32_16x16x64_bf16 v[40:43], v[64:67], v[76:83], v18
    v_cmp_ne_u32 vcc, 0, v54
    s_waitcnt lgkmcnt(2)
    v_smfmac_f32_16x16x64_bf16 v[44:47], v[64:67], v[84:91], v18
    s_cbranch_vccnz R_pcr_152
R_pcok_151:
    v_lshlrev_b32_e64 v55, 3, v19
    s_add_u32 s42, s36, 0x1000000
    s_waitcnt lgkmcnt(0)
    s_barrier
    ds_read_b128 v[56:59], v19 offset:5120
    ds_read_b128 v[60:63], v19 offset:6144
    v_smfmac_f32_16x16x64_bf16 v[40:43], v[68:71], a[240:247], v18
    ds_read_b128 v[64:67], v19 offset:7168
    v_smfmac_f32_16x16x64_bf16 v[44:47], v[68:71], a[248:255], v18
    ds_read_b128 v[68:71], v19 offset:8192
    v_smfmac_f32_16x16x64_bf16 v[40:43], v[72:75], v[96:103], v18
    v_smfmac_f32_16x16x64_bf16 v[44:47], v[72:75], v[104:111], v18
    ds_read_b128 v[72:75], v19 offset:9216
    s_waitcnt lgkmcnt(4)
    v_smfmac_f32_16x16x64_bf16 v[24:27], v[56:59], a[48:55], v18
    ds_read_b128 v[76:79], v21 offset:16384
    s_andn2_b32 s40, 1, s20
    v_smfmac_f32_16x16x64_bf16 v[28:31], v[56:59], a[56:63], v18
    ds_read_b128 v[80:83], v21 offset:17408
    s_xor_b32 s22, s22, s40
    s_waitcnt lgkmcnt(5)
    v_smfmac_f32_16x16x64_bf16 v[24:27], v[60:63], a[64:71], v18
    ds_read_b128 v[84:87], v21 offset:18432
    s_mov_b32 s52, 1
    v_smfmac_f32_16x16x64_bf16 v[28:31], v[60:63], a[72:79], v18
    ds_read_b128 v[88:91], v21 offset:19456
    s_min_u32 s40, s20, 1
    s_waitcnt lgkmcnt(6)
    v_smfmac_f32_16x16x64_bf16 v[24:27], v[64:67], a[80:87], v18
    buffer_load_dwordx4 v[8:11], v19, s[8:11], s51 offen offset:0 sc1
    s_cmp_gt_u32 s20, 58
    v_smfmac_f32_16x16x64_bf16 v[28:31], v[64:67], a[88:95], v18
    buffer_load_dwordx4 v[12:15], v19, s[8:11], s51 offen offset:1024 sc1
    s_mov_b32 s33, s56
    s_cselect_b32 s40, 0, s40
    s_waitcnt lgkmcnt(2)
    v_smfmac_f32_16x16x64_bf16 v[24:27], v[68:71], v[76:83], v18
    ds_read_b128 v[76:79], v21 offset:32768
    s_xor_b32 s56, s56, 0x4000
    s_sub_u32 s40, s20, s40
    s_waitcnt lgkmcnt(1)
    v_smfmac_f32_16x16x64_bf16 v[28:31], v[68:71], v[84:91], v18
    ds_read_b128 v[80:83], v21 offset:33792
    s_xor_b32 s32, s32, 0x4000
    v_mov_b32 v49, s40
    v_smfmac_f32_16x16x64_bf16 v[24:27], v[72:75], a[96:103], v18
    ds_read_b128 v[84:87], v21 offset:34816
    v_mov_b32 v54, 0
    v_smfmac_f32_16x16x64_bf16 v[28:31], v[72:75], a[104:111], v18
    ds_read_b128 v[88:91], v21 offset:35840
    buffer_store_dword v49, v54, s[8:11], s38 offen sc1
    v_smfmac_f32_16x16x64_bf16 v[32:35], v[56:59], a[160:167], v18
    buffer_load_dword v55, s[8:11], s36 offen sc1 lds
    v_smfmac_f32_16x16x64_bf16 v[36:39], v[56:59], a[168:175], v18
    buffer_load_dword v55, s[8:11], s42 offen sc1 lds
    s_waitcnt lgkmcnt(2)
    v_smfmac_f32_16x16x64_bf16 v[32:35], v[60:63], v[76:83], v18
    ds_read_b128 v[76:79], v21 offset:49152
    s_waitcnt lgkmcnt(1)
    v_smfmac_f32_16x16x64_bf16 v[36:39], v[60:63], v[84:91], v18
    ds_read_b128 v[80:83], v21 offset:50176
    v_cvt_pk_bf16_f32 v48, v24, v25
    v_smfmac_f32_16x16x64_bf16 v[32:35], v[64:67], a[176:183], v18
    ds_read_b128 v[84:87], v21 offset:51200
    v_cvt_pk_bf16_f32 v49, v26, v27
    v_smfmac_f32_16x16x64_bf16 v[36:39], v[64:67], a[184:191], v18
    ds_read_b128 v[88:91], v21 offset:52224
    v_cvt_pk_bf16_f32 v50, v28, v29
    v_smfmac_f32_16x16x64_bf16 v[32:35], v[68:71], a[192:199], v18
    v_cvt_pk_bf16_f32 v51, v30, v31
    v_smfmac_f32_16x16x64_bf16 v[36:39], v[68:71], a[200:207], v18
    v_add_u32 v21, 0x10000, v21
    s_waitcnt lgkmcnt(2)
    v_smfmac_f32_16x16x64_bf16 v[32:35], v[72:75], v[76:83], v18
    ds_read_b128 v[76:79], v21 offset:0
    s_waitcnt lgkmcnt(1)
    v_smfmac_f32_16x16x64_bf16 v[36:39], v[72:75], v[84:91], v18
    ds_read_b128 v[80:83], v21 offset:1024
    v_mfma_f32_16x16x16_bf16 v[24:27], v[48:49], v[16:17], 0
    ds_read_b128 v[84:87], v21 offset:2048
    v_mfma_f32_16x16x16_bf16 v[28:31], v[50:51], v[16:17], 0
    ds_read_b128 v[88:91], v21 offset:3072
    v_cvt_pk_bf16_f32 v52, v32, v33
    v_cvt_pk_bf16_f32 v53, v34, v35
    v_cvt_pk_bf16_f32 v54, v36, v37
    v_cvt_pk_bf16_f32 v55, v38, v39
    v_mfma_f32_16x16x16_bf16 v[32:35], v[52:53], v[16:17], 0
    v_cvt_pk_bf16_f32 v48, v24, v25
    v_mfma_f32_16x16x16_bf16 v[36:39], v[54:55], v[16:17], 0
    v_cvt_pk_bf16_f32 v49, v26, v27
    v_cvt_pk_bf16_f32 v50, v28, v29
    v_cvt_pk_bf16_f32 v51, v30, v31
    s_nop 1
    v_mfma_f32_16x16x32_bf16 v[24:27], v[0:3], v[48:51], 0
    v_mfma_f32_16x16x32_bf16 v[28:31], v[4:7], v[48:51], 0
    v_cvt_pk_bf16_f32 v92, v32, v33
    v_cvt_pk_bf16_f32 v93, v34, v35
    v_cvt_pk_bf16_f32 v94, v36, v37
    v_cvt_pk_bf16_f32 v95, v38, v39
    s_nop 1
    v_mfma_f32_16x16x32_bf16 v[32:35], v[92:95], v[48:51], 0
    s_nop 2
    v_cndmask_b32 v24, v24, v28, s[44:45]
    v_cndmask_b32 v25, v25, v29, s[44:45]
    v_cndmask_b32 v26, v26, v30, s[44:45]
    v_cndmask_b32 v27, v27, v31, s[44:45]
    ds_write_b128 v20, v[24:27] offset:10240
    v_cndmask_b32 v32, v32, v34, s[44:45]
    v_cndmask_b32 v33, v33, v35, s[44:45]
    ds_write_b64 v20, v[32:33] offset:0
    v_smfmac_f32_16x16x64_bf16 v[40:43], v[56:59], v[112:119], v18
    v_xor_b32 v52, 0x400, v20
    v_smfmac_f32_16x16x64_bf16 v[44:47], v[56:59], v[120:127], v18
    v_xor_b32 v54, 0x800, v20
    v_smfmac_f32_16x16x64_bf16 v[40:43], v[60:63], v[128:135], v18
    v_xor_b32 v34, 0xc00, v20
    v_smfmac_f32_16x16x64_bf16 v[44:47], v[60:63], v[136:143], v18
    v_smfmac_f32_16x16x64_bf16 v[40:43], v[64:67], v[144:151], v18
    s_cmp_eq_u32 s20, 63
    s_cbranch_scc1 R_exit_145
    s_waitcnt lgkmcnt(0)
    s_barrier
    ds_read_b128 v[28:31], v52 offset:10240
    ds_read_b64 v[52:53], v52 offset:0
    v_smfmac_f32_16x16x64_bf16 v[44:47], v[64:67], v[152:159], v18
    ds_read_b128 v[36:39], v54 offset:10240
    v_smfmac_f32_16x16x64_bf16 v[40:43], v[68:71], v[160:167], v18
    ds_read_b64 v[54:55], v54 offset:0
    v_smfmac_f32_16x16x64_bf16 v[44:47], v[68:71], v[168:175], v18
    ds_read_b128 v[48:51], v34 offset:10240
    v_smfmac_f32_16x16x64_bf16 v[40:43], v[72:75], v[76:83], v18
    ds_read_b64 v[34:35], v34 offset:0
    v_smfmac_f32_16x16x64_bf16 v[44:47], v[72:75], v[84:91], v18
    s_waitcnt lgkmcnt(5)
    v_pk_add_f32 v[24:25], v[24:25], v[28:29]
    v_pk_add_f32 v[26:27], v[26:27], v[30:31]
    s_waitcnt lgkmcnt(4)
    v_pk_add_f32 v[32:33], v[32:33], v[52:53]
    s_waitcnt lgkmcnt(1)
    v_pk_add_f32 v[36:37], v[36:37], v[48:49]
    v_pk_add_f32 v[38:39], v[38:39], v[50:51]
    s_waitcnt lgkmcnt(0)
    v_pk_add_f32 v[54:55], v[54:55], v[34:35]
    v_pk_add_f32 v[24:25], v[24:25], v[36:37]
    v_pk_add_f32 v[26:27], v[26:27], v[38:39]
    v_pk_add_f32 v[32:33], v[32:33], v[54:55]
    v_max3_f32 v34, v24, v25, v26
    v_max3_f32 v34, v34, v27, v32
    v_max_f32_e64 v34, v34, v33
    v_cvt_pk_bf16_f32 v76, v40, v41
    v_cvt_pk_bf16_f32 v77, v42, v43
    v_max_f32_dpp v34, v34, v34 row_ror:8 row_mask:0xf bank_mask:0xf
    v_mov_b32_e64 v35, v34
    v_cvt_pk_bf16_f32 v78, v44, v45
    v_cvt_pk_bf16_f32 v79, v46, v47
    v_permlane16_swap_b32 v34, v35
    v_max_f32 v34, v34, v35
    v_mov_b32 v35, v34
    v_mov_b32 v56, 0
    v_mov_b32 v57, 0
    v_permlane32_swap_b32 v34, v35
    v_max_f32 v34, v34, v35
    v_mul_f32 v34, s50, v34
    v_pk_fma_f32 v[24:25], v[24:25], s[54:55], v[34:35] op_sel_hi:[1,1,0] neg_lo:[0,0,1] neg_hi:[0,0,1]
    v_pk_fma_f32 v[26:27], v[26:27], s[54:55], v[34:35] op_sel_hi:[1,1,0] neg_lo:[0,0,1] neg_hi:[0,0,1]
    v_pk_fma_f32 v[32:33], v[32:33], s[54:55], v[34:35] op_sel_hi:[1,1,0] neg_lo:[0,0,1] neg_hi:[0,0,1]
    v_exp_f32 v24, v24
    v_exp_f32 v25, v25
    v_exp_f32 v26, v26
    v_exp_f32 v27, v27
    v_exp_f32 v32, v32
    v_exp_f32 v33, v33
    v_cvt_pk_bf16_f32 v48, v24, v25
    v_cvt_pk_bf16_f32 v49, v26, v27
    v_cvt_pk_bf16_f32 v52, v32, v33
    v_mov_b32_dpp v50, v48 row_ror:8 row_mask:0xf bank_mask:0xf
    v_mov_b32_dpp v51, v49 row_ror:8 row_mask:0xf bank_mask:0xf
    v_mov_b32_dpp v53, v52 row_ror:8 row_mask:0xf bank_mask:0xf
    v_pk_add_f32 v[24:25], v[24:25], v[26:27]
    s_waitcnt vmcnt(3)
    v_mfma_f32_16x16x32_bf16 v[28:31], v[8:11], v[48:51], 0
    v_add_f32 v32, v32, v33
    v_add_f32_e64 v24, v24, v25
    v_mfma_f32_16x16x32_bf16 v[36:39], v[12:15], v[48:51], 0
    v_fma_f32 v34, v32, 0.5, v24
    v_mfma_f32_16x16x16_bf16 v[28:31], v[76:77], v[52:53], v[28:31]
    v_mov_b32_e64 v58, 0
    v_add_f32_dpp v34, v34, v34 row_ror:8 row_mask:0xf bank_mask:0xf
    v_mfma_f32_16x16x16_bf16 v[36:39], v[78:79], v[52:53], v[36:39]
    v_mov_b32 v35, v34
    v_mov_b32 v59, 0
    v_mov_b32 v60, 0
    v_permlane16_swap_b32 v34, v35
    v_add_f32 v34, v34, v35
    v_mov_b32 v35, v34
    v_mov_b32 v61, 0
    v_mov_b32 v62, 0
    v_permlane32_swap_b32 v34, v35
    v_add_f32 v34, v34, v35
    v_rcp_f32 v34, v34
    s_mov_b64 exec, s[46:47]
    v_pk_mul_f32 v[28:29], v[28:29], v[34:35] op_sel_hi:[1,0]
    v_pk_mul_f32 v[30:31], v[30:31], v[34:35] op_sel_hi:[1,0]
    v_pk_mul_f32 v[36:37], v[36:37], v[34:35] op_sel_hi:[1,0]
    v_pk_mul_f32 v[38:39], v[38:39], v[34:35] op_sel_hi:[1,0]
    v_cvt_pk_bf16_f32 v24, v28, v29
    v_cvt_pk_bf16_f32 v25, v30, v31
    v_cvt_pk_bf16_f32 v26, v36, v37
    v_cvt_pk_bf16_f32 v27, v38, v39
    ds_write_b128 v22, v[24:27]
    s_mov_b64 exec, -1
    v_mov_b32 v63, 0
    v_mov_b32 v64, 0
    v_mov_b32 v65, 0
    v_mov_b32 v66, 0
    v_mov_b32 v67, 0
    v_mov_b32 v68, 0
    v_mov_b32 v69, 0
    v_mov_b32 v70, 0
    v_mov_b32 v71, 0
    v_mov_b32 v72, 0
    v_mov_b32 v73, 0
    v_mov_b32 v74, 0
    v_mov_b32 v75, 0
    s_waitcnt lgkmcnt(0)
    s_barrier
    ds_read_b128 v[48:51], v19 offset:5120
    ds_read_b128 v[52:55], v19 offset:6144
    v_subrev_u32 v21, 0x20000, v21
    v_lshrrev_b32_e64 v24, 8, v19
    v_bfe_u32 v25, v19, 2, 6
    v_lshl_add_u32 v24, v24, 13, v25
    s_waitcnt lgkmcnt(1)
    v_smfmac_f32_16x16x64_bf16 v[56:59], v[48:51], v[176:183], v18 abid:1
    s_waitcnt lgkmcnt(0)
    v_smfmac_f32_16x16x64_bf16 v[56:59], v[52:55], v[216:223], v18 abid:1
    v_smfmac_f32_16x16x64_bf16 v[60:63], v[48:51], v[184:191], v18 abid:1
    v_smfmac_f32_16x16x64_bf16 v[60:63], v[52:55], v[224:231], v18 abid:1
    v_add_f32_e64 v56, v56, v58
    v_smfmac_f32_16x16x64_bf16 v[64:67], v[48:51], v[192:199], v18 abid:1
    v_add_f32_e64 v57, v57, v59
    v_smfmac_f32_16x16x64_bf16 v[64:67], v[52:55], v[232:239], v18 abid:1
    v_cvt_pk_bf16_f32 v28, v56, v57
    v_add_f32_e64 v60, v60, v62
    v_smfmac_f32_16x16x64_bf16 v[68:71], v[48:51], v[200:207], v18 abid:1
    v_add_f32_e64 v61, v61, v63
    v_bfi_b32 v28, 1, s21, v28
    v_smfmac_f32_16x16x64_bf16 v[68:71], v[52:55], v[240:247], v18 abid:1
    v_cvt_pk_bf16_f32 v29, v60, v61
    v_add_f32_e64 v64, v64, v66
    v_smfmac_f32_16x16x64_bf16 v[72:75], v[48:51], v[208:215], v18 abid:1
    v_add_f32_e64 v65, v65, v67
    v_smfmac_f32_16x16x64_bf16 v[72:75], v[52:55], v[248:255], v18 abid:1
    v_add_f32_e64 v68, v68, v70
    v_add_f32 v69, v69, v71
    v_cvt_pk_bf16_f32 v30, v64, v65
    v_cvt_pk_bf16_f32 v31, v68, v69
    buffer_store_dwordx4 v[28:31], v23, s[8:11], s27 offen
    s_nop 2
    v_pk_add_f32 v[72:73], v[72:73], v[74:75]
    v_cvt_pk_bf16_f32 v72, v72, v73
    v_bfi_b32 v72, 1, s21, v72
    buffer_store_dword v72, v24, s[8:11], s28 offen
    s_cmp_lt_u32 s20, 58
    s_cbranch_scc1 R_noearly_154
    buffer_store_dwordx4 v[92:95], v19, s[8:11], s35 offen sc1
R_noearly_154:
R_nored_155:
    s_add_u32 s40, s20, 3
    s_min_u32 s40, s40, 63
fp_157:
    s_cmp_lt_u32 s40, s79
    s_cbranch_scc1 fpok_158
    v_mov_b32_e64 v52, 0
    buffer_load_dwordx4 v[48:51], v52, s[8:11], s37 offen sc1
    s_waitcnt vmcnt(0)
    v_min_u32 v48, v48, v50
    v_min3_u32 v48, v48, v49, v51
    v_lshlrev_b32 v48, 1, v48
    s_nop 0
    v_readfirstlane_b32 s79, v48
    s_add_u32 s6, s6, 1
    s_cmp_lt_u32 s6, 400000
    s_cbranch_scc1 fp_157
    s_branch fpok_158
fpok_158:
    s_add_u32 s36, s36, 0x40000
    v_mov_b32 v24, 0
    v_mov_b32 v25, 0
    v_mov_b32 v26, 0
    v_mov_b32 v27, 0
    v_mov_b32 v28, 0
    v_mov_b32 v29, 0
    v_mov_b32 v30, 0
    v_mov_b32 v31, 0
    v_mov_b32 v32, 0
    v_mov_b32 v33, 0
    v_mov_b32 v34, 0
    v_mov_b32 v35, 0
    v_mov_b32 v36, 0
    v_mov_b32 v37, 0
    v_mov_b32 v38, 0
    v_mov_b32 v39, 0
    v_mov_b32 v40, 0
    v_mov_b32 v41, 0
    v_mov_b32 v42, 0
    v_mov_b32 v43, 0
    v_mov_b32 v44, 0
    v_mov_b32 v45, 0
    v_mov_b32 v46, 0
    v_mov_b32 v47, 0
    ds_read_b128 v[76:79], v21 offset:0
    ds_read_b128 v[80:83], v21 offset:1024
    ds_read_b128 v[84:87], v21 offset:2048
    ds_read_b128 v[88:91], v21 offset:3072
    v_lshrrev_b32 v53, 2, v20
    v_add_u32 v53, 4, v53
    s_add_u32 s20, s20, 1
R_join_156:
    s_barrier
    s_nop 15
    s_nop 15
    s_nop 15
    s_nop 11
    s_branch R_top_143
R_par_149:
    buffer_load_dwordx4 v[0:3], v20, s[8:11], s32 offen sc1
    buffer_load_dword v4, v53, s[8:11], s32 offen offset:4092 sc1
    s_waitcnt vmcnt(2)
    ds_write_b128 v20, v[48:51]
    ds_write_b32 v53, v52 offset:4092
    v_bitop3_b32 v56, v48, v49, s22 bitop3:0x7e
    v_bitop3_b32 v57, v50, v51, s22 bitop3:0x7e
    v_bitop3_b32 v56, v52, v56, s22 bitop3:0xde
    v_bitop3_b32 v56, v56, v57, 1 bitop3:0xa8
    v_cmp_ne_u32 vcc, 0, v56
    s_cbranch_vccz R_paok_148
    buffer_load_dwordx4 v[48:51], v20, s[8:11], s32 offen sc1
    buffer_load_dword v52, v53, s[8:11], s32 offen offset:4092 sc1
    s_add_u32 s6, s6, 1
    s_cmp_lt_u32 s6, 400000
    s_cbranch_scc1 R_pa_147
    s_branch R_paok_148
R_pcr_152:
    s_waitcnt vmcnt(1)
    ds_write_b128 v20, v[8:11] offset:5120
    ds_write_b32 v53, v12 offset:9212
    v_bitop3_b32 v54, v8, v9, s22 bitop3:0x7e
    v_bitop3_b32 v55, v10, v11, s22 bitop3:0x7e
    v_bitop3_b32 v54, v12, v54, s22 bitop3:0xde
    v_bitop3_b32 v54, v54, v55, s52 bitop3:0xa8
    v_cmp_ne_u32_e64 vcc, 0, v54
    s_cbranch_vccz R_pcok_151
R_pcr2_159:
    s_add_u32 s6, s6, 1
    s_cmp_lt_u32 s6, 400000
    s_cbranch_scc1 R_pc2_153
    s_branch R_pcok_151
R_pc2_153:
    s_waitcnt lgkmcnt(0)
    buffer_load_dwordx4 v[48:51], v20, s[8:11], s33 offen sc1
    buffer_load_dword v52, v53, s[8:11], s33 offen offset:4092 sc1
    s_waitcnt vmcnt(0)
    ds_write_b128 v20, v[48:51] offset:5120
    ds_write_b32 v53, v52 offset:9212
    v_bitop3_b32 v54, v48, v49, s22 bitop3:0x7e
    v_bitop3_b32 v55, v50, v51, s22 bitop3:0x7e
    v_bitop3_b32 v54, v52, v54, s22 bitop3:0xde
    v_bitop3_b32 v54, v54, v55, s52 bitop3:0xa8
    v_cmp_ne_u32 vcc, 0, v54
    s_cbranch_vccnz R_pcr2_159
    s_branch R_pcok_151
R_exit_145:
    s_waitcnt lgkmcnt(0)
    buffer_store_dwordx4 v[92:95], v19, s[8:11], s35 offen sc1
    s_branch R_end_87
R_v11r_91:
    s_branch R_ent_161
.p2align 6
R_top_160:
    buffer_load_dwordx4 v[0:3], v20, s[8:11], s32 offen sc1
    buffer_load_dword v4, v53, s[8:11], s32 offen offset:4092 sc1
    s_nop 15
    s_nop 8
    buffer_load_dwordx4 v[48:51], v20, s[8:11], s32 offen sc1
    buffer_load_dword v52, v53, s[8:11], s32 offen offset:4092 sc1
R_pa_164:
    s_waitcnt vmcnt(2)
    ds_write_b128 v20, v[0:3]
    ds_write_b32 v53, v4 offset:4092
    v_bitop3_b32 v56, v0, v1, s22 bitop3:0x7e
    v_bitop3_b32 v57, v2, v3, s22 bitop3:0x7e
    v_bitop3_b32 v56, v4, v56, s22 bitop3:0xde
    v_bitop3_b32 v56, v56, v57, 1 bitop3:0xa8
    v_cmp_ne_u32 vcc, 0, v56
    s_cbranch_vccnz R_par_166
R_paok_165:
    buffer_load_dwordx4 v[48:51], v20, s[8:11], s33 offen sc1
    buffer_load_dword v52, v53, s[8:11], s33 offen offset:4092 sc1
    s_waitcnt lgkmcnt(0)
    s_barrier
R_ent_161:
    ds_read_b128 v[56:59], v19 offset:0
    ds_read_b128 v[60:63], v19 offset:1024
    ds_read_b128 v[64:67], v19 offset:2048
    ds_read_b128 v[68:71], v19 offset:3072
    ds_read_b128 v[72:75], v19 offset:4096
    s_waitcnt lgkmcnt(4)
    v_smfmac_f32_16x16x64_bf16 v[24:27], v[56:59], v[76:83], v18
    ds_read_b128 v[76:79], v21 offset:16384
    s_xor_b32 s21, s21, 1
    buffer_load_dwordx4 v[0:3], v19, s[8:11], s34 offen offset:0 sc1
    v_smfmac_f32_16x16x64_bf16 v[28:31], v[56:59], v[84:91], v18
    ds_read_b128 v[80:83], v21 offset:17408
    s_min_u32 s40, s20, 1
    buffer_load_dwordx4 v[4:7], v19, s[8:11], s34 offen offset:1024 sc1
    v_smfmac_f32_16x16x64_bf16 v[32:35], v[56:59], a[112:119], v18
    ds_read_b128 v[84:87], v21 offset:18432
    s_lshl_b32 s41, s40, 17
    v_smfmac_f32_16x16x64_bf16 v[36:39], v[56:59], a[120:127], v18
    ds_read_b128 v[88:91], v21 offset:19456
    s_waitcnt lgkmcnt(7)
    v_smfmac_f32_16x16x64_bf16 v[24:27], v[60:63], a[0:7], v18
    buffer_load_dwordx4 v[8:11], v20, s[8:11], s33 offen sc1
    v_smfmac_f32_16x16x64_bf16 v[28:31], v[60:63], a[8:15], v18
    buffer_load_dword v12, v53, s[8:11], s33 offen offset:4092 sc1
    s_waitcnt lgkmcnt(2)
    v_smfmac_f32_16x16x64_bf16 v[32:35], v[60:63], v[76:83], v18
    ds_read_b128 v[76:79], v21 offset:32768
    s_waitcnt lgkmcnt(1)
    v_smfmac_f32_16x16x64_bf16 v[36:39], v[60:63], v[84:91], v18
    ds_read_b128 v[80:83], v21 offset:33792
    v_smfmac_f32_16x16x64_bf16 v[24:27], v[64:67], a[16:23], v18
    ds_read_b128 v[84:87], v21 offset:34816
    v_smfmac_f32_16x16x64_bf16 v[28:31], v[64:67], a[24:31], v18
    ds_read_b128 v[88:91], v21 offset:35840
    v_smfmac_f32_16x16x64_bf16 v[32:35], v[64:67], a[128:135], v18
    v_smfmac_f32_16x16x64_bf16 v[36:39], v[64:67], a[136:143], v18
    s_waitcnt lgkmcnt(2)
    v_smfmac_f32_16x16x64_bf16 v[24:27], v[68:71], v[76:83], v18
    ds_read_b128 v[76:79], v21 offset:49152
    s_waitcnt lgkmcnt(1)
    v_smfmac_f32_16x16x64_bf16 v[28:31], v[68:71], v[84:91], v18
    ds_read_b128 v[80:83], v21 offset:50176
    v_smfmac_f32_16x16x64_bf16 v[32:35], v[68:71], a[144:151], v18
    ds_read_b128 v[84:87], v21 offset:51200
    v_smfmac_f32_16x16x64_bf16 v[36:39], v[68:71], a[152:159], v18
    ds_read_b128 v[88:91], v21 offset:52224
    v_smfmac_f32_16x16x64_bf16 v[24:27], v[72:75], a[32:39], v18
    v_add_u32 v21, 0x10000, v21
    buffer_store_dwordx4 v[92:95], v19, s[8:11], s35 offen sc1
    v_smfmac_f32_16x16x64_bf16 v[28:31], v[72:75], a[40:47], v18
    s_add_u32 s35, s35, s41
    s_add_u32 s51, s34, 0x1000000
    s_waitcnt lgkmcnt(2)
    v_smfmac_f32_16x16x64_bf16 v[32:35], v[72:75], v[76:83], v18
    ds_read_b128 v[76:79], v21 offset:0
    s_add_u32 s34, s34, 0x40000
    s_waitcnt lgkmcnt(1)
    v_smfmac_f32_16x16x64_bf16 v[36:39], v[72:75], v[84:91], v18
    ds_read_b128 v[80:83], v21 offset:1024
    v_smfmac_f32_16x16x64_bf16 v[40:43], v[56:59], a[208:215], v18
    ds_read_b128 v[84:87], v21 offset:2048
    v_smfmac_f32_16x16x64_bf16 v[44:47], v[56:59], a[216:223], v18
    ds_read_b128 v[88:91], v21 offset:3072
    s_waitcnt vmcnt(3)
    ds_write_b128 v20, v[48:51] offset:5120
    ds_write_b32 v53, v52 offset:9212
    v_smfmac_f32_16x16x64_bf16 v[40:43], v[60:63], a[224:231], v18
    v_bitop3_b32 v54, v48, v49, s22 bitop3:0x7e
    v_bitop3_b32 v55, v50, v51, s22 bitop3:0x7e
    v_smfmac_f32_16x16x64_bf16 v[44:47], v[60:63], a[232:239], v18
    v_bitop3_b32 v54, v52, v54, s22 bitop3:0xde
    v_bitop3_b32 v54, v54, v55, s52 bitop3:0xa8
    s_waitcnt lgkmcnt(4)
    v_smfmac_f32_16x16x64_bf16 v[40:43], v[64:67], v[76:83], v18
    v_cmp_ne_u32_e64 vcc, 0, v54
    s_waitcnt lgkmcnt(2)
    v_smfmac_f32_16x16x64_bf16 v[44:47], v[64:67], v[84:91], v18
    s_cbranch_vccnz R_pcr_169
R_pcok_168:
    s_waitcnt lgkmcnt(0)
    s_barrier
    ds_read_b128 v[56:59], v19 offset:5120
    ds_read_b128 v[60:63], v19 offset:6144
    v_smfmac_f32_16x16x64_bf16 v[40:43], v[68:71], a[240:247], v18
    ds_read_b128 v[64:67], v19 offset:7168
    v_smfmac_f32_16x16x64_bf16 v[44:47], v[68:71], a[248:255], v18
    ds_read_b128 v[68:71], v19 offset:8192
    v_smfmac_f32_16x16x64_bf16 v[40:43], v[72:75], v[96:103], v18
    v_smfmac_f32_16x16x64_bf16 v[44:47], v[72:75], v[104:111], v18
    ds_read_b128 v[72:75], v19 offset:9216
    s_waitcnt lgkmcnt(4)
    v_smfmac_f32_16x16x64_bf16 v[24:27], v[56:59], a[48:55], v18
    ds_read_b128 v[76:79], v21 offset:16384
    s_andn2_b32 s40, 1, s20
    v_smfmac_f32_16x16x64_bf16 v[28:31], v[56:59], a[56:63], v18
    ds_read_b128 v[80:83], v21 offset:17408
    s_xor_b32 s22, s22, s40
    s_waitcnt lgkmcnt(5)
    v_smfmac_f32_16x16x64_bf16 v[24:27], v[60:63], a[64:71], v18
    ds_read_b128 v[84:87], v21 offset:18432
    s_mov_b32 s52, 1
    v_smfmac_f32_16x16x64_bf16 v[28:31], v[60:63], a[72:79], v18
    ds_read_b128 v[88:91], v21 offset:19456
    s_min_u32 s40, s20, 1
    s_waitcnt lgkmcnt(6)
    v_smfmac_f32_16x16x64_bf16 v[24:27], v[64:67], a[80:87], v18
    buffer_load_dwordx4 v[8:11], v19, s[8:11], s51 offen offset:0 sc1
    v_smfmac_f32_16x16x64_bf16 v[28:31], v[64:67], a[88:95], v18
    buffer_load_dwordx4 v[12:15], v19, s[8:11], s51 offen offset:1024 sc1
    s_mov_b32 s33, s56
    s_waitcnt lgkmcnt(2)
    v_smfmac_f32_16x16x64_bf16 v[24:27], v[68:71], v[76:83], v18
    ds_read_b128 v[76:79], v21 offset:32768
    s_xor_b32 s56, s56, 0x4000
    s_waitcnt lgkmcnt(1)
    v_smfmac_f32_16x16x64_bf16 v[28:31], v[68:71], v[84:91], v18
    ds_read_b128 v[80:83], v21 offset:33792
    s_xor_b32 s32, s32, 0x4000
    v_smfmac_f32_16x16x64_bf16 v[24:27], v[72:75], a[96:103], v18
    ds_read_b128 v[84:87], v21 offset:34816
    v_smfmac_f32_16x16x64_bf16 v[28:31], v[72:75], a[104:111], v18
    ds_read_b128 v[88:91], v21 offset:35840
    v_smfmac_f32_16x16x64_bf16 v[32:35], v[56:59], a[160:167], v18
    v_smfmac_f32_16x16x64_bf16 v[36:39], v[56:59], a[168:175], v18
    s_waitcnt lgkmcnt(2)
    v_smfmac_f32_16x16x64_bf16 v[32:35], v[60:63], v[76:83], v18
    ds_read_b128 v[76:79], v21 offset:49152
    s_waitcnt lgkmcnt(1)
    v_smfmac_f32_16x16x64_bf16 v[36:39], v[60:63], v[84:91], v18
    ds_read_b128 v[80:83], v21 offset:50176
    v_cvt_pk_bf16_f32 v48, v24, v25
    v_smfmac_f32_16x16x64_bf16 v[32:35], v[64:67], a[176:183], v18
    ds_read_b128 v[84:87], v21 offset:51200
    v_cvt_pk_bf16_f32 v49, v26, v27
    v_smfmac_f32_16x16x64_bf16 v[36:39], v[64:67], a[184:191], v18
    ds_read_b128 v[88:91], v21 offset:52224
    v_cvt_pk_bf16_f32 v50, v28, v29
    v_smfmac_f32_16x16x64_bf16 v[32:35], v[68:71], a[192:199], v18
    v_cvt_pk_bf16_f32 v51, v30, v31
    v_smfmac_f32_16x16x64_bf16 v[36:39], v[68:71], a[200:207], v18
    v_add_u32 v21, 0x10000, v21
    s_waitcnt lgkmcnt(2)
    v_smfmac_f32_16x16x64_bf16 v[32:35], v[72:75], v[76:83], v18
    ds_read_b128 v[76:79], v21 offset:0
    s_waitcnt lgkmcnt(1)
    v_smfmac_f32_16x16x64_bf16 v[36:39], v[72:75], v[84:91], v18
    ds_read_b128 v[80:83], v21 offset:1024
    v_mfma_f32_16x16x16_bf16 v[24:27], v[48:49], v[16:17], 0
    ds_read_b128 v[84:87], v21 offset:2048
    v_mfma_f32_16x16x16_bf16 v[28:31], v[50:51], v[16:17], 0
    ds_read_b128 v[88:91], v21 offset:3072
    v_cvt_pk_bf16_f32 v52, v32, v33
    v_cvt_pk_bf16_f32 v53, v34, v35
    v_cvt_pk_bf16_f32 v54, v36, v37
    v_cvt_pk_bf16_f32 v55, v38, v39
    v_mfma_f32_16x16x16_bf16 v[32:35], v[52:53], v[16:17], 0
    v_cvt_pk_bf16_f32 v48, v24, v25
    v_mfma_f32_16x16x16_bf16 v[36:39], v[54:55], v[16:17], 0
    v_cvt_pk_bf16_f32 v49, v26, v27
    v_cvt_pk_bf16_f32 v50, v28, v29
    v_cvt_pk_bf16_f32 v51, v30, v31
    s_nop 1
    v_mfma_f32_16x16x32_bf16 v[24:27], v[0:3], v[48:51], 0
    v_mfma_f32_16x16x32_bf16 v[28:31], v[4:7], v[48:51], 0
    v_cvt_pk_bf16_f32 v52, v32, v33
    v_cvt_pk_bf16_f32 v53, v34, v35
    v_cvt_pk_bf16_f32 v54, v36, v37
    v_cvt_pk_bf16_f32 v55, v38, v39
    s_nop 1
    v_mfma_f32_16x16x32_bf16 v[32:35], v[52:55], v[48:51], 0
    s_nop 2
    v_cndmask_b32 v24, v24, v28, s[44:45]
    v_cndmask_b32 v25, v25, v29, s[44:45]
    v_cndmask_b32 v26, v26, v30, s[44:45]
    v_cndmask_b32 v27, v27, v31, s[44:45]
    ds_write_b128 v20, v[24:27] offset:10240
    v_cndmask_b32 v32, v32, v34, s[44:45]
    v_cndmask_b32 v33, v33, v35, s[44:45]
    ds_write_b64 v20, v[32:33] offset:0
    v_smfmac_f32_16x16x64_bf16 v[40:43], v[56:59], v[112:119], v18
    v_xor_b32 v52, 0x400, v20
    v_smfmac_f32_16x16x64_bf16 v[44:47], v[56:59], v[120:127], v18
    v_xor_b32 v54, 0x800, v20
    v_smfmac_f32_16x16x64_bf16 v[40:43], v[60:63], v[128:135], v18
    v_xor_b32 v34, 0xc00, v20
    v_smfmac_f32_16x16x64_bf16 v[44:47], v[60:63], v[136:143], v18
    v_smfmac_f32_16x16x64_bf16 v[40:43], v[64:67], v[144:151], v18
    s_cmp_eq_u32 s20, 63
    s_cbranch_scc1 R_exit_162
    s_waitcnt lgkmcnt(0)
    s_barrier
    ds_read_b128 v[28:31], v52 offset:10240
    ds_read_b64 v[52:53], v52 offset:0
    v_smfmac_f32_16x16x64_bf16 v[44:47], v[64:67], v[152:159], v18
    ds_read_b128 v[36:39], v54 offset:10240
    v_smfmac_f32_16x16x64_bf16 v[40:43], v[68:71], v[160:167], v18
    ds_read_b64 v[54:55], v54 offset:0
    v_smfmac_f32_16x16x64_bf16 v[44:47], v[68:71], v[168:175], v18
    ds_read_b128 v[48:51], v34 offset:10240
    v_smfmac_f32_16x16x64_bf16 v[40:43], v[72:75], v[76:83], v18
    ds_read_b64 v[34:35], v34 offset:0
    v_smfmac_f32_16x16x64_bf16 v[44:47], v[72:75], v[84:91], v18
    s_waitcnt lgkmcnt(5)
    v_pk_add_f32 v[24:25], v[24:25], v[28:29]
    v_pk_add_f32 v[26:27], v[26:27], v[30:31]
    s_waitcnt lgkmcnt(4)
    v_pk_add_f32 v[32:33], v[32:33], v[52:53]
    s_waitcnt lgkmcnt(1)
    v_pk_add_f32 v[36:37], v[36:37], v[48:49]
    v_pk_add_f32 v[38:39], v[38:39], v[50:51]
    s_waitcnt lgkmcnt(0)
    v_pk_add_f32 v[54:55], v[54:55], v[34:35]
    v_pk_add_f32 v[24:25], v[24:25], v[36:37]
    v_pk_add_f32 v[26:27], v[26:27], v[38:39]
    v_pk_add_f32 v[32:33], v[32:33], v[54:55]
    v_max3_f32 v34, v24, v25, v26
    v_max3_f32 v34, v34, v27, v32
    v_max_f32_e64 v34, v34, v33
    v_cvt_pk_bf16_f32 v92, v40, v41
    v_cvt_pk_bf16_f32 v93, v42, v43
    v_max_f32_dpp v34, v34, v34 row_ror:8 row_mask:0xf bank_mask:0xf
    v_mov_b32_e64 v35, v34
    v_cvt_pk_bf16_f32 v94, v44, v45
    v_cvt_pk_bf16_f32 v95, v46, v47
    v_permlane16_swap_b32 v34, v35
    v_max_f32 v34, v34, v35
    v_mov_b32 v35, v34
    v_mov_b32 v56, 0
    v_mov_b32 v57, 0
    v_permlane32_swap_b32 v34, v35
    v_max_f32 v34, v34, v35
    v_mul_f32 v34, s50, v34
    v_pk_fma_f32 v[24:25], v[24:25], s[54:55], v[34:35] op_sel_hi:[1,1,0] neg_lo:[0,0,1] neg_hi:[0,0,1]
    v_pk_fma_f32 v[26:27], v[26:27], s[54:55], v[34:35] op_sel_hi:[1,1,0] neg_lo:[0,0,1] neg_hi:[0,0,1]
    v_pk_fma_f32 v[32:33], v[32:33], s[54:55], v[34:35] op_sel_hi:[1,1,0] neg_lo:[0,0,1] neg_hi:[0,0,1]
    v_exp_f32 v24, v24
    v_exp_f32 v25, v25
    v_exp_f32 v26, v26
    v_exp_f32 v27, v27
    v_exp_f32 v32, v32
    v_exp_f32 v33, v33
    v_cvt_pk_bf16_f32 v48, v24, v25
    v_cvt_pk_bf16_f32 v49, v26, v27
    v_cvt_pk_bf16_f32 v52, v32, v33
    v_mov_b32_dpp v50, v48 row_ror:8 row_mask:0xf bank_mask:0xf
    v_mov_b32_dpp v51, v49 row_ror:8 row_mask:0xf bank_mask:0xf
    v_mov_b32_dpp v53, v52 row_ror:8 row_mask:0xf bank_mask:0xf
    v_pk_add_f32 v[24:25], v[24:25], v[26:27]
    s_waitcnt vmcnt(0)
    v_mfma_f32_16x16x32_bf16 v[28:31], v[8:11], v[48:51], 0
    v_add_f32 v32, v32, v33
    v_add_f32_e64 v24, v24, v25
    v_mfma_f32_16x16x32_bf16 v[36:39], v[12:15], v[48:51], 0
    v_fma_f32 v34, v32, 0.5, v24
    v_mfma_f32_16x16x16_bf16 v[28:31], v[92:93], v[52:53], v[28:31]
    v_mov_b32_e64 v58, 0
    v_add_f32_dpp v34, v34, v34 row_ror:8 row_mask:0xf bank_mask:0xf
    v_mfma_f32_16x16x16_bf16 v[36:39], v[94:95], v[52:53], v[36:39]
    v_mov_b32 v35, v34
    v_mov_b32 v59, 0
    v_mov_b32 v60, 0
    v_permlane16_swap_b32 v34, v35
    v_add_f32 v34, v34, v35
    v_mov_b32 v35, v34
    v_mov_b32 v61, 0
    v_mov_b32 v62, 0
    v_permlane32_swap_b32 v34, v35
    v_add_f32 v34, v34, v35
    v_rcp_f32 v34, v34
    s_mov_b64 exec, s[46:47]
    v_pk_mul_f32 v[28:29], v[28:29], v[34:35] op_sel_hi:[1,0]
    v_pk_mul_f32 v[30:31], v[30:31], v[34:35] op_sel_hi:[1,0]
    v_pk_mul_f32 v[36:37], v[36:37], v[34:35] op_sel_hi:[1,0]
    v_pk_mul_f32 v[38:39], v[38:39], v[34:35] op_sel_hi:[1,0]
    v_cvt_pk_bf16_f32 v24, v28, v29
    v_cvt_pk_bf16_f32 v25, v30, v31
    v_cvt_pk_bf16_f32 v26, v36, v37
    v_cvt_pk_bf16_f32 v27, v38, v39
    ds_write_b128 v22, v[24:27]
    s_mov_b64 exec, -1
    v_mov_b32 v63, 0
    v_mov_b32 v64, 0
    v_mov_b32 v65, 0
    v_mov_b32 v66, 0
    v_mov_b32 v67, 0
    v_mov_b32 v68, 0
    v_mov_b32 v69, 0
    v_mov_b32 v70, 0
    v_mov_b32 v71, 0
    v_mov_b32 v72, 0
    v_mov_b32 v73, 0
    v_mov_b32 v74, 0
    v_mov_b32 v75, 0
    s_waitcnt lgkmcnt(0)
    s_barrier
    ds_read_b128 v[48:51], v19 offset:5120
    ds_read_b128 v[52:55], v19 offset:6144
    v_subrev_u32 v21, 0x20000, v21
    v_lshrrev_b32_e64 v24, 8, v19
    v_bfe_u32 v25, v19, 2, 6
    v_lshl_add_u32 v24, v24, 13, v25
    s_waitcnt lgkmcnt(1)
    v_smfmac_f32_16x16x64_bf16 v[56:59], v[48:51], v[176:183], v18 abid:1
    s_waitcnt lgkmcnt(0)
    v_smfmac_f32_16x16x64_bf16 v[56:59], v[52:55], v[216:223], v18 abid:1
    v_smfmac_f32_16x16x64_bf16 v[60:63], v[48:51], v[184:191], v18 abid:1
    v_smfmac_f32_16x16x64_bf16 v[60:63], v[52:55], v[224:231], v18 abid:1
    v_add_f32_e64 v56, v56, v58
    v_smfmac_f32_16x16x64_bf16 v[64:67], v[48:51], v[192:199], v18 abid:1
    v_add_f32_e64 v57, v57, v59
    v_smfmac_f32_16x16x64_bf16 v[64:67], v[52:55], v[232:239], v18 abid:1
    v_cvt_pk_bf16_f32 v28, v56, v57
    v_add_f32_e64 v60, v60, v62
    v_smfmac_f32_16x16x64_bf16 v[68:71], v[48:51], v[200:207], v18 abid:1
    v_add_f32_e64 v61, v61, v63
    v_bfi_b32 v28, 1, s21, v28
    v_smfmac_f32_16x16x64_bf16 v[68:71], v[52:55], v[240:247], v18 abid:1
    v_cvt_pk_bf16_f32 v29, v60, v61
    v_add_f32_e64 v64, v64, v66
    v_smfmac_f32_16x16x64_bf16 v[72:75], v[48:51], v[208:215], v18 abid:1
    v_add_f32_e64 v65, v65, v67
    v_smfmac_f32_16x16x64_bf16 v[72:75], v[52:55], v[248:255], v18 abid:1
    v_add_f32_e64 v68, v68, v70
    v_add_f32 v69, v69, v71
    v_cvt_pk_bf16_f32 v30, v64, v65
    v_cvt_pk_bf16_f32 v31, v68, v69
    buffer_store_dwordx4 v[28:31], v23, s[8:11], s27 offen
    s_nop 2
    v_pk_add_f32 v[72:73], v[72:73], v[74:75]
    v_cvt_pk_bf16_f32 v72, v72, v73
    v_bfi_b32 v72, 1, s21, v72
    buffer_store_dword v72, v24, s[8:11], s28 offen
    s_cmp_lt_u32 s20, 58
    s_cbranch_scc1 R_noearly_171
    buffer_store_dwordx4 v[92:95], v19, s[8:11], s35 offen sc1
R_noearly_171:
    v_mov_b32 v24, 0
    v_mov_b32 v25, 0
    v_mov_b32 v26, 0
    v_mov_b32 v27, 0
    v_mov_b32 v28, 0
    v_mov_b32 v29, 0
    v_mov_b32 v30, 0
    v_mov_b32 v31, 0
    v_mov_b32 v32, 0
    v_mov_b32 v33, 0
    v_mov_b32 v34, 0
    v_mov_b32 v35, 0
    v_mov_b32 v36, 0
    v_mov_b32 v37, 0
    v_mov_b32 v38, 0
    v_mov_b32 v39, 0
    v_mov_b32 v40, 0
    v_mov_b32 v41, 0
    v_mov_b32 v42, 0
    v_mov_b32 v43, 0
    v_mov_b32 v44, 0
    v_mov_b32 v45, 0
    v_mov_b32 v46, 0
    v_mov_b32 v47, 0
    ds_read_b128 v[76:79], v21 offset:0
    buffer_load_dwordx4 v[56:59], v19, s[8:11], s29 offen offset:0 sc1
    buffer_load_dwordx4 v[60:63], v19, s[8:11], s29 offen offset:1024 sc1
    ds_read_b128 v[80:83], v21 offset:1024
    ds_read_b128 v[84:87], v21 offset:2048
    ds_read_b128 v[88:91], v21 offset:3072
    v_lshrrev_b32_e64 v53, 2, v20
    v_add_u32 v53, 4, v53
    s_add_u32 s20, s20, 1
    v_mov_b32 v54, 0xfffe0000
    v_lshrrev_b32_e64 v48, 2, v19
    v_and_b32 v48, 0x80, v48
    v_and_or_b32 v55, v19, 16, v48
    v_lshrrev_b32_e64 v48, 5, v19
    v_and_or_b32 v55, v48, 8, v55
    v_lshrrev_b32_e64 v48, 4, v19
    v_and_or_b32 v55, v48, 4, v55
    v_mov_b32 v48, 0x3f80
    v_cndmask_b32 v48, v48, 1.0, s[76:77]
    v_cndmask_b32 v64, 0, v48, s[60:61]
    v_cndmask_b32 v65, 0, v48, s[62:63]
    v_cndmask_b32 v66, 0, v48, s[64:65]
    v_cndmask_b32 v67, 0, v48, s[66:67]
    s_lshl_b32 s26, s22, 16
    s_sub_u32 s24, 0x10000, s26
    s_nop 7
    buffer_load_dwordx4 v[0:3], v19, s[8:11], s29 offen offset:0 sc1
    buffer_load_dwordx4 v[4:7], v19, s[8:11], s29 offen offset:1024 sc1
R_pi_174:
    s_waitcnt vmcnt(3)
    v_mfma_f32_16x16x32_bf16 v[68:71], v[56:59], v[64:67], 0
    s_waitcnt vmcnt(2)
    v_mfma_f32_16x16x32_bf16 v[68:71], v[60:63], v[64:67], v[68:71]
    v_bitop3_b32 v48, v56, v60, s21 bitop3:0x7e
    v_and_b32 v48, 1, v48
    v_cmp_ne_u32 vcc, 0, v48
    s_cbranch_vccnz R_pir_176
R_piok_175:
    s_nop 3
    v_permlane32_swap_b32 v68, v70
    v_permlane32_swap_b32 v69, v71
    v_pk_add_f32 v[68:69], v[68:69], v[70:71]
    s_nop 1
    v_permlane16_swap_b32 v68, v69
    v_add_f32_e64 v68, v68, v69
    v_add_u32 v70, s24, v68
    v_bfi_b32 v70, v54, v70, s26
    v_mov_b32_dpp v69, v68 row_shl:2 row_mask:0xf bank_mask:0xf
    s_mov_b64 exec, s[48:49]
    v_cvt_pk_bf16_f32 v70, v70, v69
    buffer_store_dword v70, v55, s[8:11], s30 offen
    buffer_store_dword v70, v55, s[8:11], s31 offen sc1
    s_mov_b64 exec, -1
    s_xor_b32 s31, s31, 0x4000
    s_xor_b32 s30, s30, 0x4000
    s_barrier
    s_nop 15
    s_nop 15
    s_nop 15
    s_nop 11
    s_branch R_top_160
R_par_166:
    buffer_load_dwordx4 v[0:3], v20, s[8:11], s32 offen sc1
    buffer_load_dword v4, v53, s[8:11], s32 offen offset:4092 sc1
    s_waitcnt vmcnt(2)
    ds_write_b128 v20, v[48:51]
    ds_write_b32 v53, v52 offset:4092
    v_bitop3_b32 v56, v48, v49, s22 bitop3:0x7e
    v_bitop3_b32 v57, v50, v51, s22 bitop3:0x7e
    v_bitop3_b32 v56, v52, v56, s22 bitop3:0xde
    v_bitop3_b32 v56, v56, v57, 1 bitop3:0xa8
    v_cmp_ne_u32 vcc, 0, v56
    s_cbranch_vccz R_paok_165
    buffer_load_dwordx4 v[48:51], v20, s[8:11], s32 offen sc1
    buffer_load_dword v52, v53, s[8:11], s32 offen offset:4092 sc1
    s_add_u32 s6, s6, 1
    s_cmp_lt_u32 s6, 400000
    s_cbranch_scc1 R_pa_164
    s_branch R_paok_165
R_pcr_169:
    s_waitcnt vmcnt(1)
    ds_write_b128 v20, v[8:11] offset:5120
    ds_write_b32 v53, v12 offset:9212
    v_bitop3_b32 v54, v8, v9, s22 bitop3:0x7e
    v_bitop3_b32 v55, v10, v11, s22 bitop3:0x7e
    v_bitop3_b32 v54, v12, v54, s22 bitop3:0xde
    v_bitop3_b32 v54, v54, v55, s52 bitop3:0xa8
    v_cmp_ne_u32_e64 vcc, 0, v54
    s_cbranch_vccz R_pcok_168
R_pcr2_178:
    s_add_u32 s6, s6, 1
    s_cmp_lt_u32 s6, 400000
    s_cbranch_scc1 R_pc2_170
    s_branch R_pcok_168
R_pc2_170:
    s_waitcnt lgkmcnt(0)
    buffer_load_dwordx4 v[48:51], v20, s[8:11], s33 offen sc1
    buffer_load_dword v52, v53, s[8:11], s33 offen offset:4092 sc1
    s_waitcnt vmcnt(0)
    ds_write_b128 v20, v[48:51] offset:5120
    ds_write_b32 v53, v52 offset:9212
    v_bitop3_b32 v54, v48, v49, s22 bitop3:0x7e
    v_bitop3_b32 v55, v50, v51, s22 bitop3:0x7e
    v_bitop3_b32 v54, v52, v54, s22 bitop3:0xde
    v_bitop3_b32 v54, v54, v55, s52 bitop3:0xa8
    v_cmp_ne_u32_e64 vcc, 0, v54
    s_cbranch_vccnz R_pcr2_178
    s_branch R_pcok_168
R_pir_176:
    buffer_load_dwordx4 v[56:59], v19, s[8:11], s29 offen offset:0 sc1
    buffer_load_dwordx4 v[60:63], v19, s[8:11], s29 offen offset:1024 sc1
    s_waitcnt vmcnt(3)
    v_mfma_f32_16x16x32_bf16 v[68:71], v[0:3], v[64:67], 0
    s_waitcnt vmcnt(2)
    v_mfma_f32_16x16x32_bf16 v[68:71], v[4:7], v[64:67], v[68:71]
    v_bitop3_b32 v48, v0, v4, s21 bitop3:0x7e
    v_and_b32_e64 v48, 1, v48
    v_cmp_ne_u32 vcc, 0, v48
    s_cbranch_vccz R_piok_175
    buffer_load_dwordx4 v[0:3], v19, s[8:11], s29 offen offset:0 sc1
    buffer_load_dwordx4 v[4:7], v19, s[8:11], s29 offen offset:1024 sc1
    s_add_u32 s6, s6, 1
    s_cmp_lt_u32 s6, 400000
    s_cbranch_scc1 R_pi_174
    s_branch R_piok_175
R_exit_162:
    s_waitcnt lgkmcnt(0)
    v_smfmac_f32_16x16x64_bf16 v[44:47], v[64:67], v[152:159], v18
    v_smfmac_f32_16x16x64_bf16 v[40:43], v[68:71], v[160:167], v18
    v_smfmac_f32_16x16x64_bf16 v[44:47], v[68:71], v[168:175], v18
    v_smfmac_f32_16x16x64_bf16 v[40:43], v[72:75], v[76:83], v18
    v_smfmac_f32_16x16x64_bf16 v[44:47], v[72:75], v[84:91], v18
    s_nop 3
    v_cvt_pk_bf16_f32 v92, v40, v41
    v_cvt_pk_bf16_f32 v93, v42, v43
    s_nop 1
    v_cvt_pk_bf16_f32 v94, v44, v45
    v_cvt_pk_bf16_f32 v95, v46, v47
    buffer_store_dwordx4 v[92:95], v19, s[8:11], s35 offen sc1
    s_branch R_end_87
R_v11h_92:
    s_branch R_ent_180
.p2align 6
R_top_179:
    buffer_load_dwordx4 v[0:3], v20, s[8:11], s32 offen sc1
    buffer_load_dword v4, v53, s[8:11], s32 offen offset:4092 sc1
    s_nop 15
    s_nop 8
    buffer_load_dwordx4 v[48:51], v20, s[8:11], s32 offen sc1
    buffer_load_dword v52, v53, s[8:11], s32 offen offset:4092 sc1
R_pa_183:
    s_waitcnt vmcnt(2)
    ds_write_b128 v20, v[0:3]
    ds_write_b32 v53, v4 offset:4092
    v_bitop3_b32 v56, v0, v1, s22 bitop3:0x7e
    v_bitop3_b32 v57, v2, v3, s22 bitop3:0x7e
    v_bitop3_b32 v56, v4, v56, s22 bitop3:0xde
    v_bitop3_b32 v56, v56, v57, 1 bitop3:0xa8
    v_cmp_ne_u32 vcc, 0, v56
    s_cbranch_vccnz R_par_185
R_paok_184:
    buffer_load_dwordx4 v[48:51], v20, s[8:11], s33 offen sc1
    buffer_load_dword v52, v53, s[8:11], s33 offen offset:4092 sc1
    s_waitcnt lgkmcnt(0)
    s_barrier
R_ent_180:
    ds_read_b128 v[56:59], v19 offset:0
    ds_read_b128 v[60:63], v19 offset:1024
    ds_read_b128 v[64:67], v19 offset:2048
    ds_read_b128 v[68:71], v19 offset:3072
    ds_read_b128 v[72:75], v19 offset:4096
    s_waitcnt lgkmcnt(4)
    v_smfmac_f32_16x16x64_bf16 v[24:27], v[56:59], v[76:83], v18
    ds_read_b128 v[76:79], v21 offset:16384
    s_xor_b32 s21, s21, 1
    buffer_load_dwordx4 v[0:3], v19, s[8:11], s34 offen offset:0 sc1
    v_smfmac_f32_16x16x64_bf16 v[28:31], v[56:59], v[84:91], v18
    ds_read_b128 v[80:83], v21 offset:17408
    s_min_u32 s40, s20, 1
    buffer_load_dwordx4 v[4:7], v19, s[8:11], s34 offen offset:1024 sc1
    v_smfmac_f32_16x16x64_bf16 v[32:35], v[56:59], a[112:119], v18
    ds_read_b128 v[84:87], v21 offset:18432
    s_lshl_b32 s41, s40, 17
    v_smfmac_f32_16x16x64_bf16 v[36:39], v[56:59], a[120:127], v18
    ds_read_b128 v[88:91], v21 offset:19456
    s_waitcnt lgkmcnt(7)
    v_smfmac_f32_16x16x64_bf16 v[24:27], v[60:63], a[0:7], v18
    buffer_load_dwordx4 v[8:11], v20, s[8:11], s33 offen sc1
    v_smfmac_f32_16x16x64_bf16 v[28:31], v[60:63], a[8:15], v18
    buffer_load_dword v12, v53, s[8:11], s33 offen offset:4092 sc1
    s_waitcnt lgkmcnt(2)
    v_smfmac_f32_16x16x64_bf16 v[32:35], v[60:63], v[76:83], v18
    ds_read_b128 v[76:79], v21 offset:32768
    s_waitcnt lgkmcnt(1)
    v_smfmac_f32_16x16x64_bf16 v[36:39], v[60:63], v[84:91], v18
    ds_read_b128 v[80:83], v21 offset:33792
    v_smfmac_f32_16x16x64_bf16 v[24:27], v[64:67], a[16:23], v18
    ds_read_b128 v[84:87], v21 offset:34816
    v_smfmac_f32_16x16x64_bf16 v[28:31], v[64:67], a[24:31], v18
    ds_read_b128 v[88:91], v21 offset:35840
    v_smfmac_f32_16x16x64_bf16 v[32:35], v[64:67], a[128:135], v18
    v_smfmac_f32_16x16x64_bf16 v[36:39], v[64:67], a[136:143], v18
    s_waitcnt lgkmcnt(2)
    v_smfmac_f32_16x16x64_bf16 v[24:27], v[68:71], v[76:83], v18
    ds_read_b128 v[76:79], v21 offset:49152
    s_waitcnt lgkmcnt(1)
    v_smfmac_f32_16x16x64_bf16 v[28:31], v[68:71], v[84:91], v18
    ds_read_b128 v[80:83], v21 offset:50176
    v_smfmac_f32_16x16x64_bf16 v[32:35], v[68:71], a[144:151], v18
    ds_read_b128 v[84:87], v21 offset:51200
    v_smfmac_f32_16x16x64_bf16 v[36:39], v[68:71], a[152:159], v18
    ds_read_b128 v[88:91], v21 offset:52224
    v_smfmac_f32_16x16x64_bf16 v[24:27], v[72:75], a[32:39], v18
    v_add_u32 v21, 0x10000, v21
    buffer_store_dwordx4 v[92:95], v19, s[8:11], s35 offen sc1
    v_smfmac_f32_16x16x64_bf16 v[28:31], v[72:75], a[40:47], v18
    s_add_u32 s35, s35, s41
    s_add_u32 s51, s34, 0x1000000
    s_waitcnt lgkmcnt(2)
    v_smfmac_f32_16x16x64_bf16 v[32:35], v[72:75], v[76:83], v18
    ds_read_b128 v[76:79], v21 offset:0
    s_add_u32 s34, s34, 0x40000
    s_waitcnt lgkmcnt(1)
    v_smfmac_f32_16x16x64_bf16 v[36:39], v[72:75], v[84:91], v18
    ds_read_b128 v[80:83], v21 offset:1024
    v_smfmac_f32_16x16x64_bf16 v[40:43], v[56:59], a[208:215], v18
    ds_read_b128 v[84:87], v21 offset:2048
    v_smfmac_f32_16x16x64_bf16 v[44:47], v[56:59], a[216:223], v18
    ds_read_b128 v[88:91], v21 offset:3072
    s_waitcnt vmcnt(3)
    ds_write_b128 v20, v[48:51] offset:5120
    ds_write_b32 v53, v52 offset:9212
    v_smfmac_f32_16x16x64_bf16 v[40:43], v[60:63], a[224:231], v18
    v_bitop3_b32 v54, v48, v49, s22 bitop3:0x7e
    v_bitop3_b32 v55, v50, v51, s22 bitop3:0x7e
    v_smfmac_f32_16x16x64_bf16 v[44:47], v[60:63], a[232:239], v18
    v_bitop3_b32 v54, v52, v54, s22 bitop3:0xde
    v_bitop3_b32 v54, v54, v55, s52 bitop3:0xa8
    s_waitcnt lgkmcnt(4)
    v_smfmac_f32_16x16x64_bf16 v[40:43], v[64:67], v[76:83], v18
    v_cmp_ne_u32_e64 vcc, 0, v54
    s_waitcnt lgkmcnt(2)
    v_smfmac_f32_16x16x64_bf16 v[44:47], v[64:67], v[84:91], v18
    s_cbranch_vccnz R_pcr_188
R_pcok_187:
    s_waitcnt lgkmcnt(0)
    s_barrier
    ds_read_b128 v[56:59], v19 offset:5120
    ds_read_b128 v[60:63], v19 offset:6144
    v_smfmac_f32_16x16x64_bf16 v[40:43], v[68:71], a[240:247], v18
    ds_read_b128 v[64:67], v19 offset:7168
    v_smfmac_f32_16x16x64_bf16 v[44:47], v[68:71], a[248:255], v18
    ds_read_b128 v[68:71], v19 offset:8192
    v_smfmac_f32_16x16x64_bf16 v[40:43], v[72:75], v[96:103], v18
    v_smfmac_f32_16x16x64_bf16 v[44:47], v[72:75], v[104:111], v18
    ds_read_b128 v[72:75], v19 offset:9216
    s_waitcnt lgkmcnt(4)
    v_smfmac_f32_16x16x64_bf16 v[24:27], v[56:59], a[48:55], v18
    ds_read_b128 v[76:79], v21 offset:16384
    s_andn2_b32 s40, 1, s20
    v_smfmac_f32_16x16x64_bf16 v[28:31], v[56:59], a[56:63], v18
    ds_read_b128 v[80:83], v21 offset:17408
    s_xor_b32 s22, s22, s40
    s_waitcnt lgkmcnt(5)
    v_smfmac_f32_16x16x64_bf16 v[24:27], v[60:63], a[64:71], v18
    ds_read_b128 v[84:87], v21 offset:18432
    s_mov_b32 s52, 1
    v_smfmac_f32_16x16x64_bf16 v[28:31], v[60:63], a[72:79], v18
    ds_read_b128 v[88:91], v21 offset:19456
    s_min_u32 s40, s20, 1
    s_waitcnt lgkmcnt(6)
    v_smfmac_f32_16x16x64_bf16 v[24:27], v[64:67], a[80:87], v18
    buffer_load_dwordx4 v[8:11], v19, s[8:11], s51 offen offset:0 sc1
    v_smfmac_f32_16x16x64_bf16 v[28:31], v[64:67], a[88:95], v18
    buffer_load_dwordx4 v[12:15], v19, s[8:11], s51 offen offset:1024 sc1
    s_mov_b32 s33, s56
    s_waitcnt lgkmcnt(2)
    v_smfmac_f32_16x16x64_bf16 v[24:27], v[68:71], v[76:83], v18
    ds_read_b128 v[76:79], v21 offset:32768
    s_xor_b32 s56, s56, 0x4000
    s_waitcnt lgkmcnt(1)
    v_smfmac_f32_16x16x64_bf16 v[28:31], v[68:71], v[84:91], v18
    ds_read_b128 v[80:83], v21 offset:33792
    s_xor_b32 s32, s32, 0x4000
    v_smfmac_f32_16x16x64_bf16 v[24:27], v[72:75], a[96:103], v18
    ds_read_b128 v[84:87], v21 offset:34816
    v_smfmac_f32_16x16x64_bf16 v[28:31], v[72:75], a[104:111], v18
    ds_read_b128 v[88:91], v21 offset:35840
    v_smfmac_f32_16x16x64_bf16 v[32:35], v[56:59], a[160:167], v18
    v_smfmac_f32_16x16x64_bf16 v[36:39], v[56:59], a[168:175], v18
    s_waitcnt lgkmcnt(2)
    v_smfmac_f32_16x16x64_bf16 v[32:35], v[60:63], v[76:83], v18
    ds_read_b128 v[76:79], v21 offset:49152
    s_waitcnt lgkmcnt(1)
    v_smfmac_f32_16x16x64_bf16 v[36:39], v[60:63], v[84:91], v18
    ds_read_b128 v[80:83], v21 offset:50176
    v_cvt_pk_bf16_f32 v48, v24, v25
    v_smfmac_f32_16x16x64_bf16 v[32:35], v[64:67], a[176:183], v18
    ds_read_b128 v[84:87], v21 offset:51200
    v_cvt_pk_bf16_f32 v49, v26, v27
    v_smfmac_f32_16x16x64_bf16 v[36:39], v[64:67], a[184:191], v18
    ds_read_b128 v[88:91], v21 offset:52224
    v_cvt_pk_bf16_f32 v50, v28, v29
    v_smfmac_f32_16x16x64_bf16 v[32:35], v[68:71], a[192:199], v18
    v_cvt_pk_bf16_f32 v51, v30, v31
    v_smfmac_f32_16x16x64_bf16 v[36:39], v[68:71], a[200:207], v18
    v_add_u32 v21, 0x10000, v21
    s_waitcnt lgkmcnt(2)
    v_smfmac_f32_16x16x64_bf16 v[32:35], v[72:75], v[76:83], v18
    ds_read_b128 v[76:79], v21 offset:0
    s_waitcnt lgkmcnt(1)
    v_smfmac_f32_16x16x64_bf16 v[36:39], v[72:75], v[84:91], v18
    ds_read_b128 v[80:83], v21 offset:1024
    v_mfma_f32_16x16x16_bf16 v[24:27], v[48:49], v[16:17], 0
    ds_read_b128 v[84:87], v21 offset:2048
    v_mfma_f32_16x16x16_bf16 v[28:31], v[50:51], v[16:17], 0
    ds_read_b128 v[88:91], v21 offset:3072
    v_cvt_pk_bf16_f32 v52, v32, v33
    v_cvt_pk_bf16_f32 v53, v34, v35
    v_cvt_pk_bf16_f32 v54, v36, v37
    v_cvt_pk_bf16_f32 v55, v38, v39
    v_mfma_f32_16x16x16_bf16 v[32:35], v[52:53], v[16:17], 0
    v_cvt_pk_bf16_f32 v48, v24, v25
    v_mfma_f32_16x16x16_bf16 v[36:39], v[54:55], v[16:17], 0
    v_cvt_pk_bf16_f32 v49, v26, v27
    v_cvt_pk_bf16_f32 v50, v28, v29
    v_cvt_pk_bf16_f32 v51, v30, v31
    s_nop 1
    v_mfma_f32_16x16x32_bf16 v[24:27], v[0:3], v[48:51], 0
    v_mfma_f32_16x16x32_bf16 v[28:31], v[4:7], v[48:51], 0
    v_cvt_pk_bf16_f32 v52, v32, v33
    v_cvt_pk_bf16_f32 v53, v34, v35
    v_cvt_pk_bf16_f32 v54, v36, v37
    v_cvt_pk_bf16_f32 v55, v38, v39
    s_nop 1
    v_mfma_f32_16x16x32_bf16 v[32:35], v[52:55], v[48:51], 0
    s_nop 2
    v_cndmask_b32 v24, v24, v28, s[44:45]
    v_cndmask_b32 v25, v25, v29, s[44:45]
    v_cndmask_b32 v26, v26, v30, s[44:45]
    v_cndmask_b32 v27, v27, v31, s[44:45]
    ds_write_b128 v20, v[24:27] offset:10240
    v_cndmask_b32 v32, v32, v34, s[44:45]
    v_cndmask_b32 v33, v33, v35, s[44:45]
    ds_write_b64 v20, v[32:33] offset:0
    v_smfmac_f32_16x16x64_bf16 v[40:43], v[56:59], v[112:119], v18
    v_xor_b32 v52, 0x400, v20
    v_smfmac_f32_16x16x64_bf16 v[44:47], v[56:59], v[120:127], v18
    v_xor_b32 v54, 0x800, v20
    v_smfmac_f32_16x16x64_bf16 v[40:43], v[60:63], v[128:135], v18
    v_xor_b32 v34, 0xc00, v20
    v_smfmac_f32_16x16x64_bf16 v[44:47], v[60:63], v[136:143], v18
    v_smfmac_f32_16x16x64_bf16 v[40:43], v[64:67], v[144:151], v18
    s_cmp_eq_u32 s20, 63
    s_cbranch_scc1 R_exit_181
    s_waitcnt lgkmcnt(0)
    s_barrier
    ds_read_b128 v[28:31], v52 offset:10240
    ds_read_b64 v[52:53], v52 offset:0
    v_smfmac_f32_16x16x64_bf16 v[44:47], v[64:67], v[152:159], v18
    ds_read_b128 v[36:39], v54 offset:10240
    v_smfmac_f32_16x16x64_bf16 v[40:43], v[68:71], v[160:167], v18
    ds_read_b64 v[54:55], v54 offset:0
    v_smfmac_f32_16x16x64_bf16 v[44:47], v[68:71], v[168:175], v18
    ds_read_b128 v[48:51], v34 offset:10240
    v_smfmac_f32_16x16x64_bf16 v[40:43], v[72:75], v[76:83], v18
    ds_read_b64 v[34:35], v34 offset:0
    v_smfmac_f32_16x16x64_bf16 v[44:47], v[72:75], v[84:91], v18
    s_waitcnt lgkmcnt(5)
    v_pk_add_f32 v[24:25], v[24:25], v[28:29]
    v_pk_add_f32 v[26:27], v[26:27], v[30:31]
    s_waitcnt lgkmcnt(4)
    v_pk_add_f32 v[32:33], v[32:33], v[52:53]
    s_waitcnt lgkmcnt(1)
    v_pk_add_f32 v[36:37], v[36:37], v[48:49]
    v_pk_add_f32 v[38:39], v[38:39], v[50:51]
    s_waitcnt lgkmcnt(0)
    v_pk_add_f32 v[54:55], v[54:55], v[34:35]
    v_pk_add_f32 v[24:25], v[24:25], v[36:37]
    v_pk_add_f32 v[26:27], v[26:27], v[38:39]
    v_pk_add_f32 v[32:33], v[32:33], v[54:55]
    v_max3_f32 v34, v24, v25, v26
    v_max3_f32 v34, v34, v27, v32
    v_max_f32_e64 v34, v34, v33
    v_cvt_pk_bf16_f32 v92, v40, v41
    v_cvt_pk_bf16_f32 v93, v42, v43
    v_max_f32_dpp v34, v34, v34 row_ror:8 row_mask:0xf bank_mask:0xf
    v_mov_b32_e64 v35, v34
    v_cvt_pk_bf16_f32 v94, v44, v45
    v_cvt_pk_bf16_f32 v95, v46, v47
    v_permlane16_swap_b32 v34, v35
    v_max_f32 v34, v34, v35
    v_mov_b32 v35, v34
    v_mov_b32 v56, 0
    v_mov_b32 v57, 0
    v_permlane32_swap_b32 v34, v35
    v_max_f32 v34, v34, v35
    v_mul_f32 v34, s50, v34
    v_pk_fma_f32 v[24:25], v[24:25], s[54:55], v[34:35] op_sel_hi:[1,1,0] neg_lo:[0,0,1] neg_hi:[0,0,1]
    v_pk_fma_f32 v[26:27], v[26:27], s[54:55], v[34:35] op_sel_hi:[1,1,0] neg_lo:[0,0,1] neg_hi:[0,0,1]
    v_pk_fma_f32 v[32:33], v[32:33], s[54:55], v[34:35] op_sel_hi:[1,1,0] neg_lo:[0,0,1] neg_hi:[0,0,1]
    v_exp_f32 v24, v24
    v_exp_f32 v25, v25
    v_exp_f32 v26, v26
    v_exp_f32 v27, v27
    v_exp_f32 v32, v32
    v_exp_f32 v33, v33
    v_cvt_pk_bf16_f32 v48, v24, v25
    v_cvt_pk_bf16_f32 v49, v26, v27
    v_cvt_pk_bf16_f32 v52, v32, v33
    v_mov_b32_dpp v50, v48 row_ror:8 row_mask:0xf bank_mask:0xf
    v_mov_b32_dpp v51, v49 row_ror:8 row_mask:0xf bank_mask:0xf
    v_mov_b32_dpp v53, v52 row_ror:8 row_mask:0xf bank_mask:0xf
    v_pk_add_f32 v[24:25], v[24:25], v[26:27]
    s_waitcnt vmcnt(0)
    v_mfma_f32_16x16x32_bf16 v[28:31], v[8:11], v[48:51], 0
    v_add_f32 v32, v32, v33
    v_add_f32_e64 v24, v24, v25
    v_mfma_f32_16x16x32_bf16 v[36:39], v[12:15], v[48:51], 0
    v_fma_f32 v34, v32, 0.5, v24
    v_mfma_f32_16x16x16_bf16 v[28:31], v[92:93], v[52:53], v[28:31]
    v_mov_b32_e64 v58, 0
    v_add_f32_dpp v34, v34, v34 row_ror:8 row_mask:0xf bank_mask:0xf
    v_mfma_f32_16x16x16_bf16 v[36:39], v[94:95], v[52:53], v[36:39]
    v_mov_b32 v35, v34
    v_mov_b32 v59, 0
    v_mov_b32 v60, 0
    v_permlane16_swap_b32 v34, v35
    v_add_f32 v34, v34, v35
    v_mov_b32 v35, v34
    v_mov_b32 v61, 0
    v_mov_b32 v62, 0
    v_permlane32_swap_b32 v34, v35
    v_add_f32 v34, v34, v35
    v_rcp_f32 v34, v34
    s_mov_b64 exec, s[46:47]
    v_pk_mul_f32 v[28:29], v[28:29], v[34:35] op_sel_hi:[1,0]
    v_pk_mul_f32 v[30:31], v[30:31], v[34:35] op_sel_hi:[1,0]
    v_pk_mul_f32 v[36:37], v[36:37], v[34:35] op_sel_hi:[1,0]
    v_pk_mul_f32 v[38:39], v[38:39], v[34:35] op_sel_hi:[1,0]
    v_cvt_pk_bf16_f32 v24, v28, v29
    v_cvt_pk_bf16_f32 v25, v30, v31
    v_cvt_pk_bf16_f32 v26, v36, v37
    v_cvt_pk_bf16_f32 v27, v38, v39
    ds_write_b128 v22, v[24:27]
    s_mov_b64 exec, -1
    v_mov_b32 v63, 0
    v_mov_b32 v64, 0
    v_mov_b32 v65, 0
    v_mov_b32 v66, 0
    v_mov_b32 v67, 0
    v_mov_b32 v68, 0
    v_mov_b32 v69, 0
    v_mov_b32 v70, 0
    v_mov_b32 v71, 0
    v_mov_b32 v72, 0
    v_mov_b32 v73, 0
    v_mov_b32 v74, 0
    v_mov_b32 v75, 0
    s_waitcnt lgkmcnt(0)
    s_barrier
    ds_read_b128 v[48:51], v19 offset:5120
    ds_read_b128 v[52:55], v19 offset:6144
    v_subrev_u32 v21, 0x20000, v21
    v_lshrrev_b32_e64 v24, 8, v19
    v_bfe_u32 v25, v19, 2, 6
    v_lshl_add_u32 v24, v24, 13, v25
    s_waitcnt lgkmcnt(1)
    v_smfmac_f32_16x16x64_bf16 v[56:59], v[48:51], v[176:183], v18 abid:1
    s_waitcnt lgkmcnt(0)
    v_smfmac_f32_16x16x64_bf16 v[56:59], v[52:55], v[216:223], v18 abid:1
    v_smfmac_f32_16x16x64_bf16 v[60:63], v[48:51], v[184:191], v18 abid:1
    v_smfmac_f32_16x16x64_bf16 v[60:63], v[52:55], v[224:231], v18 abid:1
    v_add_f32_e64 v56, v56, v58
    v_smfmac_f32_16x16x64_bf16 v[64:67], v[48:51], v[192:199], v18 abid:1
    v_add_f32_e64 v57, v57, v59
    v_smfmac_f32_16x16x64_bf16 v[64:67], v[52:55], v[232:239], v18 abid:1
    v_cvt_pk_bf16_f32 v28, v56, v57
    v_add_f32_e64 v60, v60, v62
    v_smfmac_f32_16x16x64_bf16 v[68:71], v[48:51], v[200:207], v18 abid:1
    v_add_f32_e64 v61, v61, v63
    v_bfi_b32 v28, 1, s21, v28
    v_smfmac_f32_16x16x64_bf16 v[68:71], v[52:55], v[240:247], v18 abid:1
    v_cvt_pk_bf16_f32 v29, v60, v61
    v_add_f32_e64 v64, v64, v66
    v_smfmac_f32_16x16x64_bf16 v[72:75], v[48:51], v[208:215], v18 abid:1
    v_add_f32_e64 v65, v65, v67
    v_smfmac_f32_16x16x64_bf16 v[72:75], v[52:55], v[248:255], v18 abid:1
    v_add_f32_e64 v68, v68, v70
    v_add_f32 v69, v69, v71
    v_cvt_pk_bf16_f32 v30, v64, v65
    v_cvt_pk_bf16_f32 v31, v68, v69
    buffer_store_dwordx4 v[28:31], v23, s[8:11], s27 offen
    s_nop 2
    v_pk_add_f32 v[72:73], v[72:73], v[74:75]
    v_cvt_pk_bf16_f32 v72, v72, v73
    v_bfi_b32 v72, 1, s21, v72
    buffer_store_dword v72, v24, s[8:11], s28 offen
    s_cmp_lt_u32 s20, 58
    s_cbranch_scc1 R_noearly_190
    buffer_store_dwordx4 v[92:95], v19, s[8:11], s35 offen sc1
R_noearly_190:
    s_cmp_ge_u32 s4, 16
    s_cbranch_scc1 R_nored_191
    v_mov_b32 v24, 0
    v_mov_b32 v25, 0
    v_mov_b32 v26, 0
    v_mov_b32 v27, 0
    v_mov_b32 v28, 0
    v_mov_b32 v29, 0
    v_mov_b32 v30, 0
    v_mov_b32 v31, 0
    v_mov_b32 v32, 0
    v_mov_b32 v33, 0
    v_mov_b32 v34, 0
    v_mov_b32 v35, 0
    v_mov_b32 v36, 0
    v_mov_b32 v37, 0
    v_mov_b32 v38, 0
    v_mov_b32 v39, 0
    v_mov_b32 v40, 0
    v_mov_b32 v41, 0
    v_mov_b32 v42, 0
    v_mov_b32 v43, 0
    v_mov_b32 v44, 0
    v_mov_b32 v45, 0
    v_mov_b32 v46, 0
    v_mov_b32 v47, 0
    ds_read_b128 v[76:79], v21 offset:0
    buffer_load_dwordx4 v[56:59], v19, s[8:11], s29 offen offset:0 sc1
    buffer_load_dwordx4 v[60:63], v19, s[8:11], s29 offen offset:1024 sc1
    ds_read_b128 v[80:83], v21 offset:1024
    ds_read_b128 v[84:87], v21 offset:2048
    ds_read_b128 v[88:91], v21 offset:3072
    v_lshrrev_b32_e64 v53, 2, v20
    v_add_u32 v53, 4, v53
    s_add_u32 s20, s20, 1
    v_mov_b32 v54, 0xfffe0000
    v_lshrrev_b32_e64 v48, 2, v19
    v_and_b32 v48, 0x80, v48
    v_and_or_b32 v55, v19, 16, v48
    v_lshrrev_b32_e64 v48, 5, v19
    v_and_or_b32 v55, v48, 8, v55
    v_lshrrev_b32_e64 v48, 4, v19
    v_and_or_b32 v55, v48, 4, v55
    v_mov_b32 v48, 0x3f80
    v_cndmask_b32 v48, v48, 1.0, s[76:77]
    v_cndmask_b32 v64, 0, v48, s[60:61]
    v_cndmask_b32 v65, 0, v48, s[62:63]
    v_cndmask_b32 v66, 0, v48, s[64:65]
    v_cndmask_b32 v67, 0, v48, s[66:67]
    s_lshl_b32 s26, s22, 16
    s_sub_u32 s24, 0x10000, s26
    s_nop 7
    buffer_load_dwordx4 v[0:3], v19, s[8:11], s29 offen offset:0 sc1
    buffer_load_dwordx4 v[4:7], v19, s[8:11], s29 offen offset:1024 sc1
R_pi_193:
    s_waitcnt vmcnt(3)
    v_mfma_f32_16x16x32_bf16 v[68:71], v[56:59], v[64:67], 0
    v_bitop3_b32 v48, v56, v57, s21 bitop3:0x7e
    v_bitop3_b32 v49, v58, v59, s21 bitop3:0x7e
    s_waitcnt vmcnt(2)
    v_mfma_f32_16x16x32_bf16 v[68:71], v[60:63], v[64:67], v[68:71]
    v_bitop3_b32 v50, v60, v61, s21 bitop3:0x7e
    v_bitop3_b32 v51, v62, v63, s21 bitop3:0x7e
    v_or3_b32 v48, v48, v50, v51
    v_bitop3_b32 v48, v48, v49, 1 bitop3:0xa8
    v_cmp_ne_u32_e64 vcc, 0, v48
    s_cbranch_vccnz R_pir_195
R_piok_194:
    s_nop 1
    v_permlane32_swap_b32 v68, v70
    v_permlane32_swap_b32 v69, v71
    v_pk_add_f32 v[68:69], v[68:69], v[70:71]
    s_nop 1
    v_permlane16_swap_b32 v68, v69
    v_add_f32 v68, v68, v69
    v_add_u32 v70, s24, v68
    v_bfi_b32 v70, v54, v70, s26
    v_mov_b32_dpp v69, v68 row_shl:2 row_mask:0xf bank_mask:0xf
    s_mov_b64 exec, s[48:49]
    v_cvt_pk_bf16_f32 v70, v70, v69
    buffer_store_dword v70, v55, s[8:11], s30 offen
    buffer_store_dword v70, v55, s[8:11], s31 offen sc1
    s_mov_b64 exec, -1
    s_xor_b32 s31, s31, 0x4000
    s_xor_b32 s30, s30, 0x4000
    s_branch R_join_192
R_nored_191:
    v_mov_b32 v24, 0
    v_mov_b32 v25, 0
    v_mov_b32 v26, 0
    v_mov_b32 v27, 0
    v_mov_b32 v28, 0
    v_mov_b32 v29, 0
    v_mov_b32 v30, 0
    v_mov_b32 v31, 0
    v_mov_b32 v32, 0
    v_mov_b32 v33, 0
    v_mov_b32 v34, 0
    v_mov_b32 v35, 0
    v_mov_b32 v36, 0
    v_mov_b32 v37, 0
    v_mov_b32 v38, 0
    v_mov_b32 v39, 0
    v_mov_b32 v40, 0
    v_mov_b32 v41, 0
    v_mov_b32 v42, 0
    v_mov_b32 v43, 0
    v_mov_b32 v44, 0
    v_mov_b32 v45, 0
    v_mov_b32 v46, 0
    v_mov_b32_e64 v47, 0
    ds_read_b128 v[76:79], v21 offset:0
    ds_read_b128 v[80:83], v21 offset:1024
    ds_read_b128 v[84:87], v21 offset:2048
    ds_read_b128 v[88:91], v21 offset:3072
    v_lshrrev_b32 v53, 2, v20
    v_add_u32 v53, 4, v53
    s_add_u32 s20, s20, 1
R_join_192:
    s_barrier
    s_nop 15
    s_nop 15
    s_nop 15
    s_nop 11
    s_branch R_top_179
R_par_185:
    buffer_load_dwordx4 v[0:3], v20, s[8:11], s32 offen sc1
    buffer_load_dword v4, v53, s[8:11], s32 offen offset:4092 sc1
    s_waitcnt vmcnt(2)
    ds_write_b128 v20, v[48:51]
    ds_write_b32 v53, v52 offset:4092
    v_bitop3_b32 v56, v48, v49, s22 bitop3:0x7e
    v_bitop3_b32 v57, v50, v51, s22 bitop3:0x7e
    v_bitop3_b32 v56, v52, v56, s22 bitop3:0xde
    v_bitop3_b32 v56, v56, v57, 1 bitop3:0xa8
    v_cmp_ne_u32 vcc, 0, v56
    s_cbranch_vccz R_paok_184
    buffer_load_dwordx4 v[48:51], v20, s[8:11], s32 offen sc1
    buffer_load_dword v52, v53, s[8:11], s32 offen offset:4092 sc1
    s_add_u32 s6, s6, 1
    s_cmp_lt_u32 s6, 400000
    s_cbranch_scc1 R_pa_183
    s_branch R_paok_184
R_pcr_188:
    s_waitcnt vmcnt(1)
    ds_write_b128 v20, v[8:11] offset:5120
    ds_write_b32 v53, v12 offset:9212
    v_bitop3_b32 v54, v8, v9, s22 bitop3:0x7e
    v_bitop3_b32 v55, v10, v11, s22 bitop3:0x7e
    v_bitop3_b32 v54, v12, v54, s22 bitop3:0xde
    v_bitop3_b32 v54, v54, v55, s52 bitop3:0xa8
    v_cmp_ne_u32_e64 vcc, 0, v54
    s_cbranch_vccz R_pcok_187
R_pcr2_197:
    s_add_u32 s6, s6, 1
    s_cmp_lt_u32 s6, 400000
    s_cbranch_scc1 R_pc2_189
    s_branch R_pcok_187
R_pc2_189:
    s_waitcnt lgkmcnt(0)
    buffer_load_dwordx4 v[48:51], v20, s[8:11], s33 offen sc1
    buffer_load_dword v52, v53, s[8:11], s33 offen offset:4092 sc1
    s_waitcnt vmcnt(0)
    ds_write_b128 v20, v[48:51] offset:5120
    ds_write_b32 v53, v52 offset:9212
    v_bitop3_b32 v54, v48, v49, s22 bitop3:0x7e
    v_bitop3_b32 v55, v50, v51, s22 bitop3:0x7e
    v_bitop3_b32 v54, v52, v54, s22 bitop3:0xde
    v_bitop3_b32 v54, v54, v55, s52 bitop3:0xa8
    v_cmp_ne_u32_e64 vcc, 0, v54
    s_cbranch_vccnz R_pcr2_197
    s_branch R_pcok_187
R_pir_195:
    buffer_load_dwordx4 v[56:59], v19, s[8:11], s29 offen offset:0 sc1
    buffer_load_dwordx4 v[60:63], v19, s[8:11], s29 offen offset:1024 sc1
    s_waitcnt vmcnt(3)
    v_mfma_f32_16x16x32_bf16 v[68:71], v[0:3], v[64:67], 0
    v_bitop3_b32 v48, v0, v1, s21 bitop3:0x7e
    v_bitop3_b32 v49, v2, v3, s21 bitop3:0x7e
    s_waitcnt vmcnt(2)
    v_mfma_f32_16x16x32_bf16 v[68:71], v[4:7], v[64:67], v[68:71]
    v_bitop3_b32 v50, v4, v5, s21 bitop3:0x7e
    v_bitop3_b32 v51, v6, v7, s21 bitop3:0x7e
    v_or3_b32 v48, v48, v50, v51
    v_bitop3_b32 v48, v48, v49, 1 bitop3:0xa8
    v_cmp_ne_u32 vcc, 0, v48
    s_cbranch_vccz R_piok_194
    buffer_load_dwordx4 v[0:3], v19, s[8:11], s29 offen offset:0 sc1
    buffer_load_dwordx4 v[4:7], v19, s[8:11], s29 offen offset:1024 sc1
    s_add_u32 s6, s6, 1
    s_cmp_lt_u32 s6, 400000
    s_cbranch_scc1 R_pi_193
    s_branch R_piok_194
R_exit_181:
    s_waitcnt lgkmcnt(0)
    v_smfmac_f32_16x16x64_bf16 v[44:47], v[64:67], v[152:159], v18
    v_smfmac_f32_16x16x64_bf16 v[40:43], v[68:71], v[160:167], v18
    v_smfmac_f32_16x16x64_bf16 v[44:47], v[68:71], v[168:175], v18
    v_smfmac_f32_16x16x64_bf16 v[40:43], v[72:75], v[76:83], v18
    v_smfmac_f32_16x16x64_bf16 v[44:47], v[72:75], v[84:91], v18
    s_nop 3
    v_cvt_pk_bf16_f32 v92, v40, v41
    v_cvt_pk_bf16_f32 v93, v42, v43
    s_nop 1
    v_cvt_pk_bf16_f32 v94, v44, v45
    v_cvt_pk_bf16_f32 v95, v46, v47
    buffer_store_dwordx4 v[92:95], v19, s[8:11], s35 offen sc1
    s_branch R_end_87
R_v11w3_93:
    s_branch R_ent_199
.p2align 6
R_top_198:
    buffer_load_dwordx4 v[0:3], v20, s[8:11], s32 offen sc1
    buffer_load_dword v4, v53, s[8:11], s32 offen offset:4092 sc1
    s_nop 15
    s_nop 8
    buffer_load_dwordx4 v[48:51], v20, s[8:11], s32 offen sc1
    buffer_load_dword v52, v53, s[8:11], s32 offen offset:4092 sc1
R_pa_202:
    s_waitcnt vmcnt(2)
    ds_write_b128 v20, v[0:3]
    ds_write_b32 v53, v4 offset:4092
    v_bitop3_b32 v56, v0, v1, s22 bitop3:0x7e
    v_bitop3_b32 v57, v2, v3, s22 bitop3:0x7e
    v_bitop3_b32 v56, v4, v56, s22 bitop3:0xde
    v_bitop3_b32 v56, v56, v57, 1 bitop3:0xa8
    v_cmp_ne_u32 vcc, 0, v56
    s_cbranch_vccnz R_par_204
R_paok_203:
    buffer_load_dwordx4 v[48:51], v20, s[8:11], s33 offen sc1
    buffer_load_dword v52, v53, s[8:11], s33 offen offset:4092 sc1
    s_waitcnt lgkmcnt(0)
    s_barrier
R_ent_199:
    ds_read_b128 v[56:59], v19 offset:0
    ds_read_b128 v[60:63], v19 offset:1024
    ds_read_b128 v[64:67], v19 offset:2048
    ds_read_b128 v[68:71], v19 offset:3072
    ds_read_b128 v[72:75], v19 offset:4096
    s_waitcnt lgkmcnt(4)
    v_smfmac_f32_16x16x64_bf16 v[24:27], v[56:59], v[76:83], v18
    ds_read_b128 v[76:79], v21 offset:16384
    s_xor_b32 s21, s21, 1
    buffer_load_dwordx4 v[0:3], v19, s[8:11], s34 offen offset:0 sc1
    v_smfmac_f32_16x16x64_bf16 v[28:31], v[56:59], v[84:91], v18
    ds_read_b128 v[80:83], v21 offset:17408
    s_min_u32 s40, s20, 1
    buffer_load_dwordx4 v[4:7], v19, s[8:11], s34 offen offset:1024 sc1
    v_smfmac_f32_16x16x64_bf16 v[32:35], v[56:59], a[112:119], v18
    ds_read_b128 v[84:87], v21 offset:18432
    s_lshl_b32 s41, s40, 17
    v_smfmac_f32_16x16x64_bf16 v[36:39], v[56:59], a[120:127], v18
    ds_read_b128 v[88:91], v21 offset:19456
    s_waitcnt lgkmcnt(7)
    v_smfmac_f32_16x16x64_bf16 v[24:27], v[60:63], a[0:7], v18
    buffer_load_dwordx4 v[8:11], v20, s[8:11], s33 offen sc1
    v_smfmac_f32_16x16x64_bf16 v[28:31], v[60:63], a[8:15], v18
    buffer_load_dword v12, v53, s[8:11], s33 offen offset:4092 sc1
    s_waitcnt lgkmcnt(2)
    v_smfmac_f32_16x16x64_bf16 v[32:35], v[60:63], v[76:83], v18
    ds_read_b128 v[76:79], v21 offset:32768
    s_waitcnt lgkmcnt(1)
    v_smfmac_f32_16x16x64_bf16 v[36:39], v[60:63], v[84:91], v18
    ds_read_b128 v[80:83], v21 offset:33792
    v_smfmac_f32_16x16x64_bf16 v[24:27], v[64:67], a[16:23], v18
    ds_read_b128 v[84:87], v21 offset:34816
    v_smfmac_f32_16x16x64_bf16 v[28:31], v[64:67], a[24:31], v18
    ds_read_b128 v[88:91], v21 offset:35840
    v_smfmac_f32_16x16x64_bf16 v[32:35], v[64:67], a[128:135], v18
    v_smfmac_f32_16x16x64_bf16 v[36:39], v[64:67], a[136:143], v18
    s_waitcnt lgkmcnt(2)
    v_smfmac_f32_16x16x64_bf16 v[24:27], v[68:71], v[76:83], v18
    ds_read_b128 v[76:79], v21 offset:49152
    s_waitcnt lgkmcnt(1)
    v_smfmac_f32_16x16x64_bf16 v[28:31], v[68:71], v[84:91], v18
    ds_read_b128 v[80:83], v21 offset:50176
    v_smfmac_f32_16x16x64_bf16 v[32:35], v[68:71], a[144:151], v18
    ds_read_b128 v[84:87], v21 offset:51200
    v_smfmac_f32_16x16x64_bf16 v[36:39], v[68:71], a[152:159], v18
    ds_read_b128 v[88:91], v21 offset:52224
    v_smfmac_f32_16x16x64_bf16 v[24:27], v[72:75], a[32:39], v18
    v_add_u32 v21, 0x10000, v21
    buffer_store_dwordx4 v[92:95], v19, s[8:11], s35 offen sc1
    v_smfmac_f32_16x16x64_bf16 v[28:31], v[72:75], a[40:47], v18
    s_add_u32 s35, s35, s41
    s_add_u32 s51, s34, 0x1000000
    s_waitcnt lgkmcnt(2)
    v_smfmac_f32_16x16x64_bf16 v[32:35], v[72:75], v[76:83], v18
    ds_read_b128 v[76:79], v21 offset:0
    s_add_u32 s34, s34, 0x40000
    s_waitcnt lgkmcnt(1)
    v_smfmac_f32_16x16x64_bf16 v[36:39], v[72:75], v[84:91], v18
    ds_read_b128 v[80:83], v21 offset:1024
    v_smfmac_f32_16x16x64_bf16 v[40:43], v[56:59], a[208:215], v18
    ds_read_b128 v[84:87], v21 offset:2048
    v_smfmac_f32_16x16x64_bf16 v[44:47], v[56:59], a[216:223], v18
    ds_read_b128 v[88:91], v21 offset:3072
    s_waitcnt vmcnt(3)
    ds_write_b128 v20, v[48:51] offset:5120
    ds_write_b32 v53, v52 offset:9212
    v_smfmac_f32_16x16x64_bf16 v[40:43], v[60:63], a[224:231], v18
    v_bitop3_b32 v54, v48, v49, s22 bitop3:0x7e
    v_bitop3_b32 v55, v50, v51, s22 bitop3:0x7e
    v_smfmac_f32_16x16x64_bf16 v[44:47], v[60:63], a[232:239], v18
    v_bitop3_b32 v54, v52, v54, s22 bitop3:0xde
    v_bitop3_b32 v54, v54, v55, s52 bitop3:0xa8
    s_waitcnt lgkmcnt(4)
    v_smfmac_f32_16x16x64_bf16 v[40:43], v[64:67], v[76:83], v18
    v_cmp_ne_u32 vcc, 0, v54
    s_waitcnt lgkmcnt(2)
    v_smfmac_f32_16x16x64_bf16 v[44:47], v[64:67], v[84:91], v18
    s_cbranch_vccnz R_pcr_207
R_pcok_206:
    v_lshlrev_b32_e64 v55, 3, v19
    s_add_u32 s42, s36, 0x1000000
    s_waitcnt lgkmcnt(0)
    s_barrier
    ds_read_b128 v[56:59], v19 offset:5120
    ds_read_b128 v[60:63], v19 offset:6144
    v_smfmac_f32_16x16x64_bf16 v[40:43], v[68:71], a[240:247], v18
    ds_read_b128 v[64:67], v19 offset:7168
    v_smfmac_f32_16x16x64_bf16 v[44:47], v[68:71], a[248:255], v18
    ds_read_b128 v[68:71], v19 offset:8192
    v_smfmac_f32_16x16x64_bf16 v[40:43], v[72:75], v[96:103], v18
    v_smfmac_f32_16x16x64_bf16 v[44:47], v[72:75], v[104:111], v18
    ds_read_b128 v[72:75], v19 offset:9216
    s_waitcnt lgkmcnt(4)
    v_smfmac_f32_16x16x64_bf16 v[24:27], v[56:59], a[48:55], v18
    ds_read_b128 v[76:79], v21 offset:16384
    s_andn2_b32 s40, 1, s20
    v_smfmac_f32_16x16x64_bf16 v[28:31], v[56:59], a[56:63], v18
    ds_read_b128 v[80:83], v21 offset:17408
    s_xor_b32 s22, s22, s40
    s_waitcnt lgkmcnt(5)
    v_smfmac_f32_16x16x64_bf16 v[24:27], v[60:63], a[64:71], v18
    ds_read_b128 v[84:87], v21 offset:18432
    s_mov_b32 s52, 1
    v_smfmac_f32_16x16x64_bf16 v[28:31], v[60:63], a[72:79], v18
    ds_read_b128 v[88:91], v21 offset:19456
    s_min_u32 s40, s20, 1
    s_waitcnt lgkmcnt(6)
    v_smfmac_f32_16x16x64_bf16 v[24:27], v[64:67], a[80:87], v18
    buffer_load_dwordx4 v[8:11], v19, s[8:11], s51 offen offset:0 sc1
    s_cmp_gt_u32 s20, 58
    v_smfmac_f32_16x16x64_bf16 v[28:31], v[64:67], a[88:95], v18
    buffer_load_dwordx4 v[12:15], v19, s[8:11], s51 offen offset:1024 sc1
    s_mov_b32 s33, s56
    s_cselect_b32 s40, 0, s40
    s_waitcnt lgkmcnt(2)
    v_smfmac_f32_16x16x64_bf16 v[24:27], v[68:71], v[76:83], v18
    ds_read_b128 v[76:79], v21 offset:32768
    s_xor_b32 s56, s56, 0x4000
    s_sub_u32 s40, s20, s40
    s_waitcnt lgkmcnt(1)
    v_smfmac_f32_16x16x64_bf16 v[28:31], v[68:71], v[84:91], v18
    ds_read_b128 v[80:83], v21 offset:33792
    s_xor_b32 s32, s32, 0x4000
    v_mov_b32 v49, s40
    v_smfmac_f32_16x16x64_bf16 v[24:27], v[72:75], a[96:103], v18
    ds_read_b128 v[84:87], v21 offset:34816
    v_mov_b32 v54, 0
    v_smfmac_f32_16x16x64_bf16 v[28:31], v[72:75], a[104:111], v18
    ds_read_b128 v[88:91], v21 offset:35840
    buffer_store_dword v49, v54, s[8:11], s38 offen sc1
    v_smfmac_f32_16x16x64_bf16 v[32:35], v[56:59], a[160:167], v18
    buffer_load_dword v55, s[8:11], s36 offen sc1 lds
    v_smfmac_f32_16x16x64_bf16 v[36:39], v[56:59], a[168:175], v18
    buffer_load_dword v55, s[8:11], s42 offen sc1 lds
    s_waitcnt lgkmcnt(2)
    v_smfmac_f32_16x16x64_bf16 v[32:35], v[60:63], v[76:83], v18
    ds_read_b128 v[76:79], v21 offset:49152
    s_waitcnt lgkmcnt(1)
    v_smfmac_f32_16x16x64_bf16 v[36:39], v[60:63], v[84:91], v18
    ds_read_b128 v[80:83], v21 offset:50176
    v_cvt_pk_bf16_f32 v48, v24, v25
    v_smfmac_f32_16x16x64_bf16 v[32:35], v[64:67], a[176:183], v18
    ds_read_b128 v[84:87], v21 offset:51200
    v_cvt_pk_bf16_f32 v49, v26, v27
    v_smfmac_f32_16x16x64_bf16 v[36:39], v[64:67], a[184:191], v18
    ds_read_b128 v[88:91], v21 offset:52224
    v_cvt_pk_bf16_f32 v50, v28, v29
    v_smfmac_f32_16x16x64_bf16 v[32:35], v[68:71], a[192:199], v18
    v_cvt_pk_bf16_f32 v51, v30, v31
    v_smfmac_f32_16x16x64_bf16 v[36:39], v[68:71], a[200:207], v18
    v_add_u32 v21, 0x10000, v21
    s_waitcnt lgkmcnt(2)
    v_smfmac_f32_16x16x64_bf16 v[32:35], v[72:75], v[76:83], v18
    ds_read_b128 v[76:79], v21 offset:0
    s_waitcnt lgkmcnt(1)
    v_smfmac_f32_16x16x64_bf16 v[36:39], v[72:75], v[84:91], v18
    ds_read_b128 v[80:83], v21 offset:1024
    v_mfma_f32_16x16x16_bf16 v[24:27], v[48:49], v[16:17], 0
    ds_read_b128 v[84:87], v21 offset:2048
    v_mfma_f32_16x16x16_bf16 v[28:31], v[50:51], v[16:17], 0
    ds_read_b128 v[88:91], v21 offset:3072
    v_cvt_pk_bf16_f32 v52, v32, v33
    v_cvt_pk_bf16_f32 v53, v34, v35
    v_cvt_pk_bf16_f32 v54, v36, v37
    v_cvt_pk_bf16_f32 v55, v38, v39
    v_mfma_f32_16x16x16_bf16 v[32:35], v[52:53], v[16:17], 0
    v_cvt_pk_bf16_f32 v48, v24, v25
    v_mfma_f32_16x16x16_bf16 v[36:39], v[54:55], v[16:17], 0
    v_cvt_pk_bf16_f32 v49, v26, v27
    v_cvt_pk_bf16_f32 v50, v28, v29
    v_cvt_pk_bf16_f32 v51, v30, v31
    s_nop 1
    v_mfma_f32_16x16x32_bf16 v[24:27], v[0:3], v[48:51], 0
    v_mfma_f32_16x16x32_bf16 v[28:31], v[4:7], v[48:51], 0
    v_cvt_pk_bf16_f32 v52, v32, v33
    v_cvt_pk_bf16_f32 v53, v34, v35
    v_cvt_pk_bf16_f32 v54, v36, v37
    v_cvt_pk_bf16_f32 v55, v38, v39
    s_nop 1
    v_mfma_f32_16x16x32_bf16 v[32:35], v[52:55], v[48:51], 0
    s_nop 2
    v_cndmask_b32 v24, v24, v28, s[44:45]
    v_cndmask_b32 v25, v25, v29, s[44:45]
    v_cndmask_b32 v26, v26, v30, s[44:45]
    v_cndmask_b32 v27, v27, v31, s[44:45]
    ds_write_b128 v20, v[24:27] offset:10240
    v_cndmask_b32 v32, v32, v34, s[44:45]
    v_cndmask_b32 v33, v33, v35, s[44:45]
    ds_write_b64 v20, v[32:33] offset:0
    v_smfmac_f32_16x16x64_bf16 v[40:43], v[56:59], v[112:119], v18
    v_xor_b32 v52, 0x400, v20
    v_smfmac_f32_16x16x64_bf16 v[44:47], v[56:59], v[120:127], v18
    v_xor_b32 v54, 0x800, v20
    v_smfmac_f32_16x16x64_bf16 v[40:43], v[60:63], v[128:135], v18
    v_xor_b32 v34, 0xc00, v20
    v_smfmac_f32_16x16x64_bf16 v[44:47], v[60:63], v[136:143], v18
    v_smfmac_f32_16x16x64_bf16 v[40:43], v[64:67], v[144:151], v18
    s_cmp_eq_u32 s20, 63
    s_cbranch_scc1 R_exit_200
    s_waitcnt lgkmcnt(0)
    s_barrier
    ds_read_b128 v[28:31], v52 offset:10240
    ds_read_b64 v[52:53], v52 offset:0
    v_smfmac_f32_16x16x64_bf16 v[44:47], v[64:67], v[152:159], v18
    ds_read_b128 v[36:39], v54 offset:10240
    v_smfmac_f32_16x16x64_bf16 v[40:43], v[68:71], v[160:167], v18
    ds_read_b64 v[54:55], v54 offset:0
    v_smfmac_f32_16x16x64_bf16 v[44:47], v[68:71], v[168:175], v18
    ds_read_b128 v[48:51], v34 offset:10240
    v_smfmac_f32_16x16x64_bf16 v[40:43], v[72:75], v[76:83], v18
    ds_read_b64 v[34:35], v34 offset:0
    v_smfmac_f32_16x16x64_bf16 v[44:47], v[72:75], v[84:91], v18
    s_waitcnt lgkmcnt(5)
    v_pk_add_f32 v[24:25], v[24:25], v[28:29]
    v_pk_add_f32 v[26:27], v[26:27], v[30:31]
    s_waitcnt lgkmcnt(4)
    v_pk_add_f32 v[32:33], v[32:33], v[52:53]
    s_waitcnt lgkmcnt(1)
    v_pk_add_f32 v[36:37], v[36:37], v[48:49]
    v_pk_add_f32 v[38:39], v[38:39], v[50:51]
    s_waitcnt lgkmcnt(0)
    v_pk_add_f32 v[54:55], v[54:55], v[34:35]
    v_pk_add_f32 v[24:25], v[24:25], v[36:37]
    v_pk_add_f32 v[26:27], v[26:27], v[38:39]
    v_pk_add_f32 v[32:33], v[32:33], v[54:55]
    v_max3_f32 v34, v24, v25, v26
    v_max3_f32 v34, v34, v27, v32
    v_max_f32_e64 v34, v34, v33
    v_cvt_pk_bf16_f32 v92, v40, v41
    v_cvt_pk_bf16_f32 v93, v42, v43
    v_max_f32_dpp v34, v34, v34 row_ror:8 row_mask:0xf bank_mask:0xf
    v_mov_b32_e64 v35, v34
    v_cvt_pk_bf16_f32 v94, v44, v45
    v_cvt_pk_bf16_f32 v95, v46, v47
    v_permlane16_swap_b32 v34, v35
    v_max_f32 v34, v34, v35
    v_mov_b32 v35, v34
    v_mov_b32 v56, 0
    v_mov_b32 v57, 0
    v_permlane32_swap_b32 v34, v35
    v_max_f32 v34, v34, v35
    v_mul_f32 v34, s50, v34
    v_pk_fma_f32 v[24:25], v[24:25], s[54:55], v[34:35] op_sel_hi:[1,1,0] neg_lo:[0,0,1] neg_hi:[0,0,1]
    v_pk_fma_f32 v[26:27], v[26:27], s[54:55], v[34:35] op_sel_hi:[1,1,0] neg_lo:[0,0,1] neg_hi:[0,0,1]
    v_pk_fma_f32 v[32:33], v[32:33], s[54:55], v[34:35] op_sel_hi:[1,1,0] neg_lo:[0,0,1] neg_hi:[0,0,1]
    v_exp_f32 v24, v24
    v_exp_f32 v25, v25
    v_exp_f32 v26, v26
    v_exp_f32 v27, v27
    v_exp_f32 v32, v32
    v_exp_f32 v33, v33
    v_cvt_pk_bf16_f32 v48, v24, v25
    v_cvt_pk_bf16_f32 v49, v26, v27
    v_cvt_pk_bf16_f32 v52, v32, v33
    v_mov_b32_dpp v50, v48 row_ror:8 row_mask:0xf bank_mask:0xf
    v_mov_b32_dpp v51, v49 row_ror:8 row_mask:0xf bank_mask:0xf
    v_mov_b32_dpp v53, v52 row_ror:8 row_mask:0xf bank_mask:0xf
    v_pk_add_f32 v[24:25], v[24:25], v[26:27]
    s_waitcnt vmcnt(3)
    v_mfma_f32_16x16x32_bf16 v[28:31], v[8:11], v[48:51], 0
    v_add_f32 v32, v32, v33
    v_add_f32_e64 v24, v24, v25
    v_mfma_f32_16x16x32_bf16 v[36:39], v[12:15], v[48:51], 0
    v_fma_f32 v34, v32, 0.5, v24
    v_mfma_f32_16x16x16_bf16 v[28:31], v[92:93], v[52:53], v[28:31]
    v_mov_b32_e64 v58, 0
    v_add_f32_dpp v34, v34, v34 row_ror:8 row_mask:0xf bank_mask:0xf
    v_mfma_f32_16x16x16_bf16 v[36:39], v[94:95], v[52:53], v[36:39]
    v_mov_b32 v35, v34
    v_mov_b32 v59, 0
    v_mov_b32 v60, 0
    v_permlane16_swap_b32 v34, v35
    v_add_f32 v34, v34, v35
    v_mov_b32 v35, v34
    v_mov_b32 v61, 0
    v_mov_b32 v62, 0
    v_permlane32_swap_b32 v34, v35
    v_add_f32 v34, v34, v35
    v_rcp_f32 v34, v34
    s_mov_b64 exec, s[46:47]
    v_pk_mul_f32 v[28:29], v[28:29], v[34:35] op_sel_hi:[1,0]
    v_pk_mul_f32 v[30:31], v[30:31], v[34:35] op_sel_hi:[1,0]
    v_pk_mul_f32 v[36:37], v[36:37], v[34:35] op_sel_hi:[1,0]
    v_pk_mul_f32 v[38:39], v[38:39], v[34:35] op_sel_hi:[1,0]
    v_cvt_pk_bf16_f32 v24, v28, v29
    v_cvt_pk_bf16_f32 v25, v30, v31
    v_cvt_pk_bf16_f32 v26, v36, v37
    v_cvt_pk_bf16_f32 v27, v38, v39
    ds_write_b128 v22, v[24:27]
    s_mov_b64 exec, -1
    v_mov_b32 v63, 0
    v_mov_b32 v64, 0
    v_mov_b32 v65, 0
    v_mov_b32 v66, 0
    v_mov_b32 v67, 0
    v_mov_b32 v68, 0
    v_mov_b32 v69, 0
    v_mov_b32 v70, 0
    v_mov_b32 v71, 0
    v_mov_b32 v72, 0
    v_mov_b32 v73, 0
    v_mov_b32 v74, 0
    v_mov_b32 v75, 0
    s_waitcnt lgkmcnt(0)
    s_barrier
    ds_read_b128 v[48:51], v19 offset:5120
    ds_read_b128 v[52:55], v19 offset:6144
    v_subrev_u32 v21, 0x20000, v21
    v_lshrrev_b32_e64 v24, 8, v19
    v_bfe_u32 v25, v19, 2, 6
    v_lshl_add_u32 v24, v24, 13, v25
    s_waitcnt lgkmcnt(1)
    v_smfmac_f32_16x16x64_bf16 v[56:59], v[48:51], v[176:183], v18 abid:1
    s_waitcnt lgkmcnt(0)
    v_smfmac_f32_16x16x64_bf16 v[56:59], v[52:55], v[216:223], v18 abid:1
    v_smfmac_f32_16x16x64_bf16 v[60:63], v[48:51], v[184:191], v18 abid:1
    v_smfmac_f32_16x16x64_bf16 v[60:63], v[52:55], v[224:231], v18 abid:1
    v_add_f32_e64 v56, v56, v58
    v_smfmac_f32_16x16x64_bf16 v[64:67], v[48:51], v[192:199], v18 abid:1
    v_add_f32_e64 v57, v57, v59
    v_smfmac_f32_16x16x64_bf16 v[64:67], v[52:55], v[232:239], v18 abid:1
    v_cvt_pk_bf16_f32 v28, v56, v57
    v_add_f32_e64 v60, v60, v62
    v_smfmac_f32_16x16x64_bf16 v[68:71], v[48:51], v[200:207], v18 abid:1
    v_add_f32_e64 v61, v61, v63
    v_bfi_b32 v28, 1, s21, v28
    v_smfmac_f32_16x16x64_bf16 v[68:71], v[52:55], v[240:247], v18 abid:1
    v_cvt_pk_bf16_f32 v29, v60, v61
    v_add_f32_e64 v64, v64, v66
    v_smfmac_f32_16x16x64_bf16 v[72:75], v[48:51], v[208:215], v18 abid:1
    v_add_f32_e64 v65, v65, v67
    v_smfmac_f32_16x16x64_bf16 v[72:75], v[52:55], v[248:255], v18 abid:1
    v_add_f32_e64 v68, v68, v70
    v_add_f32 v69, v69, v71
    v_cvt_pk_bf16_f32 v30, v64, v65
    v_cvt_pk_bf16_f32 v31, v68, v69
    buffer_store_dwordx4 v[28:31], v23, s[8:11], s27 offen
    s_nop 2
    v_pk_add_f32 v[72:73], v[72:73], v[74:75]
    v_cvt_pk_bf16_f32 v72, v72, v73
    v_bfi_b32 v72, 1, s21, v72
    buffer_store_dword v72, v24, s[8:11], s28 offen
    s_cmp_lt_u32 s20, 58
    s_cbranch_scc1 R_noearly_209
    buffer_store_dwordx4 v[92:95], v19, s[8:11], s35 offen sc1
R_noearly_209:
R_nored_210:
    s_add_u32 s40, s20, 3
    s_min_u32 s40, s40, 63
fp_212:
    s_cmp_lt_u32 s40, s79
    s_cbranch_scc1 fpok_213
    v_mov_b32_e64 v52, 0
    buffer_load_dwordx4 v[48:51], v52, s[8:11], s37 offen sc1
    s_waitcnt vmcnt(0)
    v_min_u32 v48, v48, v50
    v_min3_u32 v48, v48, v49, v51
    v_lshlrev_b32 v48, 1, v48
    s_nop 0
    v_readfirstlane_b32 s79, v48
    s_add_u32 s6, s6, 1
    s_cmp_lt_u32 s6, 400000
    s_cbranch_scc1 fp_212
    s_branch fpok_213
fpok_213:
    s_add_u32 s36, s36, 0x40000
    v_mov_b32 v24, 0
    v_mov_b32 v25, 0
    v_mov_b32 v26, 0
    v_mov_b32 v27, 0
    v_mov_b32 v28, 0
    v_mov_b32 v29, 0
    v_mov_b32 v30, 0
    v_mov_b32 v31, 0
    v_mov_b32 v32, 0
    v_mov_b32 v33, 0
    v_mov_b32 v34, 0
    v_mov_b32 v35, 0
    v_mov_b32 v36, 0
    v_mov_b32 v37, 0
    v_mov_b32 v38, 0
    v_mov_b32 v39, 0
    v_mov_b32 v40, 0
    v_mov_b32 v41, 0
    v_mov_b32 v42, 0
    v_mov_b32 v43, 0
    v_mov_b32 v44, 0
    v_mov_b32 v45, 0
    v_mov_b32 v46, 0
    v_mov_b32 v47, 0
    ds_read_b128 v[76:79], v21 offset:0
    ds_read_b128 v[80:83], v21 offset:1024
    ds_read_b128 v[84:87], v21 offset:2048
    ds_read_b128 v[88:91], v21 offset:3072
    v_lshrrev_b32 v53, 2, v20
    v_add_u32 v53, 4, v53
    s_add_u32 s20, s20, 1
R_join_211:
    s_barrier
    s_nop 15
    s_nop 15
    s_nop 15
    s_nop 11
    s_branch R_top_198
R_par_204:
    buffer_load_dwordx4 v[0:3], v20, s[8:11], s32 offen sc1
    buffer_load_dword v4, v53, s[8:11], s32 offen offset:4092 sc1
    s_waitcnt vmcnt(2)
    ds_write_b128 v20, v[48:51]
    ds_write_b32 v53, v52 offset:4092
    v_bitop3_b32 v56, v48, v49, s22 bitop3:0x7e
    v_bitop3_b32 v57, v50, v51, s22 bitop3:0x7e
    v_bitop3_b32 v56, v52, v56, s22 bitop3:0xde
    v_bitop3_b32 v56, v56, v57, 1 bitop3:0xa8
    v_cmp_ne_u32 vcc, 0, v56
    s_cbranch_vccz R_paok_203
    buffer_load_dwordx4 v[48:51], v20, s[8:11], s32 offen sc1
    buffer_load_dword v52, v53, s[8:11], s32 offen offset:4092 sc1
    s_add_u32 s6, s6, 1
    s_cmp_lt_u32 s6, 400000
    s_cbranch_scc1 R_pa_202
    s_branch R_paok_203
R_pcr_207:
    s_waitcnt vmcnt(1)
    ds_write_b128 v20, v[8:11] offset:5120
    ds_write_b32 v53, v12 offset:9212
    v_bitop3_b32 v54, v8, v9, s22 bitop3:0x7e
    v_bitop3_b32 v55, v10, v11, s22 bitop3:0x7e
    v_bitop3_b32 v54, v12, v54, s22 bitop3:0xde
    v_bitop3_b32 v54, v54, v55, s52 bitop3:0xa8
    v_cmp_ne_u32_e64 vcc, 0, v54
    s_cbranch_vccz R_pcok_206
R_pcr2_214:
    s_add_u32 s6, s6, 1
    s_cmp_lt_u32 s6, 400000
    s_cbranch_scc1 R_pc2_208
    s_branch R_pcok_206
R_pc2_208:
    s_waitcnt lgkmcnt(0)
    buffer_load_dwordx4 v[48:51], v20, s[8:11], s33 offen sc1
    buffer_load_dword v52, v53, s[8:11], s33 offen offset:4092 sc1
    s_waitcnt vmcnt(0)
    ds_write_b128 v20, v[48:51] offset:5120
    ds_write_b32 v53, v52 offset:9212
    v_bitop3_b32 v54, v48, v49, s22 bitop3:0x7e
    v_bitop3_b32 v55, v50, v51, s22 bitop3:0x7e
    v_bitop3_b32 v54, v52, v54, s22 bitop3:0xde
    v_bitop3_b32 v54, v54, v55, s52 bitop3:0xa8
    v_cmp_ne_u32 vcc, 0, v54
    s_cbranch_vccnz R_pcr2_214
    s_branch R_pcok_206
R_exit_200:
    s_waitcnt lgkmcnt(0)
    v_smfmac_f32_16x16x64_bf16 v[44:47], v[64:67], v[152:159], v18
    v_smfmac_f32_16x16x64_bf16 v[40:43], v[68:71], v[160:167], v18
    v_smfmac_f32_16x16x64_bf16 v[44:47], v[68:71], v[168:175], v18
    v_smfmac_f32_16x16x64_bf16 v[40:43], v[72:75], v[76:83], v18
    v_smfmac_f32_16x16x64_bf16 v[44:47], v[72:75], v[84:91], v18
    s_nop 3
    v_cvt_pk_bf16_f32 v92, v40, v41
    v_cvt_pk_bf16_f32 v93, v42, v43
    s_nop 1
    v_cvt_pk_bf16_f32 v94, v44, v45
    v_cvt_pk_bf16_f32 v95, v46, v47
    buffer_store_dwordx4 v[92:95], v19, s[8:11], s35 offen sc1
    s_branch R_end_87
R_v00r_94:
    s_branch R_ent_216
.p2align 6
R_top_215:
    buffer_load_dwordx4 v[0:3], v20, s[8:11], s32 offen sc1
    buffer_load_dword v4, v53, s[8:11], s32 offen offset:4092 sc1
    s_nop 15
    s_nop 8
    buffer_load_dwordx4 v[48:51], v20, s[8:11], s32 offen sc1
    buffer_load_dword v52, v53, s[8:11], s32 offen offset:4092 sc1
R_pa_219:
    s_waitcnt vmcnt(2)
    ds_write_b128 v20, v[0:3]
    ds_write_b32 v53, v4 offset:4092
    v_bitop3_b32 v56, v0, v1, s22 bitop3:0x7e
    v_bitop3_b32 v57, v2, v3, s22 bitop3:0x7e
    v_bitop3_b32 v56, v4, v56, s22 bitop3:0xde
    v_bitop3_b32 v56, v56, v57, 1 bitop3:0xa8
    v_cmp_ne_u32 vcc, 0, v56
    s_cbranch_vccnz R_par_221
R_paok_220:
    buffer_load_dwordx4 v[48:51], v20, s[8:11], s33 offen sc1
    buffer_load_dword v52, v53, s[8:11], s33 offen offset:4092 sc1
    s_waitcnt lgkmcnt(0)
    s_barrier
R_ent_216:
    ds_read_b128 v[56:59], v19 offset:0
    ds_read_b128 v[60:63], v19 offset:1024
    ds_read_b128 v[64:67], v19 offset:2048
    ds_read_b128 v[68:71], v19 offset:3072
    ds_read_b128 v[72:75], v19 offset:4096
    s_waitcnt lgkmcnt(4)
    v_smfmac_f32_16x16x64_bf16 v[24:27], v[56:59], v[76:83], v18
    ds_read_b128 v[76:79], v21 offset:16384
    s_xor_b32 s21, s21, 1
    buffer_load_dwordx4 v[0:3], v19, s[8:11], s34 offen offset:0 sc1
    v_smfmac_f32_16x16x64_bf16 v[28:31], v[56:59], v[84:91], v18
    ds_read_b128 v[80:83], v21 offset:17408
    s_min_u32 s40, s20, 1
    buffer_load_dwordx4 v[4:7], v19, s[8:11], s34 offen offset:1024 sc1
    v_smfmac_f32_16x16x64_bf16 v[32:35], v[56:59], a[112:119], v18
    ds_read_b128 v[84:87], v21 offset:18432
    s_lshl_b32 s41, s40, 17
    v_smfmac_f32_16x16x64_bf16 v[36:39], v[56:59], a[120:127], v18
    ds_read_b128 v[88:91], v21 offset:19456
    s_waitcnt lgkmcnt(7)
    v_smfmac_f32_16x16x64_bf16 v[24:27], v[60:63], a[0:7], v18
    buffer_load_dwordx4 v[8:11], v20, s[8:11], s33 offen sc1
    v_smfmac_f32_16x16x64_bf16 v[28:31], v[60:63], a[8:15], v18
    buffer_load_dword v12, v53, s[8:11], s33 offen offset:4092 sc1
    s_waitcnt lgkmcnt(2)
    v_smfmac_f32_16x16x64_bf16 v[32:35], v[60:63], v[76:83], v18
    ds_read_b128 v[76:79], v21 offset:32768
    s_waitcnt lgkmcnt(1)
    v_smfmac_f32_16x16x64_bf16 v[36:39], v[60:63], v[84:91], v18
    ds_read_b128 v[80:83], v21 offset:33792
    v_smfmac_f32_16x16x64_bf16 v[24:27], v[64:67], a[16:23], v18
    ds_read_b128 v[84:87], v21 offset:34816
    v_smfmac_f32_16x16x64_bf16 v[28:31], v[64:67], a[24:31], v18
    ds_read_b128 v[88:91], v21 offset:35840
    v_smfmac_f32_16x16x64_bf16 v[32:35], v[64:67], a[128:135], v18
    v_smfmac_f32_16x16x64_bf16 v[36:39], v[64:67], a[136:143], v18
    s_waitcnt lgkmcnt(2)
    v_smfmac_f32_16x16x64_bf16 v[24:27], v[68:71], v[76:83], v18
    ds_read_b128 v[76:79], v21 offset:49152
    s_waitcnt lgkmcnt(1)
    v_smfmac_f32_16x16x64_bf16 v[28:31], v[68:71], v[84:91], v18
    ds_read_b128 v[80:83], v21 offset:50176
    v_smfmac_f32_16x16x64_bf16 v[32:35], v[68:71], a[144:151], v18
    ds_read_b128 v[84:87], v21 offset:51200
    v_smfmac_f32_16x16x64_bf16 v[36:39], v[68:71], a[152:159], v18
    ds_read_b128 v[88:91], v21 offset:52224
    v_smfmac_f32_16x16x64_bf16 v[24:27], v[72:75], a[32:39], v18
    v_add_u32 v21, 0x10000, v21
    buffer_store_dwordx4 v[92:95], v19, s[8:11], s35 offen sc1
    v_smfmac_f32_16x16x64_bf16 v[28:31], v[72:75], a[40:47], v18
    s_add_u32 s35, s35, s41
    s_add_u32 s51, s34, 0x1000000
    s_waitcnt lgkmcnt(2)
    v_smfmac_f32_16x16x64_bf16 v[32:35], v[72:75], v[76:83], v18
    ds_read_b128 v[76:79], v21 offset:0
    s_add_u32 s34, s34, 0x40000
    s_waitcnt lgkmcnt(1)
    v_smfmac_f32_16x16x64_bf16 v[36:39], v[72:75], v[84:91], v18
    ds_read_b128 v[80:83], v21 offset:1024
    v_smfmac_f32_16x16x64_bf16 v[40:43], v[56:59], a[208:215], v18
    ds_read_b128 v[84:87], v21 offset:2048
    v_smfmac_f32_16x16x64_bf16 v[44:47], v[56:59], a[216:223], v18
    ds_read_b128 v[88:91], v21 offset:3072
    s_waitcnt vmcnt(3)
    ds_write_b128 v20, v[48:51] offset:5120
    ds_write_b32 v53, v52 offset:9212
    v_smfmac_f32_16x16x64_bf16 v[40:43], v[60:63], a[224:231], v18
    v_bitop3_b32 v54, v48, v49, s22 bitop3:0x7e
    v_bitop3_b32 v55, v50, v51, s22 bitop3:0x7e
    v_smfmac_f32_16x16x64_bf16 v[44:47], v[60:63], a[232:239], v18
    v_bitop3_b32 v54, v52, v54, s22 bitop3:0xde
    v_bitop3_b32 v54, v54, v55, s52 bitop3:0xa8
    s_waitcnt lgkmcnt(4)
    v_smfmac_f32_16x16x64_bf16 v[40:43], v[64:67], v[76:83], v18
    v_cmp_ne_u32_e64 vcc, 0, v54
    s_waitcnt lgkmcnt(2)
    v_smfmac_f32_16x16x64_bf16 v[44:47], v[64:67], v[84:91], v18
    s_cbranch_vccnz R_pcr_224
R_pcok_223:
    s_waitcnt lgkmcnt(0)
    s_barrier
    ds_read_b128 v[56:59], v19 offset:5120
    ds_read_b128 v[60:63], v19 offset:6144
    v_smfmac_f32_16x16x64_bf16 v[40:43], v[68:71], a[240:247], v18
    ds_read_b128 v[64:67], v19 offset:7168
    v_smfmac_f32_16x16x64_bf16 v[44:47], v[68:71], a[248:255], v18
    ds_read_b128 v[68:71], v19 offset:8192
    v_smfmac_f32_16x16x64_bf16 v[40:43], v[72:75], v[96:103], v18
    v_smfmac_f32_16x16x64_bf16 v[44:47], v[72:75], v[104:111], v18
    ds_read_b128 v[72:75], v19 offset:9216
    s_waitcnt lgkmcnt(4)
    v_smfmac_f32_16x16x64_bf16 v[24:27], v[56:59], a[48:55], v18
    ds_read_b128 v[76:79], v21 offset:16384
    s_andn2_b32 s40, 1, s20
    v_smfmac_f32_16x16x64_bf16 v[28:31], v[56:59], a[56:63], v18
    ds_read_b128 v[80:83], v21 offset:17408
    s_xor_b32 s22, s22, s40
    s_waitcnt lgkmcnt(5)
    v_smfmac_f32_16x16x64_bf16 v[24:27], v[60:63], a[64:71], v18
    ds_read_b128 v[84:87], v21 offset:18432
    s_mov_b32 s52, 1
    v_smfmac_f32_16x16x64_bf16 v[28:31], v[60:63], a[72:79], v18
    ds_read_b128 v[88:91], v21 offset:19456
    s_min_u32 s40, s20, 1
    s_waitcnt lgkmcnt(6)
    v_smfmac_f32_16x16x64_bf16 v[24:27], v[64:67], a[80:87], v18
    buffer_load_dwordx4 v[8:11], v19, s[8:11], s51 offen offset:0 sc1
    v_smfmac_f32_16x16x64_bf16 v[28:31], v[64:67], a[88:95], v18
    buffer_load_dwordx4 v[12:15], v19, s[8:11], s51 offen offset:1024 sc1
    s_mov_b32 s33, s56
    s_waitcnt lgkmcnt(2)
    v_smfmac_f32_16x16x64_bf16 v[24:27], v[68:71], v[76:83], v18
    ds_read_b128 v[76:79], v21 offset:32768
    s_xor_b32 s56, s56, 0x4000
    s_waitcnt lgkmcnt(1)
    v_smfmac_f32_16x16x64_bf16 v[28:31], v[68:71], v[84:91], v18
    ds_read_b128 v[80:83], v21 offset:33792
    s_xor_b32 s32, s32, 0x4000
    v_smfmac_f32_16x16x64_bf16 v[24:27], v[72:75], a[96:103], v18
    ds_read_b128 v[84:87], v21 offset:34816
    v_smfmac_f32_16x16x64_bf16 v[28:31], v[72:75], a[104:111], v18
    ds_read_b128 v[88:91], v21 offset:35840
    v_smfmac_f32_16x16x64_bf16 v[32:35], v[56:59], a[160:167], v18
    v_smfmac_f32_16x16x64_bf16 v[36:39], v[56:59], a[168:175], v18
    s_waitcnt lgkmcnt(2)
    v_smfmac_f32_16x16x64_bf16 v[32:35], v[60:63], v[76:83], v18
    ds_read_b128 v[76:79], v21 offset:49152
    s_waitcnt lgkmcnt(1)
    v_smfmac_f32_16x16x64_bf16 v[36:39], v[60:63], v[84:91], v18
    ds_read_b128 v[80:83], v21 offset:50176
    v_cvt_pk_bf16_f32 v48, v24, v25
    v_smfmac_f32_16x16x64_bf16 v[32:35], v[64:67], a[176:183], v18
    ds_read_b128 v[84:87], v21 offset:51200
    v_cvt_pk_bf16_f32 v49, v26, v27
    v_smfmac_f32_16x16x64_bf16 v[36:39], v[64:67], a[184:191], v18
    ds_read_b128 v[88:91], v21 offset:52224
    v_cvt_pk_bf16_f32 v50, v28, v29
    v_smfmac_f32_16x16x64_bf16 v[32:35], v[68:71], a[192:199], v18
    v_cvt_pk_bf16_f32 v51, v30, v31
    v_smfmac_f32_16x16x64_bf16 v[36:39], v[68:71], a[200:207], v18
    v_add_u32 v21, 0x10000, v21
    s_waitcnt lgkmcnt(2)
    v_smfmac_f32_16x16x64_bf16 v[32:35], v[72:75], v[76:83], v18
    ds_read_b128 v[76:79], v21 offset:0
    s_waitcnt lgkmcnt(1)
    v_smfmac_f32_16x16x64_bf16 v[36:39], v[72:75], v[84:91], v18
    ds_read_b128 v[80:83], v21 offset:1024
    v_mfma_f32_16x16x16_bf16 v[24:27], v[48:49], v[16:17], 0
    ds_read_b128 v[84:87], v21 offset:2048
    v_mfma_f32_16x16x16_bf16 v[28:31], v[50:51], v[16:17], 0
    ds_read_b128 v[88:91], v21 offset:3072
    v_cvt_pk_bf16_f32 v52, v32, v33
    v_cvt_pk_bf16_f32 v53, v34, v35
    v_cvt_pk_bf16_f32 v54, v36, v37
    v_cvt_pk_bf16_f32 v55, v38, v39
    v_mfma_f32_16x16x16_bf16 v[32:35], v[52:53], v[16:17], 0
    v_cvt_pk_bf16_f32 v48, v24, v25
    v_mfma_f32_16x16x16_bf16 v[36:39], v[54:55], v[16:17], 0
    v_cvt_pk_bf16_f32 v49, v26, v27
    v_cvt_pk_bf16_f32 v50, v28, v29
    v_cvt_pk_bf16_f32 v51, v30, v31
    s_nop 1
    v_mfma_f32_16x16x32_bf16 v[24:27], v[0:3], v[48:51], 0
    v_mfma_f32_16x16x32_bf16 v[28:31], v[4:7], v[48:51], 0
    v_cvt_pk_bf16_f32 v92, v32, v33
    v_cvt_pk_bf16_f32 v93, v34, v35
    v_cvt_pk_bf16_f32 v94, v36, v37
    v_cvt_pk_bf16_f32 v95, v38, v39
    s_nop 1
    v_mfma_f32_16x16x32_bf16 v[32:35], v[92:95], v[48:51], 0
    s_nop 2
    v_cndmask_b32 v24, v24, v28, s[44:45]
    v_cndmask_b32 v25, v25, v29, s[44:45]
    v_cndmask_b32 v26, v26, v30, s[44:45]
    v_cndmask_b32 v27, v27, v31, s[44:45]
    ds_write_b128 v20, v[24:27] offset:10240
    v_cndmask_b32 v32, v32, v34, s[44:45]
    v_cndmask_b32 v33, v33, v35, s[44:45]
    ds_write_b64 v20, v[32:33] offset:0
    v_smfmac_f32_16x16x64_bf16 v[40:43], v[56:59], v[112:119], v18
    v_xor_b32 v52, 0x400, v20
    v_smfmac_f32_16x16x64_bf16 v[44:47], v[56:59], v[120:127], v18
    v_xor_b32 v54, 0x800, v20
    v_smfmac_f32_16x16x64_bf16 v[40:43], v[60:63], v[128:135], v18
    v_xor_b32 v34, 0xc00, v20
    v_smfmac_f32_16x16x64_bf16 v[44:47], v[60:63], v[136:143], v18
    v_smfmac_f32_16x16x64_bf16 v[40:43], v[64:67], v[144:151], v18
    s_cmp_eq_u32 s20, 63
    s_cbranch_scc1 R_exit_217
    s_waitcnt lgkmcnt(0)
    s_barrier
    ds_read_b128 v[28:31], v52 offset:10240
    ds_read_b64 v[52:53], v52 offset:0
    v_smfmac_f32_16x16x64_bf16 v[44:47], v[64:67], v[152:159], v18
    ds_read_b128 v[36:39], v54 offset:10240
    v_smfmac_f32_16x16x64_bf16 v[40:43], v[68:71], v[160:167], v18
    ds_read_b64 v[54:55], v54 offset:0
    v_smfmac_f32_16x16x64_bf16 v[44:47], v[68:71], v[168:175], v18
    ds_read_b128 v[48:51], v34 offset:10240
    v_smfmac_f32_16x16x64_bf16 v[40:43], v[72:75], v[76:83], v18
    ds_read_b64 v[34:35], v34 offset:0
    v_smfmac_f32_16x16x64_bf16 v[44:47], v[72:75], v[84:91], v18
    s_waitcnt lgkmcnt(5)
    v_pk_add_f32 v[24:25], v[24:25], v[28:29]
    v_pk_add_f32 v[26:27], v[26:27], v[30:31]
    s_waitcnt lgkmcnt(4)
    v_pk_add_f32 v[32:33], v[32:33], v[52:53]
    s_waitcnt lgkmcnt(1)
    v_pk_add_f32 v[36:37], v[36:37], v[48:49]
    v_pk_add_f32 v[38:39], v[38:39], v[50:51]
    s_waitcnt lgkmcnt(0)
    v_pk_add_f32 v[54:55], v[54:55], v[34:35]
    v_pk_add_f32 v[24:25], v[24:25], v[36:37]
    v_pk_add_f32 v[26:27], v[26:27], v[38:39]
    v_pk_add_f32 v[32:33], v[32:33], v[54:55]
    v_max3_f32 v34, v24, v25, v26
    v_max3_f32 v34, v34, v27, v32
    v_max_f32_e64 v34, v34, v33
    v_cvt_pk_bf16_f32 v76, v40, v41
    v_cvt_pk_bf16_f32 v77, v42, v43
    v_max_f32_dpp v34, v34, v34 row_ror:8 row_mask:0xf bank_mask:0xf
    v_mov_b32_e64 v35, v34
    v_cvt_pk_bf16_f32 v78, v44, v45
    v_cvt_pk_bf16_f32 v79, v46, v47
    v_permlane16_swap_b32 v34, v35
    v_max_f32 v34, v34, v35
    v_mov_b32 v35, v34
    v_mov_b32 v56, 0
    v_mov_b32 v57, 0
    v_permlane32_swap_b32 v34, v35
    v_max_f32 v34, v34, v35
    v_mul_f32 v34, s50, v34
    v_pk_fma_f32 v[24:25], v[24:25], s[54:55], v[34:35] op_sel_hi:[1,1,0] neg_lo:[0,0,1] neg_hi:[0,0,1]
    v_pk_fma_f32 v[26:27], v[26:27], s[54:55], v[34:35] op_sel_hi:[1,1,0] neg_lo:[0,0,1] neg_hi:[0,0,1]
    v_pk_fma_f32 v[32:33], v[32:33], s[54:55], v[34:35] op_sel_hi:[1,1,0] neg_lo:[0,0,1] neg_hi:[0,0,1]
    v_exp_f32 v24, v24
    v_exp_f32 v25, v25
    v_exp_f32 v26, v26
    v_exp_f32 v27, v27
    v_exp_f32 v32, v32
    v_exp_f32 v33, v33
    v_cvt_pk_bf16_f32 v48, v24, v25
    v_cvt_pk_bf16_f32 v49, v26, v27
    v_cvt_pk_bf16_f32 v52, v32, v33
    v_mov_b32_dpp v50, v48 row_ror:8 row_mask:0xf bank_mask:0xf
    v_mov_b32_dpp v51, v49 row_ror:8 row_mask:0xf bank_mask:0xf
    v_mov_b32_dpp v53, v52 row_ror:8 row_mask:0xf bank_mask:0xf
    v_pk_add_f32 v[24:25], v[24:25], v[26:27]
    s_waitcnt vmcnt(0)
    v_mfma_f32_16x16x32_bf16 v[28:31], v[8:11], v[48:51], 0
    v_add_f32 v32, v32, v33
    v_add_f32_e64 v24, v24, v25
    v_mfma_f32_16x16x32_bf16 v[36:39], v[12:15], v[48:51], 0
    v_fma_f32 v34, v32, 0.5, v24
    v_mfma_f32_16x16x16_bf16 v[28:31], v[76:77], v[52:53], v[28:31]
    v_mov_b32_e64 v58, 0
    v_add_f32_dpp v34, v34, v34 row_ror:8 row_mask:0xf bank_mask:0xf
    v_mfma_f32_16x16x16_bf16 v[36:39], v[78:79], v[52:53], v[36:39]
    v_mov_b32 v35, v34
    v_mov_b32 v59, 0
    v_mov_b32 v60, 0
    v_permlane16_swap_b32 v34, v35
    v_add_f32 v34, v34, v35
    v_mov_b32 v35, v34
    v_mov_b32 v61, 0
    v_mov_b32 v62, 0
    v_permlane32_swap_b32 v34, v35
    v_add_f32 v34, v34, v35
    v_rcp_f32 v34, v34
    s_mov_b64 exec, s[46:47]
    v_pk_mul_f32 v[28:29], v[28:29], v[34:35] op_sel_hi:[1,0]
    v_pk_mul_f32 v[30:31], v[30:31], v[34:35] op_sel_hi:[1,0]
    v_pk_mul_f32 v[36:37], v[36:37], v[34:35] op_sel_hi:[1,0]
    v_pk_mul_f32 v[38:39], v[38:39], v[34:35] op_sel_hi:[1,0]
    v_cvt_pk_bf16_f32 v24, v28, v29
    v_cvt_pk_bf16_f32 v25, v30, v31
    v_cvt_pk_bf16_f32 v26, v36, v37
    v_cvt_pk_bf16_f32 v27, v38, v39
    ds_write_b128 v22, v[24:27]
    s_mov_b64 exec, -1
    v_mov_b32 v63, 0
    v_mov_b32 v64, 0
    v_mov_b32 v65, 0
    v_mov_b32 v66, 0
    v_mov_b32 v67, 0
    v_mov_b32 v68, 0
    v_mov_b32 v69, 0
    v_mov_b32 v70, 0
    v_mov_b32 v71, 0
    v_mov_b32 v72, 0
    v_mov_b32 v73, 0
    v_mov_b32 v74, 0
    v_mov_b32 v75, 0
    s_waitcnt lgkmcnt(0)
    s_barrier
    ds_read_b128 v[48:51], v19 offset:5120
    ds_read_b128 v[52:55], v19 offset:6144
    v_subrev_u32 v21, 0x20000, v21
    v_lshrrev_b32_e64 v24, 8, v19
    v_bfe_u32 v25, v19, 2, 6
    v_lshl_add_u32 v24, v24, 13, v25
    s_waitcnt lgkmcnt(1)
    v_smfmac_f32_16x16x64_bf16 v[56:59], v[48:51], v[176:183], v18 abid:1
    s_waitcnt lgkmcnt(0)
    v_smfmac_f32_16x16x64_bf16 v[56:59], v[52:55], v[216:223], v18 abid:1
    v_smfmac_f32_16x16x64_bf16 v[60:63], v[48:51], v[184:191], v18 abid:1
    v_smfmac_f32_16x16x64_bf16 v[60:63], v[52:55], v[224:231], v18 abid:1
    v_add_f32_e64 v56, v56, v58
    v_smfmac_f32_16x16x64_bf16 v[64:67], v[48:51], v[192:199], v18 abid:1
    v_add_f32_e64 v57, v57, v59
    v_smfmac_f32_16x16x64_bf16 v[64:67], v[52:55], v[232:239], v18 abid:1
    v_cvt_pk_bf16_f32 v28, v56, v57
    v_add_f32_e64 v60, v60, v62
    v_smfmac_f32_16x16x64_bf16 v[68:71], v[48:51], v[200:207], v18 abid:1
    v_add_f32_e64 v61, v61, v63
    v_bfi_b32 v28, 1, s21, v28
    v_smfmac_f32_16x16x64_bf16 v[68:71], v[52:55], v[240:247], v18 abid:1
    v_cvt_pk_bf16_f32 v29, v60, v61
    v_add_f32_e64 v64, v64, v66
    v_smfmac_f32_16x16x64_bf16 v[72:75], v[48:51], v[208:215], v18 abid:1
    v_add_f32_e64 v65, v65, v67
    v_smfmac_f32_16x16x64_bf16 v[72:75], v[52:55], v[248:255], v18 abid:1
    v_add_f32_e64 v68, v68, v70
    v_add_f32 v69, v69, v71
    v_cvt_pk_bf16_f32 v30, v64, v65
    v_cvt_pk_bf16_f32 v31, v68, v69
    buffer_store_dwordx4 v[28:31], v23, s[8:11], s27 offen sc1
    s_nop 2
    v_pk_add_f32 v[72:73], v[72:73], v[74:75]
    v_cvt_pk_bf16_f32 v72, v72, v73
    v_bfi_b32 v72, 1, s21, v72
    buffer_store_dword v72, v24, s[8:11], s28 offen sc1
    s_cmp_lt_u32 s20, 58
    s_cbranch_scc1 R_noearly_226
    buffer_store_dwordx4 v[92:95], v19, s[8:11], s35 offen sc1
R_noearly_226:
    v_mov_b32 v24, 0
    v_mov_b32 v25, 0
    v_mov_b32 v26, 0
    v_mov_b32 v27, 0
    v_mov_b32 v28, 0
    v_mov_b32 v29, 0
    v_mov_b32 v30, 0
    v_mov_b32 v31, 0
    v_mov_b32 v32, 0
    v_mov_b32 v33, 0
    v_mov_b32 v34, 0
    v_mov_b32 v35, 0
    v_mov_b32 v36, 0
    v_mov_b32 v37, 0
    v_mov_b32 v38, 0
    v_mov_b32 v39, 0
    v_mov_b32 v40, 0
    v_mov_b32 v41, 0
    v_mov_b32 v42, 0
    v_mov_b32 v43, 0
    v_mov_b32 v44, 0
    v_mov_b32 v45, 0
    v_mov_b32 v46, 0
    v_mov_b32 v47, 0
    ds_read_b128 v[76:79], v21 offset:0
    buffer_load_dwordx4 v[56:59], v19, s[8:11], s29 offen offset:0 sc1
    buffer_load_dwordx4 v[60:63], v19, s[8:11], s29 offen offset:1024 sc1
    ds_read_b128 v[80:83], v21 offset:1024
    ds_read_b128 v[84:87], v21 offset:2048
    ds_read_b128 v[88:91], v21 offset:3072
    v_lshrrev_b32_e64 v53, 2, v20
    v_add_u32 v53, 4, v53
    s_add_u32 s20, s20, 1
    v_mov_b32 v54, 0xfffe0000
    v_lshrrev_b32_e64 v48, 2, v19
    v_and_b32 v48, 0x80, v48
    v_and_or_b32 v55, v19, 16, v48
    v_lshrrev_b32_e64 v48, 5, v19
    v_and_or_b32 v55, v48, 8, v55
    v_lshrrev_b32_e64 v48, 4, v19
    v_and_or_b32 v55, v48, 4, v55
    v_mov_b32 v48, 0x3f80
    v_cndmask_b32 v48, v48, 1.0, s[76:77]
    v_cndmask_b32 v64, 0, v48, s[60:61]
    v_cndmask_b32 v65, 0, v48, s[62:63]
    v_cndmask_b32 v66, 0, v48, s[64:65]
    v_cndmask_b32 v67, 0, v48, s[66:67]
    s_lshl_b32 s26, s22, 16
    s_sub_u32 s24, 0x10000, s26
    s_nop 7
    buffer_load_dwordx4 v[0:3], v19, s[8:11], s29 offen offset:0 sc1
    buffer_load_dwordx4 v[4:7], v19, s[8:11], s29 offen offset:1024 sc1
R_pi_229:
    s_waitcnt vmcnt(3)
    v_mfma_f32_16x16x32_bf16 v[68:71], v[56:59], v[64:67], 0
    s_waitcnt vmcnt(2)
    v_mfma_f32_16x16x32_bf16 v[68:71], v[60:63], v[64:67], v[68:71]
    v_bitop3_b32 v48, v56, v60, s21 bitop3:0x7e
    v_and_b32 v48, 1, v48
    v_cmp_ne_u32 vcc, 0, v48
    s_cbranch_vccnz R_pir_231
R_piok_230:
    s_nop 3
    v_permlane32_swap_b32 v68, v70
    v_permlane32_swap_b32 v69, v71
    v_pk_add_f32 v[68:69], v[68:69], v[70:71]
    s_nop 1
    v_permlane16_swap_b32 v68, v69
    v_add_f32_e64 v68, v68, v69
    v_add_u32 v70, s24, v68
    v_bfi_b32 v70, v54, v70, s26
    v_mov_b32_dpp v69, v68 row_shl:2 row_mask:0xf bank_mask:0xf
    s_mov_b64 exec, s[48:49]
    v_cvt_pk_bf16_f32 v70, v70, v69
    buffer_store_dword v70, v55, s[8:11], s30 offen sc1
    buffer_store_dword v70, v55, s[8:11], s31 offen sc1
    s_mov_b64 exec, -1
    s_xor_b32 s31, s31, 0x4000
    s_xor_b32 s30, s30, 0x4000
    s_barrier
    s_nop 15
    s_nop 15
    s_nop 15
    s_nop 11
    s_branch R_top_215
R_par_221:
    buffer_load_dwordx4 v[0:3], v20, s[8:11], s32 offen sc1
    buffer_load_dword v4, v53, s[8:11], s32 offen offset:4092 sc1
    s_waitcnt vmcnt(2)
    ds_write_b128 v20, v[48:51]
    ds_write_b32 v53, v52 offset:4092
    v_bitop3_b32 v56, v48, v49, s22 bitop3:0x7e
    v_bitop3_b32 v57, v50, v51, s22 bitop3:0x7e
    v_bitop3_b32 v56, v52, v56, s22 bitop3:0xde
    v_bitop3_b32 v56, v56, v57, 1 bitop3:0xa8
    v_cmp_ne_u32 vcc, 0, v56
    s_cbranch_vccz R_paok_220
    buffer_load_dwordx4 v[48:51], v20, s[8:11], s32 offen sc1
    buffer_load_dword v52, v53, s[8:11], s32 offen offset:4092 sc1
    s_add_u32 s6, s6, 1
    s_cmp_lt_u32 s6, 400000
    s_cbranch_scc1 R_pa_219
    s_branch R_paok_220
R_pcr_224:
    s_waitcnt vmcnt(1)
    ds_write_b128 v20, v[8:11] offset:5120
    ds_write_b32 v53, v12 offset:9212
    v_bitop3_b32 v54, v8, v9, s22 bitop3:0x7e
    v_bitop3_b32 v55, v10, v11, s22 bitop3:0x7e
    v_bitop3_b32 v54, v12, v54, s22 bitop3:0xde
    v_bitop3_b32 v54, v54, v55, s52 bitop3:0xa8
    v_cmp_ne_u32_e64 vcc, 0, v54
    s_cbranch_vccz R_pcok_223
R_pcr2_233:
    s_add_u32 s6, s6, 1
    s_cmp_lt_u32 s6, 400000
    s_cbranch_scc1 R_pc2_225
    s_branch R_pcok_223
R_pc2_225:
    s_waitcnt lgkmcnt(0)
    buffer_load_dwordx4 v[48:51], v20, s[8:11], s33 offen sc1
    buffer_load_dword v52, v53, s[8:11], s33 offen offset:4092 sc1
    s_waitcnt vmcnt(0)
    ds_write_b128 v20, v[48:51] offset:5120
    ds_write_b32 v53, v52 offset:9212
    v_bitop3_b32 v54, v48, v49, s22 bitop3:0x7e
    v_bitop3_b32 v55, v50, v51, s22 bitop3:0x7e
    v_bitop3_b32 v54, v52, v54, s22 bitop3:0xde
    v_bitop3_b32 v54, v54, v55, s52 bitop3:0xa8
    v_cmp_ne_u32_e64 vcc, 0, v54
    s_cbranch_vccnz R_pcr2_233
    s_branch R_pcok_223
R_pir_231:
    buffer_load_dwordx4 v[56:59], v19, s[8:11], s29 offen offset:0 sc1
    buffer_load_dwordx4 v[60:63], v19, s[8:11], s29 offen offset:1024 sc1
    s_waitcnt vmcnt(3)
    v_mfma_f32_16x16x32_bf16 v[68:71], v[0:3], v[64:67], 0
    s_waitcnt vmcnt(2)
    v_mfma_f32_16x16x32_bf16 v[68:71], v[4:7], v[64:67], v[68:71]
    v_bitop3_b32 v48, v0, v4, s21 bitop3:0x7e
    v_and_b32_e64 v48, 1, v48
    v_cmp_ne_u32 vcc, 0, v48
    s_cbranch_vccz R_piok_230
    buffer_load_dwordx4 v[0:3], v19, s[8:11], s29 offen offset:0 sc1
    buffer_load_dwordx4 v[4:7], v19, s[8:11], s29 offen offset:1024 sc1
    s_add_u32 s6, s6, 1
    s_cmp_lt_u32 s6, 400000
    s_cbranch_scc1 R_pi_229
    s_branch R_piok_230
R_exit_217:
    s_waitcnt lgkmcnt(0)
    buffer_store_dwordx4 v[92:95], v19, s[8:11], s35 offen sc1
    s_branch R_end_87
R_v00h_95:
    s_branch R_ent_235
.p2align 6
R_top_234:
    buffer_load_dwordx4 v[0:3], v20, s[8:11], s32 offen sc1
    buffer_load_dword v4, v53, s[8:11], s32 offen offset:4092 sc1
    s_nop 15
    s_nop 8
    buffer_load_dwordx4 v[48:51], v20, s[8:11], s32 offen sc1
    buffer_load_dword v52, v53, s[8:11], s32 offen offset:4092 sc1
R_pa_238:
    s_waitcnt vmcnt(2)
    ds_write_b128 v20, v[0:3]
    ds_write_b32 v53, v4 offset:4092
    v_bitop3_b32 v56, v0, v1, s22 bitop3:0x7e
    v_bitop3_b32 v57, v2, v3, s22 bitop3:0x7e
    v_bitop3_b32 v56, v4, v56, s22 bitop3:0xde
    v_bitop3_b32 v56, v56, v57, 1 bitop3:0xa8
    v_cmp_ne_u32 vcc, 0, v56
    s_cbranch_vccnz R_par_240
R_paok_239:
    buffer_load_dwordx4 v[48:51], v20, s[8:11], s33 offen sc1
    buffer_load_dword v52, v53, s[8:11], s33 offen offset:4092 sc1
    s_waitcnt lgkmcnt(0)
    s_barrier
R_ent_235:
    ds_read_b128 v[56:59], v19 offset:0
    ds_read_b128 v[60:63], v19 offset:1024
    ds_read_b128 v[64:67], v19 offset:2048
    ds_read_b128 v[68:71], v19 offset:3072
    ds_read_b128 v[72:75], v19 offset:4096
    s_waitcnt lgkmcnt(4)
    v_smfmac_f32_16x16x64_bf16 v[24:27], v[56:59], v[76:83], v18
    ds_read_b128 v[76:79], v21 offset:16384
    s_xor_b32 s21, s21, 1
    buffer_load_dwordx4 v[0:3], v19, s[8:11], s34 offen offset:0 sc1
    v_smfmac_f32_16x16x64_bf16 v[28:31], v[56:59], v[84:91], v18
    ds_read_b128 v[80:83], v21 offset:17408
    s_min_u32 s40, s20, 1
    buffer_load_dwordx4 v[4:7], v19, s[8:11], s34 offen offset:1024 sc1
    v_smfmac_f32_16x16x64_bf16 v[32:35], v[56:59], a[112:119], v18
    ds_read_b128 v[84:87], v21 offset:18432
    s_lshl_b32 s41, s40, 17
    v_smfmac_f32_16x16x64_bf16 v[36:39], v[56:59], a[120:127], v18
    ds_read_b128 v[88:91], v21 offset:19456
    s_waitcnt lgkmcnt(7)
    v_smfmac_f32_16x16x64_bf16 v[24:27], v[60:63], a[0:7], v18
    buffer_load_dwordx4 v[8:11], v20, s[8:11], s33 offen sc1
    v_smfmac_f32_16x16x64_bf16 v[28:31], v[60:63], a[8:15], v18
    buffer_load_dword v12, v53, s[8:11], s33 offen offset:4092 sc1
    s_waitcnt lgkmcnt(2)
    v_smfmac_f32_16x16x64_bf16 v[32:35], v[60:63], v[76:83], v18
    ds_read_b128 v[76:79], v21 offset:32768
    s_waitcnt lgkmcnt(1)
    v_smfmac_f32_16x16x64_bf16 v[36:39], v[60:63], v[84:91], v18
    ds_read_b128 v[80:83], v21 offset:33792
    v_smfmac_f32_16x16x64_bf16 v[24:27], v[64:67], a[16:23], v18
    ds_read_b128 v[84:87], v21 offset:34816
    v_smfmac_f32_16x16x64_bf16 v[28:31], v[64:67], a[24:31], v18
    ds_read_b128 v[88:91], v21 offset:35840
    v_smfmac_f32_16x16x64_bf16 v[32:35], v[64:67], a[128:135], v18
    v_smfmac_f32_16x16x64_bf16 v[36:39], v[64:67], a[136:143], v18
    s_waitcnt lgkmcnt(2)
    v_smfmac_f32_16x16x64_bf16 v[24:27], v[68:71], v[76:83], v18
    ds_read_b128 v[76:79], v21 offset:49152
    s_waitcnt lgkmcnt(1)
    v_smfmac_f32_16x16x64_bf16 v[28:31], v[68:71], v[84:91], v18
    ds_read_b128 v[80:83], v21 offset:50176
    v_smfmac_f32_16x16x64_bf16 v[32:35], v[68:71], a[144:151], v18
    ds_read_b128 v[84:87], v21 offset:51200
    v_smfmac_f32_16x16x64_bf16 v[36:39], v[68:71], a[152:159], v18
    ds_read_b128 v[88:91], v21 offset:52224
    v_smfmac_f32_16x16x64_bf16 v[24:27], v[72:75], a[32:39], v18
    v_add_u32 v21, 0x10000, v21
    buffer_store_dwordx4 v[92:95], v19, s[8:11], s35 offen sc1
    v_smfmac_f32_16x16x64_bf16 v[28:31], v[72:75], a[40:47], v18
    s_add_u32 s35, s35, s41
    s_add_u32 s51, s34, 0x1000000
    s_waitcnt lgkmcnt(2)
    v_smfmac_f32_16x16x64_bf16 v[32:35], v[72:75], v[76:83], v18
    ds_read_b128 v[76:79], v21 offset:0
    s_add_u32 s34, s34, 0x40000
    s_waitcnt lgkmcnt(1)
    v_smfmac_f32_16x16x64_bf16 v[36:39], v[72:75], v[84:91], v18
    ds_read_b128 v[80:83], v21 offset:1024
    v_smfmac_f32_16x16x64_bf16 v[40:43], v[56:59], a[208:215], v18
    ds_read_b128 v[84:87], v21 offset:2048
    v_smfmac_f32_16x16x64_bf16 v[44:47], v[56:59], a[216:223], v18
    ds_read_b128 v[88:91], v21 offset:3072
    s_waitcnt vmcnt(3)
    ds_write_b128 v20, v[48:51] offset:5120
    ds_write_b32 v53, v52 offset:9212
    v_smfmac_f32_16x16x64_bf16 v[40:43], v[60:63], a[224:231], v18
    v_bitop3_b32 v54, v48, v49, s22 bitop3:0x7e
    v_bitop3_b32 v55, v50, v51, s22 bitop3:0x7e
    v_smfmac_f32_16x16x64_bf16 v[44:47], v[60:63], a[232:239], v18
    v_bitop3_b32 v54, v52, v54, s22 bitop3:0xde
    v_bitop3_b32 v54, v54, v55, s52 bitop3:0xa8
    s_waitcnt lgkmcnt(4)
    v_smfmac_f32_16x16x64_bf16 v[40:43], v[64:67], v[76:83], v18
    v_cmp_ne_u32_e64 vcc, 0, v54
    s_waitcnt lgkmcnt(2)
    v_smfmac_f32_16x16x64_bf16 v[44:47], v[64:67], v[84:91], v18
    s_cbranch_vccnz R_pcr_243
R_pcok_242:
    s_waitcnt lgkmcnt(0)
    s_barrier
    ds_read_b128 v[56:59], v19 offset:5120
    ds_read_b128 v[60:63], v19 offset:6144
    v_smfmac_f32_16x16x64_bf16 v[40:43], v[68:71], a[240:247], v18
    ds_read_b128 v[64:67], v19 offset:7168
    v_smfmac_f32_16x16x64_bf16 v[44:47], v[68:71], a[248:255], v18
    ds_read_b128 v[68:71], v19 offset:8192
    v_smfmac_f32_16x16x64_bf16 v[40:43], v[72:75], v[96:103], v18
    v_smfmac_f32_16x16x64_bf16 v[44:47], v[72:75], v[104:111], v18
    ds_read_b128 v[72:75], v19 offset:9216
    s_waitcnt lgkmcnt(4)
    v_smfmac_f32_16x16x64_bf16 v[24:27], v[56:59], a[48:55], v18
    ds_read_b128 v[76:79], v21 offset:16384
    s_andn2_b32 s40, 1, s20
    v_smfmac_f32_16x16x64_bf16 v[28:31], v[56:59], a[56:63], v18
    ds_read_b128 v[80:83], v21 offset:17408
    s_xor_b32 s22, s22, s40
    s_waitcnt lgkmcnt(5)
    v_smfmac_f32_16x16x64_bf16 v[24:27], v[60:63], a[64:71], v18
    ds_read_b128 v[84:87], v21 offset:18432
    s_mov_b32 s52, 1
    v_smfmac_f32_16x16x64_bf16 v[28:31], v[60:63], a[72:79], v18
    ds_read_b128 v[88:91], v21 offset:19456
    s_min_u32 s40, s20, 1
    s_waitcnt lgkmcnt(6)
    v_smfmac_f32_16x16x64_bf16 v[24:27], v[64:67], a[80:87], v18
    buffer_load_dwordx4 v[8:11], v19, s[8:11], s51 offen offset:0 sc1
    v_smfmac_f32_16x16x64_bf16 v[28:31], v[64:67], a[88:95], v18
    buffer_load_dwordx4 v[12:15], v19, s[8:11], s51 offen offset:1024 sc1
    s_mov_b32 s33, s56
    s_waitcnt lgkmcnt(2)
    v_smfmac_f32_16x16x64_bf16 v[24:27], v[68:71], v[76:83], v18
    ds_read_b128 v[76:79], v21 offset:32768
    s_xor_b32 s56, s56, 0x4000
    s_waitcnt lgkmcnt(1)
    v_smfmac_f32_16x16x64_bf16 v[28:31], v[68:71], v[84:91], v18
    ds_read_b128 v[80:83], v21 offset:33792
    s_xor_b32 s32, s32, 0x4000
    v_smfmac_f32_16x16x64_bf16 v[24:27], v[72:75], a[96:103], v18
    ds_read_b128 v[84:87], v21 offset:34816
    v_smfmac_f32_16x16x64_bf16 v[28:31], v[72:75], a[104:111], v18
    ds_read_b128 v[88:91], v21 offset:35840
    v_smfmac_f32_16x16x64_bf16 v[32:35], v[56:59], a[160:167], v18
    v_smfmac_f32_16x16x64_bf16 v[36:39], v[56:59], a[168:175], v18
    s_waitcnt lgkmcnt(2)
    v_smfmac_f32_16x16x64_bf16 v[32:35], v[60:63], v[76:83], v18
    ds_read_b128 v[76:79], v21 offset:49152
    s_waitcnt lgkmcnt(1)
    v_smfmac_f32_16x16x64_bf16 v[36:39], v[60:63], v[84:91], v18
    ds_read_b128 v[80:83], v21 offset:50176
    v_cvt_pk_bf16_f32 v48, v24, v25
    v_smfmac_f32_16x16x64_bf16 v[32:35], v[64:67], a[176:183], v18
    ds_read_b128 v[84:87], v21 offset:51200
    v_cvt_pk_bf16_f32 v49, v26, v27
    v_smfmac_f32_16x16x64_bf16 v[36:39], v[64:67], a[184:191], v18
    ds_read_b128 v[88:91], v21 offset:52224
    v_cvt_pk_bf16_f32 v50, v28, v29
    v_smfmac_f32_16x16x64_bf16 v[32:35], v[68:71], a[192:199], v18
    v_cvt_pk_bf16_f32 v51, v30, v31
    v_smfmac_f32_16x16x64_bf16 v[36:39], v[68:71], a[200:207], v18
    v_add_u32 v21, 0x10000, v21
    s_waitcnt lgkmcnt(2)
    v_smfmac_f32_16x16x64_bf16 v[32:35], v[72:75], v[76:83], v18
    ds_read_b128 v[76:79], v21 offset:0
    s_waitcnt lgkmcnt(1)
    v_smfmac_f32_16x16x64_bf16 v[36:39], v[72:75], v[84:91], v18
    ds_read_b128 v[80:83], v21 offset:1024
    v_mfma_f32_16x16x16_bf16 v[24:27], v[48:49], v[16:17], 0
    ds_read_b128 v[84:87], v21 offset:2048
    v_mfma_f32_16x16x16_bf16 v[28:31], v[50:51], v[16:17], 0
    ds_read_b128 v[88:91], v21 offset:3072
    v_cvt_pk_bf16_f32 v52, v32, v33
    v_cvt_pk_bf16_f32 v53, v34, v35
    v_cvt_pk_bf16_f32 v54, v36, v37
    v_cvt_pk_bf16_f32 v55, v38, v39
    v_mfma_f32_16x16x16_bf16 v[32:35], v[52:53], v[16:17], 0
    v_cvt_pk_bf16_f32 v48, v24, v25
    v_mfma_f32_16x16x16_bf16 v[36:39], v[54:55], v[16:17], 0
    v_cvt_pk_bf16_f32 v49, v26, v27
    v_cvt_pk_bf16_f32 v50, v28, v29
    v_cvt_pk_bf16_f32 v51, v30, v31
    s_nop 1
    v_mfma_f32_16x16x32_bf16 v[24:27], v[0:3], v[48:51], 0
    v_mfma_f32_16x16x32_bf16 v[28:31], v[4:7], v[48:51], 0
    v_cvt_pk_bf16_f32 v92, v32, v33
    v_cvt_pk_bf16_f32 v93, v34, v35
    v_cvt_pk_bf16_f32 v94, v36, v37
    v_cvt_pk_bf16_f32 v95, v38, v39
    s_nop 1
    v_mfma_f32_16x16x32_bf16 v[32:35], v[92:95], v[48:51], 0
    s_nop 2
    v_cndmask_b32 v24, v24, v28, s[44:45]
    v_cndmask_b32 v25, v25, v29, s[44:45]
    v_cndmask_b32 v26, v26, v30, s[44:45]
    v_cndmask_b32 v27, v27, v31, s[44:45]
    ds_write_b128 v20, v[24:27] offset:10240
    v_cndmask_b32 v32, v32, v34, s[44:45]
    v_cndmask_b32 v33, v33, v35, s[44:45]
    ds_write_b64 v20, v[32:33] offset:0
    v_smfmac_f32_16x16x64_bf16 v[40:43], v[56:59], v[112:119], v18
    v_xor_b32 v52, 0x400, v20
    v_smfmac_f32_16x16x64_bf16 v[44:47], v[56:59], v[120:127], v18
    v_xor_b32 v54, 0x800, v20
    v_smfmac_f32_16x16x64_bf16 v[40:43], v[60:63], v[128:135], v18
    v_xor_b32 v34, 0xc00, v20
    v_smfmac_f32_16x16x64_bf16 v[44:47], v[60:63], v[136:143], v18
    v_smfmac_f32_16x16x64_bf16 v[40:43], v[64:67], v[144:151], v18
    s_cmp_eq_u32 s20, 63
    s_cbranch_scc1 R_exit_236
    s_waitcnt lgkmcnt(0)
    s_barrier
    ds_read_b128 v[28:31], v52 offset:10240
    ds_read_b64 v[52:53], v52 offset:0
    v_smfmac_f32_16x16x64_bf16 v[44:47], v[64:67], v[152:159], v18
    ds_read_b128 v[36:39], v54 offset:10240
    v_smfmac_f32_16x16x64_bf16 v[40:43], v[68:71], v[160:167], v18
    ds_read_b64 v[54:55], v54 offset:0
    v_smfmac_f32_16x16x64_bf16 v[44:47], v[68:71], v[168:175], v18
    ds_read_b128 v[48:51], v34 offset:10240
    v_smfmac_f32_16x16x64_bf16 v[40:43], v[72:75], v[76:83], v18
    ds_read_b64 v[34:35], v34 offset:0
    v_smfmac_f32_16x16x64_bf16 v[44:47], v[72:75], v[84:91], v18
    s_waitcnt lgkmcnt(5)
    v_pk_add_f32 v[24:25], v[24:25], v[28:29]
    v_pk_add_f32 v[26:27], v[26:27], v[30:31]
    s_waitcnt lgkmcnt(4)
    v_pk_add_f32 v[32:33], v[32:33], v[52:53]
    s_waitcnt lgkmcnt(1)
    v_pk_add_f32 v[36:37], v[36:37], v[48:49]
    v_pk_add_f32 v[38:39], v[38:39], v[50:51]
    s_waitcnt lgkmcnt(0)
    v_pk_add_f32 v[54:55], v[54:55], v[34:35]
    v_pk_add_f32 v[24:25], v[24:25], v[36:37]
    v_pk_add_f32 v[26:27], v[26:27], v[38:39]
    v_pk_add_f32 v[32:33], v[32:33], v[54:55]
    v_max3_f32 v34, v24, v25, v26
    v_max3_f32 v34, v34, v27, v32
    v_max_f32_e64 v34, v34, v33
    v_cvt_pk_bf16_f32 v76, v40, v41
    v_cvt_pk_bf16_f32 v77, v42, v43
    v_max_f32_dpp v34, v34, v34 row_ror:8 row_mask:0xf bank_mask:0xf
    v_mov_b32_e64 v35, v34
    v_cvt_pk_bf16_f32 v78, v44, v45
    v_cvt_pk_bf16_f32 v79, v46, v47
    v_permlane16_swap_b32 v34, v35
    v_max_f32 v34, v34, v35
    v_mov_b32 v35, v34
    v_mov_b32 v56, 0
    v_mov_b32 v57, 0
    v_permlane32_swap_b32 v34, v35
    v_max_f32 v34, v34, v35
    v_mul_f32 v34, s50, v34
    v_pk_fma_f32 v[24:25], v[24:25], s[54:55], v[34:35] op_sel_hi:[1,1,0] neg_lo:[0,0,1] neg_hi:[0,0,1]
    v_pk_fma_f32 v[26:27], v[26:27], s[54:55], v[34:35] op_sel_hi:[1,1,0] neg_lo:[0,0,1] neg_hi:[0,0,1]
    v_pk_fma_f32 v[32:33], v[32:33], s[54:55], v[34:35] op_sel_hi:[1,1,0] neg_lo:[0,0,1] neg_hi:[0,0,1]
    v_exp_f32 v24, v24
    v_exp_f32 v25, v25
    v_exp_f32 v26, v26
    v_exp_f32 v27, v27
    v_exp_f32 v32, v32
    v_exp_f32 v33, v33
    v_cvt_pk_bf16_f32 v48, v24, v25
    v_cvt_pk_bf16_f32 v49, v26, v27
    v_cvt_pk_bf16_f32 v52, v32, v33
    v_mov_b32_dpp v50, v48 row_ror:8 row_mask:0xf bank_mask:0xf
    v_mov_b32_dpp v51, v49 row_ror:8 row_mask:0xf bank_mask:0xf
    v_mov_b32_dpp v53, v52 row_ror:8 row_mask:0xf bank_mask:0xf
    v_pk_add_f32 v[24:25], v[24:25], v[26:27]
    s_waitcnt vmcnt(0)
    v_mfma_f32_16x16x32_bf16 v[28:31], v[8:11], v[48:51], 0
    v_add_f32 v32, v32, v33
    v_add_f32_e64 v24, v24, v25
    v_mfma_f32_16x16x32_bf16 v[36:39], v[12:15], v[48:51], 0
    v_fma_f32 v34, v32, 0.5, v24
    v_mfma_f32_16x16x16_bf16 v[28:31], v[76:77], v[52:53], v[28:31]
    v_mov_b32_e64 v58, 0
    v_add_f32_dpp v34, v34, v34 row_ror:8 row_mask:0xf bank_mask:0xf
    v_mfma_f32_16x16x16_bf16 v[36:39], v[78:79], v[52:53], v[36:39]
    v_mov_b32 v35, v34
    v_mov_b32 v59, 0
    v_mov_b32 v60, 0
    v_permlane16_swap_b32 v34, v35
    v_add_f32 v34, v34, v35
    v_mov_b32 v35, v34
    v_mov_b32 v61, 0
    v_mov_b32 v62, 0
    v_permlane32_swap_b32 v34, v35
    v_add_f32 v34, v34, v35
    v_rcp_f32 v34, v34
    s_mov_b64 exec, s[46:47]
    v_pk_mul_f32 v[28:29], v[28:29], v[34:35] op_sel_hi:[1,0]
    v_pk_mul_f32 v[30:31], v[30:31], v[34:35] op_sel_hi:[1,0]
    v_pk_mul_f32 v[36:37], v[36:37], v[34:35] op_sel_hi:[1,0]
    v_pk_mul_f32 v[38:39], v[38:39], v[34:35] op_sel_hi:[1,0]
    v_cvt_pk_bf16_f32 v24, v28, v29
    v_cvt_pk_bf16_f32 v25, v30, v31
    v_cvt_pk_bf16_f32 v26, v36, v37
    v_cvt_pk_bf16_f32 v27, v38, v39
    ds_write_b128 v22, v[24:27]
    s_mov_b64 exec, -1
    v_mov_b32 v63, 0
    v_mov_b32 v64, 0
    v_mov_b32 v65, 0
    v_mov_b32 v66, 0
    v_mov_b32 v67, 0
    v_mov_b32 v68, 0
    v_mov_b32 v69, 0
    v_mov_b32 v70, 0
    v_mov_b32 v71, 0
    v_mov_b32 v72, 0
    v_mov_b32 v73, 0
    v_mov_b32 v74, 0
    v_mov_b32 v75, 0
    s_waitcnt lgkmcnt(0)
    s_barrier
    ds_read_b128 v[48:51], v19 offset:5120
    ds_read_b128 v[52:55], v19 offset:6144
    v_subrev_u32 v21, 0x20000, v21
    v_lshrrev_b32_e64 v24, 8, v19
    v_bfe_u32 v25, v19, 2, 6
    v_lshl_add_u32 v24, v24, 13, v25
    s_waitcnt lgkmcnt(1)
    v_smfmac_f32_16x16x64_bf16 v[56:59], v[48:51], v[176:183], v18 abid:1
    s_waitcnt lgkmcnt(0)
    v_smfmac_f32_16x16x64_bf16 v[56:59], v[52:55], v[216:223], v18 abid:1
    v_smfmac_f32_16x16x64_bf16 v[60:63], v[48:51], v[184:191], v18 abid:1
    v_smfmac_f32_16x16x64_bf16 v[60:63], v[52:55], v[224:231], v18 abid:1
    v_add_f32_e64 v56, v56, v58
    v_smfmac_f32_16x16x64_bf16 v[64:67], v[48:51], v[192:199], v18 abid:1
    v_add_f32_e64 v57, v57, v59
    v_smfmac_f32_16x16x64_bf16 v[64:67], v[52:55], v[232:239], v18 abid:1
    v_cvt_pk_bf16_f32 v28, v56, v57
    v_add_f32_e64 v60, v60, v62
    v_smfmac_f32_16x16x64_bf16 v[68:71], v[48:51], v[200:207], v18 abid:1
    v_add_f32_e64 v61, v61, v63
    v_bfi_b32 v28, 1, s21, v28
    v_smfmac_f32_16x16x64_bf16 v[68:71], v[52:55], v[240:247], v18 abid:1
    v_cvt_pk_bf16_f32 v29, v60, v61
    v_add_f32_e64 v64, v64, v66
    v_smfmac_f32_16x16x64_bf16 v[72:75], v[48:51], v[208:215], v18 abid:1
    v_add_f32_e64 v65, v65, v67
    v_smfmac_f32_16x16x64_bf16 v[72:75], v[52:55], v[248:255], v18 abid:1
    v_add_f32_e64 v68, v68, v70
    v_add_f32 v69, v69, v71
    v_cvt_pk_bf16_f32 v30, v64, v65
    v_cvt_pk_bf16_f32 v31, v68, v69
    buffer_store_dwordx4 v[28:31], v23, s[8:11], s27 offen sc1
    s_nop 2
    v_pk_add_f32 v[72:73], v[72:73], v[74:75]
    v_cvt_pk_bf16_f32 v72, v72, v73
    v_bfi_b32 v72, 1, s21, v72
    buffer_store_dword v72, v24, s[8:11], s28 offen sc1
    s_cmp_lt_u32 s20, 58
    s_cbranch_scc1 R_noearly_245
    buffer_store_dwordx4 v[92:95], v19, s[8:11], s35 offen sc1
R_noearly_245:
    s_cmp_ge_u32 s4, 16
    s_cbranch_scc1 R_nored_246
    v_mov_b32 v24, 0
    v_mov_b32 v25, 0
    v_mov_b32 v26, 0
    v_mov_b32 v27, 0
    v_mov_b32 v28, 0
    v_mov_b32 v29, 0
    v_mov_b32 v30, 0
    v_mov_b32 v31, 0
    v_mov_b32 v32, 0
    v_mov_b32 v33, 0
    v_mov_b32 v34, 0
    v_mov_b32 v35, 0
    v_mov_b32 v36, 0
    v_mov_b32 v37, 0
    v_mov_b32 v38, 0
    v_mov_b32 v39, 0
    v_mov_b32 v40, 0
    v_mov_b32 v41, 0
    v_mov_b32 v42, 0
    v_mov_b32 v43, 0
    v_mov_b32 v44, 0
    v_mov_b32 v45, 0
    v_mov_b32 v46, 0
    v_mov_b32 v47, 0
    ds_read_b128 v[76:79], v21 offset:0
    buffer_load_dwordx4 v[56:59], v19, s[8:11], s29 offen offset:0 sc1
    buffer_load_dwordx4 v[60:63], v19, s[8:11], s29 offen offset:1024 sc1
    ds_read_b128 v[80:83], v21 offset:1024
    ds_read_b128 v[84:87], v21 offset:2048
    ds_read_b128 v[88:91], v21 offset:3072
    v_lshrrev_b32_e64 v53, 2, v20
    v_add_u32 v53, 4, v53
    s_add_u32 s20, s20, 1
    v_mov_b32 v54, 0xfffe0000
    v_lshrrev_b32_e64 v48, 2, v19
    v_and_b32 v48, 0x80, v48
    v_and_or_b32 v55, v19, 16, v48
    v_lshrrev_b32_e64 v48, 5, v19
    v_and_or_b32 v55, v48, 8, v55
    v_lshrrev_b32_e64 v48, 4, v19
    v_and_or_b32 v55, v48, 4, v55
    v_mov_b32 v48, 0x3f80
    v_cndmask_b32 v48, v48, 1.0, s[76:77]
    v_cndmask_b32 v64, 0, v48, s[60:61]
    v_cndmask_b32 v65, 0, v48, s[62:63]
    v_cndmask_b32 v66, 0, v48, s[64:65]
    v_cndmask_b32 v67, 0, v48, s[66:67]
    s_lshl_b32 s26, s22, 16
    s_sub_u32 s24, 0x10000, s26
    s_nop 7
    buffer_load_dwordx4 v[0:3], v19, s[8:11], s29 offen offset:0 sc1
    buffer_load_dwordx4 v[4:7], v19, s[8:11], s29 offen offset:1024 sc1
R_pi_248:
    s_waitcnt vmcnt(3)
    v_mfma_f32_16x16x32_bf16 v[68:71], v[56:59], v[64:67], 0
    v_bitop3_b32 v48, v56, v57, s21 bitop3:0x7e
    v_bitop3_b32 v49, v58, v59, s21 bitop3:0x7e
    s_waitcnt vmcnt(2)
    v_mfma_f32_16x16x32_bf16 v[68:71], v[60:63], v[64:67], v[68:71]
    v_bitop3_b32 v50, v60, v61, s21 bitop3:0x7e
    v_bitop3_b32 v51, v62, v63, s21 bitop3:0x7e
    v_or3_b32 v48, v48, v50, v51
    v_bitop3_b32 v48, v48, v49, 1 bitop3:0xa8
    v_cmp_ne_u32_e64 vcc, 0, v48
    s_cbranch_vccnz R_pir_250
R_piok_249:
    s_nop 1
    v_permlane32_swap_b32 v68, v70
    v_permlane32_swap_b32 v69, v71
    v_pk_add_f32 v[68:69], v[68:69], v[70:71]
    s_nop 1
    v_permlane16_swap_b32 v68, v69
    v_add_f32 v68, v68, v69
    v_add_u32 v70, s24, v68
    v_bfi_b32 v70, v54, v70, s26
    v_mov_b32_dpp v69, v68 row_shl:2 row_mask:0xf bank_mask:0xf
    s_mov_b64 exec, s[48:49]
    v_cvt_pk_bf16_f32 v70, v70, v69
    buffer_store_dword v70, v55, s[8:11], s30 offen sc1
    buffer_store_dword v70, v55, s[8:11], s31 offen sc1
    s_mov_b64 exec, -1
    s_xor_b32 s31, s31, 0x4000
    s_xor_b32 s30, s30, 0x4000
    s_branch R_join_247
R_nored_246:
    v_mov_b32 v24, 0
    v_mov_b32 v25, 0
    v_mov_b32 v26, 0
    v_mov_b32 v27, 0
    v_mov_b32 v28, 0
    v_mov_b32 v29, 0
    v_mov_b32 v30, 0
    v_mov_b32 v31, 0
    v_mov_b32 v32, 0
    v_mov_b32 v33, 0
    v_mov_b32 v34, 0
    v_mov_b32 v35, 0
    v_mov_b32 v36, 0
    v_mov_b32 v37, 0
    v_mov_b32 v38, 0
    v_mov_b32 v39, 0
    v_mov_b32 v40, 0
    v_mov_b32 v41, 0
    v_mov_b32 v42, 0
    v_mov_b32 v43, 0
    v_mov_b32 v44, 0
    v_mov_b32 v45, 0
    v_mov_b32 v46, 0
    v_mov_b32_e64 v47, 0
    ds_read_b128 v[76:79], v21 offset:0
    ds_read_b128 v[80:83], v21 offset:1024
    ds_read_b128 v[84:87], v21 offset:2048
    ds_read_b128 v[88:91], v21 offset:3072
    v_lshrrev_b32 v53, 2, v20
    v_add_u32 v53, 4, v53
    s_add_u32 s20, s20, 1
R_join_247:
    s_barrier
    s_nop 15
    s_nop 15
    s_nop 15
    s_nop 11
    s_branch R_top_234
R_par_240:
    buffer_load_dwordx4 v[0:3], v20, s[8:11], s32 offen sc1
    buffer_load_dword v4, v53, s[8:11], s32 offen offset:4092 sc1
    s_waitcnt vmcnt(2)
    ds_write_b128 v20, v[48:51]
    ds_write_b32 v53, v52 offset:4092
    v_bitop3_b32 v56, v48, v49, s22 bitop3:0x7e
    v_bitop3_b32 v57, v50, v51, s22 bitop3:0x7e
    v_bitop3_b32 v56, v52, v56, s22 bitop3:0xde
    v_bitop3_b32 v56, v56, v57, 1 bitop3:0xa8
    v_cmp_ne_u32 vcc, 0, v56
    s_cbranch_vccz R_paok_239
    buffer_load_dwordx4 v[48:51], v20, s[8:11], s32 offen sc1
    buffer_load_dword v52, v53, s[8:11], s32 offen offset:4092 sc1
    s_add_u32 s6, s6, 1
    s_cmp_lt_u32 s6, 400000
    s_cbranch_scc1 R_pa_238
    s_branch R_paok_239
R_pcr_243:
    s_waitcnt vmcnt(1)
    ds_write_b128 v20, v[8:11] offset:5120
    ds_write_b32 v53, v12 offset:9212
    v_bitop3_b32 v54, v8, v9, s22 bitop3:0x7e
    v_bitop3_b32 v55, v10, v11, s22 bitop3:0x7e
    v_bitop3_b32 v54, v12, v54, s22 bitop3:0xde
    v_bitop3_b32 v54, v54, v55, s52 bitop3:0xa8
    v_cmp_ne_u32_e64 vcc, 0, v54
    s_cbranch_vccz R_pcok_242
R_pcr2_252:
    s_add_u32 s6, s6, 1
    s_cmp_lt_u32 s6, 400000
    s_cbranch_scc1 R_pc2_244
    s_branch R_pcok_242
R_pc2_244:
    s_waitcnt lgkmcnt(0)
    buffer_load_dwordx4 v[48:51], v20, s[8:11], s33 offen sc1
    buffer_load_dword v52, v53, s[8:11], s33 offen offset:4092 sc1
    s_waitcnt vmcnt(0)
    ds_write_b128 v20, v[48:51] offset:5120
    ds_write_b32 v53, v52 offset:9212
    v_bitop3_b32 v54, v48, v49, s22 bitop3:0x7e
    v_bitop3_b32 v55, v50, v51, s22 bitop3:0x7e
    v_bitop3_b32 v54, v52, v54, s22 bitop3:0xde
    v_bitop3_b32 v54, v54, v55, s52 bitop3:0xa8
    v_cmp_ne_u32_e64 vcc, 0, v54
    s_cbranch_vccnz R_pcr2_252
    s_branch R_pcok_242
R_pir_250:
    buffer_load_dwordx4 v[56:59], v19, s[8:11], s29 offen offset:0 sc1
    buffer_load_dwordx4 v[60:63], v19, s[8:11], s29 offen offset:1024 sc1
    s_waitcnt vmcnt(3)
    v_mfma_f32_16x16x32_bf16 v[68:71], v[0:3], v[64:67], 0
    v_bitop3_b32 v48, v0, v1, s21 bitop3:0x7e
    v_bitop3_b32 v49, v2, v3, s21 bitop3:0x7e
    s_waitcnt vmcnt(2)
    v_mfma_f32_16x16x32_bf16 v[68:71], v[4:7], v[64:67], v[68:71]
    v_bitop3_b32 v50, v4, v5, s21 bitop3:0x7e
    v_bitop3_b32 v51, v6, v7, s21 bitop3:0x7e
    v_or3_b32 v48, v48, v50, v51
    v_bitop3_b32 v48, v48, v49, 1 bitop3:0xa8
    v_cmp_ne_u32 vcc, 0, v48
    s_cbranch_vccz R_piok_249
    buffer_load_dwordx4 v[0:3], v19, s[8:11], s29 offen offset:0 sc1
    buffer_load_dwordx4 v[4:7], v19, s[8:11], s29 offen offset:1024 sc1
    s_add_u32 s6, s6, 1
    s_cmp_lt_u32 s6, 400000
    s_cbranch_scc1 R_pi_248
    s_branch R_piok_249
R_exit_236:
    s_waitcnt lgkmcnt(0)
    buffer_store_dwordx4 v[92:95], v19, s[8:11], s35 offen sc1
    s_branch R_end_87
R_v00w3_96:
    s_branch R_ent_254
.p2align 6
R_top_253:
    buffer_load_dwordx4 v[0:3], v20, s[8:11], s32 offen sc1
    buffer_load_dword v4, v53, s[8:11], s32 offen offset:4092 sc1
    s_nop 15
    s_nop 8
    buffer_load_dwordx4 v[48:51], v20, s[8:11], s32 offen sc1
    buffer_load_dword v52, v53, s[8:11], s32 offen offset:4092 sc1
R_pa_257:
    s_waitcnt vmcnt(2)
    ds_write_b128 v20, v[0:3]
    ds_write_b32 v53, v4 offset:4092
    v_bitop3_b32 v56, v0, v1, s22 bitop3:0x7e
    v_bitop3_b32 v57, v2, v3, s22 bitop3:0x7e
    v_bitop3_b32 v56, v4, v56, s22 bitop3:0xde
    v_bitop3_b32 v56, v56, v57, 1 bitop3:0xa8
    v_cmp_ne_u32 vcc, 0, v56
    s_cbranch_vccnz R_par_259
R_paok_258:
    buffer_load_dwordx4 v[48:51], v20, s[8:11], s33 offen sc1
    buffer_load_dword v52, v53, s[8:11], s33 offen offset:4092 sc1
    s_waitcnt lgkmcnt(0)
    s_barrier
R_ent_254:
    ds_read_b128 v[56:59], v19 offset:0
    ds_read_b128 v[60:63], v19 offset:1024
    ds_read_b128 v[64:67], v19 offset:2048
    ds_read_b128 v[68:71], v19 offset:3072
    ds_read_b128 v[72:75], v19 offset:4096
    s_waitcnt lgkmcnt(4)
    v_smfmac_f32_16x16x64_bf16 v[24:27], v[56:59], v[76:83], v18
    ds_read_b128 v[76:79], v21 offset:16384
    s_xor_b32 s21, s21, 1
    buffer_load_dwordx4 v[0:3], v19, s[8:11], s34 offen offset:0 sc1
    v_smfmac_f32_16x16x64_bf16 v[28:31], v[56:59], v[84:91], v18
    ds_read_b128 v[80:83], v21 offset:17408
    s_min_u32 s40, s20, 1
    buffer_load_dwordx4 v[4:7], v19, s[8:11], s34 offen offset:1024 sc1
    v_smfmac_f32_16x16x64_bf16 v[32:35], v[56:59], a[112:119], v18
    ds_read_b128 v[84:87], v21 offset:18432
    s_lshl_b32 s41, s40, 17
    v_smfmac_f32_16x16x64_bf16 v[36:39], v[56:59], a[120:127], v18
    ds_read_b128 v[88:91], v21 offset:19456
    s_waitcnt lgkmcnt(7)
    v_smfmac_f32_16x16x64_bf16 v[24:27], v[60:63], a[0:7], v18
    buffer_load_dwordx4 v[8:11], v20, s[8:11], s33 offen sc1
    v_smfmac_f32_16x16x64_bf16 v[28:31], v[60:63], a[8:15], v18
    buffer_load_dword v12, v53, s[8:11], s33 offen offset:4092 sc1
    s_waitcnt lgkmcnt(2)
    v_smfmac_f32_16x16x64_bf16 v[32:35], v[60:63], v[76:83], v18
    ds_read_b128 v[76:79], v21 offset:32768
    s_waitcnt lgkmcnt(1)
    v_smfmac_f32_16x16x64_bf16 v[36:39], v[60:63], v[84:91], v18
    ds_read_b128 v[80:83], v21 offset:33792
    v_smfmac_f32_16x16x64_bf16 v[24:27], v[64:67], a[16:23], v18
    ds_read_b128 v[84:87], v21 offset:34816
    v_smfmac_f32_16x16x64_bf16 v[28:31], v[64:67], a[24:31], v18
    ds_read_b128 v[88:91], v21 offset:35840
    v_smfmac_f32_16x16x64_bf16 v[32:35], v[64:67], a[128:135], v18
    v_smfmac_f32_16x16x64_bf16 v[36:39], v[64:67], a[136:143], v18
    s_waitcnt lgkmcnt(2)
    v_smfmac_f32_16x16x64_bf16 v[24:27], v[68:71], v[76:83], v18
    ds_read_b128 v[76:79], v21 offset:49152
    s_waitcnt lgkmcnt(1)
    v_smfmac_f32_16x16x64_bf16 v[28:31], v[68:71], v[84:91], v18
    ds_read_b128 v[80:83], v21 offset:50176
    v_smfmac_f32_16x16x64_bf16 v[32:35], v[68:71], a[144:151], v18
    ds_read_b128 v[84:87], v21 offset:51200
    v_smfmac_f32_16x16x64_bf16 v[36:39], v[68:71], a[152:159], v18
    ds_read_b128 v[88:91], v21 offset:52224
    v_smfmac_f32_16x16x64_bf16 v[24:27], v[72:75], a[32:39], v18
    v_add_u32 v21, 0x10000, v21
    buffer_store_dwordx4 v[92:95], v19, s[8:11], s35 offen sc1
    v_smfmac_f32_16x16x64_bf16 v[28:31], v[72:75], a[40:47], v18
    s_add_u32 s35, s35, s41
    s_add_u32 s51, s34, 0x1000000
    s_waitcnt lgkmcnt(2)
    v_smfmac_f32_16x16x64_bf16 v[32:35], v[72:75], v[76:83], v18
    ds_read_b128 v[76:79], v21 offset:0
    s_add_u32 s34, s34, 0x40000
    s_waitcnt lgkmcnt(1)
    v_smfmac_f32_16x16x64_bf16 v[36:39], v[72:75], v[84:91], v18
    ds_read_b128 v[80:83], v21 offset:1024
    v_smfmac_f32_16x16x64_bf16 v[40:43], v[56:59], a[208:215], v18
    ds_read_b128 v[84:87], v21 offset:2048
    v_smfmac_f32_16x16x64_bf16 v[44:47], v[56:59], a[216:223], v18
    ds_read_b128 v[88:91], v21 offset:3072
    s_waitcnt vmcnt(3)
    ds_write_b128 v20, v[48:51] offset:5120
    ds_write_b32 v53, v52 offset:9212
    v_smfmac_f32_16x16x64_bf16 v[40:43], v[60:63], a[224:231], v18
    v_bitop3_b32 v54, v48, v49, s22 bitop3:0x7e
    v_bitop3_b32 v55, v50, v51, s22 bitop3:0x7e
    v_smfmac_f32_16x16x64_bf16 v[44:47], v[60:63], a[232:239], v18
    v_bitop3_b32 v54, v52, v54, s22 bitop3:0xde
    v_bitop3_b32 v54, v54, v55, s52 bitop3:0xa8
    s_waitcnt lgkmcnt(4)
    v_smfmac_f32_16x16x64_bf16 v[40:43], v[64:67], v[76:83], v18
    v_cmp_ne_u32 vcc, 0, v54
    s_waitcnt lgkmcnt(2)
    v_smfmac_f32_16x16x64_bf16 v[44:47], v[64:67], v[84:91], v18
    s_cbranch_vccnz R_pcr_262
R_pcok_261:
    v_lshlrev_b32_e64 v55, 3, v19
    s_add_u32 s42, s36, 0x1000000
    s_waitcnt lgkmcnt(0)
    s_barrier
    ds_read_b128 v[56:59], v19 offset:5120
    ds_read_b128 v[60:63], v19 offset:6144
    v_smfmac_f32_16x16x64_bf16 v[40:43], v[68:71], a[240:247], v18
    ds_read_b128 v[64:67], v19 offset:7168
    v_smfmac_f32_16x16x64_bf16 v[44:47], v[68:71], a[248:255], v18
    ds_read_b128 v[68:71], v19 offset:8192
    v_smfmac_f32_16x16x64_bf16 v[40:43], v[72:75], v[96:103], v18
    v_smfmac_f32_16x16x64_bf16 v[44:47], v[72:75], v[104:111], v18
    ds_read_b128 v[72:75], v19 offset:9216
    s_waitcnt lgkmcnt(4)
    v_smfmac_f32_16x16x64_bf16 v[24:27], v[56:59], a[48:55], v18
    ds_read_b128 v[76:79], v21 offset:16384
    s_andn2_b32 s40, 1, s20
    v_smfmac_f32_16x16x64_bf16 v[28:31], v[56:59], a[56:63], v18
    ds_read_b128 v[80:83], v21 offset:17408
    s_xor_b32 s22, s22, s40
    s_waitcnt lgkmcnt(5)
    v_smfmac_f32_16x16x64_bf16 v[24:27], v[60:63], a[64:71], v18
    ds_read_b128 v[84:87], v21 offset:18432
    s_mov_b32 s52, 1
    v_smfmac_f32_16x16x64_bf16 v[28:31], v[60:63], a[72:79], v18
    ds_read_b128 v[88:91], v21 offset:19456
    s_min_u32 s40, s20, 1
    s_waitcnt lgkmcnt(6)
    v_smfmac_f32_16x16x64_bf16 v[24:27], v[64:67], a[80:87], v18
    buffer_load_dwordx4 v[8:11], v19, s[8:11], s51 offen offset:0 sc1
    s_cmp_gt_u32 s20, 58
    v_smfmac_f32_16x16x64_bf16 v[28:31], v[64:67], a[88:95], v18
    buffer_load_dwordx4 v[12:15], v19, s[8:11], s51 offen offset:1024 sc1
    s_mov_b32 s33, s56
    s_cselect_b32 s40, 0, s40
    s_waitcnt lgkmcnt(2)
    v_smfmac_f32_16x16x64_bf16 v[24:27], v[68:71], v[76:83], v18
    ds_read_b128 v[76:79], v21 offset:32768
    s_xor_b32 s56, s56, 0x4000
    s_sub_u32 s40, s20, s40
    s_waitcnt lgkmcnt(1)
    v_smfmac_f32_16x16x64_bf16 v[28:31], v[68:71], v[84:91], v18
    ds_read_b128 v[80:83], v21 offset:33792
    s_xor_b32 s32, s32, 0x4000
    v_mov_b32 v49, s40
    v_smfmac_f32_16x16x64_bf16 v[24:27], v[72:75], a[96:103], v18
    ds_read_b128 v[84:87], v21 offset:34816
    v_mov_b32 v54, 0
    v_smfmac_f32_16x16x64_bf16 v[28:31], v[72:75], a[104:111], v18
    ds_read_b128 v[88:91], v21 offset:35840
    buffer_store_dword v49, v54, s[8:11], s38 offen sc1
    v_smfmac_f32_16x16x64_bf16 v[32:35], v[56:59], a[160:167], v18
    buffer_load_dword v55, s[8:11], s36 offen sc1 lds
    v_smfmac_f32_16x16x64_bf16 v[36:39], v[56:59], a[168:175], v18
    buffer_load_dword v55, s[8:11], s42 offen sc1 lds
    s_waitcnt lgkmcnt(2)
    v_smfmac_f32_16x16x64_bf16 v[32:35], v[60:63], v[76:83], v18
    ds_read_b128 v[76:79], v21 offset:49152
    s_waitcnt lgkmcnt(1)
    v_smfmac_f32_16x16x64_bf16 v[36:39], v[60:63], v[84:91], v18
    ds_read_b128 v[80:83], v21 offset:50176
    v_cvt_pk_bf16_f32 v48, v24, v25
    v_smfmac_f32_16x16x64_bf16 v[32:35], v[64:67], a[176:183], v18
    ds_read_b128 v[84:87], v21 offset:51200
    v_cvt_pk_bf16_f32 v49, v26, v27
    v_smfmac_f32_16x16x64_bf16 v[36:39], v[64:67], a[184:191], v18
    ds_read_b128 v[88:91], v21 offset:52224
    v_cvt_pk_bf16_f32 v50, v28, v29
    v_smfmac_f32_16x16x64_bf16 v[32:35], v[68:71], a[192:199], v18
    v_cvt_pk_bf16_f32 v51, v30, v31
    v_smfmac_f32_16x16x64_bf16 v[36:39], v[68:71], a[200:207], v18
    v_add_u32 v21, 0x10000, v21
    s_waitcnt lgkmcnt(2)
    v_smfmac_f32_16x16x64_bf16 v[32:35], v[72:75], v[76:83], v18
    ds_read_b128 v[76:79], v21 offset:0
    s_waitcnt lgkmcnt(1)
    v_smfmac_f32_16x16x64_bf16 v[36:39], v[72:75], v[84:91], v18
    ds_read_b128 v[80:83], v21 offset:1024
    v_mfma_f32_16x16x16_bf16 v[24:27], v[48:49], v[16:17], 0
    ds_read_b128 v[84:87], v21 offset:2048
    v_mfma_f32_16x16x16_bf16 v[28:31], v[50:51], v[16:17], 0
    ds_read_b128 v[88:91], v21 offset:3072
    v_cvt_pk_bf16_f32 v52, v32, v33
    v_cvt_pk_bf16_f32 v53, v34, v35
    v_cvt_pk_bf16_f32 v54, v36, v37
    v_cvt_pk_bf16_f32 v55, v38, v39
    v_mfma_f32_16x16x16_bf16 v[32:35], v[52:53], v[16:17], 0
    v_cvt_pk_bf16_f32 v48, v24, v25
    v_mfma_f32_16x16x16_bf16 v[36:39], v[54:55], v[16:17], 0
    v_cvt_pk_bf16_f32 v49, v26, v27
    v_cvt_pk_bf16_f32 v50, v28, v29
    v_cvt_pk_bf16_f32 v51, v30, v31
    s_nop 1
    v_mfma_f32_16x16x32_bf16 v[24:27], v[0:3], v[48:51], 0
    v_mfma_f32_16x16x32_bf16 v[28:31], v[4:7], v[48:51], 0
    v_cvt_pk_bf16_f32 v92, v32, v33
    v_cvt_pk_bf16_f32 v93, v34, v35
    v_cvt_pk_bf16_f32 v94, v36, v37
    v_cvt_pk_bf16_f32 v95, v38, v39
    s_nop 1
    v_mfma_f32_16x16x32_bf16 v[32:35], v[92:95], v[48:51], 0
    s_nop 2
    v_cndmask_b32 v24, v24, v28, s[44:45]
    v_cndmask_b32 v25, v25, v29, s[44:45]
    v_cndmask_b32 v26, v26, v30, s[44:45]
    v_cndmask_b32 v27, v27, v31, s[44:45]
    ds_write_b128 v20, v[24:27] offset:10240
    v_cndmask_b32 v32, v32, v34, s[44:45]
    v_cndmask_b32 v33, v33, v35, s[44:45]
    ds_write_b64 v20, v[32:33] offset:0
    v_smfmac_f32_16x16x64_bf16 v[40:43], v[56:59], v[112:119], v18
    v_xor_b32 v52, 0x400, v20
    v_smfmac_f32_16x16x64_bf16 v[44:47], v[56:59], v[120:127], v18
    v_xor_b32 v54, 0x800, v20
    v_smfmac_f32_16x16x64_bf16 v[40:43], v[60:63], v[128:135], v18
    v_xor_b32 v34, 0xc00, v20
    v_smfmac_f32_16x16x64_bf16 v[44:47], v[60:63], v[136:143], v18
    v_smfmac_f32_16x16x64_bf16 v[40:43], v[64:67], v[144:151], v18
    s_cmp_eq_u32 s20, 63
    s_cbranch_scc1 R_exit_255
    s_waitcnt lgkmcnt(0)
    s_barrier
    ds_read_b128 v[28:31], v52 offset:10240
    ds_read_b64 v[52:53], v52 offset:0
    v_smfmac_f32_16x16x64_bf16 v[44:47], v[64:67], v[152:159], v18
    ds_read_b128 v[36:39], v54 offset:10240
    v_smfmac_f32_16x16x64_bf16 v[40:43], v[68:71], v[160:167], v18
    ds_read_b64 v[54:55], v54 offset:0
    v_smfmac_f32_16x16x64_bf16 v[44:47], v[68:71], v[168:175], v18
    ds_read_b128 v[48:51], v34 offset:10240
    v_smfmac_f32_16x16x64_bf16 v[40:43], v[72:75], v[76:83], v18
    ds_read_b64 v[34:35], v34 offset:0
    v_smfmac_f32_16x16x64_bf16 v[44:47], v[72:75], v[84:91], v18
    s_waitcnt lgkmcnt(5)
    v_pk_add_f32 v[24:25], v[24:25], v[28:29]
    v_pk_add_f32 v[26:27], v[26:27], v[30:31]
    s_waitcnt lgkmcnt(4)
    v_pk_add_f32 v[32:33], v[32:33], v[52:53]
    s_waitcnt lgkmcnt(1)
    v_pk_add_f32 v[36:37], v[36:37], v[48:49]
    v_pk_add_f32 v[38:39], v[38:39], v[50:51]
    s_waitcnt lgkmcnt(0)
    v_pk_add_f32 v[54:55], v[54:55], v[34:35]
    v_pk_add_f32 v[24:25], v[24:25], v[36:37]
    v_pk_add_f32 v[26:27], v[26:27], v[38:39]
    v_pk_add_f32 v[32:33], v[32:33], v[54:55]
    v_max3_f32 v34, v24, v25, v26
    v_max3_f32 v34, v34, v27, v32
    v_max_f32_e64 v34, v34, v33
    v_cvt_pk_bf16_f32 v76, v40, v41
    v_cvt_pk_bf16_f32 v77, v42, v43
    v_max_f32_dpp v34, v34, v34 row_ror:8 row_mask:0xf bank_mask:0xf
    v_mov_b32_e64 v35, v34
    v_cvt_pk_bf16_f32 v78, v44, v45
    v_cvt_pk_bf16_f32 v79, v46, v47
    v_permlane16_swap_b32 v34, v35
    v_max_f32 v34, v34, v35
    v_mov_b32 v35, v34
    v_mov_b32 v56, 0
    v_mov_b32 v57, 0
    v_permlane32_swap_b32 v34, v35
    v_max_f32 v34, v34, v35
    v_mul_f32 v34, s50, v34
    v_pk_fma_f32 v[24:25], v[24:25], s[54:55], v[34:35] op_sel_hi:[1,1,0] neg_lo:[0,0,1] neg_hi:[0,0,1]
    v_pk_fma_f32 v[26:27], v[26:27], s[54:55], v[34:35] op_sel_hi:[1,1,0] neg_lo:[0,0,1] neg_hi:[0,0,1]
    v_pk_fma_f32 v[32:33], v[32:33], s[54:55], v[34:35] op_sel_hi:[1,1,0] neg_lo:[0,0,1] neg_hi:[0,0,1]
    v_exp_f32 v24, v24
    v_exp_f32 v25, v25
    v_exp_f32 v26, v26
    v_exp_f32 v27, v27
    v_exp_f32 v32, v32
    v_exp_f32 v33, v33
    v_cvt_pk_bf16_f32 v48, v24, v25
    v_cvt_pk_bf16_f32 v49, v26, v27
    v_cvt_pk_bf16_f32 v52, v32, v33
    v_mov_b32_dpp v50, v48 row_ror:8 row_mask:0xf bank_mask:0xf
    v_mov_b32_dpp v51, v49 row_ror:8 row_mask:0xf bank_mask:0xf
    v_mov_b32_dpp v53, v52 row_ror:8 row_mask:0xf bank_mask:0xf
    v_pk_add_f32 v[24:25], v[24:25], v[26:27]
    s_waitcnt vmcnt(3)
    v_mfma_f32_16x16x32_bf16 v[28:31], v[8:11], v[48:51], 0
    v_add_f32 v32, v32, v33
    v_add_f32_e64 v24, v24, v25
    v_mfma_f32_16x16x32_bf16 v[36:39], v[12:15], v[48:51], 0
    v_fma_f32 v34, v32, 0.5, v24
    v_mfma_f32_16x16x16_bf16 v[28:31], v[76:77], v[52:53], v[28:31]
    v_mov_b32_e64 v58, 0
    v_add_f32_dpp v34, v34, v34 row_ror:8 row_mask:0xf bank_mask:0xf
    v_mfma_f32_16x16x16_bf16 v[36:39], v[78:79], v[52:53], v[36:39]
    v_mov_b32 v35, v34
    v_mov_b32 v59, 0
    v_mov_b32 v60, 0
    v_permlane16_swap_b32 v34, v35
    v_add_f32 v34, v34, v35
    v_mov_b32 v35, v34
    v_mov_b32 v61, 0
    v_mov_b32 v62, 0
    v_permlane32_swap_b32 v34, v35
    v_add_f32 v34, v34, v35
    v_rcp_f32 v34, v34
    s_mov_b64 exec, s[46:47]
    v_pk_mul_f32 v[28:29], v[28:29], v[34:35] op_sel_hi:[1,0]
    v_pk_mul_f32 v[30:31], v[30:31], v[34:35] op_sel_hi:[1,0]
    v_pk_mul_f32 v[36:37], v[36:37], v[34:35] op_sel_hi:[1,0]
    v_pk_mul_f32 v[38:39], v[38:39], v[34:35] op_sel_hi:[1,0]
    v_cvt_pk_bf16_f32 v24, v28, v29
    v_cvt_pk_bf16_f32 v25, v30, v31
    v_cvt_pk_bf16_f32 v26, v36, v37
    v_cvt_pk_bf16_f32 v27, v38, v39
    ds_write_b128 v22, v[24:27]
    s_mov_b64 exec, -1
    v_mov_b32 v63, 0
    v_mov_b32 v64, 0
    v_mov_b32 v65, 0
    v_mov_b32 v66, 0
    v_mov_b32 v67, 0
    v_mov_b32 v68, 0
    v_mov_b32 v69, 0
    v_mov_b32 v70, 0
    v_mov_b32 v71, 0
    v_mov_b32 v72, 0
    v_mov_b32 v73, 0
    v_mov_b32 v74, 0
    v_mov_b32 v75, 0
    s_waitcnt lgkmcnt(0)
    s_barrier
    ds_read_b128 v[48:51], v19 offset:5120
    ds_read_b128 v[52:55], v19 offset:6144
    v_subrev_u32 v21, 0x20000, v21
    v_lshrrev_b32_e64 v24, 8, v19
    v_bfe_u32 v25, v19, 2, 6
    v_lshl_add_u32 v24, v24, 13, v25
    s_waitcnt lgkmcnt(1)
    v_smfmac_f32_16x16x64_bf16 v[56:59], v[48:51], v[176:183], v18 abid:1
    s_waitcnt lgkmcnt(0)
    v_smfmac_f32_16x16x64_bf16 v[56:59], v[52:55], v[216:223], v18 abid:1
    v_smfmac_f32_16x16x64_bf16 v[60:63], v[48:51], v[184:191], v18 abid:1
    v_smfmac_f32_16x16x64_bf16 v[60:63], v[52:55], v[224:231], v18 abid:1
    v_add_f32_e64 v56, v56, v58
    v_smfmac_f32_16x16x64_bf16 v[64:67], v[48:51], v[192:199], v18 abid:1
    v_add_f32_e64 v57, v57, v59
    v_smfmac_f32_16x16x64_bf16 v[64:67], v[52:55], v[232:239], v18 abid:1
    v_cvt_pk_bf16_f32 v28, v56, v57
    v_add_f32_e64 v60, v60, v62
    v_smfmac_f32_16x16x64_bf16 v[68:71], v[48:51], v[200:207], v18 abid:1
    v_add_f32_e64 v61, v61, v63
    v_bfi_b32 v28, 1, s21, v28
    v_smfmac_f32_16x16x64_bf16 v[68:71], v[52:55], v[240:247], v18 abid:1
    v_cvt_pk_bf16_f32 v29, v60, v61
    v_add_f32_e64 v64, v64, v66
    v_smfmac_f32_16x16x64_bf16 v[72:75], v[48:51], v[208:215], v18 abid:1
    v_add_f32_e64 v65, v65, v67
    v_smfmac_f32_16x16x64_bf16 v[72:75], v[52:55], v[248:255], v18 abid:1
    v_add_f32_e64 v68, v68, v70
    v_add_f32 v69, v69, v71
    v_cvt_pk_bf16_f32 v30, v64, v65
    v_cvt_pk_bf16_f32 v31, v68, v69
    buffer_store_dwordx4 v[28:31], v23, s[8:11], s27 offen sc1
    s_nop 2
    v_pk_add_f32 v[72:73], v[72:73], v[74:75]
    v_cvt_pk_bf16_f32 v72, v72, v73
    v_bfi_b32 v72, 1, s21, v72
    buffer_store_dword v72, v24, s[8:11], s28 offen sc1
    s_cmp_lt_u32 s20, 58
    s_cbranch_scc1 R_noearly_264
    buffer_store_dwordx4 v[92:95], v19, s[8:11], s35 offen sc1
R_noearly_264:
R_nored_265:
    s_add_u32 s40, s20, 3
    s_min_u32 s40, s40, 63
fp_267:
    s_cmp_lt_u32 s40, s79
    s_cbranch_scc1 fpok_268
    v_mov_b32_e64 v52, 0
    buffer_load_dwordx4 v[48:51], v52, s[8:11], s37 offen sc1
    s_waitcnt vmcnt(0)
    v_min_u32 v48, v48, v50
    v_min3_u32 v48, v48, v49, v51
    v_lshlrev_b32 v48, 1, v48
    s_nop 0
    v_readfirstlane_b32 s79, v48
    s_add_u32 s6, s6, 1
    s_cmp_lt_u32 s6, 400000
    s_cbranch_scc1 fp_267
    s_branch fpok_268
fpok_268:
    s_add_u32 s36, s36, 0x40000
    v_mov_b32 v24, 0
    v_mov_b32 v25, 0
    v_mov_b32 v26, 0
    v_mov_b32 v27, 0
    v_mov_b32 v28, 0
    v_mov_b32 v29, 0
    v_mov_b32 v30, 0
    v_mov_b32 v31, 0
    v_mov_b32 v32, 0
    v_mov_b32 v33, 0
    v_mov_b32 v34, 0
    v_mov_b32 v35, 0
    v_mov_b32 v36, 0
    v_mov_b32 v37, 0
    v_mov_b32 v38, 0
    v_mov_b32 v39, 0
    v_mov_b32 v40, 0
    v_mov_b32 v41, 0
    v_mov_b32 v42, 0
    v_mov_b32 v43, 0
    v_mov_b32 v44, 0
    v_mov_b32 v45, 0
    v_mov_b32 v46, 0
    v_mov_b32 v47, 0
    ds_read_b128 v[76:79], v21 offset:0
    ds_read_b128 v[80:83], v21 offset:1024
    ds_read_b128 v[84:87], v21 offset:2048
    ds_read_b128 v[88:91], v21 offset:3072
    v_lshrrev_b32 v53, 2, v20
    v_add_u32 v53, 4, v53
    s_add_u32 s20, s20, 1
R_join_266:
    s_barrier
    s_nop 15
    s_nop 15
    s_nop 15
    s_nop 11
    s_branch R_top_253
R_par_259:
    buffer_load_dwordx4 v[0:3], v20, s[8:11], s32 offen sc1
    buffer_load_dword v4, v53, s[8:11], s32 offen offset:4092 sc1
    s_waitcnt vmcnt(2)
    ds_write_b128 v20, v[48:51]
    ds_write_b32 v53, v52 offset:4092
    v_bitop3_b32 v56, v48, v49, s22 bitop3:0x7e
    v_bitop3_b32 v57, v50, v51, s22 bitop3:0x7e
    v_bitop3_b32 v56, v52, v56, s22 bitop3:0xde
    v_bitop3_b32 v56, v56, v57, 1 bitop3:0xa8
    v_cmp_ne_u32 vcc, 0, v56
    s_cbranch_vccz R_paok_258
    buffer_load_dwordx4 v[48:51], v20, s[8:11], s32 offen sc1
    buffer_load_dword v52, v53, s[8:11], s32 offen offset:4092 sc1
    s_add_u32 s6, s6, 1
    s_cmp_lt_u32 s6, 400000
    s_cbranch_scc1 R_pa_257
    s_branch R_paok_258
R_pcr_262:
    s_waitcnt vmcnt(1)
    ds_write_b128 v20, v[8:11] offset:5120
    ds_write_b32 v53, v12 offset:9212
    v_bitop3_b32 v54, v8, v9, s22 bitop3:0x7e
    v_bitop3_b32 v55, v10, v11, s22 bitop3:0x7e
    v_bitop3_b32 v54, v12, v54, s22 bitop3:0xde
    v_bitop3_b32 v54, v54, v55, s52 bitop3:0xa8
    v_cmp_ne_u32_e64 vcc, 0, v54
    s_cbranch_vccz R_pcok_261
R_pcr2_269:
    s_add_u32 s6, s6, 1
    s_cmp_lt_u32 s6, 400000
    s_cbranch_scc1 R_pc2_263
    s_branch R_pcok_261
R_pc2_263:
    s_waitcnt lgkmcnt(0)
    buffer_load_dwordx4 v[48:51], v20, s[8:11], s33 offen sc1
    buffer_load_dword v52, v53, s[8:11], s33 offen offset:4092 sc1
    s_waitcnt vmcnt(0)
    ds_write_b128 v20, v[48:51] offset:5120
    ds_write_b32 v53, v52 offset:9212
    v_bitop3_b32 v54, v48, v49, s22 bitop3:0x7e
    v_bitop3_b32 v55, v50, v51, s22 bitop3:0x7e
    v_bitop3_b32 v54, v52, v54, s22 bitop3:0xde
    v_bitop3_b32 v54, v54, v55, s52 bitop3:0xa8
    v_cmp_ne_u32 vcc, 0, v54
    s_cbranch_vccnz R_pcr2_269
    s_branch R_pcok_261
R_exit_255:
    s_waitcnt lgkmcnt(0)
    buffer_store_dwordx4 v[92:95], v19, s[8:11], s35 offen sc1
    s_branch R_end_87
R_v01r_97:
    s_branch R_ent_271
.p2align 6
R_top_270:
    buffer_load_dwordx4 v[0:3], v20, s[8:11], s32 offen sc1
    buffer_load_dword v4, v53, s[8:11], s32 offen offset:4092 sc1
    s_nop 15
    s_nop 8
    buffer_load_dwordx4 v[48:51], v20, s[8:11], s32 offen sc1
    buffer_load_dword v52, v53, s[8:11], s32 offen offset:4092 sc1
R_pa_274:
    s_waitcnt vmcnt(2)
    ds_write_b128 v20, v[0:3]
    ds_write_b32 v53, v4 offset:4092
    v_bitop3_b32 v56, v0, v1, s22 bitop3:0x7e
    v_bitop3_b32 v57, v2, v3, s22 bitop3:0x7e
    v_bitop3_b32 v56, v4, v56, s22 bitop3:0xde
    v_bitop3_b32 v56, v56, v57, 1 bitop3:0xa8
    v_cmp_ne_u32 vcc, 0, v56
    s_cbranch_vccnz R_par_276
R_paok_275:
    buffer_load_dwordx4 v[48:51], v20, s[8:11], s33 offen sc1
    buffer_load_dword v52, v53, s[8:11], s33 offen offset:4092 sc1
    s_waitcnt lgkmcnt(0)
    s_barrier
R_ent_271:
    ds_read_b128 v[56:59], v19 offset:0
    ds_read_b128 v[60:63], v19 offset:1024
    ds_read_b128 v[64:67], v19 offset:2048
    ds_read_b128 v[68:71], v19 offset:3072
    ds_read_b128 v[72:75], v19 offset:4096
    s_waitcnt lgkmcnt(4)
    v_smfmac_f32_16x16x64_bf16 v[24:27], v[56:59], v[76:83], v18
    ds_read_b128 v[76:79], v21 offset:16384
    s_xor_b32 s21, s21, 1
    buffer_load_dwordx4 v[0:3], v19, s[8:11], s34 offen offset:0 sc1
    v_smfmac_f32_16x16x64_bf16 v[28:31], v[56:59], v[84:91], v18
    ds_read_b128 v[80:83], v21 offset:17408
    s_min_u32 s40, s20, 1
    buffer_load_dwordx4 v[4:7], v19, s[8:11], s34 offen offset:1024 sc1
    v_smfmac_f32_16x16x64_bf16 v[32:35], v[56:59], a[112:119], v18
    ds_read_b128 v[84:87], v21 offset:18432
    s_lshl_b32 s41, s40, 17
    v_smfmac_f32_16x16x64_bf16 v[36:39], v[56:59], a[120:127], v18
    ds_read_b128 v[88:91], v21 offset:19456
    s_waitcnt lgkmcnt(7)
    v_smfmac_f32_16x16x64_bf16 v[24:27], v[60:63], a[0:7], v18
    buffer_load_dwordx4 v[8:11], v20, s[8:11], s33 offen sc1
    v_smfmac_f32_16x16x64_bf16 v[28:31], v[60:63], a[8:15], v18
    buffer_load_dword v12, v53, s[8:11], s33 offen offset:4092 sc1
    s_waitcnt lgkmcnt(2)
    v_smfmac_f32_16x16x64_bf16 v[32:35], v[60:63], v[76:83], v18
    ds_read_b128 v[76:79], v21 offset:32768
    s_waitcnt lgkmcnt(1)
    v_smfmac_f32_16x16x64_bf16 v[36:39], v[60:63], v[84:91], v18
    ds_read_b128 v[80:83], v21 offset:33792
    v_smfmac_f32_16x16x64_bf16 v[24:27], v[64:67], a[16:23], v18
    ds_read_b128 v[84:87], v21 offset:34816
    v_smfmac_f32_16x16x64_bf16 v[28:31], v[64:67], a[24:31], v18
    ds_read_b128 v[88:91], v21 offset:35840
    v_smfmac_f32_16x16x64_bf16 v[32:35], v[64:67], a[128:135], v18
    v_smfmac_f32_16x16x64_bf16 v[36:39], v[64:67], a[136:143], v18
    s_waitcnt lgkmcnt(2)
    v_smfmac_f32_16x16x64_bf16 v[24:27], v[68:71], v[76:83], v18
    ds_read_b128 v[76:79], v21 offset:49152
    s_waitcnt lgkmcnt(1)
    v_smfmac_f32_16x16x64_bf16 v[28:31], v[68:71], v[84:91], v18
    ds_read_b128 v[80:83], v21 offset:50176
    v_smfmac_f32_16x16x64_bf16 v[32:35], v[68:71], a[144:151], v18
    ds_read_b128 v[84:87], v21 offset:51200
    v_smfmac_f32_16x16x64_bf16 v[36:39], v[68:71], a[152:159], v18
    ds_read_b128 v[88:91], v21 offset:52224
    v_smfmac_f32_16x16x64_bf16 v[24:27], v[72:75], a[32:39], v18
    v_add_u32 v21, 0x10000, v21
    buffer_store_dwordx4 v[92:95], v19, s[8:11], s35 offen sc1
    v_smfmac_f32_16x16x64_bf16 v[28:31], v[72:75], a[40:47], v18
    s_add_u32 s35, s35, s41
    s_add_u32 s51, s34, 0x1000000
    s_waitcnt lgkmcnt(2)
    v_smfmac_f32_16x16x64_bf16 v[32:35], v[72:75], v[76:83], v18
    ds_read_b128 v[76:79], v21 offset:0
    s_add_u32 s34, s34, 0x40000
    s_waitcnt lgkmcnt(1)
    v_smfmac_f32_16x16x64_bf16 v[36:39], v[72:75], v[84:91], v18
    ds_read_b128 v[80:83], v21 offset:1024
    v_smfmac_f32_16x16x64_bf16 v[40:43], v[56:59], a[208:215], v18
    ds_read_b128 v[84:87], v21 offset:2048
    v_smfmac_f32_16x16x64_bf16 v[44:47], v[56:59], a[216:223], v18
    ds_read_b128 v[88:91], v21 offset:3072
    s_waitcnt vmcnt(3)
    ds_write_b128 v20, v[48:51] offset:5120
    ds_write_b32 v53, v52 offset:9212
    v_smfmac_f32_16x16x64_bf16 v[40:43], v[60:63], a[224:231], v18
    v_bitop3_b32 v54, v48, v49, s22 bitop3:0x7e
    v_bitop3_b32 v55, v50, v51, s22 bitop3:0x7e
    v_smfmac_f32_16x16x64_bf16 v[44:47], v[60:63], a[232:239], v18
    v_bitop3_b32 v54, v52, v54, s22 bitop3:0xde
    v_bitop3_b32 v54, v54, v55, s52 bitop3:0xa8
    s_waitcnt lgkmcnt(4)
    v_smfmac_f32_16x16x64_bf16 v[40:43], v[64:67], v[76:83], v18
    v_cmp_ne_u32_e64 vcc, 0, v54
    s_waitcnt lgkmcnt(2)
    v_smfmac_f32_16x16x64_bf16 v[44:47], v[64:67], v[84:91], v18
    s_cbranch_vccnz R_pcr_279
R_pcok_278:
    s_waitcnt lgkmcnt(0)
    s_barrier
    ds_read_b128 v[56:59], v19 offset:5120
    ds_read_b128 v[60:63], v19 offset:6144
    v_smfmac_f32_16x16x64_bf16 v[40:43], v[68:71], a[240:247], v18
    ds_read_b128 v[64:67], v19 offset:7168
    v_smfmac_f32_16x16x64_bf16 v[44:47], v[68:71], a[248:255], v18
    ds_read_b128 v[68:71], v19 offset:8192
    v_smfmac_f32_16x16x64_bf16 v[40:43], v[72:75], v[96:103], v18
    v_smfmac_f32_16x16x64_bf16 v[44:47], v[72:75], v[104:111], v18
    ds_read_b128 v[72:75], v19 offset:9216
    s_waitcnt lgkmcnt(4)
    v_smfmac_f32_16x16x64_bf16 v[24:27], v[56:59], a[48:55], v18
    ds_read_b128 v[76:79], v21 offset:16384
    s_andn2_b32 s40, 1, s20
    v_smfmac_f32_16x16x64_bf16 v[28:31], v[56:59], a[56:63], v18
    ds_read_b128 v[80:83], v21 offset:17408
    s_xor_b32 s22, s22, s40
    s_waitcnt lgkmcnt(5)
    v_smfmac_f32_16x16x64_bf16 v[24:27], v[60:63], a[64:71], v18
    ds_read_b128 v[84:87], v21 offset:18432
    s_mov_b32 s52, 1
    v_smfmac_f32_16x16x64_bf16 v[28:31], v[60:63], a[72:79], v18
    ds_read_b128 v[88:91], v21 offset:19456
    s_min_u32 s40, s20, 1
    s_waitcnt lgkmcnt(6)
    v_smfmac_f32_16x16x64_bf16 v[24:27], v[64:67], a[80:87], v18
    buffer_load_dwordx4 v[8:11], v19, s[8:11], s51 offen offset:0 sc1
    v_smfmac_f32_16x16x64_bf16 v[28:31], v[64:67], a[88:95], v18
    buffer_load_dwordx4 v[12:15], v19, s[8:11], s51 offen offset:1024 sc1
    s_mov_b32 s33, s56
    s_waitcnt lgkmcnt(2)
    v_smfmac_f32_16x16x64_bf16 v[24:27], v[68:71], v[76:83], v18
    ds_read_b128 v[76:79], v21 offset:32768
    s_xor_b32 s56, s56, 0x4000
    s_waitcnt lgkmcnt(1)
    v_smfmac_f32_16x16x64_bf16 v[28:31], v[68:71], v[84:91], v18
    ds_read_b128 v[80:83], v21 offset:33792
    s_xor_b32 s32, s32, 0x4000
    v_smfmac_f32_16x16x64_bf16 v[24:27], v[72:75], a[96:103], v18
    ds_read_b128 v[84:87], v21 offset:34816
    v_smfmac_f32_16x16x64_bf16 v[28:31], v[72:75], a[104:111], v18
    ds_read_b128 v[88:91], v21 offset:35840
    v_smfmac_f32_16x16x64_bf16 v[32:35], v[56:59], a[160:167], v18
    v_smfmac_f32_16x16x64_bf16 v[36:39], v[56:59], a[168:175], v18
    s_waitcnt lgkmcnt(2)
    v_smfmac_f32_16x16x64_bf16 v[32:35], v[60:63], v[76:83], v18
    ds_read_b128 v[76:79], v21 offset:49152
    s_waitcnt lgkmcnt(1)
    v_smfmac_f32_16x16x64_bf16 v[36:39], v[60:63], v[84:91], v18
    ds_read_b128 v[80:83], v21 offset:50176
    v_cvt_pk_bf16_f32 v48, v24, v25
    v_smfmac_f32_16x16x64_bf16 v[32:35], v[64:67], a[176:183], v18
    ds_read_b128 v[84:87], v21 offset:51200
    v_cvt_pk_bf16_f32 v49, v26, v27
    v_smfmac_f32_16x16x64_bf16 v[36:39], v[64:67], a[184:191], v18
    ds_read_b128 v[88:91], v21 offset:52224
    v_cvt_pk_bf16_f32 v50, v28, v29
    v_smfmac_f32_16x16x64_bf16 v[32:35], v[68:71], a[192:199], v18
    v_cvt_pk_bf16_f32 v51, v30, v31
    v_smfmac_f32_16x16x64_bf16 v[36:39], v[68:71], a[200:207], v18
    v_add_u32 v21, 0x10000, v21
    s_waitcnt lgkmcnt(2)
    v_smfmac_f32_16x16x64_bf16 v[32:35], v[72:75], v[76:83], v18
    ds_read_b128 v[76:79], v21 offset:0
    s_waitcnt lgkmcnt(1)
    v_smfmac_f32_16x16x64_bf16 v[36:39], v[72:75], v[84:91], v18
    ds_read_b128 v[80:83], v21 offset:1024
    v_mfma_f32_16x16x16_bf16 v[24:27], v[48:49], v[16:17], 0
    ds_read_b128 v[84:87], v21 offset:2048
    v_mfma_f32_16x16x16_bf16 v[28:31], v[50:51], v[16:17], 0
    ds_read_b128 v[88:91], v21 offset:3072
    v_cvt_pk_bf16_f32 v52, v32, v33
    v_cvt_pk_bf16_f32 v53, v34, v35
    v_cvt_pk_bf16_f32 v54, v36, v37
    v_cvt_pk_bf16_f32 v55, v38, v39
    v_mfma_f32_16x16x16_bf16 v[32:35], v[52:53], v[16:17], 0
    v_cvt_pk_bf16_f32 v48, v24, v25
    v_mfma_f32_16x16x16_bf16 v[36:39], v[54:55], v[16:17], 0
    v_cvt_pk_bf16_f32 v49, v26, v27
    v_cvt_pk_bf16_f32 v50, v28, v29
    v_cvt_pk_bf16_f32 v51, v30, v31
    s_nop 1
    v_mfma_f32_16x16x32_bf16 v[24:27], v[0:3], v[48:51], 0
    v_mfma_f32_16x16x32_bf16 v[28:31], v[4:7], v[48:51], 0
    v_cvt_pk_bf16_f32 v52, v32, v33
    v_cvt_pk_bf16_f32 v53, v34, v35
    v_cvt_pk_bf16_f32 v54, v36, v37
    v_cvt_pk_bf16_f32 v55, v38, v39
    s_nop 1
    v_mfma_f32_16x16x32_bf16 v[32:35], v[52:55], v[48:51], 0
    s_nop 2
    v_cndmask_b32 v24, v24, v28, s[44:45]
    v_cndmask_b32 v25, v25, v29, s[44:45]
    v_cndmask_b32 v26, v26, v30, s[44:45]
    v_cndmask_b32 v27, v27, v31, s[44:45]
    ds_write_b128 v20, v[24:27] offset:10240
    v_cndmask_b32 v32, v32, v34, s[44:45]
    v_cndmask_b32 v33, v33, v35, s[44:45]
    ds_write_b64 v20, v[32:33] offset:0
    v_smfmac_f32_16x16x64_bf16 v[40:43], v[56:59], v[112:119], v18
    v_xor_b32 v52, 0x400, v20
    v_smfmac_f32_16x16x64_bf16 v[44:47], v[56:59], v[120:127], v18
    v_xor_b32 v54, 0x800, v20
    v_smfmac_f32_16x16x64_bf16 v[40:43], v[60:63], v[128:135], v18
    v_xor_b32 v34, 0xc00, v20
    v_smfmac_f32_16x16x64_bf16 v[44:47], v[60:63], v[136:143], v18
    v_smfmac_f32_16x16x64_bf16 v[40:43], v[64:67], v[144:151], v18
    s_cmp_eq_u32 s20, 63
    s_cbranch_scc1 R_exit_272
    s_waitcnt lgkmcnt(0)
    s_barrier
    ds_read_b128 v[28:31], v52 offset:10240
    ds_read_b64 v[52:53], v52 offset:0
    v_smfmac_f32_16x16x64_bf16 v[44:47], v[64:67], v[152:159], v18
    ds_read_b128 v[36:39], v54 offset:10240
    v_smfmac_f32_16x16x64_bf16 v[40:43], v[68:71], v[160:167], v18
    ds_read_b64 v[54:55], v54 offset:0
    v_smfmac_f32_16x16x64_bf16 v[44:47], v[68:71], v[168:175], v18
    ds_read_b128 v[48:51], v34 offset:10240
    v_smfmac_f32_16x16x64_bf16 v[40:43], v[72:75], v[76:83], v18
    ds_read_b64 v[34:35], v34 offset:0
    v_smfmac_f32_16x16x64_bf16 v[44:47], v[72:75], v[84:91], v18
    s_waitcnt lgkmcnt(5)
    v_pk_add_f32 v[24:25], v[24:25], v[28:29]
    v_pk_add_f32 v[26:27], v[26:27], v[30:31]
    s_waitcnt lgkmcnt(4)
    v_pk_add_f32 v[32:33], v[32:33], v[52:53]
    s_waitcnt lgkmcnt(1)
    v_pk_add_f32 v[36:37], v[36:37], v[48:49]
    v_pk_add_f32 v[38:39], v[38:39], v[50:51]
    s_waitcnt lgkmcnt(0)
    v_pk_add_f32 v[54:55], v[54:55], v[34:35]
    v_pk_add_f32 v[24:25], v[24:25], v[36:37]
    v_pk_add_f32 v[26:27], v[26:27], v[38:39]
    v_pk_add_f32 v[32:33], v[32:33], v[54:55]
    v_max3_f32 v34, v24, v25, v26
    v_max3_f32 v34, v34, v27, v32
    v_max_f32_e64 v34, v34, v33
    v_cvt_pk_bf16_f32 v92, v40, v41
    v_cvt_pk_bf16_f32 v93, v42, v43
    v_max_f32_dpp v34, v34, v34 row_ror:8 row_mask:0xf bank_mask:0xf
    v_mov_b32_e64 v35, v34
    v_cvt_pk_bf16_f32 v94, v44, v45
    v_cvt_pk_bf16_f32 v95, v46, v47
    v_permlane16_swap_b32 v34, v35
    v_max_f32 v34, v34, v35
    v_mov_b32 v35, v34
    v_mov_b32 v56, 0
    v_mov_b32 v57, 0
    v_permlane32_swap_b32 v34, v35
    v_max_f32 v34, v34, v35
    v_mul_f32 v34, s50, v34
    v_pk_fma_f32 v[24:25], v[24:25], s[54:55], v[34:35] op_sel_hi:[1,1,0] neg_lo:[0,0,1] neg_hi:[0,0,1]
    v_pk_fma_f32 v[26:27], v[26:27], s[54:55], v[34:35] op_sel_hi:[1,1,0] neg_lo:[0,0,1] neg_hi:[0,0,1]
    v_pk_fma_f32 v[32:33], v[32:33], s[54:55], v[34:35] op_sel_hi:[1,1,0] neg_lo:[0,0,1] neg_hi:[0,0,1]
    v_exp_f32 v24, v24
    v_exp_f32 v25, v25
    v_exp_f32 v26, v26
    v_exp_f32 v27, v27
    v_exp_f32 v32, v32
    v_exp_f32 v33, v33
    v_cvt_pk_bf16_f32 v48, v24, v25
    v_cvt_pk_bf16_f32 v49, v26, v27
    v_cvt_pk_bf16_f32 v52, v32, v33
    v_mov_b32_dpp v50, v48 row_ror:8 row_mask:0xf bank_mask:0xf
    v_mov_b32_dpp v51, v49 row_ror:8 row_mask:0xf bank_mask:0xf
    v_mov_b32_dpp v53, v52 row_ror:8 row_mask:0xf bank_mask:0xf
    v_pk_add_f32 v[24:25], v[24:25], v[26:27]
    s_waitcnt vmcnt(0)
    v_mfma_f32_16x16x32_bf16 v[28:31], v[8:11], v[48:51], 0
    v_add_f32 v32, v32, v33
    v_add_f32_e64 v24, v24, v25
    v_mfma_f32_16x16x32_bf16 v[36:39], v[12:15], v[48:51], 0
    v_fma_f32 v34, v32, 0.5, v24
    v_mfma_f32_16x16x16_bf16 v[28:31], v[92:93], v[52:53], v[28:31]
    v_mov_b32_e64 v58, 0
    v_add_f32_dpp v34, v34, v34 row_ror:8 row_mask:0xf bank_mask:0xf
    v_mfma_f32_16x16x16_bf16 v[36:39], v[94:95], v[52:53], v[36:39]
    v_mov_b32 v35, v34
    v_mov_b32 v59, 0
    v_mov_b32 v60, 0
    v_permlane16_swap_b32 v34, v35
    v_add_f32 v34, v34, v35
    v_mov_b32 v35, v34
    v_mov_b32 v61, 0
    v_mov_b32 v62, 0
    v_permlane32_swap_b32 v34, v35
    v_add_f32 v34, v34, v35
    v_rcp_f32 v34, v34
    s_mov_b64 exec, s[46:47]
    v_pk_mul_f32 v[28:29], v[28:29], v[34:35] op_sel_hi:[1,0]
    v_pk_mul_f32 v[30:31], v[30:31], v[34:35] op_sel_hi:[1,0]
    v_pk_mul_f32 v[36:37], v[36:37], v[34:35] op_sel_hi:[1,0]
    v_pk_mul_f32 v[38:39], v[38:39], v[34:35] op_sel_hi:[1,0]
    v_cvt_pk_bf16_f32 v24, v28, v29
    v_cvt_pk_bf16_f32 v25, v30, v31
    v_cvt_pk_bf16_f32 v26, v36, v37
    v_cvt_pk_bf16_f32 v27, v38, v39
    ds_write_b128 v22, v[24:27]
    s_mov_b64 exec, -1
    v_mov_b32 v63, 0
    v_mov_b32 v64, 0
    v_mov_b32 v65, 0
    v_mov_b32 v66, 0
    v_mov_b32 v67, 0
    v_mov_b32 v68, 0
    v_mov_b32 v69, 0
    v_mov_b32 v70, 0
    v_mov_b32 v71, 0
    v_mov_b32 v72, 0
    v_mov_b32 v73, 0
    v_mov_b32 v74, 0
    v_mov_b32 v75, 0
    s_waitcnt lgkmcnt(0)
    s_barrier
    ds_read_b128 v[48:51], v19 offset:5120
    ds_read_b128 v[52:55], v19 offset:6144
    v_subrev_u32 v21, 0x20000, v21
    v_lshrrev_b32_e64 v24, 8, v19
    v_bfe_u32 v25, v19, 2, 6
    v_lshl_add_u32 v24, v24, 13, v25
    s_waitcnt lgkmcnt(1)
    v_smfmac_f32_16x16x64_bf16 v[56:59], v[48:51], v[176:183], v18 abid:1
    s_waitcnt lgkmcnt(0)
    v_smfmac_f32_16x16x64_bf16 v[56:59], v[52:55], v[216:223], v18 abid:1
    v_smfmac_f32_16x16x64_bf16 v[60:63], v[48:51], v[184:191], v18 abid:1
    v_smfmac_f32_16x16x64_bf16 v[60:63], v[52:55], v[224:231], v18 abid:1
    v_add_f32_e64 v56, v56, v58
    v_smfmac_f32_16x16x64_bf16 v[64:67], v[48:51], v[192:199], v18 abid:1
    v_add_f32_e64 v57, v57, v59
    v_smfmac_f32_16x16x64_bf16 v[64:67], v[52:55], v[232:239], v18 abid:1
    v_cvt_pk_bf16_f32 v28, v56, v57
    v_add_f32_e64 v60, v60, v62
    v_smfmac_f32_16x16x64_bf16 v[68:71], v[48:51], v[200:207], v18 abid:1
    v_add_f32_e64 v61, v61, v63
    v_bfi_b32 v28, 1, s21, v28
    v_smfmac_f32_16x16x64_bf16 v[68:71], v[52:55], v[240:247], v18 abid:1
    v_cvt_pk_bf16_f32 v29, v60, v61
    v_add_f32_e64 v64, v64, v66
    v_smfmac_f32_16x16x64_bf16 v[72:75], v[48:51], v[208:215], v18 abid:1
    v_add_f32_e64 v65, v65, v67
    v_smfmac_f32_16x16x64_bf16 v[72:75], v[52:55], v[248:255], v18 abid:1
    v_add_f32_e64 v68, v68, v70
    v_add_f32 v69, v69, v71
    v_cvt_pk_bf16_f32 v30, v64, v65
    v_cvt_pk_bf16_f32 v31, v68, v69
    buffer_store_dwordx4 v[28:31], v23, s[8:11], s27 offen sc1
    s_nop 2
    v_pk_add_f32 v[72:73], v[72:73], v[74:75]
    v_cvt_pk_bf16_f32 v72, v72, v73
    v_bfi_b32 v72, 1, s21, v72
    buffer_store_dword v72, v24, s[8:11], s28 offen sc1
    s_cmp_lt_u32 s20, 58
    s_cbranch_scc1 R_noearly_281
    buffer_store_dwordx4 v[92:95], v19, s[8:11], s35 offen sc1
R_noearly_281:
    v_mov_b32 v24, 0
    v_mov_b32 v25, 0
    v_mov_b32 v26, 0
    v_mov_b32 v27, 0
    v_mov_b32 v28, 0
    v_mov_b32 v29, 0
    v_mov_b32 v30, 0
    v_mov_b32 v31, 0
    v_mov_b32 v32, 0
    v_mov_b32 v33, 0
    v_mov_b32 v34, 0
    v_mov_b32 v35, 0
    v_mov_b32 v36, 0
    v_mov_b32 v37, 0
    v_mov_b32 v38, 0
    v_mov_b32 v39, 0
    v_mov_b32 v40, 0
    v_mov_b32 v41, 0
    v_mov_b32 v42, 0
    v_mov_b32 v43, 0
    v_mov_b32 v44, 0
    v_mov_b32 v45, 0
    v_mov_b32 v46, 0
    v_mov_b32 v47, 0
    ds_read_b128 v[76:79], v21 offset:0
    buffer_load_dwordx4 v[56:59], v19, s[8:11], s29 offen offset:0 sc1
    buffer_load_dwordx4 v[60:63], v19, s[8:11], s29 offen offset:1024 sc1
    ds_read_b128 v[80:83], v21 offset:1024
    ds_read_b128 v[84:87], v21 offset:2048
    ds_read_b128 v[88:91], v21 offset:3072
    v_lshrrev_b32_e64 v53, 2, v20
    v_add_u32 v53, 4, v53
    s_add_u32 s20, s20, 1
    v_mov_b32 v54, 0xfffe0000
    v_lshrrev_b32_e64 v48, 2, v19
    v_and_b32 v48, 0x80, v48
    v_and_or_b32 v55, v19, 16, v48
    v_lshrrev_b32_e64 v48, 5, v19
    v_and_or_b32 v55, v48, 8, v55
    v_lshrrev_b32_e64 v48, 4, v19
    v_and_or_b32 v55, v48, 4, v55
    v_mov_b32 v48, 0x3f80
    v_cndmask_b32 v48, v48, 1.0, s[76:77]
    v_cndmask_b32 v64, 0, v48, s[60:61]
    v_cndmask_b32 v65, 0, v48, s[62:63]
    v_cndmask_b32 v66, 0, v48, s[64:65]
    v_cndmask_b32 v67, 0, v48, s[66:67]
    s_lshl_b32 s26, s22, 16
    s_sub_u32 s24, 0x10000, s26
    s_nop 7
    buffer_load_dwordx4 v[0:3], v19, s[8:11], s29 offen offset:0 sc1
    buffer_load_dwordx4 v[4:7], v19, s[8:11], s29 offen offset:1024 sc1
R_pi_284:
    s_waitcnt vmcnt(3)
    v_mfma_f32_16x16x32_bf16 v[68:71], v[56:59], v[64:67], 0
    s_waitcnt vmcnt(2)
    v_mfma_f32_16x16x32_bf16 v[68:71], v[60:63], v[64:67], v[68:71]
    v_bitop3_b32 v48, v56, v60, s21 bitop3:0x7e
    v_and_b32 v48, 1, v48
    v_cmp_ne_u32 vcc, 0, v48
    s_cbranch_vccnz R_pir_286
R_piok_285:
    s_nop 3
    v_permlane32_swap_b32 v68, v70
    v_permlane32_swap_b32 v69, v71
    v_pk_add_f32 v[68:69], v[68:69], v[70:71]
    s_nop 1
    v_permlane16_swap_b32 v68, v69
    v_add_f32_e64 v68, v68, v69
    v_add_u32 v70, s24, v68
    v_bfi_b32 v70, v54, v70, s26
    v_mov_b32_dpp v69, v68 row_shl:2 row_mask:0xf bank_mask:0xf
    s_mov_b64 exec, s[48:49]
    v_cvt_pk_bf16_f32 v70, v70, v69
    buffer_store_dword v70, v55, s[8:11], s30 offen sc1
    buffer_store_dword v70, v55, s[8:11], s31 offen sc1
    s_mov_b64 exec, -1
    s_xor_b32 s31, s31, 0x4000
    s_xor_b32 s30, s30, 0x4000
    s_barrier
    s_nop 15
    s_nop 15
    s_nop 15
    s_nop 11
    s_branch R_top_270
R_par_276:
    buffer_load_dwordx4 v[0:3], v20, s[8:11], s32 offen sc1
    buffer_load_dword v4, v53, s[8:11], s32 offen offset:4092 sc1
    s_waitcnt vmcnt(2)
    ds_write_b128 v20, v[48:51]
    ds_write_b32 v53, v52 offset:4092
    v_bitop3_b32 v56, v48, v49, s22 bitop3:0x7e
    v_bitop3_b32 v57, v50, v51, s22 bitop3:0x7e
    v_bitop3_b32 v56, v52, v56, s22 bitop3:0xde
    v_bitop3_b32 v56, v56, v57, 1 bitop3:0xa8
    v_cmp_ne_u32 vcc, 0, v56
    s_cbranch_vccz R_paok_275
    buffer_load_dwordx4 v[48:51], v20, s[8:11], s32 offen sc1
    buffer_load_dword v52, v53, s[8:11], s32 offen offset:4092 sc1
    s_add_u32 s6, s6, 1
    s_cmp_lt_u32 s6, 400000
    s_cbranch_scc1 R_pa_274
    s_branch R_paok_275
R_pcr_279:
    s_waitcnt vmcnt(1)
    ds_write_b128 v20, v[8:11] offset:5120
    ds_write_b32 v53, v12 offset:9212
    v_bitop3_b32 v54, v8, v9, s22 bitop3:0x7e
    v_bitop3_b32 v55, v10, v11, s22 bitop3:0x7e
    v_bitop3_b32 v54, v12, v54, s22 bitop3:0xde
    v_bitop3_b32 v54, v54, v55, s52 bitop3:0xa8
    v_cmp_ne_u32_e64 vcc, 0, v54
    s_cbranch_vccz R_pcok_278
R_pcr2_288:
    s_add_u32 s6, s6, 1
    s_cmp_lt_u32 s6, 400000
    s_cbranch_scc1 R_pc2_280
    s_branch R_pcok_278
R_pc2_280:
    s_waitcnt lgkmcnt(0)
    buffer_load_dwordx4 v[48:51], v20, s[8:11], s33 offen sc1
    buffer_load_dword v52, v53, s[8:11], s33 offen offset:4092 sc1
    s_waitcnt vmcnt(0)
    ds_write_b128 v20, v[48:51] offset:5120
    ds_write_b32 v53, v52 offset:9212
    v_bitop3_b32 v54, v48, v49, s22 bitop3:0x7e
    v_bitop3_b32 v55, v50, v51, s22 bitop3:0x7e
    v_bitop3_b32 v54, v52, v54, s22 bitop3:0xde
    v_bitop3_b32 v54, v54, v55, s52 bitop3:0xa8
    v_cmp_ne_u32_e64 vcc, 0, v54
    s_cbranch_vccnz R_pcr2_288
    s_branch R_pcok_278
R_pir_286:
    buffer_load_dwordx4 v[56:59], v19, s[8:11], s29 offen offset:0 sc1
    buffer_load_dwordx4 v[60:63], v19, s[8:11], s29 offen offset:1024 sc1
    s_waitcnt vmcnt(3)
    v_mfma_f32_16x16x32_bf16 v[68:71], v[0:3], v[64:67], 0
    s_waitcnt vmcnt(2)
    v_mfma_f32_16x16x32_bf16 v[68:71], v[4:7], v[64:67], v[68:71]
    v_bitop3_b32 v48, v0, v4, s21 bitop3:0x7e
    v_and_b32_e64 v48, 1, v48
    v_cmp_ne_u32 vcc, 0, v48
    s_cbranch_vccz R_piok_285
    buffer_load_dwordx4 v[0:3], v19, s[8:11], s29 offen offset:0 sc1
    buffer_load_dwordx4 v[4:7], v19, s[8:11], s29 offen offset:1024 sc1
    s_add_u32 s6, s6, 1
    s_cmp_lt_u32 s6, 400000
    s_cbranch_scc1 R_pi_284
    s_branch R_piok_285
R_exit_272:
    s_waitcnt lgkmcnt(0)
    v_smfmac_f32_16x16x64_bf16 v[44:47], v[64:67], v[152:159], v18
    v_smfmac_f32_16x16x64_bf16 v[40:43], v[68:71], v[160:167], v18
    v_smfmac_f32_16x16x64_bf16 v[44:47], v[68:71], v[168:175], v18
    v_smfmac_f32_16x16x64_bf16 v[40:43], v[72:75], v[76:83], v18
    v_smfmac_f32_16x16x64_bf16 v[44:47], v[72:75], v[84:91], v18
    s_nop 3
    v_cvt_pk_bf16_f32 v92, v40, v41
    v_cvt_pk_bf16_f32 v93, v42, v43
    s_nop 1
    v_cvt_pk_bf16_f32 v94, v44, v45
    v_cvt_pk_bf16_f32 v95, v46, v47
    buffer_store_dwordx4 v[92:95], v19, s[8:11], s35 offen sc1
    s_branch R_end_87
R_v01h_98:
    s_branch R_ent_290
.p2align 6
R_top_289:
    buffer_load_dwordx4 v[0:3], v20, s[8:11], s32 offen sc1
    buffer_load_dword v4, v53, s[8:11], s32 offen offset:4092 sc1
    s_nop 15
    s_nop 8
    buffer_load_dwordx4 v[48:51], v20, s[8:11], s32 offen sc1
    buffer_load_dword v52, v53, s[8:11], s32 offen offset:4092 sc1
R_pa_293:
    s_waitcnt vmcnt(2)
    ds_write_b128 v20, v[0:3]
    ds_write_b32 v53, v4 offset:4092
    v_bitop3_b32 v56, v0, v1, s22 bitop3:0x7e
    v_bitop3_b32 v57, v2, v3, s22 bitop3:0x7e
    v_bitop3_b32 v56, v4, v56, s22 bitop3:0xde
    v_bitop3_b32 v56, v56, v57, 1 bitop3:0xa8
    v_cmp_ne_u32 vcc, 0, v56
    s_cbranch_vccnz R_par_295
R_paok_294:
    buffer_load_dwordx4 v[48:51], v20, s[8:11], s33 offen sc1
    buffer_load_dword v52, v53, s[8:11], s33 offen offset:4092 sc1
    s_waitcnt lgkmcnt(0)
    s_barrier
R_ent_290:
    ds_read_b128 v[56:59], v19 offset:0
    ds_read_b128 v[60:63], v19 offset:1024
    ds_read_b128 v[64:67], v19 offset:2048
    ds_read_b128 v[68:71], v19 offset:3072
    ds_read_b128 v[72:75], v19 offset:4096
    s_waitcnt lgkmcnt(4)
    v_smfmac_f32_16x16x64_bf16 v[24:27], v[56:59], v[76:83], v18
    ds_read_b128 v[76:79], v21 offset:16384
    s_xor_b32 s21, s21, 1
    buffer_load_dwordx4 v[0:3], v19, s[8:11], s34 offen offset:0 sc1
    v_smfmac_f32_16x16x64_bf16 v[28:31], v[56:59], v[84:91], v18
    ds_read_b128 v[80:83], v21 offset:17408
    s_min_u32 s40, s20, 1
    buffer_load_dwordx4 v[4:7], v19, s[8:11], s34 offen offset:1024 sc1
    v_smfmac_f32_16x16x64_bf16 v[32:35], v[56:59], a[112:119], v18
    ds_read_b128 v[84:87], v21 offset:18432
    s_lshl_b32 s41, s40, 17
    v_smfmac_f32_16x16x64_bf16 v[36:39], v[56:59], a[120:127], v18
    ds_read_b128 v[88:91], v21 offset:19456
    s_waitcnt lgkmcnt(7)
    v_smfmac_f32_16x16x64_bf16 v[24:27], v[60:63], a[0:7], v18
    buffer_load_dwordx4 v[8:11], v20, s[8:11], s33 offen sc1
    v_smfmac_f32_16x16x64_bf16 v[28:31], v[60:63], a[8:15], v18
    buffer_load_dword v12, v53, s[8:11], s33 offen offset:4092 sc1
    s_waitcnt lgkmcnt(2)
    v_smfmac_f32_16x16x64_bf16 v[32:35], v[60:63], v[76:83], v18
    ds_read_b128 v[76:79], v21 offset:32768
    s_waitcnt lgkmcnt(1)
    v_smfmac_f32_16x16x64_bf16 v[36:39], v[60:63], v[84:91], v18
    ds_read_b128 v[80:83], v21 offset:33792
    v_smfmac_f32_16x16x64_bf16 v[24:27], v[64:67], a[16:23], v18
    ds_read_b128 v[84:87], v21 offset:34816
    v_smfmac_f32_16x16x64_bf16 v[28:31], v[64:67], a[24:31], v18
    ds_read_b128 v[88:91], v21 offset:35840
    v_smfmac_f32_16x16x64_bf16 v[32:35], v[64:67], a[128:135], v18
    v_smfmac_f32_16x16x64_bf16 v[36:39], v[64:67], a[136:143], v18
    s_waitcnt lgkmcnt(2)
    v_smfmac_f32_16x16x64_bf16 v[24:27], v[68:71], v[76:83], v18
    ds_read_b128 v[76:79], v21 offset:49152
    s_waitcnt lgkmcnt(1)
    v_smfmac_f32_16x16x64_bf16 v[28:31], v[68:71], v[84:91], v18
    ds_read_b128 v[80:83], v21 offset:50176
    v_smfmac_f32_16x16x64_bf16 v[32:35], v[68:71], a[144:151], v18
    ds_read_b128 v[84:87], v21 offset:51200
    v_smfmac_f32_16x16x64_bf16 v[36:39], v[68:71], a[152:159], v18
    ds_read_b128 v[88:91], v21 offset:52224
    v_smfmac_f32_16x16x64_bf16 v[24:27], v[72:75], a[32:39], v18
    v_add_u32 v21, 0x10000, v21
    buffer_store_dwordx4 v[92:95], v19, s[8:11], s35 offen sc1
    v_smfmac_f32_16x16x64_bf16 v[28:31], v[72:75], a[40:47], v18
    s_add_u32 s35, s35, s41
    s_add_u32 s51, s34, 0x1000000
    s_waitcnt lgkmcnt(2)
    v_smfmac_f32_16x16x64_bf16 v[32:35], v[72:75], v[76:83], v18
    ds_read_b128 v[76:79], v21 offset:0
    s_add_u32 s34, s34, 0x40000
    s_waitcnt lgkmcnt(1)
    v_smfmac_f32_16x16x64_bf16 v[36:39], v[72:75], v[84:91], v18
    ds_read_b128 v[80:83], v21 offset:1024
    v_smfmac_f32_16x16x64_bf16 v[40:43], v[56:59], a[208:215], v18
    ds_read_b128 v[84:87], v21 offset:2048
    v_smfmac_f32_16x16x64_bf16 v[44:47], v[56:59], a[216:223], v18
    ds_read_b128 v[88:91], v21 offset:3072
    s_waitcnt vmcnt(3)
    ds_write_b128 v20, v[48:51] offset:5120
    ds_write_b32 v53, v52 offset:9212
    v_smfmac_f32_16x16x64_bf16 v[40:43], v[60:63], a[224:231], v18
    v_bitop3_b32 v54, v48, v49, s22 bitop3:0x7e
    v_bitop3_b32 v55, v50, v51, s22 bitop3:0x7e
    v_smfmac_f32_16x16x64_bf16 v[44:47], v[60:63], a[232:239], v18
    v_bitop3_b32 v54, v52, v54, s22 bitop3:0xde
    v_bitop3_b32 v54, v54, v55, s52 bitop3:0xa8
    s_waitcnt lgkmcnt(4)
    v_smfmac_f32_16x16x64_bf16 v[40:43], v[64:67], v[76:83], v18
    v_cmp_ne_u32_e64 vcc, 0, v54
    s_waitcnt lgkmcnt(2)
    v_smfmac_f32_16x16x64_bf16 v[44:47], v[64:67], v[84:91], v18
    s_cbranch_vccnz R_pcr_298
R_pcok_297:
    s_waitcnt lgkmcnt(0)
    s_barrier
    ds_read_b128 v[56:59], v19 offset:5120
    ds_read_b128 v[60:63], v19 offset:6144
    v_smfmac_f32_16x16x64_bf16 v[40:43], v[68:71], a[240:247], v18
    ds_read_b128 v[64:67], v19 offset:7168
    v_smfmac_f32_16x16x64_bf16 v[44:47], v[68:71], a[248:255], v18
    ds_read_b128 v[68:71], v19 offset:8192
    v_smfmac_f32_16x16x64_bf16 v[40:43], v[72:75], v[96:103], v18
    v_smfmac_f32_16x16x64_bf16 v[44:47], v[72:75], v[104:111], v18
    ds_read_b128 v[72:75], v19 offset:9216
    s_waitcnt lgkmcnt(4)
    v_smfmac_f32_16x16x64_bf16 v[24:27], v[56:59], a[48:55], v18
    ds_read_b128 v[76:79], v21 offset:16384
    s_andn2_b32 s40, 1, s20
    v_smfmac_f32_16x16x64_bf16 v[28:31], v[56:59], a[56:63], v18
    ds_read_b128 v[80:83], v21 offset:17408
    s_xor_b32 s22, s22, s40
    s_waitcnt lgkmcnt(5)
    v_smfmac_f32_16x16x64_bf16 v[24:27], v[60:63], a[64:71], v18
    ds_read_b128 v[84:87], v21 offset:18432
    s_mov_b32 s52, 1
    v_smfmac_f32_16x16x64_bf16 v[28:31], v[60:63], a[72:79], v18
    ds_read_b128 v[88:91], v21 offset:19456
    s_min_u32 s40, s20, 1
    s_waitcnt lgkmcnt(6)
    v_smfmac_f32_16x16x64_bf16 v[24:27], v[64:67], a[80:87], v18
    buffer_load_dwordx4 v[8:11], v19, s[8:11], s51 offen offset:0 sc1
    v_smfmac_f32_16x16x64_bf16 v[28:31], v[64:67], a[88:95], v18
    buffer_load_dwordx4 v[12:15], v19, s[8:11], s51 offen offset:1024 sc1
    s_mov_b32 s33, s56
    s_waitcnt lgkmcnt(2)
    v_smfmac_f32_16x16x64_bf16 v[24:27], v[68:71], v[76:83], v18
    ds_read_b128 v[76:79], v21 offset:32768
    s_xor_b32 s56, s56, 0x4000
    s_waitcnt lgkmcnt(1)
    v_smfmac_f32_16x16x64_bf16 v[28:31], v[68:71], v[84:91], v18
    ds_read_b128 v[80:83], v21 offset:33792
    s_xor_b32 s32, s32, 0x4000
    v_smfmac_f32_16x16x64_bf16 v[24:27], v[72:75], a[96:103], v18
    ds_read_b128 v[84:87], v21 offset:34816
    v_smfmac_f32_16x16x64_bf16 v[28:31], v[72:75], a[104:111], v18
    ds_read_b128 v[88:91], v21 offset:35840
    v_smfmac_f32_16x16x64_bf16 v[32:35], v[56:59], a[160:167], v18
    v_smfmac_f32_16x16x64_bf16 v[36:39], v[56:59], a[168:175], v18
    s_waitcnt lgkmcnt(2)
    v_smfmac_f32_16x16x64_bf16 v[32:35], v[60:63], v[76:83], v18
    ds_read_b128 v[76:79], v21 offset:49152
    s_waitcnt lgkmcnt(1)
    v_smfmac_f32_16x16x64_bf16 v[36:39], v[60:63], v[84:91], v18
    ds_read_b128 v[80:83], v21 offset:50176
    v_cvt_pk_bf16_f32 v48, v24, v25
    v_smfmac_f32_16x16x64_bf16 v[32:35], v[64:67], a[176:183], v18
    ds_read_b128 v[84:87], v21 offset:51200
    v_cvt_pk_bf16_f32 v49, v26, v27
    v_smfmac_f32_16x16x64_bf16 v[36:39], v[64:67], a[184:191], v18
    ds_read_b128 v[88:91], v21 offset:52224
    v_cvt_pk_bf16_f32 v50, v28, v29
    v_smfmac_f32_16x16x64_bf16 v[32:35], v[68:71], a[192:199], v18
    v_cvt_pk_bf16_f32 v51, v30, v31
    v_smfmac_f32_16x16x64_bf16 v[36:39], v[68:71], a[200:207], v18
    v_add_u32 v21, 0x10000, v21
    s_waitcnt lgkmcnt(2)
    v_smfmac_f32_16x16x64_bf16 v[32:35], v[72:75], v[76:83], v18
    ds_read_b128 v[76:79], v21 offset:0
    s_waitcnt lgkmcnt(1)
    v_smfmac_f32_16x16x64_bf16 v[36:39], v[72:75], v[84:91], v18
    ds_read_b128 v[80:83], v21 offset:1024
    v_mfma_f32_16x16x16_bf16 v[24:27], v[48:49], v[16:17], 0
    ds_read_b128 v[84:87], v21 offset:2048
    v_mfma_f32_16x16x16_bf16 v[28:31], v[50:51], v[16:17], 0
    ds_read_b128 v[88:91], v21 offset:3072
    v_cvt_pk_bf16_f32 v52, v32, v33
    v_cvt_pk_bf16_f32 v53, v34, v35
    v_cvt_pk_bf16_f32 v54, v36, v37
    v_cvt_pk_bf16_f32 v55, v38, v39
    v_mfma_f32_16x16x16_bf16 v[32:35], v[52:53], v[16:17], 0
    v_cvt_pk_bf16_f32 v48, v24, v25
    v_mfma_f32_16x16x16_bf16 v[36:39], v[54:55], v[16:17], 0
    v_cvt_pk_bf16_f32 v49, v26, v27
    v_cvt_pk_bf16_f32 v50, v28, v29
    v_cvt_pk_bf16_f32 v51, v30, v31
    s_nop 1
    v_mfma_f32_16x16x32_bf16 v[24:27], v[0:3], v[48:51], 0
    v_mfma_f32_16x16x32_bf16 v[28:31], v[4:7], v[48:51], 0
    v_cvt_pk_bf16_f32 v52, v32, v33
    v_cvt_pk_bf16_f32 v53, v34, v35
    v_cvt_pk_bf16_f32 v54, v36, v37
    v_cvt_pk_bf16_f32 v55, v38, v39
    s_nop 1
    v_mfma_f32_16x16x32_bf16 v[32:35], v[52:55], v[48:51], 0
    s_nop 2
    v_cndmask_b32 v24, v24, v28, s[44:45]
    v_cndmask_b32 v25, v25, v29, s[44:45]
    v_cndmask_b32 v26, v26, v30, s[44:45]
    v_cndmask_b32 v27, v27, v31, s[44:45]
    ds_write_b128 v20, v[24:27] offset:10240
    v_cndmask_b32 v32, v32, v34, s[44:45]
    v_cndmask_b32 v33, v33, v35, s[44:45]
    ds_write_b64 v20, v[32:33] offset:0
    v_smfmac_f32_16x16x64_bf16 v[40:43], v[56:59], v[112:119], v18
    v_xor_b32 v52, 0x400, v20
    v_smfmac_f32_16x16x64_bf16 v[44:47], v[56:59], v[120:127], v18
    v_xor_b32 v54, 0x800, v20
    v_smfmac_f32_16x16x64_bf16 v[40:43], v[60:63], v[128:135], v18
    v_xor_b32 v34, 0xc00, v20
    v_smfmac_f32_16x16x64_bf16 v[44:47], v[60:63], v[136:143], v18
    v_smfmac_f32_16x16x64_bf16 v[40:43], v[64:67], v[144:151], v18
    s_cmp_eq_u32 s20, 63
    s_cbranch_scc1 R_exit_291
    s_waitcnt lgkmcnt(0)
    s_barrier
    ds_read_b128 v[28:31], v52 offset:10240
    ds_read_b64 v[52:53], v52 offset:0
    v_smfmac_f32_16x16x64_bf16 v[44:47], v[64:67], v[152:159], v18
    ds_read_b128 v[36:39], v54 offset:10240
    v_smfmac_f32_16x16x64_bf16 v[40:43], v[68:71], v[160:167], v18
    ds_read_b64 v[54:55], v54 offset:0
    v_smfmac_f32_16x16x64_bf16 v[44:47], v[68:71], v[168:175], v18
    ds_read_b128 v[48:51], v34 offset:10240
    v_smfmac_f32_16x16x64_bf16 v[40:43], v[72:75], v[76:83], v18
    ds_read_b64 v[34:35], v34 offset:0
    v_smfmac_f32_16x16x64_bf16 v[44:47], v[72:75], v[84:91], v18
    s_waitcnt lgkmcnt(5)
    v_pk_add_f32 v[24:25], v[24:25], v[28:29]
    v_pk_add_f32 v[26:27], v[26:27], v[30:31]
    s_waitcnt lgkmcnt(4)
    v_pk_add_f32 v[32:33], v[32:33], v[52:53]
    s_waitcnt lgkmcnt(1)
    v_pk_add_f32 v[36:37], v[36:37], v[48:49]
    v_pk_add_f32 v[38:39], v[38:39], v[50:51]
    s_waitcnt lgkmcnt(0)
    v_pk_add_f32 v[54:55], v[54:55], v[34:35]
    v_pk_add_f32 v[24:25], v[24:25], v[36:37]
    v_pk_add_f32 v[26:27], v[26:27], v[38:39]
    v_pk_add_f32 v[32:33], v[32:33], v[54:55]
    v_max3_f32 v34, v24, v25, v26
    v_max3_f32 v34, v34, v27, v32
    v_max_f32_e64 v34, v34, v33
    v_cvt_pk_bf16_f32 v92, v40, v41
    v_cvt_pk_bf16_f32 v93, v42, v43
    v_max_f32_dpp v34, v34, v34 row_ror:8 row_mask:0xf bank_mask:0xf
    v_mov_b32_e64 v35, v34
    v_cvt_pk_bf16_f32 v94, v44, v45
    v_cvt_pk_bf16_f32 v95, v46, v47
    v_permlane16_swap_b32 v34, v35
    v_max_f32 v34, v34, v35
    v_mov_b32 v35, v34
    v_mov_b32 v56, 0
    v_mov_b32 v57, 0
    v_permlane32_swap_b32 v34, v35
    v_max_f32 v34, v34, v35
    v_mul_f32 v34, s50, v34
    v_pk_fma_f32 v[24:25], v[24:25], s[54:55], v[34:35] op_sel_hi:[1,1,0] neg_lo:[0,0,1] neg_hi:[0,0,1]
    v_pk_fma_f32 v[26:27], v[26:27], s[54:55], v[34:35] op_sel_hi:[1,1,0] neg_lo:[0,0,1] neg_hi:[0,0,1]
    v_pk_fma_f32 v[32:33], v[32:33], s[54:55], v[34:35] op_sel_hi:[1,1,0] neg_lo:[0,0,1] neg_hi:[0,0,1]
    v_exp_f32 v24, v24
    v_exp_f32 v25, v25
    v_exp_f32 v26, v26
    v_exp_f32 v27, v27
    v_exp_f32 v32, v32
    v_exp_f32 v33, v33
    v_cvt_pk_bf16_f32 v48, v24, v25
    v_cvt_pk_bf16_f32 v49, v26, v27
    v_cvt_pk_bf16_f32 v52, v32, v33
    v_mov_b32_dpp v50, v48 row_ror:8 row_mask:0xf bank_mask:0xf
    v_mov_b32_dpp v51, v49 row_ror:8 row_mask:0xf bank_mask:0xf
    v_mov_b32_dpp v53, v52 row_ror:8 row_mask:0xf bank_mask:0xf
    v_pk_add_f32 v[24:25], v[24:25], v[26:27]
    s_waitcnt vmcnt(0)
    v_mfma_f32_16x16x32_bf16 v[28:31], v[8:11], v[48:51], 0
    v_add_f32 v32, v32, v33
    v_add_f32_e64 v24, v24, v25
    v_mfma_f32_16x16x32_bf16 v[36:39], v[12:15], v[48:51], 0
    v_fma_f32 v34, v32, 0.5, v24
    v_mfma_f32_16x16x16_bf16 v[28:31], v[92:93], v[52:53], v[28:31]
    v_mov_b32_e64 v58, 0
    v_add_f32_dpp v34, v34, v34 row_ror:8 row_mask:0xf bank_mask:0xf
    v_mfma_f32_16x16x16_bf16 v[36:39], v[94:95], v[52:53], v[36:39]
    v_mov_b32 v35, v34
    v_mov_b32 v59, 0
    v_mov_b32 v60, 0
    v_permlane16_swap_b32 v34, v35
    v_add_f32 v34, v34, v35
    v_mov_b32 v35, v34
    v_mov_b32 v61, 0
    v_mov_b32 v62, 0
    v_permlane32_swap_b32 v34, v35
    v_add_f32 v34, v34, v35
    v_rcp_f32 v34, v34
    s_mov_b64 exec, s[46:47]
    v_pk_mul_f32 v[28:29], v[28:29], v[34:35] op_sel_hi:[1,0]
    v_pk_mul_f32 v[30:31], v[30:31], v[34:35] op_sel_hi:[1,0]
    v_pk_mul_f32 v[36:37], v[36:37], v[34:35] op_sel_hi:[1,0]
    v_pk_mul_f32 v[38:39], v[38:39], v[34:35] op_sel_hi:[1,0]
    v_cvt_pk_bf16_f32 v24, v28, v29
    v_cvt_pk_bf16_f32 v25, v30, v31
    v_cvt_pk_bf16_f32 v26, v36, v37
    v_cvt_pk_bf16_f32 v27, v38, v39
    ds_write_b128 v22, v[24:27]
    s_mov_b64 exec, -1
    v_mov_b32 v63, 0
    v_mov_b32 v64, 0
    v_mov_b32 v65, 0
    v_mov_b32 v66, 0
    v_mov_b32 v67, 0
    v_mov_b32 v68, 0
    v_mov_b32 v69, 0
    v_mov_b32 v70, 0
    v_mov_b32 v71, 0
    v_mov_b32 v72, 0
    v_mov_b32 v73, 0
    v_mov_b32 v74, 0
    v_mov_b32 v75, 0
    s_waitcnt lgkmcnt(0)
    s_barrier
    ds_read_b128 v[48:51], v19 offset:5120
    ds_read_b128 v[52:55], v19 offset:6144
    v_subrev_u32 v21, 0x20000, v21
    v_lshrrev_b32_e64 v24, 8, v19
    v_bfe_u32 v25, v19, 2, 6
    v_lshl_add_u32 v24, v24, 13, v25
    s_waitcnt lgkmcnt(1)
    v_smfmac_f32_16x16x64_bf16 v[56:59], v[48:51], v[176:183], v18 abid:1
    s_waitcnt lgkmcnt(0)
    v_smfmac_f32_16x16x64_bf16 v[56:59], v[52:55], v[216:223], v18 abid:1
    v_smfmac_f32_16x16x64_bf16 v[60:63], v[48:51], v[184:191], v18 abid:1
    v_smfmac_f32_16x16x64_bf16 v[60:63], v[52:55], v[224:231], v18 abid:1
    v_add_f32_e64 v56, v56, v58
    v_smfmac_f32_16x16x64_bf16 v[64:67], v[48:51], v[192:199], v18 abid:1
    v_add_f32_e64 v57, v57, v59
    v_smfmac_f32_16x16x64_bf16 v[64:67], v[52:55], v[232:239], v18 abid:1
    v_cvt_pk_bf16_f32 v28, v56, v57
    v_add_f32_e64 v60, v60, v62
    v_smfmac_f32_16x16x64_bf16 v[68:71], v[48:51], v[200:207], v18 abid:1
    v_add_f32_e64 v61, v61, v63
    v_bfi_b32 v28, 1, s21, v28
    v_smfmac_f32_16x16x64_bf16 v[68:71], v[52:55], v[240:247], v18 abid:1
    v_cvt_pk_bf16_f32 v29, v60, v61
    v_add_f32_e64 v64, v64, v66
    v_smfmac_f32_16x16x64_bf16 v[72:75], v[48:51], v[208:215], v18 abid:1
    v_add_f32_e64 v65, v65, v67
    v_smfmac_f32_16x16x64_bf16 v[72:75], v[52:55], v[248:255], v18 abid:1
    v_add_f32_e64 v68, v68, v70
    v_add_f32 v69, v69, v71
    v_cvt_pk_bf16_f32 v30, v64, v65
    v_cvt_pk_bf16_f32 v31, v68, v69
    buffer_store_dwordx4 v[28:31], v23, s[8:11], s27 offen sc1
    s_nop 2
    v_pk_add_f32 v[72:73], v[72:73], v[74:75]
    v_cvt_pk_bf16_f32 v72, v72, v73
    v_bfi_b32 v72, 1, s21, v72
    buffer_store_dword v72, v24, s[8:11], s28 offen sc1
    s_cmp_lt_u32 s20, 58
    s_cbranch_scc1 R_noearly_300
    buffer_store_dwordx4 v[92:95], v19, s[8:11], s35 offen sc1
R_noearly_300:
    s_cmp_ge_u32 s4, 16
    s_cbranch_scc1 R_nored_301
    v_mov_b32 v24, 0
    v_mov_b32 v25, 0
    v_mov_b32 v26, 0
    v_mov_b32 v27, 0
    v_mov_b32 v28, 0
    v_mov_b32 v29, 0
    v_mov_b32 v30, 0
    v_mov_b32 v31, 0
    v_mov_b32 v32, 0
    v_mov_b32 v33, 0
    v_mov_b32 v34, 0
    v_mov_b32 v35, 0
    v_mov_b32 v36, 0
    v_mov_b32 v37, 0
    v_mov_b32 v38, 0
    v_mov_b32 v39, 0
    v_mov_b32 v40, 0
    v_mov_b32 v41, 0
    v_mov_b32 v42, 0
    v_mov_b32 v43, 0
    v_mov_b32 v44, 0
    v_mov_b32 v45, 0
    v_mov_b32 v46, 0
    v_mov_b32 v47, 0
    ds_read_b128 v[76:79], v21 offset:0
    buffer_load_dwordx4 v[56:59], v19, s[8:11], s29 offen offset:0 sc1
    buffer_load_dwordx4 v[60:63], v19, s[8:11], s29 offen offset:1024 sc1
    ds_read_b128 v[80:83], v21 offset:1024
    ds_read_b128 v[84:87], v21 offset:2048
    ds_read_b128 v[88:91], v21 offset:3072
    v_lshrrev_b32_e64 v53, 2, v20
    v_add_u32 v53, 4, v53
    s_add_u32 s20, s20, 1
    v_mov_b32 v54, 0xfffe0000
    v_lshrrev_b32_e64 v48, 2, v19
    v_and_b32 v48, 0x80, v48
    v_and_or_b32 v55, v19, 16, v48
    v_lshrrev_b32_e64 v48, 5, v19
    v_and_or_b32 v55, v48, 8, v55
    v_lshrrev_b32_e64 v48, 4, v19
    v_and_or_b32 v55, v48, 4, v55
    v_mov_b32 v48, 0x3f80
    v_cndmask_b32 v48, v48, 1.0, s[76:77]
    v_cndmask_b32 v64, 0, v48, s[60:61]
    v_cndmask_b32 v65, 0, v48, s[62:63]
    v_cndmask_b32 v66, 0, v48, s[64:65]
    v_cndmask_b32 v67, 0, v48, s[66:67]
    s_lshl_b32 s26, s22, 16
    s_sub_u32 s24, 0x10000, s26
    s_nop 7
    buffer_load_dwordx4 v[0:3], v19, s[8:11], s29 offen offset:0 sc1
    buffer_load_dwordx4 v[4:7], v19, s[8:11], s29 offen offset:1024 sc1
R_pi_303:
    s_waitcnt vmcnt(3)
    v_mfma_f32_16x16x32_bf16 v[68:71], v[56:59], v[64:67], 0
    v_bitop3_b32 v48, v56, v57, s21 bitop3:0x7e
    v_bitop3_b32 v49, v58, v59, s21 bitop3:0x7e
    s_waitcnt vmcnt(2)
    v_mfma_f32_16x16x32_bf16 v[68:71], v[60:63], v[64:67], v[68:71]
    v_bitop3_b32 v50, v60, v61, s21 bitop3:0x7e
    v_bitop3_b32 v51, v62, v63, s21 bitop3:0x7e
    v_or3_b32 v48, v48, v50, v51
    v_bitop3_b32 v48, v48, v49, 1 bitop3:0xa8
    v_cmp_ne_u32_e64 vcc, 0, v48
    s_cbranch_vccnz R_pir_305
R_piok_304:
    s_nop 1
    v_permlane32_swap_b32 v68, v70
    v_permlane32_swap_b32 v69, v71
    v_pk_add_f32 v[68:69], v[68:69], v[70:71]
    s_nop 1
    v_permlane16_swap_b32 v68, v69
    v_add_f32 v68, v68, v69
    v_add_u32 v70, s24, v68
    v_bfi_b32 v70, v54, v70, s26
    v_mov_b32_dpp v69, v68 row_shl:2 row_mask:0xf bank_mask:0xf
    s_mov_b64 exec, s[48:49]
    v_cvt_pk_bf16_f32 v70, v70, v69
    buffer_store_dword v70, v55, s[8:11], s30 offen sc1
    buffer_store_dword v70, v55, s[8:11], s31 offen sc1
    s_mov_b64 exec, -1
    s_xor_b32 s31, s31, 0x4000
    s_xor_b32 s30, s30, 0x4000
    s_branch R_join_302
R_nored_301:
    v_mov_b32 v24, 0
    v_mov_b32 v25, 0
    v_mov_b32 v26, 0
    v_mov_b32 v27, 0
    v_mov_b32 v28, 0
    v_mov_b32 v29, 0
    v_mov_b32 v30, 0
    v_mov_b32 v31, 0
    v_mov_b32 v32, 0
    v_mov_b32 v33, 0
    v_mov_b32 v34, 0
    v_mov_b32 v35, 0
    v_mov_b32 v36, 0
    v_mov_b32 v37, 0
    v_mov_b32 v38, 0
    v_mov_b32 v39, 0
    v_mov_b32 v40, 0
    v_mov_b32 v41, 0
    v_mov_b32 v42, 0
    v_mov_b32 v43, 0
    v_mov_b32 v44, 0
    v_mov_b32 v45, 0
    v_mov_b32 v46, 0
    v_mov_b32_e64 v47, 0
    ds_read_b128 v[76:79], v21 offset:0
    ds_read_b128 v[80:83], v21 offset:1024
    ds_read_b128 v[84:87], v21 offset:2048
    ds_read_b128 v[88:91], v21 offset:3072
    v_lshrrev_b32 v53, 2, v20
    v_add_u32 v53, 4, v53
    s_add_u32 s20, s20, 1
R_join_302:
    s_barrier
    s_nop 15
    s_nop 15
    s_nop 15
    s_nop 11
    s_branch R_top_289
R_par_295:
    buffer_load_dwordx4 v[0:3], v20, s[8:11], s32 offen sc1
    buffer_load_dword v4, v53, s[8:11], s32 offen offset:4092 sc1
    s_waitcnt vmcnt(2)
    ds_write_b128 v20, v[48:51]
    ds_write_b32 v53, v52 offset:4092
    v_bitop3_b32 v56, v48, v49, s22 bitop3:0x7e
    v_bitop3_b32 v57, v50, v51, s22 bitop3:0x7e
    v_bitop3_b32 v56, v52, v56, s22 bitop3:0xde
    v_bitop3_b32 v56, v56, v57, 1 bitop3:0xa8
    v_cmp_ne_u32 vcc, 0, v56
    s_cbranch_vccz R_paok_294
    buffer_load_dwordx4 v[48:51], v20, s[8:11], s32 offen sc1
    buffer_load_dword v52, v53, s[8:11], s32 offen offset:4092 sc1
    s_add_u32 s6, s6, 1
    s_cmp_lt_u32 s6, 400000
    s_cbranch_scc1 R_pa_293
    s_branch R_paok_294
R_pcr_298:
    s_waitcnt vmcnt(1)
    ds_write_b128 v20, v[8:11] offset:5120
    ds_write_b32 v53, v12 offset:9212
    v_bitop3_b32 v54, v8, v9, s22 bitop3:0x7e
    v_bitop3_b32 v55, v10, v11, s22 bitop3:0x7e
    v_bitop3_b32 v54, v12, v54, s22 bitop3:0xde
    v_bitop3_b32 v54, v54, v55, s52 bitop3:0xa8
    v_cmp_ne_u32_e64 vcc, 0, v54
    s_cbranch_vccz R_pcok_297
R_pcr2_307:
    s_add_u32 s6, s6, 1
    s_cmp_lt_u32 s6, 400000
    s_cbranch_scc1 R_pc2_299
    s_branch R_pcok_297
R_pc2_299:
    s_waitcnt lgkmcnt(0)
    buffer_load_dwordx4 v[48:51], v20, s[8:11], s33 offen sc1
    buffer_load_dword v52, v53, s[8:11], s33 offen offset:4092 sc1
    s_waitcnt vmcnt(0)
    ds_write_b128 v20, v[48:51] offset:5120
    ds_write_b32 v53, v52 offset:9212
    v_bitop3_b32 v54, v48, v49, s22 bitop3:0x7e
    v_bitop3_b32 v55, v50, v51, s22 bitop3:0x7e
    v_bitop3_b32 v54, v52, v54, s22 bitop3:0xde
    v_bitop3_b32 v54, v54, v55, s52 bitop3:0xa8
    v_cmp_ne_u32_e64 vcc, 0, v54
    s_cbranch_vccnz R_pcr2_307
    s_branch R_pcok_297
R_pir_305:
    buffer_load_dwordx4 v[56:59], v19, s[8:11], s29 offen offset:0 sc1
    buffer_load_dwordx4 v[60:63], v19, s[8:11], s29 offen offset:1024 sc1
    s_waitcnt vmcnt(3)
    v_mfma_f32_16x16x32_bf16 v[68:71], v[0:3], v[64:67], 0
    v_bitop3_b32 v48, v0, v1, s21 bitop3:0x7e
    v_bitop3_b32 v49, v2, v3, s21 bitop3:0x7e
    s_waitcnt vmcnt(2)
    v_mfma_f32_16x16x32_bf16 v[68:71], v[4:7], v[64:67], v[68:71]
    v_bitop3_b32 v50, v4, v5, s21 bitop3:0x7e
    v_bitop3_b32 v51, v6, v7, s21 bitop3:0x7e
    v_or3_b32 v48, v48, v50, v51
    v_bitop3_b32 v48, v48, v49, 1 bitop3:0xa8
    v_cmp_ne_u32 vcc, 0, v48
    s_cbranch_vccz R_piok_304
    buffer_load_dwordx4 v[0:3], v19, s[8:11], s29 offen offset:0 sc1
    buffer_load_dwordx4 v[4:7], v19, s[8:11], s29 offen offset:1024 sc1
    s_add_u32 s6, s6, 1
    s_cmp_lt_u32 s6, 400000
    s_cbranch_scc1 R_pi_303
    s_branch R_piok_304
R_exit_291:
    s_waitcnt lgkmcnt(0)
    v_smfmac_f32_16x16x64_bf16 v[44:47], v[64:67], v[152:159], v18
    v_smfmac_f32_16x16x64_bf16 v[40:43], v[68:71], v[160:167], v18
    v_smfmac_f32_16x16x64_bf16 v[44:47], v[68:71], v[168:175], v18
    v_smfmac_f32_16x16x64_bf16 v[40:43], v[72:75], v[76:83], v18
    v_smfmac_f32_16x16x64_bf16 v[44:47], v[72:75], v[84:91], v18
    s_nop 3
    v_cvt_pk_bf16_f32 v92, v40, v41
    v_cvt_pk_bf16_f32 v93, v42, v43
    s_nop 1
    v_cvt_pk_bf16_f32 v94, v44, v45
    v_cvt_pk_bf16_f32 v95, v46, v47
    buffer_store_dwordx4 v[92:95], v19, s[8:11], s35 offen sc1
    s_branch R_end_87
R_v01w3_99:
    s_branch R_ent_309
.p2align 6
R_top_308:
    buffer_load_dwordx4 v[0:3], v20, s[8:11], s32 offen sc1
    buffer_load_dword v4, v53, s[8:11], s32 offen offset:4092 sc1
    s_nop 15
    s_nop 8
    buffer_load_dwordx4 v[48:51], v20, s[8:11], s32 offen sc1
    buffer_load_dword v52, v53, s[8:11], s32 offen offset:4092 sc1
R_pa_312:
    s_waitcnt vmcnt(2)
    ds_write_b128 v20, v[0:3]
    ds_write_b32 v53, v4 offset:4092
    v_bitop3_b32 v56, v0, v1, s22 bitop3:0x7e
    v_bitop3_b32 v57, v2, v3, s22 bitop3:0x7e
    v_bitop3_b32 v56, v4, v56, s22 bitop3:0xde
    v_bitop3_b32 v56, v56, v57, 1 bitop3:0xa8
    v_cmp_ne_u32 vcc, 0, v56
    s_cbranch_vccnz R_par_314
R_paok_313:
    buffer_load_dwordx4 v[48:51], v20, s[8:11], s33 offen sc1
    buffer_load_dword v52, v53, s[8:11], s33 offen offset:4092 sc1
    s_waitcnt lgkmcnt(0)
    s_barrier
R_ent_309:
    ds_read_b128 v[56:59], v19 offset:0
    ds_read_b128 v[60:63], v19 offset:1024
    ds_read_b128 v[64:67], v19 offset:2048
    ds_read_b128 v[68:71], v19 offset:3072
    ds_read_b128 v[72:75], v19 offset:4096
    s_waitcnt lgkmcnt(4)
    v_smfmac_f32_16x16x64_bf16 v[24:27], v[56:59], v[76:83], v18
    ds_read_b128 v[76:79], v21 offset:16384
    s_xor_b32 s21, s21, 1
    buffer_load_dwordx4 v[0:3], v19, s[8:11], s34 offen offset:0 sc1
    v_smfmac_f32_16x16x64_bf16 v[28:31], v[56:59], v[84:91], v18
    ds_read_b128 v[80:83], v21 offset:17408
    s_min_u32 s40, s20, 1
    buffer_load_dwordx4 v[4:7], v19, s[8:11], s34 offen offset:1024 sc1
    v_smfmac_f32_16x16x64_bf16 v[32:35], v[56:59], a[112:119], v18
    ds_read_b128 v[84:87], v21 offset:18432
    s_lshl_b32 s41, s40, 17
    v_smfmac_f32_16x16x64_bf16 v[36:39], v[56:59], a[120:127], v18
    ds_read_b128 v[88:91], v21 offset:19456
    s_waitcnt lgkmcnt(7)
    v_smfmac_f32_16x16x64_bf16 v[24:27], v[60:63], a[0:7], v18
    buffer_load_dwordx4 v[8:11], v20, s[8:11], s33 offen sc1
    v_smfmac_f32_16x16x64_bf16 v[28:31], v[60:63], a[8:15], v18
    buffer_load_dword v12, v53, s[8:11], s33 offen offset:4092 sc1
    s_waitcnt lgkmcnt(2)
    v_smfmac_f32_16x16x64_bf16 v[32:35], v[60:63], v[76:83], v18
    ds_read_b128 v[76:79], v21 offset:32768
    s_waitcnt lgkmcnt(1)
    v_smfmac_f32_16x16x64_bf16 v[36:39], v[60:63], v[84:91], v18
    ds_read_b128 v[80:83], v21 offset:33792
    v_smfmac_f32_16x16x64_bf16 v[24:27], v[64:67], a[16:23], v18
    ds_read_b128 v[84:87], v21 offset:34816
    v_smfmac_f32_16x16x64_bf16 v[28:31], v[64:67], a[24:31], v18
    ds_read_b128 v[88:91], v21 offset:35840
    v_smfmac_f32_16x16x64_bf16 v[32:35], v[64:67], a[128:135], v18
    v_smfmac_f32_16x16x64_bf16 v[36:39], v[64:67], a[136:143], v18
    s_waitcnt lgkmcnt(2)
    v_smfmac_f32_16x16x64_bf16 v[24:27], v[68:71], v[76:83], v18
    ds_read_b128 v[76:79], v21 offset:49152
    s_waitcnt lgkmcnt(1)
    v_smfmac_f32_16x16x64_bf16 v[28:31], v[68:71], v[84:91], v18
    ds_read_b128 v[80:83], v21 offset:50176
    v_smfmac_f32_16x16x64_bf16 v[32:35], v[68:71], a[144:151], v18
    ds_read_b128 v[84:87], v21 offset:51200
    v_smfmac_f32_16x16x64_bf16 v[36:39], v[68:71], a[152:159], v18
    ds_read_b128 v[88:91], v21 offset:52224
    v_smfmac_f32_16x16x64_bf16 v[24:27], v[72:75], a[32:39], v18
    v_add_u32 v21, 0x10000, v21
    buffer_store_dwordx4 v[92:95], v19, s[8:11], s35 offen sc1
    v_smfmac_f32_16x16x64_bf16 v[28:31], v[72:75], a[40:47], v18
    s_add_u32 s35, s35, s41
    s_add_u32 s51, s34, 0x1000000
    s_waitcnt lgkmcnt(2)
    v_smfmac_f32_16x16x64_bf16 v[32:35], v[72:75], v[76:83], v18
    ds_read_b128 v[76:79], v21 offset:0
    s_add_u32 s34, s34, 0x40000
    s_waitcnt lgkmcnt(1)
    v_smfmac_f32_16x16x64_bf16 v[36:39], v[72:75], v[84:91], v18
    ds_read_b128 v[80:83], v21 offset:1024
    v_smfmac_f32_16x16x64_bf16 v[40:43], v[56:59], a[208:215], v18
    ds_read_b128 v[84:87], v21 offset:2048
    v_smfmac_f32_16x16x64_bf16 v[44:47], v[56:59], a[216:223], v18
    ds_read_b128 v[88:91], v21 offset:3072
    s_waitcnt vmcnt(3)
    ds_write_b128 v20, v[48:51] offset:5120
    ds_write_b32 v53, v52 offset:9212
    v_smfmac_f32_16x16x64_bf16 v[40:43], v[60:63], a[224:231], v18
    v_bitop3_b32 v54, v48, v49, s22 bitop3:0x7e
    v_bitop3_b32 v55, v50, v51, s22 bitop3:0x7e
    v_smfmac_f32_16x16x64_bf16 v[44:47], v[60:63], a[232:239], v18
    v_bitop3_b32 v54, v52, v54, s22 bitop3:0xde
    v_bitop3_b32 v54, v54, v55, s52 bitop3:0xa8
    s_waitcnt lgkmcnt(4)
    v_smfmac_f32_16x16x64_bf16 v[40:43], v[64:67], v[76:83], v18
    v_cmp_ne_u32 vcc, 0, v54
    s_waitcnt lgkmcnt(2)
    v_smfmac_f32_16x16x64_bf16 v[44:47], v[64:67], v[84:91], v18
    s_cbranch_vccnz R_pcr_317
R_pcok_316:
    v_lshlrev_b32_e64 v55, 3, v19
    s_add_u32 s42, s36, 0x1000000
    s_waitcnt lgkmcnt(0)
    s_barrier
    ds_read_b128 v[56:59], v19 offset:5120
    ds_read_b128 v[60:63], v19 offset:6144
    v_smfmac_f32_16x16x64_bf16 v[40:43], v[68:71], a[240:247], v18
    ds_read_b128 v[64:67], v19 offset:7168
    v_smfmac_f32_16x16x64_bf16 v[44:47], v[68:71], a[248:255], v18
    ds_read_b128 v[68:71], v19 offset:8192
    v_smfmac_f32_16x16x64_bf16 v[40:43], v[72:75], v[96:103], v18
    v_smfmac_f32_16x16x64_bf16 v[44:47], v[72:75], v[104:111], v18
    ds_read_b128 v[72:75], v19 offset:9216
    s_waitcnt lgkmcnt(4)
    v_smfmac_f32_16x16x64_bf16 v[24:27], v[56:59], a[48:55], v18
    ds_read_b128 v[76:79], v21 offset:16384
    s_andn2_b32 s40, 1, s20
    v_smfmac_f32_16x16x64_bf16 v[28:31], v[56:59], a[56:63], v18
    ds_read_b128 v[80:83], v21 offset:17408
    s_xor_b32 s22, s22, s40
    s_waitcnt lgkmcnt(5)
    v_smfmac_f32_16x16x64_bf16 v[24:27], v[60:63], a[64:71], v18
    ds_read_b128 v[84:87], v21 offset:18432
    s_mov_b32 s52, 1
    v_smfmac_f32_16x16x64_bf16 v[28:31], v[60:63], a[72:79], v18
    ds_read_b128 v[88:91], v21 offset:19456
    s_min_u32 s40, s20, 1
    s_waitcnt lgkmcnt(6)
    v_smfmac_f32_16x16x64_bf16 v[24:27], v[64:67], a[80:87], v18
    buffer_load_dwordx4 v[8:11], v19, s[8:11], s51 offen offset:0 sc1
    s_cmp_gt_u32 s20, 58
    v_smfmac_f32_16x16x64_bf16 v[28:31], v[64:67], a[88:95], v18
    buffer_load_dwordx4 v[12:15], v19, s[8:11], s51 offen offset:1024 sc1
    s_mov_b32 s33, s56
    s_cselect_b32 s40, 0, s40
    s_waitcnt lgkmcnt(2)
    v_smfmac_f32_16x16x64_bf16 v[24:27], v[68:71], v[76:83], v18
    ds_read_b128 v[76:79], v21 offset:32768
    s_xor_b32 s56, s56, 0x4000
    s_sub_u32 s40, s20, s40
    s_waitcnt lgkmcnt(1)
    v_smfmac_f32_16x16x64_bf16 v[28:31], v[68:71], v[84:91], v18
    ds_read_b128 v[80:83], v21 offset:33792
    s_xor_b32 s32, s32, 0x4000
    v_mov_b32 v49, s40
    v_smfmac_f32_16x16x64_bf16 v[24:27], v[72:75], a[96:103], v18
    ds_read_b128 v[84:87], v21 offset:34816
    v_mov_b32 v54, 0
    v_smfmac_f32_16x16x64_bf16 v[28:31], v[72:75], a[104:111], v18
    ds_read_b128 v[88:91], v21 offset:35840
    buffer_store_dword v49, v54, s[8:11], s38 offen sc1
    v_smfmac_f32_16x16x64_bf16 v[32:35], v[56:59], a[160:167], v18
    buffer_load_dword v55, s[8:11], s36 offen sc1 lds
    v_smfmac_f32_16x16x64_bf16 v[36:39], v[56:59], a[168:175], v18
    buffer_load_dword v55, s[8:11], s42 offen sc1 lds
    s_waitcnt lgkmcnt(2)
    v_smfmac_f32_16x16x64_bf16 v[32:35], v[60:63], v[76:83], v18
    ds_read_b128 v[76:79], v21 offset:49152
    s_waitcnt lgkmcnt(1)
    v_smfmac_f32_16x16x64_bf16 v[36:39], v[60:63], v[84:91], v18
    ds_read_b128 v[80:83], v21 offset:50176
    v_cvt_pk_bf16_f32 v48, v24, v25
    v_smfmac_f32_16x16x64_bf16 v[32:35], v[64:67], a[176:183], v18
    ds_read_b128 v[84:87], v21 offset:51200
    v_cvt_pk_bf16_f32 v49, v26, v27
    v_smfmac_f32_16x16x64_bf16 v[36:39], v[64:67], a[184:191], v18
    ds_read_b128 v[88:91], v21 offset:52224
    v_cvt_pk_bf16_f32 v50, v28, v29
    v_smfmac_f32_16x16x64_bf16 v[32:35], v[68:71], a[192:199], v18
    v_cvt_pk_bf16_f32 v51, v30, v31
    v_smfmac_f32_16x16x64_bf16 v[36:39], v[68:71], a[200:207], v18
    v_add_u32 v21, 0x10000, v21
    s_waitcnt lgkmcnt(2)
    v_smfmac_f32_16x16x64_bf16 v[32:35], v[72:75], v[76:83], v18
    ds_read_b128 v[76:79], v21 offset:0
    s_waitcnt lgkmcnt(1)
    v_smfmac_f32_16x16x64_bf16 v[36:39], v[72:75], v[84:91], v18
    ds_read_b128 v[80:83], v21 offset:1024
    v_mfma_f32_16x16x16_bf16 v[24:27], v[48:49], v[16:17], 0
    ds_read_b128 v[84:87], v21 offset:2048
    v_mfma_f32_16x16x16_bf16 v[28:31], v[50:51], v[16:17], 0
    ds_read_b128 v[88:91], v21 offset:3072
    v_cvt_pk_bf16_f32 v52, v32, v33
    v_cvt_pk_bf16_f32 v53, v34, v35
    v_cvt_pk_bf16_f32 v54, v36, v37
    v_cvt_pk_bf16_f32 v55, v38, v39
    v_mfma_f32_16x16x16_bf16 v[32:35], v[52:53], v[16:17], 0
    v_cvt_pk_bf16_f32 v48, v24, v25
    v_mfma_f32_16x16x16_bf16 v[36:39], v[54:55], v[16:17], 0
    v_cvt_pk_bf16_f32 v49, v26, v27
    v_cvt_pk_bf16_f32 v50, v28, v29
    v_cvt_pk_bf16_f32 v51, v30, v31
    s_nop 1
    v_mfma_f32_16x16x32_bf16 v[24:27], v[0:3], v[48:51], 0
    v_mfma_f32_16x16x32_bf16 v[28:31], v[4:7], v[48:51], 0
    v_cvt_pk_bf16_f32 v52, v32, v33
    v_cvt_pk_bf16_f32 v53, v34, v35
    v_cvt_pk_bf16_f32 v54, v36, v37
    v_cvt_pk_bf16_f32 v55, v38, v39
    s_nop 1
    v_mfma_f32_16x16x32_bf16 v[32:35], v[52:55], v[48:51], 0
    s_nop 2
    v_cndmask_b32 v24, v24, v28, s[44:45]
    v_cndmask_b32 v25, v25, v29, s[44:45]
    v_cndmask_b32 v26, v26, v30, s[44:45]
    v_cndmask_b32 v27, v27, v31, s[44:45]
    ds_write_b128 v20, v[24:27] offset:10240
    v_cndmask_b32 v32, v32, v34, s[44:45]
    v_cndmask_b32 v33, v33, v35, s[44:45]
    ds_write_b64 v20, v[32:33] offset:0
    v_smfmac_f32_16x16x64_bf16 v[40:43], v[56:59], v[112:119], v18
    v_xor_b32 v52, 0x400, v20
    v_smfmac_f32_16x16x64_bf16 v[44:47], v[56:59], v[120:127], v18
    v_xor_b32 v54, 0x800, v20
    v_smfmac_f32_16x16x64_bf16 v[40:43], v[60:63], v[128:135], v18
    v_xor_b32 v34, 0xc00, v20
    v_smfmac_f32_16x16x64_bf16 v[44:47], v[60:63], v[136:143], v18
    v_smfmac_f32_16x16x64_bf16 v[40:43], v[64:67], v[144:151], v18
    s_cmp_eq_u32 s20, 63
    s_cbranch_scc1 R_exit_310
    s_waitcnt lgkmcnt(0)
    s_barrier
    ds_read_b128 v[28:31], v52 offset:10240
    ds_read_b64 v[52:53], v52 offset:0
    v_smfmac_f32_16x16x64_bf16 v[44:47], v[64:67], v[152:159], v18
    ds_read_b128 v[36:39], v54 offset:10240
    v_smfmac_f32_16x16x64_bf16 v[40:43], v[68:71], v[160:167], v18
    ds_read_b64 v[54:55], v54 offset:0
    v_smfmac_f32_16x16x64_bf16 v[44:47], v[68:71], v[168:175], v18
    ds_read_b128 v[48:51], v34 offset:10240
    v_smfmac_f32_16x16x64_bf16 v[40:43], v[72:75], v[76:83], v18
    ds_read_b64 v[34:35], v34 offset:0
    v_smfmac_f32_16x16x64_bf16 v[44:47], v[72:75], v[84:91], v18
    s_waitcnt lgkmcnt(5)
    v_pk_add_f32 v[24:25], v[24:25], v[28:29]
    v_pk_add_f32 v[26:27], v[26:27], v[30:31]
    s_waitcnt lgkmcnt(4)
    v_pk_add_f32 v[32:33], v[32:33], v[52:53]
    s_waitcnt lgkmcnt(1)
    v_pk_add_f32 v[36:37], v[36:37], v[48:49]
    v_pk_add_f32 v[38:39], v[38:39], v[50:51]
    s_waitcnt lgkmcnt(0)
    v_pk_add_f32 v[54:55], v[54:55], v[34:35]
    v_pk_add_f32 v[24:25], v[24:25], v[36:37]
    v_pk_add_f32 v[26:27], v[26:27], v[38:39]
    v_pk_add_f32 v[32:33], v[32:33], v[54:55]
    v_max3_f32 v34, v24, v25, v26
    v_max3_f32 v34, v34, v27, v32
    v_max_f32_e64 v34, v34, v33
    v_cvt_pk_bf16_f32 v92, v40, v41
    v_cvt_pk_bf16_f32 v93, v42, v43
    v_max_f32_dpp v34, v34, v34 row_ror:8 row_mask:0xf bank_mask:0xf
    v_mov_b32_e64 v35, v34
    v_cvt_pk_bf16_f32 v94, v44, v45
    v_cvt_pk_bf16_f32 v95, v46, v47
    v_permlane16_swap_b32 v34, v35
    v_max_f32 v34, v34, v35
    v_mov_b32 v35, v34
    v_mov_b32 v56, 0
    v_mov_b32 v57, 0
    v_permlane32_swap_b32 v34, v35
    v_max_f32 v34, v34, v35
    v_mul_f32 v34, s50, v34
    v_pk_fma_f32 v[24:25], v[24:25], s[54:55], v[34:35] op_sel_hi:[1,1,0] neg_lo:[0,0,1] neg_hi:[0,0,1]
    v_pk_fma_f32 v[26:27], v[26:27], s[54:55], v[34:35] op_sel_hi:[1,1,0] neg_lo:[0,0,1] neg_hi:[0,0,1]
    v_pk_fma_f32 v[32:33], v[32:33], s[54:55], v[34:35] op_sel_hi:[1,1,0] neg_lo:[0,0,1] neg_hi:[0,0,1]
    v_exp_f32 v24, v24
    v_exp_f32 v25, v25
    v_exp_f32 v26, v26
    v_exp_f32 v27, v27
    v_exp_f32 v32, v32
    v_exp_f32 v33, v33
    v_cvt_pk_bf16_f32 v48, v24, v25
    v_cvt_pk_bf16_f32 v49, v26, v27
    v_cvt_pk_bf16_f32 v52, v32, v33
    v_mov_b32_dpp v50, v48 row_ror:8 row_mask:0xf bank_mask:0xf
    v_mov_b32_dpp v51, v49 row_ror:8 row_mask:0xf bank_mask:0xf
    v_mov_b32_dpp v53, v52 row_ror:8 row_mask:0xf bank_mask:0xf
    v_pk_add_f32 v[24:25], v[24:25], v[26:27]
    s_waitcnt vmcnt(3)
    v_mfma_f32_16x16x32_bf16 v[28:31], v[8:11], v[48:51], 0
    v_add_f32 v32, v32, v33
    v_add_f32_e64 v24, v24, v25
    v_mfma_f32_16x16x32_bf16 v[36:39], v[12:15], v[48:51], 0
    v_fma_f32 v34, v32, 0.5, v24
    v_mfma_f32_16x16x16_bf16 v[28:31], v[92:93], v[52:53], v[28:31]
    v_mov_b32_e64 v58, 0
    v_add_f32_dpp v34, v34, v34 row_ror:8 row_mask:0xf bank_mask:0xf
    v_mfma_f32_16x16x16_bf16 v[36:39], v[94:95], v[52:53], v[36:39]
    v_mov_b32 v35, v34
    v_mov_b32 v59, 0
    v_mov_b32 v60, 0
    v_permlane16_swap_b32 v34, v35
    v_add_f32 v34, v34, v35
    v_mov_b32 v35, v34
    v_mov_b32 v61, 0
    v_mov_b32 v62, 0
    v_permlane32_swap_b32 v34, v35
    v_add_f32 v34, v34, v35
    v_rcp_f32 v34, v34
    s_mov_b64 exec, s[46:47]
    v_pk_mul_f32 v[28:29], v[28:29], v[34:35] op_sel_hi:[1,0]
    v_pk_mul_f32 v[30:31], v[30:31], v[34:35] op_sel_hi:[1,0]
    v_pk_mul_f32 v[36:37], v[36:37], v[34:35] op_sel_hi:[1,0]
    v_pk_mul_f32 v[38:39], v[38:39], v[34:35] op_sel_hi:[1,0]
    v_cvt_pk_bf16_f32 v24, v28, v29
    v_cvt_pk_bf16_f32 v25, v30, v31
    v_cvt_pk_bf16_f32 v26, v36, v37
    v_cvt_pk_bf16_f32 v27, v38, v39
    ds_write_b128 v22, v[24:27]
    s_mov_b64 exec, -1
    v_mov_b32 v63, 0
    v_mov_b32 v64, 0
    v_mov_b32 v65, 0
    v_mov_b32 v66, 0
    v_mov_b32 v67, 0
    v_mov_b32 v68, 0
    v_mov_b32 v69, 0
    v_mov_b32 v70, 0
    v_mov_b32 v71, 0
    v_mov_b32 v72, 0
    v_mov_b32 v73, 0
    v_mov_b32 v74, 0
    v_mov_b32 v75, 0
    s_waitcnt lgkmcnt(0)
    s_barrier
    ds_read_b128 v[48:51], v19 offset:5120
    ds_read_b128 v[52:55], v19 offset:6144
    v_subrev_u32 v21, 0x20000, v21
    v_lshrrev_b32_e64 v24, 8, v19
    v_bfe_u32 v25, v19, 2, 6
    v_lshl_add_u32 v24, v24, 13, v25
    s_waitcnt lgkmcnt(1)
    v_smfmac_f32_16x16x64_bf16 v[56:59], v[48:51], v[176:183], v18 abid:1
    s_waitcnt lgkmcnt(0)
    v_smfmac_f32_16x16x64_bf16 v[56:59], v[52:55], v[216:223], v18 abid:1
    v_smfmac_f32_16x16x64_bf16 v[60:63], v[48:51], v[184:191], v18 abid:1
    v_smfmac_f32_16x16x64_bf16 v[60:63], v[52:55], v[224:231], v18 abid:1
    v_add_f32_e64 v56, v56, v58
    v_smfmac_f32_16x16x64_bf16 v[64:67], v[48:51], v[192:199], v18 abid:1
    v_add_f32_e64 v57, v57, v59
    v_smfmac_f32_16x16x64_bf16 v[64:67], v[52:55], v[232:239], v18 abid:1
    v_cvt_pk_bf16_f32 v28, v56, v57
    v_add_f32_e64 v60, v60, v62
    v_smfmac_f32_16x16x64_bf16 v[68:71], v[48:51], v[200:207], v18 abid:1
    v_add_f32_e64 v61, v61, v63
    v_bfi_b32 v28, 1, s21, v28
    v_smfmac_f32_16x16x64_bf16 v[68:71], v[52:55], v[240:247], v18 abid:1
    v_cvt_pk_bf16_f32 v29, v60, v61
    v_add_f32_e64 v64, v64, v66
    v_smfmac_f32_16x16x64_bf16 v[72:75], v[48:51], v[208:215], v18 abid:1
    v_add_f32_e64 v65, v65, v67
    v_smfmac_f32_16x16x64_bf16 v[72:75], v[52:55], v[248:255], v18 abid:1
    v_add_f32_e64 v68, v68, v70
    v_add_f32 v69, v69, v71
    v_cvt_pk_bf16_f32 v30, v64, v65
    v_cvt_pk_bf16_f32 v31, v68, v69
    buffer_store_dwordx4 v[28:31], v23, s[8:11], s27 offen sc1
    s_nop 2
    v_pk_add_f32 v[72:73], v[72:73], v[74:75]
    v_cvt_pk_bf16_f32 v72, v72, v73
    v_bfi_b32 v72, 1, s21, v72
    buffer_store_dword v72, v24, s[8:11], s28 offen sc1
    s_cmp_lt_u32 s20, 58
    s_cbranch_scc1 R_noearly_319
    buffer_store_dwordx4 v[92:95], v19, s[8:11], s35 offen sc1
R_noearly_319:
R_nored_320:
    s_add_u32 s40, s20, 3
    s_min_u32 s40, s40, 63
fp_322:
    s_cmp_lt_u32 s40, s79
    s_cbranch_scc1 fpok_323
    v_mov_b32_e64 v52, 0
    buffer_load_dwordx4 v[48:51], v52, s[8:11], s37 offen sc1
    s_waitcnt vmcnt(0)
    v_min_u32 v48, v48, v50
    v_min3_u32 v48, v48, v49, v51
    v_lshlrev_b32 v48, 1, v48
    s_nop 0
    v_readfirstlane_b32 s79, v48
    s_add_u32 s6, s6, 1
    s_cmp_lt_u32 s6, 400000
    s_cbranch_scc1 fp_322
    s_branch fpok_323
fpok_323:
    s_add_u32 s36, s36, 0x40000
    v_mov_b32 v24, 0
    v_mov_b32 v25, 0
    v_mov_b32 v26, 0
    v_mov_b32 v27, 0
    v_mov_b32 v28, 0
    v_mov_b32 v29, 0
    v_mov_b32 v30, 0
    v_mov_b32 v31, 0
    v_mov_b32 v32, 0
    v_mov_b32 v33, 0
    v_mov_b32 v34, 0
    v_mov_b32 v35, 0
    v_mov_b32 v36, 0
    v_mov_b32 v37, 0
    v_mov_b32 v38, 0
    v_mov_b32 v39, 0
    v_mov_b32 v40, 0
    v_mov_b32 v41, 0
    v_mov_b32 v42, 0
    v_mov_b32 v43, 0
    v_mov_b32 v44, 0
    v_mov_b32 v45, 0
    v_mov_b32 v46, 0
    v_mov_b32 v47, 0
    ds_read_b128 v[76:79], v21 offset:0
    ds_read_b128 v[80:83], v21 offset:1024
    ds_read_b128 v[84:87], v21 offset:2048
    ds_read_b128 v[88:91], v21 offset:3072
    v_lshrrev_b32 v53, 2, v20
    v_add_u32 v53, 4, v53
    s_add_u32 s20, s20, 1
R_join_321:
    s_barrier
    s_nop 15
    s_nop 15
    s_nop 15
    s_nop 11
    s_branch R_top_308
R_par_314:
    buffer_load_dwordx4 v[0:3], v20, s[8:11], s32 offen sc1
    buffer_load_dword v4, v53, s[8:11], s32 offen offset:4092 sc1
    s_waitcnt vmcnt(2)
    ds_write_b128 v20, v[48:51]
    ds_write_b32 v53, v52 offset:4092
    v_bitop3_b32 v56, v48, v49, s22 bitop3:0x7e
    v_bitop3_b32 v57, v50, v51, s22 bitop3:0x7e
    v_bitop3_b32 v56, v52, v56, s22 bitop3:0xde
    v_bitop3_b32 v56, v56, v57, 1 bitop3:0xa8
    v_cmp_ne_u32 vcc, 0, v56
    s_cbranch_vccz R_paok_313
    buffer_load_dwordx4 v[48:51], v20, s[8:11], s32 offen sc1
    buffer_load_dword v52, v53, s[8:11], s32 offen offset:4092 sc1
    s_add_u32 s6, s6, 1
    s_cmp_lt_u32 s6, 400000
    s_cbranch_scc1 R_pa_312
    s_branch R_paok_313
R_pcr_317:
    s_waitcnt vmcnt(1)
    ds_write_b128 v20, v[8:11] offset:5120
    ds_write_b32 v53, v12 offset:9212
    v_bitop3_b32 v54, v8, v9, s22 bitop3:0x7e
    v_bitop3_b32 v55, v10, v11, s22 bitop3:0x7e
    v_bitop3_b32 v54, v12, v54, s22 bitop3:0xde
    v_bitop3_b32 v54, v54, v55, s52 bitop3:0xa8
    v_cmp_ne_u32_e64 vcc, 0, v54
    s_cbranch_vccz R_pcok_316
R_pcr2_324:
    s_add_u32 s6, s6, 1
    s_cmp_lt_u32 s6, 400000
    s_cbranch_scc1 R_pc2_318
    s_branch R_pcok_316
R_pc2_318:
    s_waitcnt lgkmcnt(0)
    buffer_load_dwordx4 v[48:51], v20, s[8:11], s33 offen sc1
    buffer_load_dword v52, v53, s[8:11], s33 offen offset:4092 sc1
    s_waitcnt vmcnt(0)
    ds_write_b128 v20, v[48:51] offset:5120
    ds_write_b32 v53, v52 offset:9212
    v_bitop3_b32 v54, v48, v49, s22 bitop3:0x7e
    v_bitop3_b32 v55, v50, v51, s22 bitop3:0x7e
    v_bitop3_b32 v54, v52, v54, s22 bitop3:0xde
    v_bitop3_b32 v54, v54, v55, s52 bitop3:0xa8
    v_cmp_ne_u32 vcc, 0, v54
    s_cbranch_vccnz R_pcr2_324
    s_branch R_pcok_316
R_exit_310:
    s_waitcnt lgkmcnt(0)
    v_smfmac_f32_16x16x64_bf16 v[44:47], v[64:67], v[152:159], v18
    v_smfmac_f32_16x16x64_bf16 v[40:43], v[68:71], v[160:167], v18
    v_smfmac_f32_16x16x64_bf16 v[44:47], v[68:71], v[168:175], v18
    v_smfmac_f32_16x16x64_bf16 v[40:43], v[72:75], v[76:83], v18
    v_smfmac_f32_16x16x64_bf16 v[44:47], v[72:75], v[84:91], v18
    s_nop 3
    v_cvt_pk_bf16_f32 v92, v40, v41
    v_cvt_pk_bf16_f32 v93, v42, v43
    s_nop 1
    v_cvt_pk_bf16_f32 v94, v44, v45
    v_cvt_pk_bf16_f32 v95, v46, v47
    buffer_store_dwordx4 v[92:95], v19, s[8:11], s35 offen sc1
    s_branch R_end_87
R_end_87:
    s_waitcnt vmcnt(0) lgkmcnt(0)
    s_barrier
    s_cmp_lg_u32 s5, 3
    s_cbranch_scc1 R_fin_325
    v_mov_b32 v0, 64
    v_mov_b32 v1, 0
    s_mov_b64 exec, 1
    buffer_store_dword v0, v1, s[8:11], s38 offen sc1
    s_mov_b64 exec, -1
R_fin_325:
L_fin:
    s_cmp_lt_u32 s6, 400000
    s_cbranch_scc1 L_done
    v_mov_b32 v0, 1
    v_mov_b32 v1, 0
    buffer_atomic_add v0, v1, s[12:15], 0 offen offset:44
L_done:
    s_endpgm
.section .rodata,"a"
.p2align 6
.amdhsa_kernel sequential_preLN__memory_aug_recurrent_mem_tr__mixer_s_mlp__prompt_kernel
  .amdhsa_next_free_vgpr 512
  .amdhsa_next_free_sgpr 102
  .amdhsa_accum_offset 256
  .amdhsa_group_segment_fixed_size 0
  .amdhsa_kernarg_size 120
  .amdhsa_user_sgpr_count 2
  .amdhsa_user_sgpr_kernarg_segment_ptr 1
  .amdhsa_system_sgpr_workgroup_id_x 1
  .amdhsa_float_denorm_mode_32 3
.end_amdhsa_kernel
```
